```python
import torch

def _softmax(x, axis=-1):
    return torch.softmax(x, dim=axis)

def _gelu(x):
    return torch.nn.functional.gelu(x, approximate='tanh')

def _silu(x):
    return torch.nn.functional.silu(x)

def _sigmoid(x):
    return torch.sigmoid(x)

def _layernorm(x, axis=-1, eps=1e-05):
    m = x.mean(dim=axis, keepdim=True)
    v = x.var(dim=axis, keepdim=True, unbiased=False)
    return (x - m) / torch.sqrt(v + eps)

def _scatter_add(tgt, idx, src, axis=0):
    return tgt.clone().index_add_(axis, idx, src)

def _segment_sum(src, seg, n):
    out = torch.zeros((n,) + src.shape[1:], dtype=src.dtype)
    return out.index_add_(0, seg, src)

def _pad(x, pw):
    flat = tuple((v for pair in reversed(pw) for v in pair))
    return torch.nn.functional.pad(x, flat)
kernel_name = 'adaLN_cond__sliding_block__mixer_gmlp__prompt'

def setup_inputs():

    _w = lambda a: (lambda t: t.to(torch.bfloat16) if t.is_floating_point() else t)(torch.as_tensor(a))

    def _A_setup():
        B, S, D = (1, 2048, 640)
        return {'x': _w((lambda *s: torch.randn(*s, dtype=torch.bfloat16) * 0.05)(B, S, D)), 'wqkv': _w((lambda *s: torch.randn(*s, dtype=torch.bfloat16) * 0.05)(D, 3 * D)), 'wo': _w((lambda *s: torch.randn(*s, dtype=torch.bfloat16) * 0.05)(D, D))}
    _A_in = _A_setup()

    def _B_setup():
        B, S, D, F = (1, 2048, 640, 1728)
        Fh = F // 2
        return {'x': _w((lambda *s: torch.randn(*s, dtype=torch.bfloat16) * 0.05)(B, S, D)), 'w_in': _w((lambda *s: torch.randn(*s, dtype=torch.bfloat16) * 0.4)(D, 2 * Fh)), 'w_sp': _w(0.01 * (lambda *s: torch.randn(*s, dtype=torch.bfloat16) * 0.4)(S, S)), 'b_sp': _w(1.0 + 0.01 * (lambda *s: torch.randn(*s, dtype=torch.bfloat16) * 0.05)(S)), 'w_out': _w((lambda *s: torch.randn(*s, dtype=torch.bfloat16) * 0.05)(Fh, D))}
    _B_in = _B_setup()
    return {'A_x': _A_in['x'], 'A_wqkv': _A_in['wqkv'], 'A_wo': _A_in['wo'], 'B_x': _B_in['x'], 'B_w_in': _B_in['w_in'], 'B_w_sp': _B_in['w_sp'], 'B_b_sp': _B_in['b_sp'], 'B_w_out': _B_in['w_out'], 'c': _w((lambda *s: torch.randn(*s, dtype=torch.bfloat16) * 0.1)(1, 640) * 8.0), 'w_mod': _w((lambda *s: torch.randn(*s, dtype=torch.bfloat16) * 0.1)(640, 6 * 640) * 640 ** (-0.5) * 8.0)}

def reference(A_x, A_wqkv, A_wo, B_x, B_w_in, B_w_sp, B_b_sp, B_w_out, c, w_mod):

    def _A_ref(x, wqkv, wo):
        B, S, D = x.shape
        H = 32
        Dh = D // H
        W = 256
        qkv = (lambda x, *d: x.permute(*d))((x @ wqkv).reshape(B, S, 3, H, Dh), 2, 0, 3, 1, 4)
        q, k, v = (qkv[0], qkv[1], qkv[2])
        scores = torch.einsum('bhqd,bhkd->bhqk', q, k) * Dh ** (-0.5)
        idx = torch.arange(S)
        mask = (idx[:, None] - idx[None, :] >= 0) & (idx[:, None] - idx[None, :] < W)
        scores = torch.where(mask[None, None], scores, -1000000000.0)
        p = _softmax(scores, axis=-1)
        o = torch.einsum('bhqk,bhkd->bhqd', p, v)
        return (lambda x, *d: x.permute(*d))(o, 0, 2, 1, 3).reshape(B, S, D) @ wo

    def _B_ref(x, w_in, w_sp, b_sp, w_out):
        B, S, D = x.shape
        F = w_in.shape[-1]
        Fh = F // 2
        z = _gelu(torch.einsum('bsd,df->bsf', x, w_in))
        z1 = z[..., :Fh].clone()
        z2 = _layernorm(z[..., Fh:], axis=-1)
        g = torch.einsum('ts,bsf->btf', w_sp, z2) + b_sp[None, :, None]
        return torch.einsum('bsf,fd->bsd', z1 * g, w_out)
    x = A_x
    mod = (_silu(c) @ w_mod).reshape(c.shape[0], 6, 1, -1)
    sa, ca, ga, sb, cb, gb = (mod[:, 0].clone(), mod[:, 1].clone(), mod[:, 2].clone(), mod[:, 3].clone(), mod[:, 4].clone(), mod[:, 5].clone())
    h = _layernorm(x, axis=-1) * (1 + ca) + sa
    x = x + ga * _A_ref(h, A_wqkv, A_wo)
    h = _layernorm(x, axis=-1) * (1 + cb) + sb
    x = x + gb * _B_ref(h, B_w_in, B_w_sp, B_b_sp, B_w_out)
    return x
```

```asm
; @launch grid=(256,1,1) block=(512,1,1) lds=163840
.amdgcn_target "amdgcn-amd-amdhsa--gfx950"
.text
.globl adaLN_cond__sliding_block__mixer_gmlp__prompt_kernel
.p2align 8
.type adaLN_cond__sliding_block__mixer_gmlp__prompt_kernel,@function
adaLN_cond__sliding_block__mixer_gmlp__prompt_kernel:
  s_cmp_ge_u32 s2, 256
  s_cbranch_scc1 L_exit
  s_load_dwordx2 s[32:33], s[0:1], 64
  s_load_dwordx2 s[36:37], s[0:1], 72
  s_load_dwordx2 s[44:45], s[0:1], 96
  s_load_dwordx2 s[4:5], s[0:1], 0
  s_load_dwordx2 s[8:9], s[0:1], 8
  s_load_dwordx2 s[12:13], s[0:1], 16
  s_load_dwordx2 s[16:17], s[0:1], 32
  s_load_dwordx2 s[20:21], s[0:1], 40
  s_load_dwordx2 s[24:25], s[0:1], 48
  s_load_dwordx2 s[28:29], s[0:1], 56
  s_load_dwordx2 s[40:41], s[0:1], 80
  s_mov_b32 s6, 2621440
  s_mov_b32 s7, 0x20000
  s_mov_b32 s10, 2457600
  s_mov_b32 s11, 0x20000
  s_mov_b32 s14, 819200
  s_mov_b32 s15, 0x20000
  s_mov_b32 s18, 2211840
  s_mov_b32 s19, 0x20000
  s_mov_b32 s22, 8388608
  s_mov_b32 s23, 0x20000
  s_mov_b32 s26, 4096
  s_mov_b32 s27, 0x20000
  s_mov_b32 s30, 1105920
  s_mov_b32 s31, 0x20000
  s_mov_b32 s34, 1280
  s_mov_b32 s35, 0x20000
  s_mov_b32 s38, 4915200
  s_mov_b32 s39, 0x20000
  s_mov_b32 s42, 2621440
  s_mov_b32 s43, 0x20000
  s_mov_b32 s46, 34054144
  s_mov_b32 s47, 0x20000
  v_and_b32 v1, 63, v0
  v_lshrrev_b32 v2, 6, v0
  s_nop 0
  v_readfirstlane_b32 s55, v2
  s_and_b32 s48, s2, 7
  s_lshr_b32 s49, s2, 3
  s_lshr_b32 s63, s49, 4
  s_lshl_b32 s50, s48, 1
  s_add_u32 s50, s50, s63
  s_and_b32 s51, s49, 15
  s_lshr_b32 s63, s49, 3
  s_and_b32 s56, s63, 1
  s_lshl_b32 s52, s48, 2
  s_add_u32 s52, s52, s63
  s_and_b32 s53, s49, 7
  s_mov_b32 s57, 0xffff0000
  s_and_b32 s59, s55, 3
  s_lshr_b32 s60, s55, 2
  s_getreg_b32 s81, hwreg(HW_REG_XCC_ID, 0, 4)
  s_lshr_b32 s61, s49, 2
  s_lshl_b32 s61, s61, 3
  s_add_u32 s61, s61, s48
  s_lshl_b32 s62, s61, 2
  s_and_b32 s63, s49, 3
  s_add_u32 s62, s62, s63
  s_cmp_lt_u32 s61, 20
  s_cbranch_scc0 IF_2_else
  v_lshrrev_b32 v19, 3, v0
  v_mul_u32_u24 v20, 7680, v19
  v_and_b32 v21, 7, v0
  v_lshl_add_u32 v20, v21, 4, v20
  v_lshlrev_b32 v19, 1, v19
  s_and_b32 s63, s62, 3
  s_mul_i32 s58, s63, 1228800
  s_mul_i32 s3, s63, 320
  s_lshl_b32 s63, s61, 7
  s_add_u32 s63, s63, s58
  s_waitcnt lgkmcnt(0)
  buffer_load_dwordx4 v[4:7], v20, s[36:39], s63 offen
  buffer_load_ushort v16, v19, s[32:35], s3 offen offset:0
  s_add_u32 s63, s63, 491520
  buffer_load_dwordx4 v[8:11], v20, s[36:39], s63 offen
  buffer_load_ushort v17, v19, s[32:35], s3 offen offset:128
  s_add_u32 s63, s63, 491520
  s_cmp_eq_u32 s60, 0
  s_cselect_b32 s63, s63, 2147483648
  s_cselect_b32 s3, s3, 2147483648
  buffer_load_dwordx4 v[12:15], v20, s[36:39], s63 offen
  buffer_load_ushort v18, v19, s[32:35], s3 offen offset:256
  s_branch IF_2_end
IF_2_else:
  s_cmp_ge_u32 s49, 12
  s_cbranch_scc0 IF_1_else
  s_sub_u32 s63, s2, 96
  s_and_b32 s64, s63, 15
  s_lshr_b32 s63, s63, 4
  s_and_b32 s65, s63, 1
  s_mul_i32 s65, s65, 5
  s_lshr_b32 s63, s63, 1
  s_add_u32 s65, s65, s63
  v_lshrrev_b32 v44, 4, v1
  v_bfe_u32 v45, v1, 2, 2
  v_xor_b32 v45, v45, v44
  v_and_b32 v46, 3, v1
  v_lshl_add_u32 v45, v45, 2, v46
  v_mul_u32_u24 v46, 52, v45
  v_lshrrev_b32 v46, 8, v46
  v_mul_u32_u24 v47, 1200, v46
  v_lshl_add_u32 v47, v45, 4, v47
  v_mul_u32_u24 v44, 3840, v44
  v_add_u32 v32, v47, v44
  v_cmp_eq_u32 vcc, 15, v45
  v_mov_b32 v44, 2147483648
  s_nop 0
  v_cndmask_b32 v32, v32, v44, vcc
  s_lshl_b32 s63, s65, 3
  s_add_u32 s63, s63, s55
  s_mul_i32 s63, s63, 30720
  s_mul_i32 s66, s64, 80
  s_add_u32 s63, s63, s66
  s_lshl_b32 s66, s55, 11
  s_add_u32 m0, s66, 65536
  s_waitcnt lgkmcnt(0)
  buffer_load_dwordx4 v32, s[8:11], s63 offen  lds
  s_add_u32 m0, s66, 66560
  s_add_u32 s63, s63, 15360
  buffer_load_dwordx4 v32, s[8:11], s63 offen  lds
IF_1_else:
IF_2_end:
  v_mov_b32 v2, 0
  s_waitcnt lgkmcnt(0)
  buffer_load_dword v22, v2, s[44:47], 0 offen sc1
  s_cmp_eq_u32 s55, 1
  s_cbranch_scc0 IF_3_else
  s_lshl_b32 s3, s48, 5
  s_add_u32 s3, s3, s49
  s_lshl_b32 s3, s3, 1
  s_add_u32 s3, s3, s55
  s_sub_u32 s3, s3, 1
  v_lshlrev_b32 v21, 7, v1
  v_cmp_gt_u32 vcc, 40, v1
  v_mov_b32 v20, 2147483648
  s_nop 0
  v_cndmask_b32 v21, v20, v21, vcc
  s_mov_b32 m0, 161536
  s_mul_i32 s63, s3, 5120
  buffer_load_dword v21, s[4:7], s63 offen  lds
IF_3_else:
  s_cmp_eq_u32 s55, 2
  s_cbranch_scc0 IF_4_else
  s_lshl_b32 s3, s48, 5
  s_add_u32 s3, s3, s49
  s_lshl_b32 s3, s3, 1
  s_add_u32 s3, s3, s55
  s_sub_u32 s3, s3, 1
  v_lshlrev_b32 v21, 7, v1
  v_cmp_gt_u32 vcc, 40, v1
  v_mov_b32 v20, 2147483648
  s_nop 0
  v_cndmask_b32 v21, v20, v21, vcc
  s_mov_b32 m0, 161536
  s_mul_i32 s63, s3, 5120
  buffer_load_dword v21, s[4:7], s63 offen  lds
IF_4_else:
  s_cmp_eq_u32 s55, 3
  s_cbranch_scc0 IF_5_else
  s_getpc_b64 s[76:77]
L_pc:
  s_and_b32 s76, s76, 0xffffff80
  s_mov_b32 s78, L_code_end-L_pc
  s_mov_b32 s79, 0x20000
  v_lshlrev_b32 v21, 7, v1
  v_cmp_gt_u32 vcc, 16, v1
  v_mov_b32 v20, 2147483648
  s_nop 0
  v_cndmask_b32 v21, v20, v21, vcc
  s_mov_b32 m0, 161536
  s_mul_i32 s63, s49, 2048
  buffer_load_dword v21, s[76:79], s63 offen  lds
IF_5_else:
  s_lshl_b32 s63, s50, 2
  s_add_u32 s63, s63, s59
  s_mul_i32 s67, s63, 40960
  s_mul_i32 s63, s60, 640
  s_add_u32 s67, s67, s63
  s_add_u32 s68, s67, 10240
  s_add_u32 s69, s67, 20480
  s_add_u32 s70, s67, 30720
  s_lshl_b32 s72, s59, 12
  s_mul_i32 s63, s60, 81920
  s_add_u32 s71, s72, s63
  s_lshl_b32 s63, s60, 14
  s_add_u32 s72, s72, s63
  s_add_u32 s72, s72, 65536
  v_lshrrev_b32 v34, 3, v1
  v_mul_u32_u24 v34, 1280, v34
  v_lshrrev_b32 v35, 4, v1
  v_and_b32 v36, 7, v1
  v_xor_b32 v35, v35, v36
  v_xor_b32 v36, 4, v35
  v_lshl_add_u32 v35, v35, 4, v34
  v_lshl_add_u32 v36, v36, 4, v34
  s_add_u32 m0, s71, 0
  s_nop 0
  buffer_load_dwordx4 v35, s[4:7], s67 offen offset:0  lds
  s_add_u32 m0, s71, 1024
  s_nop 0
  buffer_load_dwordx4 v36, s[4:7], s68 offen offset:0  lds
  s_add_u32 m0, s71, 2048
  s_nop 0
  buffer_load_dwordx4 v35, s[4:7], s69 offen offset:0  lds
  s_add_u32 m0, s71, 3072
  s_nop 0
  buffer_load_dwordx4 v36, s[4:7], s70 offen offset:0  lds
  s_add_u32 m0, s71, 16256
  s_nop 0
  buffer_load_dwordx4 v35, s[4:7], s67 offen offset:128  lds
  s_add_u32 m0, s71, 17280
  s_nop 0
  buffer_load_dwordx4 v36, s[4:7], s68 offen offset:128  lds
  s_add_u32 m0, s71, 18304
  s_nop 0
  buffer_load_dwordx4 v35, s[4:7], s69 offen offset:128  lds
  s_add_u32 m0, s71, 19328
  s_nop 0
  buffer_load_dwordx4 v36, s[4:7], s70 offen offset:128  lds
  v_and_b32 v37, 31, v1
  v_lshrrev_b32 v42, 1, v37
  v_and_b32 v42, 7, v42
  v_lshlrev_b32 v37, 7, v37
  v_lshrrev_b32 v43, 5, v1
  v_add_u32 v38, 0, v43
  v_xor_b32 v38, v38, v42
  v_lshl_add_u32 v38, v38, 4, v37
  v_add_u32 v28, s72, v38
  v_add_u32 v38, s71, v38
  v_add_u32 v39, 2, v43
  v_xor_b32 v39, v39, v42
  v_lshl_add_u32 v39, v39, 4, v37
  v_add_u32 v29, s72, v39
  v_add_u32 v39, s71, v39
  v_add_u32 v40, 4, v43
  v_xor_b32 v40, v40, v42
  v_lshl_add_u32 v40, v40, 4, v37
  v_add_u32 v30, s72, v40
  v_add_u32 v40, s71, v40
  v_add_u32 v41, 6, v43
  v_xor_b32 v41, v41, v42
  v_lshl_add_u32 v41, v41, 4, v37
  v_add_u32 v31, s72, v41
  v_add_u32 v41, s71, v41
  v_lshlrev_b32 v33, 4, v1
  s_mul_i32 s73, s51, 163840
  s_add_u32 s73, s73, 18743296
  s_mov_b32 s75, 0x3f803f80
  v_mov_b32 v136, 0
  v_mov_b32 v137, 0
  v_mov_b32 v138, 0
  v_mov_b32 v139, 0
  s_waitcnt vmcnt(8)
  v_readfirstlane_b32 s54, v22
  s_nop 0
  s_mul_i32 s54, s54, 0x9E3779B1
  s_add_u32 s54, s54, 0x7F4A7C15
  s_cmp_lt_u32 s61, 20
  s_cbranch_scc0 IF_8_else
  v_lshlrev_b32 v16, 16, v16
  v_mul_f32 v44, 0xbfb8aa3b, v16
  v_lshlrev_b32 v17, 16, v17
  v_mul_f32 v45, 0xbfb8aa3b, v17
  v_lshlrev_b32 v18, 16, v18
  v_mul_f32 v46, 0xbfb8aa3b, v18
  v_exp_f32 v44, v44
  v_exp_f32 v45, v45
  v_exp_f32 v46, v46
  v_add_f32 v44, 1.0, v44
  v_add_f32 v45, 1.0, v45
  v_add_f32 v46, 1.0, v46
  v_rcp_f32 v44, v44
  v_rcp_f32 v45, v45
  v_rcp_f32 v46, v46
  v_mul_f32 v16, v16, v44
  v_mul_f32 v17, v17, v45
  v_mul_f32 v18, v18, v46
  v_cvt_pk_bf16_f32 v16, v16, v16
  v_cvt_pk_bf16_f32 v17, v17, v17
  v_cvt_pk_bf16_f32 v18, v18, v18
  v_lshlrev_b32 v16, 16, v16
  v_lshlrev_b32 v17, 16, v17
  v_lshlrev_b32 v18, 16, v18
  v_lshlrev_b32 v44, 16, v4
  v_and_b32 v45, s57, v4
  v_mul_f32 v48, v16, v44
  v_mul_f32 v49, v16, v45
  v_lshlrev_b32 v44, 16, v5
  v_and_b32 v45, s57, v5
  v_mul_f32 v50, v16, v44
  v_mul_f32 v51, v16, v45
  v_lshlrev_b32 v44, 16, v6
  v_and_b32 v45, s57, v6
  v_mul_f32 v52, v16, v44
  v_mul_f32 v53, v16, v45
  v_lshlrev_b32 v44, 16, v7
  v_and_b32 v45, s57, v7
  v_mul_f32 v54, v16, v44
  v_mul_f32 v55, v16, v45
  v_lshlrev_b32 v44, 16, v8
  v_and_b32 v45, s57, v8
  v_fmac_f32 v48, v17, v44
  v_fmac_f32 v49, v17, v45
  v_lshlrev_b32 v44, 16, v9
  v_and_b32 v45, s57, v9
  v_fmac_f32 v50, v17, v44
  v_fmac_f32 v51, v17, v45
  v_lshlrev_b32 v44, 16, v10
  v_and_b32 v45, s57, v10
  v_fmac_f32 v52, v17, v44
  v_fmac_f32 v53, v17, v45
  v_lshlrev_b32 v44, 16, v11
  v_and_b32 v45, s57, v11
  v_fmac_f32 v54, v17, v44
  v_fmac_f32 v55, v17, v45
  v_lshlrev_b32 v44, 16, v12
  v_and_b32 v45, s57, v12
  v_fmac_f32 v48, v18, v44
  v_fmac_f32 v49, v18, v45
  v_lshlrev_b32 v44, 16, v13
  v_and_b32 v45, s57, v13
  v_fmac_f32 v50, v18, v44
  v_fmac_f32 v51, v18, v45
  v_lshlrev_b32 v44, 16, v14
  v_and_b32 v45, s57, v14
  v_fmac_f32 v52, v18, v44
  v_fmac_f32 v53, v18, v45
  v_lshlrev_b32 v44, 16, v15
  v_and_b32 v45, s57, v15
  v_fmac_f32 v54, v18, v44
  v_fmac_f32 v55, v18, v45
  v_permlane32_swap_b32 v48, v52
  v_permlane32_swap_b32 v49, v53
  v_permlane32_swap_b32 v50, v54
  v_permlane32_swap_b32 v51, v55
  v_add_f32 v48, v48, v52
  v_add_f32 v49, v49, v53
  v_add_f32 v50, v50, v54
  v_add_f32 v51, v51, v55
  v_and_b32 v44, 7, v1
  v_lshrrev_b32 v45, 4, v1
  v_permlane16_swap_b32 v48, v50
  v_permlane16_swap_b32 v49, v51
  v_add_f32 v48, v48, v50
  v_add_f32 v49, v49, v51
  v_lshl_add_u32 v44, v44, 2, v45
  v_lshlrev_b32 v44, 3, v44
  s_lshl_b32 s63, s55, 8
  s_add_u32 s63, s63, 155648
  v_add_f32_dpp v48, v48, v48 row_ror:8 row_mask:0xf bank_mask:0xf
  v_add_f32_dpp v49, v49, v49 row_ror:8 row_mask:0xf bank_mask:0xf
  v_add_u32 v44, s63, v44
  ds_write_b64 v44, v[48:49]
  s_waitcnt lgkmcnt(0)
  s_barrier
  s_cmp_eq_u32 s55, 5
  s_cbranch_scc0 IF_6_else
  v_lshlrev_b32 v12, 2, v1
  v_add_u32 v13, 155648, v12
  ds_read_b32 v4, v13 offset:0
  ds_read_b32 v5, v13 offset:256
  ds_read_b32 v6, v13 offset:512
  ds_read_b32 v7, v13 offset:768
  ds_read_b32 v8, v13 offset:1024
  ds_read_b32 v9, v13 offset:1280
  ds_read_b32 v10, v13 offset:1536
  ds_read_b32 v11, v13 offset:1792
  s_lshl_b32 s63, s62, 9
  s_add_u32 s63, s63, 4096
  v_mul_u32_u24 v13, 3, v12
  v_add_u32 v14, 4, v13
  v_add_u32 v15, 8, v13
  v_lshlrev_b32 v12, 4, v1
  v_cmp_gt_u32 vcc, 22, v1
  s_waitcnt lgkmcnt(3)
  v_add_f32 v4, v4, v8
  s_waitcnt lgkmcnt(2)
  v_add_f32 v5, v5, v9
  s_waitcnt lgkmcnt(1)
  v_add_f32 v6, v6, v10
  s_waitcnt lgkmcnt(0)
  v_add_f32 v7, v7, v11
  v_mov_b32 v8, 2147483648
  v_add_f32 v4, v4, v5
  v_add_f32 v6, v6, v7
  v_cndmask_b32 v12, v8, v12, vcc
  v_add_f32 v8, v4, v6
  ds_bpermute_b32 v4, v13, v8
  ds_bpermute_b32 v5, v14, v8
  ds_bpermute_b32 v6, v15, v8
  v_mov_b32 v7, s54
  s_waitcnt lgkmcnt(0)
  buffer_store_dwordx4 v[4:7], v12, s[44:47], s63 offen sc1
IF_6_else:
  s_branch IF_8_end
IF_8_else:
  s_cmp_ge_u32 s49, 12
  s_cbranch_scc0 IF_7_else
  v_and_b32 v6, 15, v1
  v_lshrrev_b32 v7, 2, v6
  v_lshrrev_b32 v8, 5, v1
  v_lshl_add_u32 v9, v8, 3, v7
  v_lshlrev_b32 v9, 8, v9
  v_bfe_u32 v10, v1, 4, 1
  v_lshl_add_u32 v9, v10, 5, v9
  v_and_b32 v10, 3, v1
  v_lshl_add_u32 v9, v10, 3, v9
  s_lshr_b32 s63, s55, 1
  s_lshl_b32 s63, s63, 12
  s_add_u32 s63, s63, 65536
  v_add_u32 v9, s63, v9
  s_and_b32 s63, s55, 1
  s_lshl_b32 s63, s63, 1
  v_xor_b32 v10, s63, v7
  v_xor_b32 v11, 1, v10
  v_lshl_add_u32 v10, v10, 6, v9
  v_lshl_add_u32 v11, v11, 6, v9
  v_lshlrev_b32 v12, 4, v1
  s_mul_i32 s66, s64, 10
  s_add_u32 s66, s66, s65
  s_lshl_b32 s66, s66, 3
  s_add_u32 s66, s66, s55
  s_lshl_b32 s77, s66, 11
  s_add_u32 s77, s77, 18743296
  s_barrier
  ds_read_b64_tr_b16 v[16:17], v10 offset:0
  ds_read_b64_tr_b16 v[18:19], v10 offset:1024
  ds_read_b64_tr_b16 v[20:21], v11 offset:0
  ds_read_b64_tr_b16 v[22:23], v11 offset:1024
  s_waitcnt lgkmcnt(2)
  buffer_store_dwordx4 v[16:19], v12, s[44:47], s77 offen offset:0 sc1
  s_waitcnt lgkmcnt(0)
  buffer_store_dwordx4 v[20:23], v12, s[44:47], s77 offen offset:1024 sc1
  s_barrier
IF_7_else:
IF_8_end:
  s_cmp_eq_u32 s55, 6
  s_cbranch_scc0 IF_9_else
  v_mov_b32 v24, s81
  v_mov_b32 v25, s54
  v_lshlrev_b32 v26, 3, v1
  v_cmp_gt_u32 vcc, 16, v1
  v_mov_b32 v27, 2147483648
  s_nop 0
  v_cndmask_b32 v26, v27, v26, vcc
  s_lshl_b32 s63, s2, 7
  s_add_u32 s63, s63, 1703936
  buffer_store_dwordx2 v[24:25], v26, s[44:47], s63 offen sc1
IF_9_else:
  s_waitcnt vmcnt(4)
  ds_read_b128 v[176:179], v38 offset:0
  ds_read_b128 v[180:183], v39 offset:0
  ds_read_b128 v[184:187], v40 offset:0
  ds_read_b128 v[188:191], v41 offset:0
  s_add_u32 m0, s71, 32512
  s_nop 0
  buffer_load_dwordx4 v35, s[4:7], s67 offen offset:256  lds
  s_add_u32 m0, s71, 33536
  s_nop 0
  buffer_load_dwordx4 v36, s[4:7], s68 offen offset:256  lds
  s_add_u32 m0, s71, 34560
  s_nop 0
  buffer_load_dwordx4 v35, s[4:7], s69 offen offset:256  lds
  s_add_u32 m0, s71, 35584
  s_nop 0
  buffer_load_dwordx4 v36, s[4:7], s70 offen offset:256  lds
  s_cmp_ge_u32 s49, 12
  s_cbranch_scc0 IF_10_else
  s_lshl_b32 s63, s66, 7
  s_add_u32 s63, s63, 1966080
  v_mov_b32 v14, s54
  v_lshlrev_b32 v15, 26, v1
  v_and_b32 v15, 2147483648, v15
  v_lshl_or_b32 v15, v1, 2, v15
  s_waitcnt vmcnt(4)
  buffer_store_dword v14, v15, s[44:47], s63 offen sc1
IF_10_else:
  s_waitcnt lgkmcnt(3)
  v_dot2c_f32_bf16 v136, s75, v176
  v_dot2c_f32_bf16 v138, v176, v176
  v_dot2c_f32_bf16 v137, s75, v177
  v_dot2c_f32_bf16 v139, v177, v177
  v_dot2c_f32_bf16 v136, s75, v178
  v_dot2c_f32_bf16 v138, v178, v178
  v_dot2c_f32_bf16 v137, s75, v179
  v_dot2c_f32_bf16 v139, v179, v179
  s_waitcnt lgkmcnt(2)
  v_dot2c_f32_bf16 v136, s75, v180
  v_dot2c_f32_bf16 v138, v180, v180
  v_dot2c_f32_bf16 v137, s75, v181
  v_dot2c_f32_bf16 v139, v181, v181
  v_dot2c_f32_bf16 v136, s75, v182
  v_dot2c_f32_bf16 v138, v182, v182
  v_dot2c_f32_bf16 v137, s75, v183
  v_dot2c_f32_bf16 v139, v183, v183
  s_waitcnt lgkmcnt(1)
  v_dot2c_f32_bf16 v136, s75, v184
  v_dot2c_f32_bf16 v138, v184, v184
  v_dot2c_f32_bf16 v137, s75, v185
  v_dot2c_f32_bf16 v139, v185, v185
  v_dot2c_f32_bf16 v136, s75, v186
  v_dot2c_f32_bf16 v138, v186, v186
  v_dot2c_f32_bf16 v137, s75, v187
  v_dot2c_f32_bf16 v139, v187, v187
  s_waitcnt lgkmcnt(0)
  v_dot2c_f32_bf16 v136, s75, v188
  v_dot2c_f32_bf16 v138, v188, v188
  v_dot2c_f32_bf16 v137, s75, v189
  v_dot2c_f32_bf16 v139, v189, v189
  v_dot2c_f32_bf16 v136, s75, v190
  v_dot2c_f32_bf16 v138, v190, v190
  v_dot2c_f32_bf16 v137, s75, v191
  v_dot2c_f32_bf16 v139, v191, v191
  v_mul_u32_u24 v88, 2979, v0
  v_lshrrev_b32 v88, 16, v88
  v_mul_u32_u24 v89, 22, v88
  v_sub_u32 v89, v0, v89
  v_mul_u32_u24 v85, 12, v89
  v_lshl_add_u32 v85, v88, 8, v85
  v_add_u32 v85, 149504, v85
  v_mov_b32 v84, v88
  v_lshlrev_b32 v84, 11, v84
  v_lshl_add_u32 v84, v89, 4, v84
  v_cmp_gt_u32 vcc, 20, v88
  v_mov_b32 v90, 161536
  s_nop 0
  v_cndmask_b32 v84, 0, v84, vcc
  v_cndmask_b32 v85, v90, v85, vcc
  v_cmp_gt_u32 vcc, 21, v89
  s_nop 1
  v_cndmask_b32 v86, v90, v85, vcc
  v_cmp_le_u32 vcc, 10, v88
  s_nop 1
  v_cndmask_b32 v87, 0, 1.0, vcc
  s_mul_i32 s10, s51, 10240
  s_add_u32 s10, s10, 1966080
  s_cmp_eq_u32 s55, 7
  s_cselect_b32 s9, 63, 0
  v_and_b32 v82, s9, v1
  v_lshlrev_b32 v82, 7, v82
  s_cselect_b32 s9, 15, 0
  v_and_b32 v83, s9, v1
  v_lshlrev_b32 v83, 7, v83
  v_add_u32 v83, 8192, v83
  s_mov_b32 s11, 740819968
  s_cmp_lt_u32 s55, 4
  s_cselect_b32 s11, s11, 875564040
  s_lshl_b32 s3, s59, 3
  s_lshr_b32 s11, s11, s3
  s_and_b32 s11, s11, 0xff
  s_lshl_b32 s11, s11, 7
  s_add_u32 s11, s11, s10
  v_and_b32 v92, 3, v1
  v_lshlrev_b32 v92, 7, v92
  v_and_b32 v134, 15, v1
  v_lshrrev_b32 v133, 5, v1
  s_mul_i32 s63, s60, 98304
  v_add_u32 v24, s63, v33
  s_mul_i32 s63, s60, 1280
  s_add_u32 s63, s63, 149504
  v_lshlrev_b32 v23, 5, v133
  v_add_u32 v23, s63, v23
  v_lshrrev_b32 v22, 3, v134
  v_lshlrev_b32 v22, 6, v22
  v_and_b32 v135, 7, v1
  v_lshl_add_u32 v22, v135, 2, v22
  v_add_u32 v22, v23, v22
  s_cmp_eq_u32 s60, 0
  s_cselect_b32 s76, 16384, 0
  s_cselect_b32 s63, 0, 16384
  s_add_u32 s76, s76, s63
  s_cmp_eq_u32 s60, 0
  s_cselect_b32 s77, 16384, 0
  s_cselect_b32 s63, 0, 16384
  s_add_u32 s77, s77, s63
  s_cmp_eq_u32 s60, 0
  s_cselect_b32 s78, 16384, 0
  s_cselect_b32 s63, 0, 4294918144
  s_add_u32 s78, s78, s63
  s_cmp_eq_u32 s60, 0
  s_cselect_b32 s79, 16384, 0
  s_cselect_b32 s63, 0, 16384
  s_add_u32 s79, s79, s63
  s_waitcnt vmcnt(4)
  ds_read_b128 v[192:195], v38 offset:16384
  ds_read_b128 v[196:199], v39 offset:16384
  ds_read_b128 v[200:203], v40 offset:16384
  ds_read_b128 v[204:207], v41 offset:16384
  s_add_u32 m0, s71, 48768
  s_nop 0
  buffer_load_dwordx4 v35, s[4:7], s67 offen offset:384  lds
  s_add_u32 m0, s71, 49792
  s_nop 0
  buffer_load_dwordx4 v36, s[4:7], s68 offen offset:384  lds
  s_add_u32 m0, s71, 50816
  s_nop 0
  buffer_load_dwordx4 v35, s[4:7], s69 offen offset:384  lds
  s_add_u32 m0, s71, 51840
  s_nop 0
  buffer_load_dwordx4 v36, s[4:7], s70 offen offset:384  lds
  s_waitcnt lgkmcnt(3)
  v_dot2c_f32_bf16 v136, s75, v192
  v_dot2c_f32_bf16 v138, v192, v192
  v_dot2c_f32_bf16 v137, s75, v193
  v_dot2c_f32_bf16 v139, v193, v193
  v_dot2c_f32_bf16 v136, s75, v194
  v_dot2c_f32_bf16 v138, v194, v194
  v_dot2c_f32_bf16 v137, s75, v195
  v_dot2c_f32_bf16 v139, v195, v195
  s_waitcnt lgkmcnt(2)
  v_dot2c_f32_bf16 v136, s75, v196
  v_dot2c_f32_bf16 v138, v196, v196
  v_dot2c_f32_bf16 v137, s75, v197
  v_dot2c_f32_bf16 v139, v197, v197
  v_dot2c_f32_bf16 v136, s75, v198
  v_dot2c_f32_bf16 v138, v198, v198
  v_dot2c_f32_bf16 v137, s75, v199
  v_dot2c_f32_bf16 v139, v199, v199
  s_waitcnt lgkmcnt(1)
  v_dot2c_f32_bf16 v136, s75, v200
  v_dot2c_f32_bf16 v138, v200, v200
  v_dot2c_f32_bf16 v137, s75, v201
  v_dot2c_f32_bf16 v139, v201, v201
  v_dot2c_f32_bf16 v136, s75, v202
  v_dot2c_f32_bf16 v138, v202, v202
  v_dot2c_f32_bf16 v137, s75, v203
  v_dot2c_f32_bf16 v139, v203, v203
  s_waitcnt lgkmcnt(0)
  v_dot2c_f32_bf16 v136, s75, v204
  v_dot2c_f32_bf16 v138, v204, v204
  v_dot2c_f32_bf16 v137, s75, v205
  v_dot2c_f32_bf16 v139, v205, v205
  v_dot2c_f32_bf16 v136, s75, v206
  v_dot2c_f32_bf16 v138, v206, v206
  v_dot2c_f32_bf16 v137, s75, v207
  v_dot2c_f32_bf16 v139, v207, v207
  s_waitcnt vmcnt(4)
  ds_read_b128 v[208:211], v38 offset:32768
  ds_read_b128 v[212:215], v39 offset:32768
  ds_read_b128 v[216:219], v40 offset:32768
  ds_read_b128 v[220:223], v41 offset:32768
  buffer_load_dwordx4 v[112:115], v35, s[4:7], s67 offen offset:512
  buffer_load_dwordx4 v[116:119], v36, s[4:7], s68 offen offset:512
  buffer_load_dwordx4 v[120:123], v35, s[4:7], s69 offen offset:512
  buffer_load_dwordx4 v[124:127], v36, s[4:7], s70 offen offset:512
  s_waitcnt lgkmcnt(3)
  v_dot2c_f32_bf16 v136, s75, v208
  v_dot2c_f32_bf16 v138, v208, v208
  v_dot2c_f32_bf16 v137, s75, v209
  v_dot2c_f32_bf16 v139, v209, v209
  v_dot2c_f32_bf16 v136, s75, v210
  v_dot2c_f32_bf16 v138, v210, v210
  v_dot2c_f32_bf16 v137, s75, v211
  v_dot2c_f32_bf16 v139, v211, v211
  s_waitcnt lgkmcnt(2)
  v_dot2c_f32_bf16 v136, s75, v212
  v_dot2c_f32_bf16 v138, v212, v212
  v_dot2c_f32_bf16 v137, s75, v213
  v_dot2c_f32_bf16 v139, v213, v213
  v_dot2c_f32_bf16 v136, s75, v214
  v_dot2c_f32_bf16 v138, v214, v214
  v_dot2c_f32_bf16 v137, s75, v215
  v_dot2c_f32_bf16 v139, v215, v215
  s_waitcnt lgkmcnt(1)
  v_dot2c_f32_bf16 v136, s75, v216
  v_dot2c_f32_bf16 v138, v216, v216
  v_dot2c_f32_bf16 v137, s75, v217
  v_dot2c_f32_bf16 v139, v217, v217
  v_dot2c_f32_bf16 v136, s75, v218
  v_dot2c_f32_bf16 v138, v218, v218
  v_dot2c_f32_bf16 v137, s75, v219
  v_dot2c_f32_bf16 v139, v219, v219
  s_waitcnt lgkmcnt(0)
  v_dot2c_f32_bf16 v136, s75, v220
  v_dot2c_f32_bf16 v138, v220, v220
  v_dot2c_f32_bf16 v137, s75, v221
  v_dot2c_f32_bf16 v139, v221, v221
  v_dot2c_f32_bf16 v136, s75, v222
  v_dot2c_f32_bf16 v138, v222, v222
  v_dot2c_f32_bf16 v137, s75, v223
  v_dot2c_f32_bf16 v139, v223, v223
  s_waitcnt vmcnt(4)
  ds_read_b128 v[224:227], v38 offset:49152
  ds_read_b128 v[228:231], v39 offset:49152
  ds_read_b128 v[232:235], v40 offset:49152
  ds_read_b128 v[236:239], v41 offset:49152
  s_waitcnt lgkmcnt(3)
  v_dot2c_f32_bf16 v136, s75, v224
  v_dot2c_f32_bf16 v138, v224, v224
  v_dot2c_f32_bf16 v137, s75, v225
  v_dot2c_f32_bf16 v139, v225, v225
  v_dot2c_f32_bf16 v136, s75, v226
  v_dot2c_f32_bf16 v138, v226, v226
  v_dot2c_f32_bf16 v137, s75, v227
  v_dot2c_f32_bf16 v139, v227, v227
  s_waitcnt lgkmcnt(2)
  v_dot2c_f32_bf16 v136, s75, v228
  v_dot2c_f32_bf16 v138, v228, v228
  v_dot2c_f32_bf16 v137, s75, v229
  v_dot2c_f32_bf16 v139, v229, v229
  v_dot2c_f32_bf16 v136, s75, v230
  v_dot2c_f32_bf16 v138, v230, v230
  v_dot2c_f32_bf16 v137, s75, v231
  v_dot2c_f32_bf16 v139, v231, v231
  s_waitcnt lgkmcnt(1)
  v_dot2c_f32_bf16 v136, s75, v232
  v_dot2c_f32_bf16 v138, v232, v232
  v_dot2c_f32_bf16 v137, s75, v233
  v_dot2c_f32_bf16 v139, v233, v233
  v_dot2c_f32_bf16 v136, s75, v234
  v_dot2c_f32_bf16 v138, v234, v234
  v_dot2c_f32_bf16 v137, s75, v235
  v_dot2c_f32_bf16 v139, v235, v235
  s_waitcnt lgkmcnt(0)
  v_dot2c_f32_bf16 v136, s75, v236
  v_dot2c_f32_bf16 v138, v236, v236
  v_dot2c_f32_bf16 v137, s75, v237
  v_dot2c_f32_bf16 v139, v237, v237
  v_dot2c_f32_bf16 v136, s75, v238
  v_dot2c_f32_bf16 v138, v238, v238
  v_dot2c_f32_bf16 v137, s75, v239
  v_dot2c_f32_bf16 v139, v239, v239
  v_add_u32 v6, s72, v33
  s_waitcnt vmcnt(3)
  ds_write_b128 v6, v[112:115] offset:0
  s_waitcnt vmcnt(2)
  ds_write_b128 v6, v[116:119] offset:1024
  s_waitcnt vmcnt(1)
  ds_write_b128 v6, v[120:123] offset:2048
  s_waitcnt vmcnt(0)
  ds_write_b128 v6, v[124:127] offset:3072
  s_waitcnt lgkmcnt(0)
  ds_read_b128 v[240:243], v28 offset:0
  ds_read_b128 v[244:247], v29 offset:0
  ds_read_b128 v[248:251], v30 offset:0
  ds_read_b128 v[252:255], v31 offset:0
  s_waitcnt lgkmcnt(3)
  v_dot2c_f32_bf16 v136, s75, v240
  v_dot2c_f32_bf16 v138, v240, v240
  v_dot2c_f32_bf16 v137, s75, v241
  v_dot2c_f32_bf16 v139, v241, v241
  v_dot2c_f32_bf16 v136, s75, v242
  v_dot2c_f32_bf16 v138, v242, v242
  v_dot2c_f32_bf16 v137, s75, v243
  v_dot2c_f32_bf16 v139, v243, v243
  s_waitcnt lgkmcnt(2)
  v_dot2c_f32_bf16 v136, s75, v244
  v_dot2c_f32_bf16 v138, v244, v244
  v_dot2c_f32_bf16 v137, s75, v245
  v_dot2c_f32_bf16 v139, v245, v245
  v_dot2c_f32_bf16 v136, s75, v246
  v_dot2c_f32_bf16 v138, v246, v246
  v_dot2c_f32_bf16 v137, s75, v247
  v_dot2c_f32_bf16 v139, v247, v247
  s_waitcnt lgkmcnt(1)
  v_dot2c_f32_bf16 v136, s75, v248
  v_dot2c_f32_bf16 v138, v248, v248
  v_dot2c_f32_bf16 v137, s75, v249
  v_dot2c_f32_bf16 v139, v249, v249
  v_dot2c_f32_bf16 v136, s75, v250
  v_dot2c_f32_bf16 v138, v250, v250
  v_dot2c_f32_bf16 v137, s75, v251
  v_dot2c_f32_bf16 v139, v251, v251
  s_waitcnt lgkmcnt(0)
  v_dot2c_f32_bf16 v136, s75, v252
  v_dot2c_f32_bf16 v138, v252, v252
  v_dot2c_f32_bf16 v137, s75, v253
  v_dot2c_f32_bf16 v139, v253, v253
  v_dot2c_f32_bf16 v136, s75, v254
  v_dot2c_f32_bf16 v138, v254, v254
  v_dot2c_f32_bf16 v137, s75, v255
  v_dot2c_f32_bf16 v139, v255, v255
  s_nop 1
  v_add_f32 v2, v136, v137
  v_add_f32 v3, v138, v139
  v_mov_b32 v4, v2
  v_mov_b32 v5, v3
  v_and_b32 v6, 31, v1
  v_lshlrev_b32 v6, 3, v6
  v_permlane32_swap_b32 v2, v4
  v_permlane32_swap_b32 v3, v5
  s_lshl_b32 s63, s55, 8
  s_add_u32 s63, s63, 147456
  v_add_u32 v7, s63, v6
  s_xor_b32 s63, s55, 4
  s_lshl_b32 s63, s63, 8
  s_add_u32 s63, s63, 147456
  v_add_f32 v2, v2, v4
  v_add_f32 v3, v3, v5
  v_add_u32 v6, s63, v6
  ds_write_b64 v7, v[2:3]
  s_waitcnt lgkmcnt(0)
  s_barrier
  ds_read_b64 v[138:139], v6
  s_waitcnt lgkmcnt(0)
  v_add_f32 v28, v2, v138
  v_add_f32 v30, v3, v139
  v_mul_f32 v28, 0.0015625, v28
  v_mul_f32 v3, v28, v28
  v_mul_f32 v30, 0.0015625, v30
  v_sub_f32 v30, v30, v3
  v_max_f32 v30, 0, v30
  v_add_f32 v30, 0x3727c5ac, v30
  v_rsq_f32 v30, v30
  s_nop 0
  v_mul_f32 v28, v28, v30
  v_sub_f32 v28, 0, v28
  s_cmp_lt_u32 s2, 160
  s_cbranch_scc0 IF_11_else
  s_add_u32 s62, s2, 80
  s_lshr_b32 s61, s62, 2
  v_lshrrev_b32 v19, 3, v0
  v_mul_u32_u24 v20, 7680, v19
  v_and_b32 v21, 7, v0
  v_lshl_add_u32 v20, v21, 4, v20
  v_lshlrev_b32 v19, 1, v19
  s_and_b32 s63, s62, 3
  s_mul_i32 s58, s63, 1228800
  s_mul_i32 s3, s63, 320
  s_lshl_b32 s63, s61, 7
  s_add_u32 s63, s63, s58
  buffer_load_dwordx4 v[4:7], v20, s[36:39], s63 offen
  buffer_load_ushort v16, v19, s[32:35], s3 offen offset:0
  s_add_u32 s63, s63, 491520
  buffer_load_dwordx4 v[8:11], v20, s[36:39], s63 offen
  buffer_load_ushort v17, v19, s[32:35], s3 offen offset:128
  s_add_u32 s63, s63, 491520
  s_cmp_eq_u32 s60, 0
  s_cselect_b32 s63, s63, 2147483648
  s_cselect_b32 s3, s3, 2147483648
  buffer_load_dwordx4 v[12:15], v20, s[36:39], s63 offen
  buffer_load_ushort v18, v19, s[32:35], s3 offen offset:256
IF_11_else:
  v_lshlrev_b32 v128, 16, v176
  v_and_b32 v129, s57, v176
  v_pk_fma_f32 v[128:129], v[128:129], v[30:31], v[28:29] op_sel_hi:[1,0,0]
  v_cvt_pk_bf16_f32 v176, v128, v129
  v_lshlrev_b32 v130, 16, v177
  v_and_b32 v131, s57, v177
  v_pk_fma_f32 v[130:131], v[130:131], v[30:31], v[28:29] op_sel_hi:[1,0,0]
  v_cvt_pk_bf16_f32 v177, v130, v131
  v_lshlrev_b32 v132, 16, v178
  v_and_b32 v133, s57, v178
  v_pk_fma_f32 v[132:133], v[132:133], v[30:31], v[28:29] op_sel_hi:[1,0,0]
  v_cvt_pk_bf16_f32 v178, v132, v133
  v_lshlrev_b32 v134, 16, v179
  v_and_b32 v135, s57, v179
  v_pk_fma_f32 v[134:135], v[134:135], v[30:31], v[28:29] op_sel_hi:[1,0,0]
  v_cvt_pk_bf16_f32 v179, v134, v135
  v_lshlrev_b32 v128, 16, v180
  v_and_b32 v129, s57, v180
  v_pk_fma_f32 v[128:129], v[128:129], v[30:31], v[28:29] op_sel_hi:[1,0,0]
  v_cvt_pk_bf16_f32 v180, v128, v129
  v_lshlrev_b32 v130, 16, v181
  v_and_b32 v131, s57, v181
  v_pk_fma_f32 v[130:131], v[130:131], v[30:31], v[28:29] op_sel_hi:[1,0,0]
  v_cvt_pk_bf16_f32 v181, v130, v131
  v_lshlrev_b32 v132, 16, v182
  v_and_b32 v133, s57, v182
  v_pk_fma_f32 v[132:133], v[132:133], v[30:31], v[28:29] op_sel_hi:[1,0,0]
  v_cvt_pk_bf16_f32 v182, v132, v133
  v_lshlrev_b32 v134, 16, v183
  v_and_b32 v135, s57, v183
  v_pk_fma_f32 v[134:135], v[134:135], v[30:31], v[28:29] op_sel_hi:[1,0,0]
  v_cvt_pk_bf16_f32 v183, v134, v135
  v_lshlrev_b32 v128, 16, v184
  v_and_b32 v129, s57, v184
  v_pk_fma_f32 v[128:129], v[128:129], v[30:31], v[28:29] op_sel_hi:[1,0,0]
  v_cvt_pk_bf16_f32 v184, v128, v129
  v_lshlrev_b32 v130, 16, v185
  v_and_b32 v131, s57, v185
  v_pk_fma_f32 v[130:131], v[130:131], v[30:31], v[28:29] op_sel_hi:[1,0,0]
  v_cvt_pk_bf16_f32 v185, v130, v131
  buffer_load_dword v93, v92, s[44:47], s11 offen sc1
  v_lshlrev_b32 v132, 16, v186
  v_and_b32 v133, s57, v186
  v_pk_fma_f32 v[132:133], v[132:133], v[30:31], v[28:29] op_sel_hi:[1,0,0]
  v_cvt_pk_bf16_f32 v186, v132, v133
  v_lshlrev_b32 v134, 16, v187
  v_and_b32 v135, s57, v187
  v_pk_fma_f32 v[134:135], v[134:135], v[30:31], v[28:29] op_sel_hi:[1,0,0]
  v_cvt_pk_bf16_f32 v187, v134, v135
  v_lshlrev_b32 v128, 16, v188
  v_and_b32 v129, s57, v188
  v_pk_fma_f32 v[128:129], v[128:129], v[30:31], v[28:29] op_sel_hi:[1,0,0]
  v_cvt_pk_bf16_f32 v188, v128, v129
  v_lshlrev_b32 v130, 16, v189
  v_and_b32 v131, s57, v189
  v_pk_fma_f32 v[130:131], v[130:131], v[30:31], v[28:29] op_sel_hi:[1,0,0]
  v_cvt_pk_bf16_f32 v189, v130, v131
  v_lshlrev_b32 v132, 16, v190
  v_and_b32 v133, s57, v190
  v_pk_fma_f32 v[132:133], v[132:133], v[30:31], v[28:29] op_sel_hi:[1,0,0]
  v_cvt_pk_bf16_f32 v190, v132, v133
  v_lshlrev_b32 v134, 16, v191
  v_and_b32 v135, s57, v191
  v_pk_fma_f32 v[134:135], v[134:135], v[30:31], v[28:29] op_sel_hi:[1,0,0]
  v_cvt_pk_bf16_f32 v191, v134, v135
  v_lshlrev_b32 v128, 16, v192
  v_and_b32 v129, s57, v192
  v_pk_fma_f32 v[128:129], v[128:129], v[30:31], v[28:29] op_sel_hi:[1,0,0]
  v_cvt_pk_bf16_f32 v192, v128, v129
  v_lshlrev_b32 v130, 16, v193
  v_and_b32 v131, s57, v193
  v_pk_fma_f32 v[130:131], v[130:131], v[30:31], v[28:29] op_sel_hi:[1,0,0]
  v_cvt_pk_bf16_f32 v193, v130, v131
  v_lshlrev_b32 v132, 16, v194
  v_and_b32 v133, s57, v194
  v_pk_fma_f32 v[132:133], v[132:133], v[30:31], v[28:29] op_sel_hi:[1,0,0]
  v_cvt_pk_bf16_f32 v194, v132, v133
  v_lshlrev_b32 v134, 16, v195
  v_and_b32 v135, s57, v195
  v_pk_fma_f32 v[134:135], v[134:135], v[30:31], v[28:29] op_sel_hi:[1,0,0]
  v_cvt_pk_bf16_f32 v195, v134, v135
  v_lshlrev_b32 v128, 16, v196
  v_and_b32 v129, s57, v196
  v_pk_fma_f32 v[128:129], v[128:129], v[30:31], v[28:29] op_sel_hi:[1,0,0]
  v_cvt_pk_bf16_f32 v196, v128, v129
  v_lshlrev_b32 v130, 16, v197
  v_and_b32 v131, s57, v197
  v_pk_fma_f32 v[130:131], v[130:131], v[30:31], v[28:29] op_sel_hi:[1,0,0]
  v_cvt_pk_bf16_f32 v197, v130, v131
  v_lshlrev_b32 v132, 16, v198
  v_and_b32 v133, s57, v198
  v_pk_fma_f32 v[132:133], v[132:133], v[30:31], v[28:29] op_sel_hi:[1,0,0]
  v_cvt_pk_bf16_f32 v198, v132, v133
  v_lshlrev_b32 v134, 16, v199
  v_and_b32 v135, s57, v199
  v_pk_fma_f32 v[134:135], v[134:135], v[30:31], v[28:29] op_sel_hi:[1,0,0]
  v_cvt_pk_bf16_f32 v199, v134, v135
  v_lshlrev_b32 v128, 16, v200
  v_and_b32 v129, s57, v200
  v_pk_fma_f32 v[128:129], v[128:129], v[30:31], v[28:29] op_sel_hi:[1,0,0]
  v_cvt_pk_bf16_f32 v200, v128, v129
  v_lshlrev_b32 v130, 16, v201
  v_and_b32 v131, s57, v201
  v_pk_fma_f32 v[130:131], v[130:131], v[30:31], v[28:29] op_sel_hi:[1,0,0]
  v_cvt_pk_bf16_f32 v201, v130, v131
  v_lshlrev_b32 v132, 16, v202
  v_and_b32 v133, s57, v202
  v_pk_fma_f32 v[132:133], v[132:133], v[30:31], v[28:29] op_sel_hi:[1,0,0]
  v_cvt_pk_bf16_f32 v202, v132, v133
  v_lshlrev_b32 v134, 16, v203
  v_and_b32 v135, s57, v203
  v_pk_fma_f32 v[134:135], v[134:135], v[30:31], v[28:29] op_sel_hi:[1,0,0]
  v_cvt_pk_bf16_f32 v203, v134, v135
  v_lshlrev_b32 v128, 16, v204
  v_and_b32 v129, s57, v204
  v_pk_fma_f32 v[128:129], v[128:129], v[30:31], v[28:29] op_sel_hi:[1,0,0]
  v_cvt_pk_bf16_f32 v204, v128, v129
  v_lshlrev_b32 v130, 16, v205
  v_and_b32 v131, s57, v205
  v_pk_fma_f32 v[130:131], v[130:131], v[30:31], v[28:29] op_sel_hi:[1,0,0]
  v_cvt_pk_bf16_f32 v205, v130, v131
  s_cmp_eq_u32 s55, 0
  s_cbranch_scc0 IF_14_else
  s_waitcnt vmcnt(0)
  v_cmp_ne_u32 vcc, s54, v93
  s_cbranch_vccz IF_13_else
  s_mov_b32 s58, 1048576
LP_12:
  s_sleep 2
  buffer_load_dword v93, v92, s[44:47], s11 offen sc1
  s_waitcnt vmcnt(0)
  v_cmp_ne_u32 vcc, s54, v93
  s_sub_u32 s58, s58, 1
  s_cselect_b64 vcc, 0, vcc
  s_cbranch_vccnz LP_12
IF_13_else:
  s_add_u32 s74, s73, 0
  s_mov_b32 m0, 0
  s_nop 0
  buffer_load_dwordx4 v33, s[44:47], s74 offen offset:0 sc1 lds
  s_mov_b32 m0, 0
  s_nop 0
  buffer_load_dwordx4 v33, s[44:47], s74 offen offset:1024 sc1 lds
  s_mov_b32 m0, 0
  s_nop 0
  buffer_load_dwordx4 v33, s[44:47], s74 offen offset:2048 sc1 lds
  s_mov_b32 m0, 0
  s_nop 0
  buffer_load_dwordx4 v33, s[44:47], s74 offen offset:3072 sc1 lds
  s_add_u32 s74, s73, 4096
  s_mov_b32 m0, 4096
  s_nop 0
  buffer_load_dwordx4 v33, s[44:47], s74 offen offset:0 sc1 lds
  s_mov_b32 m0, 4096
  s_nop 0
  buffer_load_dwordx4 v33, s[44:47], s74 offen offset:1024 sc1 lds
  s_mov_b32 m0, 4096
  s_nop 0
  buffer_load_dwordx4 v33, s[44:47], s74 offen offset:2048 sc1 lds
  s_mov_b32 m0, 4096
  s_nop 0
  buffer_load_dwordx4 v33, s[44:47], s74 offen offset:3072 sc1 lds
IF_14_else:
  v_lshlrev_b32 v132, 16, v206
  v_and_b32 v133, s57, v206
  v_pk_fma_f32 v[132:133], v[132:133], v[30:31], v[28:29] op_sel_hi:[1,0,0]
  v_cvt_pk_bf16_f32 v206, v132, v133
  v_lshlrev_b32 v134, 16, v207
  v_and_b32 v135, s57, v207
  v_pk_fma_f32 v[134:135], v[134:135], v[30:31], v[28:29] op_sel_hi:[1,0,0]
  v_cvt_pk_bf16_f32 v207, v134, v135
  v_lshlrev_b32 v128, 16, v208
  v_and_b32 v129, s57, v208
  v_pk_fma_f32 v[128:129], v[128:129], v[30:31], v[28:29] op_sel_hi:[1,0,0]
  v_cvt_pk_bf16_f32 v208, v128, v129
  v_lshlrev_b32 v130, 16, v209
  v_and_b32 v131, s57, v209
  v_pk_fma_f32 v[130:131], v[130:131], v[30:31], v[28:29] op_sel_hi:[1,0,0]
  v_cvt_pk_bf16_f32 v209, v130, v131
  v_lshlrev_b32 v132, 16, v210
  v_and_b32 v133, s57, v210
  v_pk_fma_f32 v[132:133], v[132:133], v[30:31], v[28:29] op_sel_hi:[1,0,0]
  v_cvt_pk_bf16_f32 v210, v132, v133
  v_lshlrev_b32 v134, 16, v211
  v_and_b32 v135, s57, v211
  v_pk_fma_f32 v[134:135], v[134:135], v[30:31], v[28:29] op_sel_hi:[1,0,0]
  v_cvt_pk_bf16_f32 v211, v134, v135
  s_cmp_eq_u32 s55, 1
  s_cbranch_scc0 IF_17_else
  s_waitcnt vmcnt(0)
  v_cmp_ne_u32 vcc, s54, v93
  s_cbranch_vccz IF_16_else
  s_mov_b32 s58, 1048576
LP_15:
  s_sleep 2
  buffer_load_dword v93, v92, s[44:47], s11 offen sc1
  s_waitcnt vmcnt(0)
  v_cmp_ne_u32 vcc, s54, v93
  s_sub_u32 s58, s58, 1
  s_cselect_b64 vcc, 0, vcc
  s_cbranch_vccnz LP_15
IF_16_else:
  s_add_u32 s74, s73, 8192
  s_mov_b32 m0, 8192
  s_nop 0
  buffer_load_dwordx4 v33, s[44:47], s74 offen offset:0 sc1 lds
  s_mov_b32 m0, 8192
  s_nop 0
  buffer_load_dwordx4 v33, s[44:47], s74 offen offset:1024 sc1 lds
  s_mov_b32 m0, 8192
  s_nop 0
  buffer_load_dwordx4 v33, s[44:47], s74 offen offset:2048 sc1 lds
  s_mov_b32 m0, 8192
  s_nop 0
  buffer_load_dwordx4 v33, s[44:47], s74 offen offset:3072 sc1 lds
  s_add_u32 s74, s73, 12288
  s_mov_b32 m0, 12288
  s_nop 0
  buffer_load_dwordx4 v33, s[44:47], s74 offen offset:0 sc1 lds
  s_mov_b32 m0, 12288
  s_nop 0
  buffer_load_dwordx4 v33, s[44:47], s74 offen offset:1024 sc1 lds
  s_mov_b32 m0, 12288
  s_nop 0
  buffer_load_dwordx4 v33, s[44:47], s74 offen offset:2048 sc1 lds
  s_mov_b32 m0, 12288
  s_nop 0
  buffer_load_dwordx4 v33, s[44:47], s74 offen offset:3072 sc1 lds
IF_17_else:
  v_lshlrev_b32 v128, 16, v212
  v_and_b32 v129, s57, v212
  v_pk_fma_f32 v[128:129], v[128:129], v[30:31], v[28:29] op_sel_hi:[1,0,0]
  v_cvt_pk_bf16_f32 v212, v128, v129
  v_lshlrev_b32 v130, 16, v213
  v_and_b32 v131, s57, v213
  v_pk_fma_f32 v[130:131], v[130:131], v[30:31], v[28:29] op_sel_hi:[1,0,0]
  v_cvt_pk_bf16_f32 v213, v130, v131
  v_lshlrev_b32 v132, 16, v214
  v_and_b32 v133, s57, v214
  v_pk_fma_f32 v[132:133], v[132:133], v[30:31], v[28:29] op_sel_hi:[1,0,0]
  v_cvt_pk_bf16_f32 v214, v132, v133
  v_lshlrev_b32 v134, 16, v215
  v_and_b32 v135, s57, v215
  v_pk_fma_f32 v[134:135], v[134:135], v[30:31], v[28:29] op_sel_hi:[1,0,0]
  v_cvt_pk_bf16_f32 v215, v134, v135
  v_lshlrev_b32 v128, 16, v216
  v_and_b32 v129, s57, v216
  v_pk_fma_f32 v[128:129], v[128:129], v[30:31], v[28:29] op_sel_hi:[1,0,0]
  v_cvt_pk_bf16_f32 v216, v128, v129
  v_lshlrev_b32 v130, 16, v217
  v_and_b32 v131, s57, v217
  v_pk_fma_f32 v[130:131], v[130:131], v[30:31], v[28:29] op_sel_hi:[1,0,0]
  v_cvt_pk_bf16_f32 v217, v130, v131
  s_cmp_eq_u32 s55, 2
  s_cbranch_scc0 IF_20_else
  s_waitcnt vmcnt(0)
  v_cmp_ne_u32 vcc, s54, v93
  s_cbranch_vccz IF_19_else
  s_mov_b32 s58, 1048576
LP_18:
  s_sleep 2
  buffer_load_dword v93, v92, s[44:47], s11 offen sc1
  s_waitcnt vmcnt(0)
  v_cmp_ne_u32 vcc, s54, v93
  s_sub_u32 s58, s58, 1
  s_cselect_b64 vcc, 0, vcc
  s_cbranch_vccnz LP_18
IF_19_else:
  s_add_u32 s74, s73, 81920
  s_mov_b32 m0, 98304
  s_nop 0
  buffer_load_dwordx4 v33, s[44:47], s74 offen offset:0 sc1 lds
  s_mov_b32 m0, 98304
  s_nop 0
  buffer_load_dwordx4 v33, s[44:47], s74 offen offset:1024 sc1 lds
  s_mov_b32 m0, 98304
  s_nop 0
  buffer_load_dwordx4 v33, s[44:47], s74 offen offset:2048 sc1 lds
  s_mov_b32 m0, 98304
  s_nop 0
  buffer_load_dwordx4 v33, s[44:47], s74 offen offset:3072 sc1 lds
  s_add_u32 s74, s73, 86016
  s_mov_b32 m0, 102400
  s_nop 0
  buffer_load_dwordx4 v33, s[44:47], s74 offen offset:0 sc1 lds
  s_mov_b32 m0, 102400
  s_nop 0
  buffer_load_dwordx4 v33, s[44:47], s74 offen offset:1024 sc1 lds
  s_mov_b32 m0, 102400
  s_nop 0
  buffer_load_dwordx4 v33, s[44:47], s74 offen offset:2048 sc1 lds
  s_mov_b32 m0, 102400
  s_nop 0
  buffer_load_dwordx4 v33, s[44:47], s74 offen offset:3072 sc1 lds
IF_20_else:
  v_lshlrev_b32 v132, 16, v218
  v_and_b32 v133, s57, v218
  v_pk_fma_f32 v[132:133], v[132:133], v[30:31], v[28:29] op_sel_hi:[1,0,0]
  v_cvt_pk_bf16_f32 v218, v132, v133
  v_lshlrev_b32 v134, 16, v219
  v_and_b32 v135, s57, v219
  v_pk_fma_f32 v[134:135], v[134:135], v[30:31], v[28:29] op_sel_hi:[1,0,0]
  v_cvt_pk_bf16_f32 v219, v134, v135
  v_lshlrev_b32 v128, 16, v220
  v_and_b32 v129, s57, v220
  v_pk_fma_f32 v[128:129], v[128:129], v[30:31], v[28:29] op_sel_hi:[1,0,0]
  v_cvt_pk_bf16_f32 v220, v128, v129
  v_lshlrev_b32 v130, 16, v221
  v_and_b32 v131, s57, v221
  v_pk_fma_f32 v[130:131], v[130:131], v[30:31], v[28:29] op_sel_hi:[1,0,0]
  v_cvt_pk_bf16_f32 v221, v130, v131
  v_lshlrev_b32 v132, 16, v222
  v_and_b32 v133, s57, v222
  v_pk_fma_f32 v[132:133], v[132:133], v[30:31], v[28:29] op_sel_hi:[1,0,0]
  v_cvt_pk_bf16_f32 v222, v132, v133
  v_lshlrev_b32 v134, 16, v223
  v_and_b32 v135, s57, v223
  v_pk_fma_f32 v[134:135], v[134:135], v[30:31], v[28:29] op_sel_hi:[1,0,0]
  v_cvt_pk_bf16_f32 v223, v134, v135
  s_cmp_eq_u32 s55, 3
  s_cbranch_scc0 IF_23_else
  s_waitcnt vmcnt(0)
  v_cmp_ne_u32 vcc, s54, v93
  s_cbranch_vccz IF_22_else
  s_mov_b32 s58, 1048576
LP_21:
  s_sleep 2
  buffer_load_dword v93, v92, s[44:47], s11 offen sc1
  s_waitcnt vmcnt(0)
  v_cmp_ne_u32 vcc, s54, v93
  s_sub_u32 s58, s58, 1
  s_cselect_b64 vcc, 0, vcc
  s_cbranch_vccnz LP_21
IF_22_else:
  s_add_u32 s74, s73, 90112
  s_mov_b32 m0, 106496
  s_nop 0
  buffer_load_dwordx4 v33, s[44:47], s74 offen offset:0 sc1 lds
  s_mov_b32 m0, 106496
  s_nop 0
  buffer_load_dwordx4 v33, s[44:47], s74 offen offset:1024 sc1 lds
  s_mov_b32 m0, 106496
  s_nop 0
  buffer_load_dwordx4 v33, s[44:47], s74 offen offset:2048 sc1 lds
  s_mov_b32 m0, 106496
  s_nop 0
  buffer_load_dwordx4 v33, s[44:47], s74 offen offset:3072 sc1 lds
  s_add_u32 s74, s73, 94208
  s_mov_b32 m0, 110592
  s_nop 0
  buffer_load_dwordx4 v33, s[44:47], s74 offen offset:0 sc1 lds
  s_mov_b32 m0, 110592
  s_nop 0
  buffer_load_dwordx4 v33, s[44:47], s74 offen offset:1024 sc1 lds
  s_mov_b32 m0, 110592
  s_nop 0
  buffer_load_dwordx4 v33, s[44:47], s74 offen offset:2048 sc1 lds
  s_mov_b32 m0, 110592
  s_nop 0
  buffer_load_dwordx4 v33, s[44:47], s74 offen offset:3072 sc1 lds
IF_23_else:
  v_lshlrev_b32 v128, 16, v224
  v_and_b32 v129, s57, v224
  v_pk_fma_f32 v[128:129], v[128:129], v[30:31], v[28:29] op_sel_hi:[1,0,0]
  v_cvt_pk_bf16_f32 v224, v128, v129
  v_lshlrev_b32 v130, 16, v225
  v_and_b32 v131, s57, v225
  v_pk_fma_f32 v[130:131], v[130:131], v[30:31], v[28:29] op_sel_hi:[1,0,0]
  v_cvt_pk_bf16_f32 v225, v130, v131
  s_mov_b32 s8, 4096
  buffer_load_dwordx4 v[64:67], v84, s[44:47], s8 offen offset:0 sc1
  buffer_load_dwordx4 v[68:71], v84, s[44:47], s8 offen offset:512 sc1
  buffer_load_dwordx4 v[72:75], v84, s[44:47], s8 offen offset:1024 sc1
  buffer_load_dwordx4 v[76:79], v84, s[44:47], s8 offen offset:1536 sc1
  buffer_load_dword v80, v82, s[44:47], s10 offen sc1
  buffer_load_dword v81, v83, s[44:47], s10 offen sc1
  v_lshlrev_b32 v132, 16, v226
  v_and_b32 v133, s57, v226
  v_pk_fma_f32 v[132:133], v[132:133], v[30:31], v[28:29] op_sel_hi:[1,0,0]
  v_cvt_pk_bf16_f32 v226, v132, v133
  v_lshlrev_b32 v134, 16, v227
  v_and_b32 v135, s57, v227
  v_pk_fma_f32 v[134:135], v[134:135], v[30:31], v[28:29] op_sel_hi:[1,0,0]
  v_cvt_pk_bf16_f32 v227, v134, v135
  v_lshlrev_b32 v128, 16, v228
  v_and_b32 v129, s57, v228
  v_pk_fma_f32 v[128:129], v[128:129], v[30:31], v[28:29] op_sel_hi:[1,0,0]
  v_cvt_pk_bf16_f32 v228, v128, v129
  v_lshlrev_b32 v130, 16, v229
  v_and_b32 v131, s57, v229
  v_pk_fma_f32 v[130:131], v[130:131], v[30:31], v[28:29] op_sel_hi:[1,0,0]
  v_cvt_pk_bf16_f32 v229, v130, v131
  s_cmp_eq_u32 s55, 4
  s_cbranch_scc0 IF_26_else
  s_waitcnt vmcnt(6)
  v_cmp_ne_u32 vcc, s54, v93
  s_cbranch_vccz IF_25_else
  s_mov_b32 s58, 1048576
LP_24:
  s_sleep 2
  buffer_load_dword v93, v92, s[44:47], s11 offen sc1
  s_waitcnt vmcnt(0)
  v_cmp_ne_u32 vcc, s54, v93
  s_sub_u32 s58, s58, 1
  s_cselect_b64 vcc, 0, vcc
  s_cbranch_vccnz LP_24
IF_25_else:
  s_add_u32 s74, s73, 16384
  s_mov_b32 m0, 16384
  s_nop 0
  buffer_load_dwordx4 v33, s[44:47], s74 offen offset:0 sc1 lds
  s_mov_b32 m0, 16384
  s_nop 0
  buffer_load_dwordx4 v33, s[44:47], s74 offen offset:1024 sc1 lds
  s_mov_b32 m0, 16384
  s_nop 0
  buffer_load_dwordx4 v33, s[44:47], s74 offen offset:2048 sc1 lds
  s_mov_b32 m0, 16384
  s_nop 0
  buffer_load_dwordx4 v33, s[44:47], s74 offen offset:3072 sc1 lds
  s_add_u32 s74, s73, 20480
  s_mov_b32 m0, 20480
  s_nop 0
  buffer_load_dwordx4 v33, s[44:47], s74 offen offset:0 sc1 lds
  s_mov_b32 m0, 20480
  s_nop 0
  buffer_load_dwordx4 v33, s[44:47], s74 offen offset:1024 sc1 lds
  s_mov_b32 m0, 20480
  s_nop 0
  buffer_load_dwordx4 v33, s[44:47], s74 offen offset:2048 sc1 lds
  s_mov_b32 m0, 20480
  s_nop 0
  buffer_load_dwordx4 v33, s[44:47], s74 offen offset:3072 sc1 lds
IF_26_else:
  v_lshlrev_b32 v132, 16, v230
  v_and_b32 v133, s57, v230
  v_pk_fma_f32 v[132:133], v[132:133], v[30:31], v[28:29] op_sel_hi:[1,0,0]
  v_cvt_pk_bf16_f32 v230, v132, v133
  v_lshlrev_b32 v134, 16, v231
  v_and_b32 v135, s57, v231
  v_pk_fma_f32 v[134:135], v[134:135], v[30:31], v[28:29] op_sel_hi:[1,0,0]
  v_cvt_pk_bf16_f32 v231, v134, v135
  v_lshlrev_b32 v128, 16, v232
  v_and_b32 v129, s57, v232
  v_pk_fma_f32 v[128:129], v[128:129], v[30:31], v[28:29] op_sel_hi:[1,0,0]
  v_cvt_pk_bf16_f32 v232, v128, v129
  v_lshlrev_b32 v130, 16, v233
  v_and_b32 v131, s57, v233
  v_pk_fma_f32 v[130:131], v[130:131], v[30:31], v[28:29] op_sel_hi:[1,0,0]
  v_cvt_pk_bf16_f32 v233, v130, v131
  v_lshlrev_b32 v132, 16, v234
  v_and_b32 v133, s57, v234
  v_pk_fma_f32 v[132:133], v[132:133], v[30:31], v[28:29] op_sel_hi:[1,0,0]
  v_cvt_pk_bf16_f32 v234, v132, v133
  v_lshlrev_b32 v134, 16, v235
  v_and_b32 v135, s57, v235
  v_pk_fma_f32 v[134:135], v[134:135], v[30:31], v[28:29] op_sel_hi:[1,0,0]
  v_cvt_pk_bf16_f32 v235, v134, v135
  s_cmp_eq_u32 s55, 5
  s_cbranch_scc0 IF_29_else
  s_waitcnt vmcnt(6)
  v_cmp_ne_u32 vcc, s54, v93
  s_cbranch_vccz IF_28_else
  s_mov_b32 s58, 1048576
LP_27:
  s_sleep 2
  buffer_load_dword v93, v92, s[44:47], s11 offen sc1
  s_waitcnt vmcnt(0)
  v_cmp_ne_u32 vcc, s54, v93
  s_sub_u32 s58, s58, 1
  s_cselect_b64 vcc, 0, vcc
  s_cbranch_vccnz LP_27
IF_28_else:
  s_add_u32 s74, s73, 24576
  s_mov_b32 m0, 24576
  s_nop 0
  buffer_load_dwordx4 v33, s[44:47], s74 offen offset:0 sc1 lds
  s_mov_b32 m0, 24576
  s_nop 0
  buffer_load_dwordx4 v33, s[44:47], s74 offen offset:1024 sc1 lds
  s_mov_b32 m0, 24576
  s_nop 0
  buffer_load_dwordx4 v33, s[44:47], s74 offen offset:2048 sc1 lds
  s_mov_b32 m0, 24576
  s_nop 0
  buffer_load_dwordx4 v33, s[44:47], s74 offen offset:3072 sc1 lds
  s_add_u32 s74, s73, 28672
  s_mov_b32 m0, 28672
  s_nop 0
  buffer_load_dwordx4 v33, s[44:47], s74 offen offset:0 sc1 lds
  s_mov_b32 m0, 28672
  s_nop 0
  buffer_load_dwordx4 v33, s[44:47], s74 offen offset:1024 sc1 lds
  s_mov_b32 m0, 28672
  s_nop 0
  buffer_load_dwordx4 v33, s[44:47], s74 offen offset:2048 sc1 lds
  s_mov_b32 m0, 28672
  s_nop 0
  buffer_load_dwordx4 v33, s[44:47], s74 offen offset:3072 sc1 lds
IF_29_else:
  v_lshlrev_b32 v128, 16, v236
  v_and_b32 v129, s57, v236
  v_pk_fma_f32 v[128:129], v[128:129], v[30:31], v[28:29] op_sel_hi:[1,0,0]
  v_cvt_pk_bf16_f32 v236, v128, v129
  v_lshlrev_b32 v130, 16, v237
  v_and_b32 v131, s57, v237
  v_pk_fma_f32 v[130:131], v[130:131], v[30:31], v[28:29] op_sel_hi:[1,0,0]
  v_cvt_pk_bf16_f32 v237, v130, v131
  v_lshlrev_b32 v132, 16, v238
  v_and_b32 v133, s57, v238
  v_pk_fma_f32 v[132:133], v[132:133], v[30:31], v[28:29] op_sel_hi:[1,0,0]
  v_cvt_pk_bf16_f32 v238, v132, v133
  v_lshlrev_b32 v134, 16, v239
  v_and_b32 v135, s57, v239
  v_pk_fma_f32 v[134:135], v[134:135], v[30:31], v[28:29] op_sel_hi:[1,0,0]
  v_cvt_pk_bf16_f32 v239, v134, v135
  v_lshlrev_b32 v128, 16, v240
  v_and_b32 v129, s57, v240
  v_pk_fma_f32 v[128:129], v[128:129], v[30:31], v[28:29] op_sel_hi:[1,0,0]
  v_cvt_pk_bf16_f32 v240, v128, v129
  v_lshlrev_b32 v130, 16, v241
  v_and_b32 v131, s57, v241
  v_pk_fma_f32 v[130:131], v[130:131], v[30:31], v[28:29] op_sel_hi:[1,0,0]
  v_cvt_pk_bf16_f32 v241, v130, v131
  s_cmp_eq_u32 s55, 6
  s_cbranch_scc0 IF_32_else
  s_waitcnt vmcnt(6)
  v_cmp_ne_u32 vcc, s54, v93
  s_cbranch_vccz IF_31_else
  s_mov_b32 s58, 1048576
LP_30:
  s_sleep 2
  buffer_load_dword v93, v92, s[44:47], s11 offen sc1
  s_waitcnt vmcnt(0)
  v_cmp_ne_u32 vcc, s54, v93
  s_sub_u32 s58, s58, 1
  s_cselect_b64 vcc, 0, vcc
  s_cbranch_vccnz LP_30
IF_31_else:
  s_add_u32 s74, s73, 98304
  s_mov_b32 m0, 114688
  s_nop 0
  buffer_load_dwordx4 v33, s[44:47], s74 offen offset:0 sc1 lds
  s_mov_b32 m0, 114688
  s_nop 0
  buffer_load_dwordx4 v33, s[44:47], s74 offen offset:1024 sc1 lds
  s_mov_b32 m0, 114688
  s_nop 0
  buffer_load_dwordx4 v33, s[44:47], s74 offen offset:2048 sc1 lds
  s_mov_b32 m0, 114688
  s_nop 0
  buffer_load_dwordx4 v33, s[44:47], s74 offen offset:3072 sc1 lds
  s_add_u32 s74, s73, 102400
  s_mov_b32 m0, 118784
  s_nop 0
  buffer_load_dwordx4 v33, s[44:47], s74 offen offset:0 sc1 lds
  s_mov_b32 m0, 118784
  s_nop 0
  buffer_load_dwordx4 v33, s[44:47], s74 offen offset:1024 sc1 lds
  s_mov_b32 m0, 118784
  s_nop 0
  buffer_load_dwordx4 v33, s[44:47], s74 offen offset:2048 sc1 lds
  s_mov_b32 m0, 118784
  s_nop 0
  buffer_load_dwordx4 v33, s[44:47], s74 offen offset:3072 sc1 lds
IF_32_else:
  v_lshlrev_b32 v132, 16, v242
  v_and_b32 v133, s57, v242
  v_pk_fma_f32 v[132:133], v[132:133], v[30:31], v[28:29] op_sel_hi:[1,0,0]
  v_cvt_pk_bf16_f32 v242, v132, v133
  v_lshlrev_b32 v134, 16, v243
  v_and_b32 v135, s57, v243
  v_pk_fma_f32 v[134:135], v[134:135], v[30:31], v[28:29] op_sel_hi:[1,0,0]
  v_cvt_pk_bf16_f32 v243, v134, v135
  v_lshlrev_b32 v128, 16, v244
  v_and_b32 v129, s57, v244
  v_pk_fma_f32 v[128:129], v[128:129], v[30:31], v[28:29] op_sel_hi:[1,0,0]
  v_cvt_pk_bf16_f32 v244, v128, v129
  v_lshlrev_b32 v130, 16, v245
  v_and_b32 v131, s57, v245
  v_pk_fma_f32 v[130:131], v[130:131], v[30:31], v[28:29] op_sel_hi:[1,0,0]
  v_cvt_pk_bf16_f32 v245, v130, v131
  v_lshlrev_b32 v132, 16, v246
  v_and_b32 v133, s57, v246
  v_pk_fma_f32 v[132:133], v[132:133], v[30:31], v[28:29] op_sel_hi:[1,0,0]
  v_cvt_pk_bf16_f32 v246, v132, v133
  v_lshlrev_b32 v134, 16, v247
  v_and_b32 v135, s57, v247
  v_pk_fma_f32 v[134:135], v[134:135], v[30:31], v[28:29] op_sel_hi:[1,0,0]
  v_cvt_pk_bf16_f32 v247, v134, v135
  s_cmp_eq_u32 s55, 7
  s_cbranch_scc0 IF_35_else
  s_waitcnt vmcnt(6)
  v_cmp_ne_u32 vcc, s54, v93
  s_cbranch_vccz IF_34_else
  s_mov_b32 s58, 1048576
LP_33:
  s_sleep 2
  buffer_load_dword v93, v92, s[44:47], s11 offen sc1
  s_waitcnt vmcnt(0)
  v_cmp_ne_u32 vcc, s54, v93
  s_sub_u32 s58, s58, 1
  s_cselect_b64 vcc, 0, vcc
  s_cbranch_vccnz LP_33
IF_34_else:
  s_add_u32 s74, s73, 106496
  s_mov_b32 m0, 122880
  s_nop 0
  buffer_load_dwordx4 v33, s[44:47], s74 offen offset:0 sc1 lds
  s_mov_b32 m0, 122880
  s_nop 0
  buffer_load_dwordx4 v33, s[44:47], s74 offen offset:1024 sc1 lds
  s_mov_b32 m0, 122880
  s_nop 0
  buffer_load_dwordx4 v33, s[44:47], s74 offen offset:2048 sc1 lds
  s_mov_b32 m0, 122880
  s_nop 0
  buffer_load_dwordx4 v33, s[44:47], s74 offen offset:3072 sc1 lds
  s_add_u32 s74, s73, 110592
  s_mov_b32 m0, 126976
  s_nop 0
  buffer_load_dwordx4 v33, s[44:47], s74 offen offset:0 sc1 lds
  s_mov_b32 m0, 126976
  s_nop 0
  buffer_load_dwordx4 v33, s[44:47], s74 offen offset:1024 sc1 lds
  s_mov_b32 m0, 126976
  s_nop 0
  buffer_load_dwordx4 v33, s[44:47], s74 offen offset:2048 sc1 lds
  s_mov_b32 m0, 126976
  s_nop 0
  buffer_load_dwordx4 v33, s[44:47], s74 offen offset:3072 sc1 lds
IF_35_else:
  v_lshlrev_b32 v128, 16, v248
  v_and_b32 v129, s57, v248
  v_pk_fma_f32 v[128:129], v[128:129], v[30:31], v[28:29] op_sel_hi:[1,0,0]
  v_cvt_pk_bf16_f32 v248, v128, v129
  v_lshlrev_b32 v130, 16, v249
  v_and_b32 v131, s57, v249
  v_pk_fma_f32 v[130:131], v[130:131], v[30:31], v[28:29] op_sel_hi:[1,0,0]
  v_cvt_pk_bf16_f32 v249, v130, v131
  v_lshlrev_b32 v132, 16, v250
  v_and_b32 v133, s57, v250
  v_pk_fma_f32 v[132:133], v[132:133], v[30:31], v[28:29] op_sel_hi:[1,0,0]
  v_cvt_pk_bf16_f32 v250, v132, v133
  v_lshlrev_b32 v134, 16, v251
  v_and_b32 v135, s57, v251
  v_pk_fma_f32 v[134:135], v[134:135], v[30:31], v[28:29] op_sel_hi:[1,0,0]
  v_cvt_pk_bf16_f32 v251, v134, v135
  v_lshlrev_b32 v128, 16, v252
  v_and_b32 v129, s57, v252
  v_pk_fma_f32 v[128:129], v[128:129], v[30:31], v[28:29] op_sel_hi:[1,0,0]
  v_cvt_pk_bf16_f32 v252, v128, v129
  v_lshlrev_b32 v130, 16, v253
  v_and_b32 v131, s57, v253
  v_pk_fma_f32 v[130:131], v[130:131], v[30:31], v[28:29] op_sel_hi:[1,0,0]
  v_cvt_pk_bf16_f32 v253, v130, v131
  v_lshlrev_b32 v132, 16, v254
  v_and_b32 v133, s57, v254
  v_pk_fma_f32 v[132:133], v[132:133], v[30:31], v[28:29] op_sel_hi:[1,0,0]
  v_cvt_pk_bf16_f32 v254, v132, v133
  v_lshlrev_b32 v134, 16, v255
  v_and_b32 v135, s57, v255
  v_pk_fma_f32 v[134:135], v[134:135], v[30:31], v[28:29] op_sel_hi:[1,0,0]
  v_cvt_pk_bf16_f32 v255, v134, v135
  s_waitcnt vmcnt(5)
  v_xor_b32 v88, s54, v67
  s_waitcnt vmcnt(4)
  v_xor_b32 v89, s54, v71
  s_waitcnt vmcnt(3)
  v_xor_b32 v90, s54, v75
  s_waitcnt vmcnt(2)
  v_xor_b32 v91, s54, v79
  v_or3_b32 v88, v88, v89, v90
  v_or_b32 v88, v88, v91
  s_waitcnt vmcnt(1)
  v_xor_b32 v89, s54, v80
  s_waitcnt vmcnt(0)
  v_xor_b32 v90, s54, v81
  v_or3_b32 v88, v88, v89, v90
  v_cmp_ne_u32 vcc, 0, v88
  s_cbranch_vccz IF_37_else
  s_mov_b32 s58, 1048576
LP_36:
  s_sleep 2
  s_mov_b32 s8, 4096
  buffer_load_dwordx4 v[64:67], v84, s[44:47], s8 offen offset:0 sc1
  buffer_load_dwordx4 v[68:71], v84, s[44:47], s8 offen offset:512 sc1
  buffer_load_dwordx4 v[72:75], v84, s[44:47], s8 offen offset:1024 sc1
  buffer_load_dwordx4 v[76:79], v84, s[44:47], s8 offen offset:1536 sc1
  buffer_load_dword v80, v82, s[44:47], s10 offen sc1
  buffer_load_dword v81, v83, s[44:47], s10 offen sc1
  s_waitcnt vmcnt(5)
  v_xor_b32 v88, s54, v67
  s_waitcnt vmcnt(4)
  v_xor_b32 v89, s54, v71
  s_waitcnt vmcnt(3)
  v_xor_b32 v90, s54, v75
  s_waitcnt vmcnt(2)
  v_xor_b32 v91, s54, v79
  v_or3_b32 v88, v88, v89, v90
  v_or_b32 v88, v88, v91
  s_waitcnt vmcnt(1)
  v_xor_b32 v89, s54, v80
  s_waitcnt vmcnt(0)
  v_xor_b32 v90, s54, v81
  v_or3_b32 v88, v88, v89, v90
  v_cmp_ne_u32 vcc, 0, v88
  s_sub_u32 s58, s58, 1
  s_cselect_b64 vcc, 0, vcc
  s_cbranch_vccnz LP_36
IF_37_else:
  v_add_f32 v64, v64, v68
  v_add_f32 v72, v72, v76
  v_add_f32 v65, v65, v69
  v_add_f32 v73, v73, v77
  v_add_f32 v66, v66, v70
  v_add_f32 v74, v74, v78
  v_add_f32 v64, v64, v72
  v_add_f32 v65, v65, v73
  v_add_f32 v66, v66, v74
  v_cvt_pk_bf16_f32 v68, v64, v65
  v_cvt_pk_bf16_f32 v69, v66, v66
  v_lshlrev_b32 v64, 16, v68
  v_and_b32 v65, s57, v68
  v_lshlrev_b32 v66, 16, v69
  v_add_f32 v64, v64, v87
  v_add_f32 v65, v65, v87
  v_add_f32 v66, v66, v87
  v_cvt_pk_bf16_f32 v68, v64, v65
  v_cvt_pk_bf16_f32 v69, v66, v66
  v_lshlrev_b32 v64, 16, v68
  v_and_b32 v65, s57, v68
  v_lshlrev_b32 v66, 16, v69
  ds_write_b32 v85, v64
  ds_write2_b32 v86, v65, v66 offset0:1 offset1:2
  s_cmp_lt_u32 s55, 4
  s_cbranch_scc0 IF_39_else
  s_cmp_lt_u32 s2, 160
  s_cbranch_scc0 IF_38_else
  s_branch IF_38_end
IF_38_else:
IF_38_end:
IF_39_else:
  s_waitcnt lgkmcnt(0)
  s_barrier
  ds_read_b32 v38, v22 offset:2560
  ds_read_b32 v39, v22 offset:2688
  ds_read_b32 v40, v22 offset:2816
  ds_read_b32 v41, v22 offset:2944
  ds_read_b32 v42, v22 offset:3072
  ds_read_b32 v43, v22 offset:3200
  ds_read_b32 v44, v22 offset:3328
  ds_read_b32 v45, v22 offset:3456
  ds_read_b32 v46, v22 offset:3584
  ds_read_b32 v47, v22 offset:3712
  ds_read_b128 v[64:67], v23 offset:0
  ds_read_b128 v[68:71], v23 offset:16
  ds_read_b128 v[80:83], v24 offset:0
  ds_read_b128 v[84:87], v24 offset:1024
  ds_read_b128 v[88:91], v24 offset:2048
  ds_read_b128 v[92:95], v24 offset:3072
  ds_read_b128 v[72:75], v23 offset:64
  ds_read_b128 v[76:79], v23 offset:80
  v_lshlrev_b32 v48, 16, v176
  v_and_b32 v49, s57, v176
  v_lshlrev_b32 v50, 16, v177
  v_and_b32 v51, s57, v177
  s_waitcnt lgkmcnt(7)
  v_fmac_f32_dpp v64, v38, v48 row_newbcast:0 row_mask:0xf bank_mask:0xf
  v_fmac_f32_dpp v65, v38, v49 row_newbcast:1 row_mask:0xf bank_mask:0xf
  v_lshlrev_b32 v52, 16, v178
  v_and_b32 v53, s57, v178
  v_fmac_f32_dpp v66, v38, v50 row_newbcast:2 row_mask:0xf bank_mask:0xf
  v_fmac_f32_dpp v67, v38, v51 row_newbcast:3 row_mask:0xf bank_mask:0xf
  v_lshlrev_b32 v54, 16, v179
  v_and_b32 v55, s57, v179
  v_cvt_pk_bf16_f32 v56, v64, v65
  s_waitcnt lgkmcnt(6)
  v_fmac_f32_dpp v68, v38, v52 row_newbcast:4 row_mask:0xf bank_mask:0xf
  v_fmac_f32_dpp v69, v38, v53 row_newbcast:5 row_mask:0xf bank_mask:0xf
  v_cvt_pk_bf16_f32 v57, v66, v67
  v_fmac_f32_dpp v70, v38, v54 row_newbcast:6 row_mask:0xf bank_mask:0xf
  v_fmac_f32_dpp v71, v38, v55 row_newbcast:7 row_mask:0xf bank_mask:0xf
  v_cvt_pk_bf16_f32 v58, v68, v69
  v_cvt_pk_bf16_f32 v59, v70, v71
  s_cmp_eq_u32 s55, 4
  s_cbranch_scc0 IF_40_else
  s_add_u32 s74, s73, 32768
  s_mov_b32 m0, 32768
  s_nop 0
  buffer_load_dwordx4 v33, s[44:47], s74 offen offset:0 sc1 lds
  s_mov_b32 m0, 32768
  s_nop 0
  buffer_load_dwordx4 v33, s[44:47], s74 offen offset:1024 sc1 lds
  s_mov_b32 m0, 32768
  s_nop 0
  buffer_load_dwordx4 v33, s[44:47], s74 offen offset:2048 sc1 lds
  s_mov_b32 m0, 32768
  s_nop 0
  buffer_load_dwordx4 v33, s[44:47], s74 offen offset:3072 sc1 lds
  s_add_u32 s74, s73, 36864
  s_mov_b32 m0, 36864
  s_nop 0
  buffer_load_dwordx4 v33, s[44:47], s74 offen offset:0 sc1 lds
  s_mov_b32 m0, 36864
  s_nop 0
  buffer_load_dwordx4 v33, s[44:47], s74 offen offset:1024 sc1 lds
  s_mov_b32 m0, 36864
  s_nop 0
  buffer_load_dwordx4 v33, s[44:47], s74 offen offset:2048 sc1 lds
  s_mov_b32 m0, 36864
  s_nop 0
  buffer_load_dwordx4 v33, s[44:47], s74 offen offset:3072 sc1 lds
IF_40_else:
  s_waitcnt lgkmcnt(5)
  v_mfma_f32_32x32x16_bf16 v[112:127], v[80:83], v[56:59], 0
  ds_read_b128 v[64:67], v23 offset:128
  ds_read_b128 v[68:71], v23 offset:144
  ds_read_b128 v[96:99], v24 offset:4096
  ds_read_b128 v[100:103], v24 offset:5120
  v_lshlrev_b32 v48, 16, v180
  v_and_b32 v49, s57, v180
  v_lshlrev_b32 v50, 16, v181
  s_waitcnt lgkmcnt(8)
  v_mfma_f32_32x32x16_bf16 v[128:143], v[84:87], v[56:59], 0
  ds_read_b128 v[104:107], v24 offset:6144
  ds_read_b128 v[108:111], v24 offset:7168
  v_and_b32 v51, s57, v181
  s_waitcnt lgkmcnt(7)
  v_fmac_f32_dpp v72, v38, v48 row_newbcast:8 row_mask:0xf bank_mask:0xf
  v_fmac_f32_dpp v73, v38, v49 row_newbcast:9 row_mask:0xf bank_mask:0xf
  v_lshlrev_b32 v52, 16, v182
  v_and_b32 v53, s57, v182
  v_mfma_f32_32x32x16_bf16 v[144:159], v[88:91], v[56:59], 0
  v_fmac_f32_dpp v74, v38, v50 row_newbcast:10 row_mask:0xf bank_mask:0xf
  v_fmac_f32_dpp v75, v38, v51 row_newbcast:11 row_mask:0xf bank_mask:0xf
  v_lshlrev_b32 v54, 16, v183
  v_and_b32 v55, s57, v183
  v_cvt_pk_bf16_f32 v60, v72, v73
  s_waitcnt lgkmcnt(6)
  v_fmac_f32_dpp v76, v38, v52 row_newbcast:12 row_mask:0xf bank_mask:0xf
  v_mfma_f32_32x32x16_bf16 v[160:175], v[92:95], v[56:59], 0
  v_fmac_f32_dpp v77, v38, v53 row_newbcast:13 row_mask:0xf bank_mask:0xf
  v_cvt_pk_bf16_f32 v61, v74, v75
  v_fmac_f32_dpp v78, v38, v54 row_newbcast:14 row_mask:0xf bank_mask:0xf
  v_fmac_f32_dpp v79, v38, v55 row_newbcast:15 row_mask:0xf bank_mask:0xf
  v_cvt_pk_bf16_f32 v62, v76, v77
  v_cvt_pk_bf16_f32 v63, v78, v79
  s_cmp_eq_u32 s55, 5
  s_cbranch_scc0 IF_41_else
  s_add_u32 s74, s73, 40960
  s_mov_b32 m0, 40960
  s_nop 0
  buffer_load_dwordx4 v33, s[44:47], s74 offen offset:0 sc1 lds
  s_mov_b32 m0, 40960
  s_nop 0
  buffer_load_dwordx4 v33, s[44:47], s74 offen offset:1024 sc1 lds
  s_mov_b32 m0, 40960
  s_nop 0
  buffer_load_dwordx4 v33, s[44:47], s74 offen offset:2048 sc1 lds
  s_mov_b32 m0, 40960
  s_nop 0
  buffer_load_dwordx4 v33, s[44:47], s74 offen offset:3072 sc1 lds
  s_add_u32 s74, s73, 45056
  s_mov_b32 m0, 45056
  s_nop 0
  buffer_load_dwordx4 v33, s[44:47], s74 offen offset:0 sc1 lds
  s_mov_b32 m0, 45056
  s_nop 0
  buffer_load_dwordx4 v33, s[44:47], s74 offen offset:1024 sc1 lds
  s_mov_b32 m0, 45056
  s_nop 0
  buffer_load_dwordx4 v33, s[44:47], s74 offen offset:2048 sc1 lds
  s_mov_b32 m0, 45056
  s_nop 0
  buffer_load_dwordx4 v33, s[44:47], s74 offen offset:3072 sc1 lds
IF_41_else:
  v_bfe_u32 v20, v1, 2, 1
  v_mul_u32_u24 v20, 20480, v20
  v_bfe_u32 v21, v1, 3, 2
  v_lshl_add_u32 v20, v21, 6, v20
  v_and_b32 v21, 3, v1
  v_lshl_add_u32 v20, v21, 4, v20
  v_lshrrev_b32 v21, 5, v1
  v_lshl_add_u32 v31, v21, 8, v20
  v_lshl_or_b32 v20, v21, 31, v20
  s_lshl_b32 s63, s50, 2
  s_add_u32 s63, s63, s59
  s_mul_i32 s63, s63, 40960
  s_mul_i32 s3, s51, 1280
  s_add_u32 s63, s63, s3
  s_add_u32 s63, s63, 8257536
  s_mul_i32 s3, s60, 768
  s_add_u32 s3, s3, s63
  buffer_store_dwordx4 v[24:27], v31, s[44:47], s3 offen sc1
  buffer_store_dwordx4 v[24:27], v20, s[44:47], s63 offen offset:512 sc1
  s_lshl_b32 s3, s50, 4
  s_add_u32 s3, s3, s51
  s_lshl_b32 s3, s3, 3
  s_add_u32 s3, s3, s55
  s_lshl_b32 s63, s3, 7
  s_add_u32 s63, s63, 131072
  v_not_b32 v21, s54
  v_lshlrev_b32 v22, 26, v1
  v_and_b32 v22, 2147483648, v22
  v_lshl_or_b32 v22, v1, 2, v22
  buffer_store_dword v21, v22, s[44:47], s63 offen sc1
  s_waitcnt lgkmcnt(3)
  v_mfma_f32_32x32x16_bf16 v[112:127], v[96:99], v[60:63], v[112:127]
  ds_read_b128 v[72:75], v23 offset:192
  ds_read_b128 v[76:79], v23 offset:208
  ds_read_b128 v[80:83], v24 offset:8192
  ds_read_b128 v[84:87], v24 offset:9216
  v_lshlrev_b32 v48, 16, v184
  v_and_b32 v49, s57, v184
  v_lshlrev_b32 v50, 16, v185
  s_waitcnt lgkmcnt(6)
  v_mfma_f32_32x32x16_bf16 v[128:143], v[100:103], v[60:63], v[128:143]
  ds_read_b128 v[88:91], v24 offset:10240
  ds_read_b128 v[92:95], v24 offset:11264
  v_and_b32 v51, s57, v185
  v_fmac_f32_dpp v64, v39, v48 row_newbcast:0 row_mask:0xf bank_mask:0xf
  v_fmac_f32_dpp v65, v39, v49 row_newbcast:1 row_mask:0xf bank_mask:0xf
  v_lshlrev_b32 v52, 16, v186
  v_and_b32 v53, s57, v186
  s_waitcnt lgkmcnt(7)
  v_mfma_f32_32x32x16_bf16 v[144:159], v[104:107], v[60:63], v[144:159]
  v_fmac_f32_dpp v66, v39, v50 row_newbcast:2 row_mask:0xf bank_mask:0xf
  v_fmac_f32_dpp v67, v39, v51 row_newbcast:3 row_mask:0xf bank_mask:0xf
  v_lshlrev_b32 v54, 16, v187
  v_and_b32 v55, s57, v187
  v_cvt_pk_bf16_f32 v56, v64, v65
  v_fmac_f32_dpp v68, v39, v52 row_newbcast:4 row_mask:0xf bank_mask:0xf
  s_waitcnt lgkmcnt(6)
  v_mfma_f32_32x32x16_bf16 v[160:175], v[108:111], v[60:63], v[160:175]
  v_fmac_f32_dpp v69, v39, v53 row_newbcast:5 row_mask:0xf bank_mask:0xf
  v_cvt_pk_bf16_f32 v57, v66, v67
  v_fmac_f32_dpp v70, v39, v54 row_newbcast:6 row_mask:0xf bank_mask:0xf
  v_fmac_f32_dpp v71, v39, v55 row_newbcast:7 row_mask:0xf bank_mask:0xf
  v_cvt_pk_bf16_f32 v58, v68, v69
  v_cvt_pk_bf16_f32 v59, v70, v71
  s_cmp_eq_u32 s55, 6
  s_cbranch_scc0 IF_42_else
  s_add_u32 s74, s73, 114688
  s_mov_b32 m0, 131072
  s_nop 0
  buffer_load_dwordx4 v33, s[44:47], s74 offen offset:0 sc1 lds
  s_mov_b32 m0, 131072
  s_nop 0
  buffer_load_dwordx4 v33, s[44:47], s74 offen offset:1024 sc1 lds
  s_mov_b32 m0, 131072
  s_nop 0
  buffer_load_dwordx4 v33, s[44:47], s74 offen offset:2048 sc1 lds
  s_mov_b32 m0, 131072
  s_nop 0
  buffer_load_dwordx4 v33, s[44:47], s74 offen offset:3072 sc1 lds
  s_add_u32 s74, s73, 118784
  s_mov_b32 m0, 135168
  s_nop 0
  buffer_load_dwordx4 v33, s[44:47], s74 offen offset:0 sc1 lds
  s_mov_b32 m0, 135168
  s_nop 0
  buffer_load_dwordx4 v33, s[44:47], s74 offen offset:1024 sc1 lds
  s_mov_b32 m0, 135168
  s_nop 0
  buffer_load_dwordx4 v33, s[44:47], s74 offen offset:2048 sc1 lds
  s_mov_b32 m0, 135168
  s_nop 0
  buffer_load_dwordx4 v33, s[44:47], s74 offen offset:3072 sc1 lds
IF_42_else:
  s_waitcnt lgkmcnt(3)
  v_mfma_f32_32x32x16_bf16 v[112:127], v[80:83], v[56:59], v[112:127]
  ds_read_b128 v[64:67], v23 offset:256
  ds_read_b128 v[68:71], v23 offset:272
  ds_read_b128 v[96:99], v24 offset:12288
  ds_read_b128 v[100:103], v24 offset:13312
  v_lshlrev_b32 v48, 16, v188
  v_and_b32 v49, s57, v188
  v_lshlrev_b32 v50, 16, v189
  s_waitcnt lgkmcnt(6)
  v_mfma_f32_32x32x16_bf16 v[128:143], v[84:87], v[56:59], v[128:143]
  ds_read_b128 v[104:107], v24 offset:14336
  ds_read_b128 v[108:111], v24 offset:15360
  v_and_b32 v51, s57, v189
  v_fmac_f32_dpp v72, v39, v48 row_newbcast:8 row_mask:0xf bank_mask:0xf
  v_fmac_f32_dpp v73, v39, v49 row_newbcast:9 row_mask:0xf bank_mask:0xf
  v_lshlrev_b32 v52, 16, v190
  v_and_b32 v53, s57, v190
  s_waitcnt lgkmcnt(7)
  v_mfma_f32_32x32x16_bf16 v[144:159], v[88:91], v[56:59], v[144:159]
  v_fmac_f32_dpp v74, v39, v50 row_newbcast:10 row_mask:0xf bank_mask:0xf
  v_fmac_f32_dpp v75, v39, v51 row_newbcast:11 row_mask:0xf bank_mask:0xf
  v_lshlrev_b32 v54, 16, v191
  v_and_b32 v55, s57, v191
  v_cvt_pk_bf16_f32 v60, v72, v73
  v_fmac_f32_dpp v76, v39, v52 row_newbcast:12 row_mask:0xf bank_mask:0xf
  s_waitcnt lgkmcnt(6)
  v_mfma_f32_32x32x16_bf16 v[160:175], v[92:95], v[56:59], v[160:175]
  v_fmac_f32_dpp v77, v39, v53 row_newbcast:13 row_mask:0xf bank_mask:0xf
  v_cvt_pk_bf16_f32 v61, v74, v75
  v_fmac_f32_dpp v78, v39, v54 row_newbcast:14 row_mask:0xf bank_mask:0xf
  v_fmac_f32_dpp v79, v39, v55 row_newbcast:15 row_mask:0xf bank_mask:0xf
  v_cvt_pk_bf16_f32 v62, v76, v77
  v_cvt_pk_bf16_f32 v63, v78, v79
  s_cmp_eq_u32 s55, 7
  s_cbranch_scc0 IF_44_else
  s_cmp_lt_u32 s2, 160
  s_cbranch_scc0 IF_43_else
  s_branch IF_43_end
IF_43_else:
IF_43_end:
IF_44_else:
  s_bitcmp1_b32 0x70, s55
  s_cbranch_scc0 IF_46_else
  s_cmp_lt_u32 s2, 160
  s_cbranch_scc0 IF_45_else
  s_branch IF_45_end
IF_45_else:
IF_45_end:
IF_46_else:
  s_barrier
  s_cmp_eq_u32 s55, 7
  s_cbranch_scc0 IF_47_else
  s_add_u32 s74, s73, 122880
  s_mov_b32 m0, 139264
  s_nop 0
  buffer_load_dwordx4 v33, s[44:47], s74 offen offset:0 sc1 lds
  s_mov_b32 m0, 139264
  s_nop 0
  buffer_load_dwordx4 v33, s[44:47], s74 offen offset:1024 sc1 lds
  s_mov_b32 m0, 139264
  s_nop 0
  buffer_load_dwordx4 v33, s[44:47], s74 offen offset:2048 sc1 lds
  s_mov_b32 m0, 139264
  s_nop 0
  buffer_load_dwordx4 v33, s[44:47], s74 offen offset:3072 sc1 lds
  s_add_u32 s74, s73, 126976
  s_mov_b32 m0, 143360
  s_nop 0
  buffer_load_dwordx4 v33, s[44:47], s74 offen offset:0 sc1 lds
  s_mov_b32 m0, 143360
  s_nop 0
  buffer_load_dwordx4 v33, s[44:47], s74 offen offset:1024 sc1 lds
  s_mov_b32 m0, 143360
  s_nop 0
  buffer_load_dwordx4 v33, s[44:47], s74 offen offset:2048 sc1 lds
  s_mov_b32 m0, 143360
  s_nop 0
  buffer_load_dwordx4 v33, s[44:47], s74 offen offset:3072 sc1 lds
IF_47_else:
  s_waitcnt lgkmcnt(3)
  v_mfma_f32_32x32x16_bf16 v[112:127], v[96:99], v[60:63], v[112:127]
  ds_read_b128 v[72:75], v23 offset:320
  ds_read_b128 v[76:79], v23 offset:336
  v_add_u32 v24, s76, v24
  ds_read_b128 v[80:83], v24 offset:0
  ds_read_b128 v[84:87], v24 offset:1024
  v_lshlrev_b32 v48, 16, v192
  v_and_b32 v49, s57, v192
  v_lshlrev_b32 v50, 16, v193
  s_waitcnt lgkmcnt(6)
  v_mfma_f32_32x32x16_bf16 v[128:143], v[100:103], v[60:63], v[128:143]
  ds_read_b128 v[88:91], v24 offset:2048
  ds_read_b128 v[92:95], v24 offset:3072
  v_and_b32 v51, s57, v193
  v_fmac_f32_dpp v64, v40, v48 row_newbcast:0 row_mask:0xf bank_mask:0xf
  v_fmac_f32_dpp v65, v40, v49 row_newbcast:1 row_mask:0xf bank_mask:0xf
  v_lshlrev_b32 v52, 16, v194
  v_and_b32 v53, s57, v194
  s_waitcnt lgkmcnt(7)
  v_mfma_f32_32x32x16_bf16 v[144:159], v[104:107], v[60:63], v[144:159]
  v_fmac_f32_dpp v66, v40, v50 row_newbcast:2 row_mask:0xf bank_mask:0xf
  v_fmac_f32_dpp v67, v40, v51 row_newbcast:3 row_mask:0xf bank_mask:0xf
  v_lshlrev_b32 v54, 16, v195
  v_and_b32 v55, s57, v195
  v_cvt_pk_bf16_f32 v56, v64, v65
  v_fmac_f32_dpp v68, v40, v52 row_newbcast:4 row_mask:0xf bank_mask:0xf
  s_waitcnt lgkmcnt(6)
  v_mfma_f32_32x32x16_bf16 v[160:175], v[108:111], v[60:63], v[160:175]
  v_fmac_f32_dpp v69, v40, v53 row_newbcast:5 row_mask:0xf bank_mask:0xf
  v_cvt_pk_bf16_f32 v57, v66, v67
  v_fmac_f32_dpp v70, v40, v54 row_newbcast:6 row_mask:0xf bank_mask:0xf
  v_fmac_f32_dpp v71, v40, v55 row_newbcast:7 row_mask:0xf bank_mask:0xf
  v_cvt_pk_bf16_f32 v58, v68, v69
  v_cvt_pk_bf16_f32 v59, v70, v71
  s_cmp_eq_u32 s55, 0
  s_cbranch_scc0 IF_48_else
  s_add_u32 s74, s73, 49152
  s_mov_b32 m0, 49152
  s_nop 0
  buffer_load_dwordx4 v33, s[44:47], s74 offen offset:0 sc1 lds
  s_mov_b32 m0, 49152
  s_nop 0
  buffer_load_dwordx4 v33, s[44:47], s74 offen offset:1024 sc1 lds
  s_mov_b32 m0, 49152
  s_nop 0
  buffer_load_dwordx4 v33, s[44:47], s74 offen offset:2048 sc1 lds
  s_mov_b32 m0, 49152
  s_nop 0
  buffer_load_dwordx4 v33, s[44:47], s74 offen offset:3072 sc1 lds
  s_add_u32 s74, s73, 53248
  s_mov_b32 m0, 53248
  s_nop 0
  buffer_load_dwordx4 v33, s[44:47], s74 offen offset:0 sc1 lds
  s_mov_b32 m0, 53248
  s_nop 0
  buffer_load_dwordx4 v33, s[44:47], s74 offen offset:1024 sc1 lds
  s_mov_b32 m0, 53248
  s_nop 0
  buffer_load_dwordx4 v33, s[44:47], s74 offen offset:2048 sc1 lds
  s_mov_b32 m0, 53248
  s_nop 0
  buffer_load_dwordx4 v33, s[44:47], s74 offen offset:3072 sc1 lds
IF_48_else:
  s_waitcnt lgkmcnt(3)
  v_mfma_f32_32x32x16_bf16 v[112:127], v[80:83], v[56:59], v[112:127]
  ds_read_b128 v[64:67], v23 offset:384
  ds_read_b128 v[68:71], v23 offset:400
  ds_read_b128 v[96:99], v24 offset:4096
  ds_read_b128 v[100:103], v24 offset:5120
  v_lshlrev_b32 v48, 16, v196
  v_and_b32 v49, s57, v196
  v_lshlrev_b32 v50, 16, v197
  s_waitcnt lgkmcnt(6)
  v_mfma_f32_32x32x16_bf16 v[128:143], v[84:87], v[56:59], v[128:143]
  ds_read_b128 v[104:107], v24 offset:6144
  ds_read_b128 v[108:111], v24 offset:7168
  v_and_b32 v51, s57, v197
  v_fmac_f32_dpp v72, v40, v48 row_newbcast:8 row_mask:0xf bank_mask:0xf
  v_fmac_f32_dpp v73, v40, v49 row_newbcast:9 row_mask:0xf bank_mask:0xf
  v_lshlrev_b32 v52, 16, v198
  v_and_b32 v53, s57, v198
  s_waitcnt lgkmcnt(7)
  v_mfma_f32_32x32x16_bf16 v[144:159], v[88:91], v[56:59], v[144:159]
  v_fmac_f32_dpp v74, v40, v50 row_newbcast:10 row_mask:0xf bank_mask:0xf
  v_fmac_f32_dpp v75, v40, v51 row_newbcast:11 row_mask:0xf bank_mask:0xf
  v_lshlrev_b32 v54, 16, v199
  v_and_b32 v55, s57, v199
  v_cvt_pk_bf16_f32 v60, v72, v73
  v_fmac_f32_dpp v76, v40, v52 row_newbcast:12 row_mask:0xf bank_mask:0xf
  s_waitcnt lgkmcnt(6)
  v_mfma_f32_32x32x16_bf16 v[160:175], v[92:95], v[56:59], v[160:175]
  v_fmac_f32_dpp v77, v40, v53 row_newbcast:13 row_mask:0xf bank_mask:0xf
  v_cvt_pk_bf16_f32 v61, v74, v75
  v_fmac_f32_dpp v78, v40, v54 row_newbcast:14 row_mask:0xf bank_mask:0xf
  v_fmac_f32_dpp v79, v40, v55 row_newbcast:15 row_mask:0xf bank_mask:0xf
  v_cvt_pk_bf16_f32 v62, v76, v77
  v_cvt_pk_bf16_f32 v63, v78, v79
  s_cmp_eq_u32 s55, 1
  s_cbranch_scc0 IF_49_else
  s_add_u32 s74, s73, 57344
  s_mov_b32 m0, 57344
  s_nop 0
  buffer_load_dwordx4 v33, s[44:47], s74 offen offset:0 sc1 lds
  s_mov_b32 m0, 57344
  s_nop 0
  buffer_load_dwordx4 v33, s[44:47], s74 offen offset:1024 sc1 lds
  s_mov_b32 m0, 57344
  s_nop 0
  buffer_load_dwordx4 v33, s[44:47], s74 offen offset:2048 sc1 lds
  s_mov_b32 m0, 57344
  s_nop 0
  buffer_load_dwordx4 v33, s[44:47], s74 offen offset:3072 sc1 lds
  s_add_u32 s74, s73, 61440
  s_mov_b32 m0, 61440
  s_nop 0
  buffer_load_dwordx4 v33, s[44:47], s74 offen offset:0 sc1 lds
  s_mov_b32 m0, 61440
  s_nop 0
  buffer_load_dwordx4 v33, s[44:47], s74 offen offset:1024 sc1 lds
  s_mov_b32 m0, 61440
  s_nop 0
  buffer_load_dwordx4 v33, s[44:47], s74 offen offset:2048 sc1 lds
  s_mov_b32 m0, 61440
  s_nop 0
  buffer_load_dwordx4 v33, s[44:47], s74 offen offset:3072 sc1 lds
IF_49_else:
  s_waitcnt lgkmcnt(3)
  v_mfma_f32_32x32x16_bf16 v[112:127], v[96:99], v[60:63], v[112:127]
  ds_read_b128 v[72:75], v23 offset:448
  ds_read_b128 v[76:79], v23 offset:464
  ds_read_b128 v[80:83], v24 offset:8192
  ds_read_b128 v[84:87], v24 offset:9216
  v_lshlrev_b32 v48, 16, v200
  v_and_b32 v49, s57, v200
  v_lshlrev_b32 v50, 16, v201
  s_waitcnt lgkmcnt(6)
  v_mfma_f32_32x32x16_bf16 v[128:143], v[100:103], v[60:63], v[128:143]
  ds_read_b128 v[88:91], v24 offset:10240
  ds_read_b128 v[92:95], v24 offset:11264
  v_and_b32 v51, s57, v201
  v_fmac_f32_dpp v64, v41, v48 row_newbcast:0 row_mask:0xf bank_mask:0xf
  v_fmac_f32_dpp v65, v41, v49 row_newbcast:1 row_mask:0xf bank_mask:0xf
  v_lshlrev_b32 v52, 16, v202
  v_and_b32 v53, s57, v202
  s_waitcnt lgkmcnt(7)
  v_mfma_f32_32x32x16_bf16 v[144:159], v[104:107], v[60:63], v[144:159]
  v_fmac_f32_dpp v66, v41, v50 row_newbcast:2 row_mask:0xf bank_mask:0xf
  v_fmac_f32_dpp v67, v41, v51 row_newbcast:3 row_mask:0xf bank_mask:0xf
  v_lshlrev_b32 v54, 16, v203
  v_and_b32 v55, s57, v203
  v_cvt_pk_bf16_f32 v56, v64, v65
  v_fmac_f32_dpp v68, v41, v52 row_newbcast:4 row_mask:0xf bank_mask:0xf
  s_waitcnt lgkmcnt(6)
  v_mfma_f32_32x32x16_bf16 v[160:175], v[108:111], v[60:63], v[160:175]
  v_fmac_f32_dpp v69, v41, v53 row_newbcast:5 row_mask:0xf bank_mask:0xf
  v_cvt_pk_bf16_f32 v57, v66, v67
  v_fmac_f32_dpp v70, v41, v54 row_newbcast:6 row_mask:0xf bank_mask:0xf
  v_fmac_f32_dpp v71, v41, v55 row_newbcast:7 row_mask:0xf bank_mask:0xf
  v_cvt_pk_bf16_f32 v58, v68, v69
  v_cvt_pk_bf16_f32 v59, v70, v71
  s_cmp_eq_u32 s55, 2
  s_cbranch_scc0 IF_50_else
  s_add_u32 s74, s73, 131072
  s_mov_b32 m0, 81920
  s_nop 0
  buffer_load_dwordx4 v33, s[44:47], s74 offen offset:0 sc1 lds
  s_mov_b32 m0, 81920
  s_nop 0
  buffer_load_dwordx4 v33, s[44:47], s74 offen offset:1024 sc1 lds
  s_mov_b32 m0, 81920
  s_nop 0
  buffer_load_dwordx4 v33, s[44:47], s74 offen offset:2048 sc1 lds
  s_mov_b32 m0, 81920
  s_nop 0
  buffer_load_dwordx4 v33, s[44:47], s74 offen offset:3072 sc1 lds
  s_add_u32 s74, s73, 135168
  s_mov_b32 m0, 86016
  s_nop 0
  buffer_load_dwordx4 v33, s[44:47], s74 offen offset:0 sc1 lds
  s_mov_b32 m0, 86016
  s_nop 0
  buffer_load_dwordx4 v33, s[44:47], s74 offen offset:1024 sc1 lds
  s_mov_b32 m0, 86016
  s_nop 0
  buffer_load_dwordx4 v33, s[44:47], s74 offen offset:2048 sc1 lds
  s_mov_b32 m0, 86016
  s_nop 0
  buffer_load_dwordx4 v33, s[44:47], s74 offen offset:3072 sc1 lds
IF_50_else:
  s_waitcnt lgkmcnt(3)
  v_mfma_f32_32x32x16_bf16 v[112:127], v[80:83], v[56:59], v[112:127]
  ds_read_b128 v[64:67], v23 offset:512
  ds_read_b128 v[68:71], v23 offset:528
  ds_read_b128 v[96:99], v24 offset:12288
  ds_read_b128 v[100:103], v24 offset:13312
  v_lshlrev_b32 v48, 16, v204
  v_and_b32 v49, s57, v204
  v_lshlrev_b32 v50, 16, v205
  s_waitcnt lgkmcnt(6)
  v_mfma_f32_32x32x16_bf16 v[128:143], v[84:87], v[56:59], v[128:143]
  ds_read_b128 v[104:107], v24 offset:14336
  ds_read_b128 v[108:111], v24 offset:15360
  v_and_b32 v51, s57, v205
  v_fmac_f32_dpp v72, v41, v48 row_newbcast:8 row_mask:0xf bank_mask:0xf
  v_fmac_f32_dpp v73, v41, v49 row_newbcast:9 row_mask:0xf bank_mask:0xf
  v_lshlrev_b32 v52, 16, v206
  v_and_b32 v53, s57, v206
  s_waitcnt lgkmcnt(7)
  v_mfma_f32_32x32x16_bf16 v[144:159], v[88:91], v[56:59], v[144:159]
  v_fmac_f32_dpp v74, v41, v50 row_newbcast:10 row_mask:0xf bank_mask:0xf
  v_fmac_f32_dpp v75, v41, v51 row_newbcast:11 row_mask:0xf bank_mask:0xf
  v_lshlrev_b32 v54, 16, v207
  v_and_b32 v55, s57, v207
  v_cvt_pk_bf16_f32 v60, v72, v73
  v_fmac_f32_dpp v76, v41, v52 row_newbcast:12 row_mask:0xf bank_mask:0xf
  s_waitcnt lgkmcnt(6)
  v_mfma_f32_32x32x16_bf16 v[160:175], v[92:95], v[56:59], v[160:175]
  v_fmac_f32_dpp v77, v41, v53 row_newbcast:13 row_mask:0xf bank_mask:0xf
  v_cvt_pk_bf16_f32 v61, v74, v75
  v_fmac_f32_dpp v78, v41, v54 row_newbcast:14 row_mask:0xf bank_mask:0xf
  v_fmac_f32_dpp v79, v41, v55 row_newbcast:15 row_mask:0xf bank_mask:0xf
  v_cvt_pk_bf16_f32 v62, v76, v77
  v_cvt_pk_bf16_f32 v63, v78, v79
  s_cmp_lt_u32 s55, 4
  s_cbranch_scc1 IF_51_end
  s_waitcnt vmcnt(0)
IF_51_end:
  s_barrier
  s_cmp_eq_u32 s55, 3
  s_cbranch_scc0 IF_52_else
  s_add_u32 s74, s73, 139264
  s_mov_b32 m0, 90112
  s_nop 0
  buffer_load_dwordx4 v33, s[44:47], s74 offen offset:0 sc1 lds
  s_mov_b32 m0, 90112
  s_nop 0
  buffer_load_dwordx4 v33, s[44:47], s74 offen offset:1024 sc1 lds
  s_mov_b32 m0, 90112
  s_nop 0
  buffer_load_dwordx4 v33, s[44:47], s74 offen offset:2048 sc1 lds
  s_mov_b32 m0, 90112
  s_nop 0
  buffer_load_dwordx4 v33, s[44:47], s74 offen offset:3072 sc1 lds
  s_add_u32 s74, s73, 143360
  s_mov_b32 m0, 94208
  s_nop 0
  buffer_load_dwordx4 v33, s[44:47], s74 offen offset:0 sc1 lds
  s_mov_b32 m0, 94208
  s_nop 0
  buffer_load_dwordx4 v33, s[44:47], s74 offen offset:1024 sc1 lds
  s_mov_b32 m0, 94208
  s_nop 0
  buffer_load_dwordx4 v33, s[44:47], s74 offen offset:2048 sc1 lds
  s_mov_b32 m0, 94208
  s_nop 0
  buffer_load_dwordx4 v33, s[44:47], s74 offen offset:3072 sc1 lds
IF_52_else:
  s_waitcnt lgkmcnt(3)
  v_mfma_f32_32x32x16_bf16 v[112:127], v[96:99], v[60:63], v[112:127]
  ds_read_b128 v[72:75], v23 offset:576
  ds_read_b128 v[76:79], v23 offset:592
  v_add_u32 v24, s77, v24
  ds_read_b128 v[80:83], v24 offset:0
  ds_read_b128 v[84:87], v24 offset:1024
  v_lshlrev_b32 v48, 16, v208
  v_and_b32 v49, s57, v208
  v_lshlrev_b32 v50, 16, v209
  s_waitcnt lgkmcnt(6)
  v_mfma_f32_32x32x16_bf16 v[128:143], v[100:103], v[60:63], v[128:143]
  ds_read_b128 v[88:91], v24 offset:2048
  ds_read_b128 v[92:95], v24 offset:3072
  v_and_b32 v51, s57, v209
  v_fmac_f32_dpp v64, v42, v48 row_newbcast:0 row_mask:0xf bank_mask:0xf
  v_fmac_f32_dpp v65, v42, v49 row_newbcast:1 row_mask:0xf bank_mask:0xf
  v_lshlrev_b32 v52, 16, v210
  v_and_b32 v53, s57, v210
  s_waitcnt lgkmcnt(7)
  v_mfma_f32_32x32x16_bf16 v[144:159], v[104:107], v[60:63], v[144:159]
  v_fmac_f32_dpp v66, v42, v50 row_newbcast:2 row_mask:0xf bank_mask:0xf
  v_fmac_f32_dpp v67, v42, v51 row_newbcast:3 row_mask:0xf bank_mask:0xf
  v_lshlrev_b32 v54, 16, v211
  v_and_b32 v55, s57, v211
  v_cvt_pk_bf16_f32 v56, v64, v65
  v_fmac_f32_dpp v68, v42, v52 row_newbcast:4 row_mask:0xf bank_mask:0xf
  s_waitcnt lgkmcnt(6)
  v_mfma_f32_32x32x16_bf16 v[160:175], v[108:111], v[60:63], v[160:175]
  v_fmac_f32_dpp v69, v42, v53 row_newbcast:5 row_mask:0xf bank_mask:0xf
  v_cvt_pk_bf16_f32 v57, v66, v67
  v_fmac_f32_dpp v70, v42, v54 row_newbcast:6 row_mask:0xf bank_mask:0xf
  v_fmac_f32_dpp v71, v42, v55 row_newbcast:7 row_mask:0xf bank_mask:0xf
  v_cvt_pk_bf16_f32 v58, v68, v69
  v_cvt_pk_bf16_f32 v59, v70, v71
  s_cmp_eq_u32 s55, 4
  s_cbranch_scc0 IF_53_else
  s_add_u32 s74, s73, 65536
  s_mov_b32 m0, 65536
  s_nop 0
  buffer_load_dwordx4 v33, s[44:47], s74 offen offset:0 sc1 lds
  s_mov_b32 m0, 65536
  s_nop 0
  buffer_load_dwordx4 v33, s[44:47], s74 offen offset:1024 sc1 lds
  s_mov_b32 m0, 65536
  s_nop 0
  buffer_load_dwordx4 v33, s[44:47], s74 offen offset:2048 sc1 lds
  s_mov_b32 m0, 65536
  s_nop 0
  buffer_load_dwordx4 v33, s[44:47], s74 offen offset:3072 sc1 lds
  s_add_u32 s74, s73, 69632
  s_mov_b32 m0, 69632
  s_nop 0
  buffer_load_dwordx4 v33, s[44:47], s74 offen offset:0 sc1 lds
  s_mov_b32 m0, 69632
  s_nop 0
  buffer_load_dwordx4 v33, s[44:47], s74 offen offset:1024 sc1 lds
  s_mov_b32 m0, 69632
  s_nop 0
  buffer_load_dwordx4 v33, s[44:47], s74 offen offset:2048 sc1 lds
  s_mov_b32 m0, 69632
  s_nop 0
  buffer_load_dwordx4 v33, s[44:47], s74 offen offset:3072 sc1 lds
IF_53_else:
  s_waitcnt lgkmcnt(3)
  v_mfma_f32_32x32x16_bf16 v[112:127], v[80:83], v[56:59], v[112:127]
  ds_read_b128 v[64:67], v23 offset:640
  ds_read_b128 v[68:71], v23 offset:656
  ds_read_b128 v[96:99], v24 offset:4096
  ds_read_b128 v[100:103], v24 offset:5120
  v_lshlrev_b32 v48, 16, v212
  v_and_b32 v49, s57, v212
  v_lshlrev_b32 v50, 16, v213
  s_waitcnt lgkmcnt(6)
  v_mfma_f32_32x32x16_bf16 v[128:143], v[84:87], v[56:59], v[128:143]
  ds_read_b128 v[104:107], v24 offset:6144
  ds_read_b128 v[108:111], v24 offset:7168
  v_and_b32 v51, s57, v213
  v_fmac_f32_dpp v72, v42, v48 row_newbcast:8 row_mask:0xf bank_mask:0xf
  v_fmac_f32_dpp v73, v42, v49 row_newbcast:9 row_mask:0xf bank_mask:0xf
  v_lshlrev_b32 v52, 16, v214
  v_and_b32 v53, s57, v214
  s_waitcnt lgkmcnt(7)
  v_mfma_f32_32x32x16_bf16 v[144:159], v[88:91], v[56:59], v[144:159]
  v_fmac_f32_dpp v74, v42, v50 row_newbcast:10 row_mask:0xf bank_mask:0xf
  v_fmac_f32_dpp v75, v42, v51 row_newbcast:11 row_mask:0xf bank_mask:0xf
  v_lshlrev_b32 v54, 16, v215
  v_and_b32 v55, s57, v215
  v_cvt_pk_bf16_f32 v60, v72, v73
  v_fmac_f32_dpp v76, v42, v52 row_newbcast:12 row_mask:0xf bank_mask:0xf
  s_waitcnt lgkmcnt(6)
  v_mfma_f32_32x32x16_bf16 v[160:175], v[92:95], v[56:59], v[160:175]
  v_fmac_f32_dpp v77, v42, v53 row_newbcast:13 row_mask:0xf bank_mask:0xf
  v_cvt_pk_bf16_f32 v61, v74, v75
  v_fmac_f32_dpp v78, v42, v54 row_newbcast:14 row_mask:0xf bank_mask:0xf
  v_fmac_f32_dpp v79, v42, v55 row_newbcast:15 row_mask:0xf bank_mask:0xf
  v_cvt_pk_bf16_f32 v62, v76, v77
  v_cvt_pk_bf16_f32 v63, v78, v79
  s_cmp_eq_u32 s55, 5
  s_cbranch_scc0 IF_54_else
  s_add_u32 s74, s73, 73728
  s_mov_b32 m0, 73728
  s_nop 0
  buffer_load_dwordx4 v33, s[44:47], s74 offen offset:0 sc1 lds
  s_mov_b32 m0, 73728
  s_nop 0
  buffer_load_dwordx4 v33, s[44:47], s74 offen offset:1024 sc1 lds
  s_mov_b32 m0, 73728
  s_nop 0
  buffer_load_dwordx4 v33, s[44:47], s74 offen offset:2048 sc1 lds
  s_mov_b32 m0, 73728
  s_nop 0
  buffer_load_dwordx4 v33, s[44:47], s74 offen offset:3072 sc1 lds
  s_add_u32 s74, s73, 77824
  s_mov_b32 m0, 77824
  s_nop 0
  buffer_load_dwordx4 v33, s[44:47], s74 offen offset:0 sc1 lds
  s_mov_b32 m0, 77824
  s_nop 0
  buffer_load_dwordx4 v33, s[44:47], s74 offen offset:1024 sc1 lds
  s_mov_b32 m0, 77824
  s_nop 0
  buffer_load_dwordx4 v33, s[44:47], s74 offen offset:2048 sc1 lds
  s_mov_b32 m0, 77824
  s_nop 0
  buffer_load_dwordx4 v33, s[44:47], s74 offen offset:3072 sc1 lds
IF_54_else:
  v_and_b32 v32, 31, v1
  v_lshlrev_b32 v32, 10, v32
  s_lshl_b32 s8, s48, 7
  s_add_u32 s8, s8, 1703936
  buffer_load_dwordx2 v[34:35], v32, s[44:47], s8 offen sc1
  s_waitcnt lgkmcnt(3)
  v_mfma_f32_32x32x16_bf16 v[112:127], v[96:99], v[60:63], v[112:127]
  ds_read_b128 v[72:75], v23 offset:704
  ds_read_b128 v[76:79], v23 offset:720
  ds_read_b128 v[80:83], v24 offset:8192
  ds_read_b128 v[84:87], v24 offset:9216
  v_lshlrev_b32 v48, 16, v216
  v_and_b32 v49, s57, v216
  v_lshlrev_b32 v50, 16, v217
  s_waitcnt lgkmcnt(6)
  v_mfma_f32_32x32x16_bf16 v[128:143], v[100:103], v[60:63], v[128:143]
  ds_read_b128 v[88:91], v24 offset:10240
  ds_read_b128 v[92:95], v24 offset:11264
  v_and_b32 v51, s57, v217
  v_fmac_f32_dpp v64, v43, v48 row_newbcast:0 row_mask:0xf bank_mask:0xf
  v_fmac_f32_dpp v65, v43, v49 row_newbcast:1 row_mask:0xf bank_mask:0xf
  v_lshlrev_b32 v52, 16, v218
  v_and_b32 v53, s57, v218
  s_waitcnt lgkmcnt(7)
  v_mfma_f32_32x32x16_bf16 v[144:159], v[104:107], v[60:63], v[144:159]
  v_fmac_f32_dpp v66, v43, v50 row_newbcast:2 row_mask:0xf bank_mask:0xf
  v_fmac_f32_dpp v67, v43, v51 row_newbcast:3 row_mask:0xf bank_mask:0xf
  v_lshlrev_b32 v54, 16, v219
  v_and_b32 v55, s57, v219
  v_cvt_pk_bf16_f32 v56, v64, v65
  v_fmac_f32_dpp v68, v43, v52 row_newbcast:4 row_mask:0xf bank_mask:0xf
  s_waitcnt lgkmcnt(6)
  v_mfma_f32_32x32x16_bf16 v[160:175], v[108:111], v[60:63], v[160:175]
  v_fmac_f32_dpp v69, v43, v53 row_newbcast:5 row_mask:0xf bank_mask:0xf
  v_cvt_pk_bf16_f32 v57, v66, v67
  v_fmac_f32_dpp v70, v43, v54 row_newbcast:6 row_mask:0xf bank_mask:0xf
  v_fmac_f32_dpp v71, v43, v55 row_newbcast:7 row_mask:0xf bank_mask:0xf
  v_cvt_pk_bf16_f32 v58, v68, v69
  v_cvt_pk_bf16_f32 v59, v70, v71
  s_cmp_eq_u32 s55, 6
  s_cbranch_scc0 IF_55_else
  s_add_u32 s74, s73, 147456
  s_mov_b32 m0, 98304
  s_nop 0
  buffer_load_dwordx4 v33, s[44:47], s74 offen offset:0 sc1 lds
  s_mov_b32 m0, 98304
  s_nop 0
  buffer_load_dwordx4 v33, s[44:47], s74 offen offset:1024 sc1 lds
  s_mov_b32 m0, 98304
  s_nop 0
  buffer_load_dwordx4 v33, s[44:47], s74 offen offset:2048 sc1 lds
  s_mov_b32 m0, 98304
  s_nop 0
  buffer_load_dwordx4 v33, s[44:47], s74 offen offset:3072 sc1 lds
  s_add_u32 s74, s73, 151552
  s_mov_b32 m0, 102400
  s_nop 0
  buffer_load_dwordx4 v33, s[44:47], s74 offen offset:0 sc1 lds
  s_mov_b32 m0, 102400
  s_nop 0
  buffer_load_dwordx4 v33, s[44:47], s74 offen offset:1024 sc1 lds
  s_mov_b32 m0, 102400
  s_nop 0
  buffer_load_dwordx4 v33, s[44:47], s74 offen offset:2048 sc1 lds
  s_mov_b32 m0, 102400
  s_nop 0
  buffer_load_dwordx4 v33, s[44:47], s74 offen offset:3072 sc1 lds
IF_55_else:
  s_waitcnt lgkmcnt(3)
  v_mfma_f32_32x32x16_bf16 v[112:127], v[80:83], v[56:59], v[112:127]
  ds_read_b128 v[64:67], v23 offset:768
  ds_read_b128 v[68:71], v23 offset:784
  ds_read_b128 v[96:99], v24 offset:12288
  ds_read_b128 v[100:103], v24 offset:13312
  v_lshlrev_b32 v48, 16, v220
  v_and_b32 v49, s57, v220
  v_lshlrev_b32 v50, 16, v221
  s_waitcnt lgkmcnt(6)
  v_mfma_f32_32x32x16_bf16 v[128:143], v[84:87], v[56:59], v[128:143]
  ds_read_b128 v[104:107], v24 offset:14336
  ds_read_b128 v[108:111], v24 offset:15360
  v_and_b32 v51, s57, v221
  v_fmac_f32_dpp v72, v43, v48 row_newbcast:8 row_mask:0xf bank_mask:0xf
  v_fmac_f32_dpp v73, v43, v49 row_newbcast:9 row_mask:0xf bank_mask:0xf
  v_lshlrev_b32 v52, 16, v222
  v_and_b32 v53, s57, v222
  s_waitcnt lgkmcnt(7)
  v_mfma_f32_32x32x16_bf16 v[144:159], v[88:91], v[56:59], v[144:159]
  v_fmac_f32_dpp v74, v43, v50 row_newbcast:10 row_mask:0xf bank_mask:0xf
  v_fmac_f32_dpp v75, v43, v51 row_newbcast:11 row_mask:0xf bank_mask:0xf
  v_lshlrev_b32 v54, 16, v223
  v_and_b32 v55, s57, v223
  v_cvt_pk_bf16_f32 v60, v72, v73
  v_fmac_f32_dpp v76, v43, v52 row_newbcast:12 row_mask:0xf bank_mask:0xf
  s_waitcnt lgkmcnt(6)
  v_mfma_f32_32x32x16_bf16 v[160:175], v[92:95], v[56:59], v[160:175]
  v_fmac_f32_dpp v77, v43, v53 row_newbcast:13 row_mask:0xf bank_mask:0xf
  v_cvt_pk_bf16_f32 v61, v74, v75
  v_fmac_f32_dpp v78, v43, v54 row_newbcast:14 row_mask:0xf bank_mask:0xf
  v_fmac_f32_dpp v79, v43, v55 row_newbcast:15 row_mask:0xf bank_mask:0xf
  v_cvt_pk_bf16_f32 v62, v76, v77
  v_cvt_pk_bf16_f32 v63, v78, v79
  s_cmp_lt_u32 s55, 4
  s_cbranch_scc0 IF_56_else
  s_waitcnt vmcnt(1)
IF_56_else:
  s_barrier
  s_cmp_eq_u32 s55, 7
  s_cbranch_scc0 IF_57_else
  s_add_u32 s74, s73, 155648
  s_mov_b32 m0, 106496
  s_nop 0
  buffer_load_dwordx4 v33, s[44:47], s74 offen offset:0 sc1 lds
  s_mov_b32 m0, 106496
  s_nop 0
  buffer_load_dwordx4 v33, s[44:47], s74 offen offset:1024 sc1 lds
  s_mov_b32 m0, 106496
  s_nop 0
  buffer_load_dwordx4 v33, s[44:47], s74 offen offset:2048 sc1 lds
  s_mov_b32 m0, 106496
  s_nop 0
  buffer_load_dwordx4 v33, s[44:47], s74 offen offset:3072 sc1 lds
  s_add_u32 s74, s73, 159744
  s_mov_b32 m0, 110592
  s_nop 0
  buffer_load_dwordx4 v33, s[44:47], s74 offen offset:0 sc1 lds
  s_mov_b32 m0, 110592
  s_nop 0
  buffer_load_dwordx4 v33, s[44:47], s74 offen offset:1024 sc1 lds
  s_mov_b32 m0, 110592
  s_nop 0
  buffer_load_dwordx4 v33, s[44:47], s74 offen offset:2048 sc1 lds
  s_mov_b32 m0, 110592
  s_nop 0
  buffer_load_dwordx4 v33, s[44:47], s74 offen offset:3072 sc1 lds
IF_57_else:
  s_waitcnt lgkmcnt(3)
  v_mfma_f32_32x32x16_bf16 v[112:127], v[96:99], v[60:63], v[112:127]
  ds_read_b128 v[72:75], v23 offset:832
  ds_read_b128 v[76:79], v23 offset:848
  v_add_u32 v24, s78, v24
  ds_read_b128 v[80:83], v24 offset:0
  ds_read_b128 v[84:87], v24 offset:1024
  v_lshlrev_b32 v48, 16, v224
  v_and_b32 v49, s57, v224
  v_lshlrev_b32 v50, 16, v225
  s_waitcnt lgkmcnt(6)
  v_mfma_f32_32x32x16_bf16 v[128:143], v[100:103], v[60:63], v[128:143]
  ds_read_b128 v[88:91], v24 offset:2048
  ds_read_b128 v[92:95], v24 offset:3072
  v_and_b32 v51, s57, v225
  v_fmac_f32_dpp v64, v44, v48 row_newbcast:0 row_mask:0xf bank_mask:0xf
  v_fmac_f32_dpp v65, v44, v49 row_newbcast:1 row_mask:0xf bank_mask:0xf
  v_lshlrev_b32 v52, 16, v226
  v_and_b32 v53, s57, v226
  s_waitcnt lgkmcnt(7)
  v_mfma_f32_32x32x16_bf16 v[144:159], v[104:107], v[60:63], v[144:159]
  v_fmac_f32_dpp v66, v44, v50 row_newbcast:2 row_mask:0xf bank_mask:0xf
  v_fmac_f32_dpp v67, v44, v51 row_newbcast:3 row_mask:0xf bank_mask:0xf
  v_lshlrev_b32 v54, 16, v227
  v_and_b32 v55, s57, v227
  v_cvt_pk_bf16_f32 v56, v64, v65
  v_fmac_f32_dpp v68, v44, v52 row_newbcast:4 row_mask:0xf bank_mask:0xf
  s_waitcnt lgkmcnt(6)
  v_mfma_f32_32x32x16_bf16 v[160:175], v[108:111], v[60:63], v[160:175]
  v_fmac_f32_dpp v69, v44, v53 row_newbcast:5 row_mask:0xf bank_mask:0xf
  v_cvt_pk_bf16_f32 v57, v66, v67
  v_fmac_f32_dpp v70, v44, v54 row_newbcast:6 row_mask:0xf bank_mask:0xf
  v_fmac_f32_dpp v71, v44, v55 row_newbcast:7 row_mask:0xf bank_mask:0xf
  v_cvt_pk_bf16_f32 v58, v68, v69
  v_cvt_pk_bf16_f32 v59, v70, v71
  s_cmp_eq_u32 s55, 0
  s_cbranch_scc0 IF_58_else
  v_lshlrev_b32 v21, 7, v1
  v_cmp_gt_u32 vcc, 25, v1
  v_mov_b32 v20, 2147483648
  s_nop 0
  v_cndmask_b32 v21, v20, v21, vcc
  s_mov_b32 m0, 161536
  s_mul_i32 s63, s2, 3200
  buffer_load_dword v21, s[12:15], s63 offen  lds
IF_58_else:
  s_cmp_eq_u32 s55, 1
  s_cbranch_scc0 IF_59_else
  v_lshlrev_b32 v21, 7, v1
  v_cmp_gt_u32 vcc, 34, v1
  v_mov_b32 v20, 2147483648
  s_nop 0
  v_cndmask_b32 v21, v20, v21, vcc
  s_mov_b32 m0, 161536
  s_mul_i32 s63, s2, 4352
  buffer_load_dword v21, s[16:19], s63 offen  lds
IF_59_else:
  s_cmp_eq_u32 s55, 2
  s_cbranch_scc0 IF_60_else
  v_lshlrev_b32 v21, 7, v1
  v_cmp_gt_u32 vcc, 34, v1
  v_mov_b32 v20, 2147483648
  s_nop 0
  v_cndmask_b32 v21, v20, v21, vcc
  s_mov_b32 m0, 161536
  s_mul_i32 s63, s2, 4352
  s_add_u32 s63, s63, 1114112
  buffer_load_dword v21, s[16:19], s63 offen  lds
IF_60_else:
  s_waitcnt lgkmcnt(3)
  v_mfma_f32_32x32x16_bf16 v[112:127], v[80:83], v[56:59], v[112:127]
  ds_read_b128 v[64:67], v23 offset:896
  ds_read_b128 v[68:71], v23 offset:912
  ds_read_b128 v[96:99], v24 offset:4096
  ds_read_b128 v[100:103], v24 offset:5120
  v_lshlrev_b32 v48, 16, v228
  v_and_b32 v49, s57, v228
  v_lshlrev_b32 v50, 16, v229
  s_waitcnt lgkmcnt(6)
  v_mfma_f32_32x32x16_bf16 v[128:143], v[84:87], v[56:59], v[128:143]
  ds_read_b128 v[104:107], v24 offset:6144
  ds_read_b128 v[108:111], v24 offset:7168
  v_and_b32 v51, s57, v229
  v_fmac_f32_dpp v72, v44, v48 row_newbcast:8 row_mask:0xf bank_mask:0xf
  v_fmac_f32_dpp v73, v44, v49 row_newbcast:9 row_mask:0xf bank_mask:0xf
  v_lshlrev_b32 v52, 16, v230
  v_and_b32 v53, s57, v230
  s_waitcnt lgkmcnt(7)
  v_mfma_f32_32x32x16_bf16 v[144:159], v[88:91], v[56:59], v[144:159]
  v_fmac_f32_dpp v74, v44, v50 row_newbcast:10 row_mask:0xf bank_mask:0xf
  v_fmac_f32_dpp v75, v44, v51 row_newbcast:11 row_mask:0xf bank_mask:0xf
  v_lshlrev_b32 v54, 16, v231
  v_and_b32 v55, s57, v231
  v_cvt_pk_bf16_f32 v60, v72, v73
  v_fmac_f32_dpp v76, v44, v52 row_newbcast:12 row_mask:0xf bank_mask:0xf
  s_waitcnt lgkmcnt(6)
  v_mfma_f32_32x32x16_bf16 v[160:175], v[92:95], v[56:59], v[160:175]
  v_fmac_f32_dpp v77, v44, v53 row_newbcast:13 row_mask:0xf bank_mask:0xf
  v_cvt_pk_bf16_f32 v61, v74, v75
  v_fmac_f32_dpp v78, v44, v54 row_newbcast:14 row_mask:0xf bank_mask:0xf
  v_fmac_f32_dpp v79, v44, v55 row_newbcast:15 row_mask:0xf bank_mask:0xf
  v_cvt_pk_bf16_f32 v62, v76, v77
  v_cvt_pk_bf16_f32 v63, v78, v79
  s_cmp_eq_u32 s55, 0
  s_cbranch_scc0 IF_61_else
  s_lshl_b32 s3, s48, 5
  s_add_u32 s3, s3, s49
  s_lshl_b32 s3, s3, 2
  v_lshlrev_b32 v21, 7, v1
  s_mov_b32 m0, 161536
  s_mul_i32 s63, s3, 8192
  buffer_load_dword v21, s[20:23], s63 offen  lds
IF_61_else:
  s_waitcnt lgkmcnt(3)
  v_mfma_f32_32x32x16_bf16 v[112:127], v[96:99], v[60:63], v[112:127]
  ds_read_b128 v[72:75], v23 offset:960
  ds_read_b128 v[76:79], v23 offset:976
  ds_read_b128 v[80:83], v24 offset:8192
  ds_read_b128 v[84:87], v24 offset:9216
  v_lshlrev_b32 v48, 16, v232
  v_and_b32 v49, s57, v232
  v_lshlrev_b32 v50, 16, v233
  s_waitcnt lgkmcnt(6)
  v_mfma_f32_32x32x16_bf16 v[128:143], v[100:103], v[60:63], v[128:143]
  ds_read_b128 v[88:91], v24 offset:10240
  ds_read_b128 v[92:95], v24 offset:11264
  v_and_b32 v51, s57, v233
  v_fmac_f32_dpp v64, v45, v48 row_newbcast:0 row_mask:0xf bank_mask:0xf
  v_fmac_f32_dpp v65, v45, v49 row_newbcast:1 row_mask:0xf bank_mask:0xf
  v_lshlrev_b32 v52, 16, v234
  v_and_b32 v53, s57, v234
  s_waitcnt lgkmcnt(7)
  v_mfma_f32_32x32x16_bf16 v[144:159], v[104:107], v[60:63], v[144:159]
  v_fmac_f32_dpp v66, v45, v50 row_newbcast:2 row_mask:0xf bank_mask:0xf
  v_fmac_f32_dpp v67, v45, v51 row_newbcast:3 row_mask:0xf bank_mask:0xf
  v_lshlrev_b32 v54, 16, v235
  v_and_b32 v55, s57, v235
  v_cvt_pk_bf16_f32 v56, v64, v65
  v_fmac_f32_dpp v68, v45, v52 row_newbcast:4 row_mask:0xf bank_mask:0xf
  s_waitcnt lgkmcnt(6)
  v_mfma_f32_32x32x16_bf16 v[160:175], v[108:111], v[60:63], v[160:175]
  v_fmac_f32_dpp v69, v45, v53 row_newbcast:5 row_mask:0xf bank_mask:0xf
  v_cvt_pk_bf16_f32 v57, v66, v67
  v_fmac_f32_dpp v70, v45, v54 row_newbcast:6 row_mask:0xf bank_mask:0xf
  v_fmac_f32_dpp v71, v45, v55 row_newbcast:7 row_mask:0xf bank_mask:0xf
  v_cvt_pk_bf16_f32 v58, v68, v69
  v_cvt_pk_bf16_f32 v59, v70, v71
  s_waitcnt lgkmcnt(3)
  s_nop 0
  v_mfma_f32_32x32x16_bf16 v[112:127], v[80:83], v[56:59], v[112:127]
  ds_read_b128 v[64:67], v23 offset:1024
  ds_read_b128 v[68:71], v23 offset:1040
  ds_read_b128 v[96:99], v24 offset:12288
  ds_read_b128 v[100:103], v24 offset:13312
  v_lshlrev_b32 v48, 16, v236
  v_and_b32 v49, s57, v236
  v_lshlrev_b32 v50, 16, v237
  s_waitcnt lgkmcnt(6)
  v_mfma_f32_32x32x16_bf16 v[128:143], v[84:87], v[56:59], v[128:143]
  ds_read_b128 v[104:107], v24 offset:14336
  ds_read_b128 v[108:111], v24 offset:15360
  v_and_b32 v51, s57, v237
  v_fmac_f32_dpp v72, v45, v48 row_newbcast:8 row_mask:0xf bank_mask:0xf
  v_fmac_f32_dpp v73, v45, v49 row_newbcast:9 row_mask:0xf bank_mask:0xf
  v_lshlrev_b32 v52, 16, v238
  v_and_b32 v53, s57, v238
  s_waitcnt lgkmcnt(7)
  v_mfma_f32_32x32x16_bf16 v[144:159], v[88:91], v[56:59], v[144:159]
  v_fmac_f32_dpp v74, v45, v50 row_newbcast:10 row_mask:0xf bank_mask:0xf
  v_fmac_f32_dpp v75, v45, v51 row_newbcast:11 row_mask:0xf bank_mask:0xf
  v_lshlrev_b32 v54, 16, v239
  v_and_b32 v55, s57, v239
  v_cvt_pk_bf16_f32 v60, v72, v73
  v_fmac_f32_dpp v76, v45, v52 row_newbcast:12 row_mask:0xf bank_mask:0xf
  s_waitcnt lgkmcnt(6)
  v_mfma_f32_32x32x16_bf16 v[160:175], v[92:95], v[56:59], v[160:175]
  v_fmac_f32_dpp v77, v45, v53 row_newbcast:13 row_mask:0xf bank_mask:0xf
  v_cvt_pk_bf16_f32 v61, v74, v75
  v_fmac_f32_dpp v78, v45, v54 row_newbcast:14 row_mask:0xf bank_mask:0xf
  v_fmac_f32_dpp v79, v45, v55 row_newbcast:15 row_mask:0xf bank_mask:0xf
  v_cvt_pk_bf16_f32 v62, v76, v77
  v_cvt_pk_bf16_f32 v63, v78, v79
  s_cmp_lt_u32 s55, 4
  s_cbranch_scc1 IF_62_end
  s_waitcnt vmcnt(0)
IF_62_end:
  s_waitcnt lgkmcnt(0)
  s_barrier
  v_mfma_f32_32x32x16_bf16 v[112:127], v[96:99], v[60:63], v[112:127]
  ds_read_b128 v[72:75], v23 offset:1088
  ds_read_b128 v[76:79], v23 offset:1104
  v_add_u32 v24, s79, v24
  ds_read_b128 v[80:83], v24 offset:0
  ds_read_b128 v[84:87], v24 offset:1024
  v_lshlrev_b32 v48, 16, v240
  v_and_b32 v49, s57, v240
  v_lshlrev_b32 v50, 16, v241
  v_mfma_f32_32x32x16_bf16 v[128:143], v[100:103], v[60:63], v[128:143]
  ds_read_b128 v[88:91], v24 offset:2048
  ds_read_b128 v[92:95], v24 offset:3072
  v_and_b32 v51, s57, v241
  v_fmac_f32_dpp v64, v46, v48 row_newbcast:0 row_mask:0xf bank_mask:0xf
  v_fmac_f32_dpp v65, v46, v49 row_newbcast:1 row_mask:0xf bank_mask:0xf
  v_lshlrev_b32 v52, 16, v242
  v_and_b32 v53, s57, v242
  v_mfma_f32_32x32x16_bf16 v[144:159], v[104:107], v[60:63], v[144:159]
  v_fmac_f32_dpp v66, v46, v50 row_newbcast:2 row_mask:0xf bank_mask:0xf
  v_fmac_f32_dpp v67, v46, v51 row_newbcast:3 row_mask:0xf bank_mask:0xf
  v_lshlrev_b32 v54, 16, v243
  v_and_b32 v55, s57, v243
  v_cvt_pk_bf16_f32 v56, v64, v65
  v_fmac_f32_dpp v68, v46, v52 row_newbcast:4 row_mask:0xf bank_mask:0xf
  v_mfma_f32_32x32x16_bf16 v[160:175], v[108:111], v[60:63], v[160:175]
  v_fmac_f32_dpp v69, v46, v53 row_newbcast:5 row_mask:0xf bank_mask:0xf
  v_cvt_pk_bf16_f32 v57, v66, v67
  v_fmac_f32_dpp v70, v46, v54 row_newbcast:6 row_mask:0xf bank_mask:0xf
  v_fmac_f32_dpp v71, v46, v55 row_newbcast:7 row_mask:0xf bank_mask:0xf
  v_cvt_pk_bf16_f32 v58, v68, v69
  v_cvt_pk_bf16_f32 v59, v70, v71
  s_waitcnt lgkmcnt(3)
  s_nop 0
  v_mfma_f32_32x32x16_bf16 v[112:127], v[80:83], v[56:59], v[112:127]
  ds_read_b128 v[64:67], v23 offset:1152
  ds_read_b128 v[68:71], v23 offset:1168
  ds_read_b128 v[96:99], v24 offset:4096
  ds_read_b128 v[100:103], v24 offset:5120
  v_lshlrev_b32 v48, 16, v244
  v_and_b32 v49, s57, v244
  v_lshlrev_b32 v50, 16, v245
  s_waitcnt lgkmcnt(6)
  v_mfma_f32_32x32x16_bf16 v[128:143], v[84:87], v[56:59], v[128:143]
  ds_read_b128 v[104:107], v24 offset:6144
  ds_read_b128 v[108:111], v24 offset:7168
  v_and_b32 v51, s57, v245
  v_fmac_f32_dpp v72, v46, v48 row_newbcast:8 row_mask:0xf bank_mask:0xf
  v_fmac_f32_dpp v73, v46, v49 row_newbcast:9 row_mask:0xf bank_mask:0xf
  v_lshlrev_b32 v52, 16, v246
  v_and_b32 v53, s57, v246
  s_waitcnt lgkmcnt(7)
  v_mfma_f32_32x32x16_bf16 v[144:159], v[88:91], v[56:59], v[144:159]
  v_fmac_f32_dpp v74, v46, v50 row_newbcast:10 row_mask:0xf bank_mask:0xf
  v_fmac_f32_dpp v75, v46, v51 row_newbcast:11 row_mask:0xf bank_mask:0xf
  v_lshlrev_b32 v54, 16, v247
  v_and_b32 v55, s57, v247
  v_cvt_pk_bf16_f32 v60, v72, v73
  v_fmac_f32_dpp v76, v46, v52 row_newbcast:12 row_mask:0xf bank_mask:0xf
  s_waitcnt lgkmcnt(6)
  v_mfma_f32_32x32x16_bf16 v[160:175], v[92:95], v[56:59], v[160:175]
  v_fmac_f32_dpp v77, v46, v53 row_newbcast:13 row_mask:0xf bank_mask:0xf
  v_cvt_pk_bf16_f32 v61, v74, v75
  v_fmac_f32_dpp v78, v46, v54 row_newbcast:14 row_mask:0xf bank_mask:0xf
  v_fmac_f32_dpp v79, v46, v55 row_newbcast:15 row_mask:0xf bank_mask:0xf
  v_cvt_pk_bf16_f32 v62, v76, v77
  v_cvt_pk_bf16_f32 v63, v78, v79
  s_waitcnt lgkmcnt(3)
  s_nop 0
  v_mfma_f32_32x32x16_bf16 v[112:127], v[96:99], v[60:63], v[112:127]
  ds_read_b128 v[72:75], v23 offset:1216
  ds_read_b128 v[76:79], v23 offset:1232
  ds_read_b128 v[80:83], v24 offset:8192
  ds_read_b128 v[84:87], v24 offset:9216
  v_lshlrev_b32 v48, 16, v248
  v_and_b32 v49, s57, v248
  v_lshlrev_b32 v50, 16, v249
  s_waitcnt lgkmcnt(6)
  v_mfma_f32_32x32x16_bf16 v[128:143], v[100:103], v[60:63], v[128:143]
  ds_read_b128 v[88:91], v24 offset:10240
  ds_read_b128 v[92:95], v24 offset:11264
  v_and_b32 v51, s57, v249
  v_fmac_f32_dpp v64, v47, v48 row_newbcast:0 row_mask:0xf bank_mask:0xf
  v_fmac_f32_dpp v65, v47, v49 row_newbcast:1 row_mask:0xf bank_mask:0xf
  v_lshlrev_b32 v52, 16, v250
  v_and_b32 v53, s57, v250
  s_waitcnt lgkmcnt(7)
  v_mfma_f32_32x32x16_bf16 v[144:159], v[104:107], v[60:63], v[144:159]
  v_fmac_f32_dpp v66, v47, v50 row_newbcast:2 row_mask:0xf bank_mask:0xf
  v_fmac_f32_dpp v67, v47, v51 row_newbcast:3 row_mask:0xf bank_mask:0xf
  v_lshlrev_b32 v54, 16, v251
  v_and_b32 v55, s57, v251
  v_cvt_pk_bf16_f32 v56, v64, v65
  v_fmac_f32_dpp v68, v47, v52 row_newbcast:4 row_mask:0xf bank_mask:0xf
  s_waitcnt lgkmcnt(6)
  v_mfma_f32_32x32x16_bf16 v[160:175], v[108:111], v[60:63], v[160:175]
  v_fmac_f32_dpp v69, v47, v53 row_newbcast:5 row_mask:0xf bank_mask:0xf
  v_cvt_pk_bf16_f32 v57, v66, v67
  v_fmac_f32_dpp v70, v47, v54 row_newbcast:6 row_mask:0xf bank_mask:0xf
  v_fmac_f32_dpp v71, v47, v55 row_newbcast:7 row_mask:0xf bank_mask:0xf
  v_cvt_pk_bf16_f32 v58, v68, v69
  v_cvt_pk_bf16_f32 v59, v70, v71
  s_waitcnt lgkmcnt(3)
  s_nop 0
  v_mfma_f32_32x32x16_bf16 v[112:127], v[80:83], v[56:59], v[112:127]
  ds_read_b128 v[96:99], v24 offset:12288
  ds_read_b128 v[100:103], v24 offset:13312
  v_lshlrev_b32 v48, 16, v252
  v_and_b32 v49, s57, v252
  v_lshlrev_b32 v50, 16, v253
  s_waitcnt lgkmcnt(4)
  v_mfma_f32_32x32x16_bf16 v[128:143], v[84:87], v[56:59], v[128:143]
  ds_read_b128 v[104:107], v24 offset:14336
  ds_read_b128 v[108:111], v24 offset:15360
  v_and_b32 v51, s57, v253
  v_fmac_f32_dpp v72, v47, v48 row_newbcast:8 row_mask:0xf bank_mask:0xf
  v_fmac_f32_dpp v73, v47, v49 row_newbcast:9 row_mask:0xf bank_mask:0xf
  v_lshlrev_b32 v52, 16, v254
  v_and_b32 v53, s57, v254
  s_waitcnt lgkmcnt(5)
  v_mfma_f32_32x32x16_bf16 v[144:159], v[88:91], v[56:59], v[144:159]
  v_fmac_f32_dpp v74, v47, v50 row_newbcast:10 row_mask:0xf bank_mask:0xf
  v_fmac_f32_dpp v75, v47, v51 row_newbcast:11 row_mask:0xf bank_mask:0xf
  v_lshlrev_b32 v54, 16, v255
  v_and_b32 v55, s57, v255
  v_cvt_pk_bf16_f32 v60, v72, v73
  v_fmac_f32_dpp v76, v47, v52 row_newbcast:12 row_mask:0xf bank_mask:0xf
  s_waitcnt lgkmcnt(4)
  v_mfma_f32_32x32x16_bf16 v[160:175], v[92:95], v[56:59], v[160:175]
  v_fmac_f32_dpp v77, v47, v53 row_newbcast:13 row_mask:0xf bank_mask:0xf
  v_cvt_pk_bf16_f32 v61, v74, v75
  v_fmac_f32_dpp v78, v47, v54 row_newbcast:14 row_mask:0xf bank_mask:0xf
  v_fmac_f32_dpp v79, v47, v55 row_newbcast:15 row_mask:0xf bank_mask:0xf
  v_cvt_pk_bf16_f32 v62, v76, v77
  v_cvt_pk_bf16_f32 v63, v78, v79
  s_waitcnt lgkmcnt(3)
  s_nop 0
  v_mfma_f32_32x32x16_bf16 v[112:127], v[96:99], v[60:63], v[112:127]
  s_waitcnt lgkmcnt(2)
  v_mfma_f32_32x32x16_bf16 v[128:143], v[100:103], v[60:63], v[128:143]
  s_waitcnt lgkmcnt(1)
  v_mfma_f32_32x32x16_bf16 v[144:159], v[104:107], v[60:63], v[144:159]
  s_waitcnt lgkmcnt(0)
  v_mfma_f32_32x32x16_bf16 v[160:175], v[108:111], v[60:63], v[160:175]
  v_lshlrev_b32 v30, 4, v1
  s_xor_b32 s64, s55, 4
  s_mul_i32 s63, s64, 5120
  s_cmp_lt_u32 s64, 3
  s_cselect_b32 s3, 81920, 0
  s_cselect_b32 s58, 0, 99328
  s_add_u32 s63, s63, s3
  s_add_u32 s63, s63, s58
  v_add_u32 v27, s63, v30
  s_cmp_lt_u32 s55, 4
  s_cbranch_scc0 IF_63_else
  ds_write_b128 v27, v[144:147] offset:0
  ds_write_b128 v27, v[148:151] offset:1024
  ds_write_b128 v27, v[160:163] offset:2048
  ds_write_b128 v27, v[164:167] offset:3072
  ds_write_b128 v27, v[168:171] offset:4096
  s_branch IF_63_end
IF_63_else:
  ds_write_b128 v27, v[132:135] offset:0
  ds_write_b128 v27, v[136:139] offset:1024
  ds_write_b128 v27, v[140:143] offset:2048
  ds_write_b128 v27, v[152:155] offset:3072
  ds_write_b128 v27, v[156:159] offset:4096
IF_63_end:
  s_mul_i32 s63, s55, 5120
  s_cmp_lt_u32 s55, 3
  s_cselect_b32 s3, 81920, 0
  s_cselect_b32 s58, 0, 99328
  s_add_u32 s63, s63, s3
  s_add_u32 s63, s63, s58
  v_add_u32 v31, s63, v30
  s_mul_i32 s63, s64, 3072
  s_cmp_lt_u32 s64, 5
  s_cselect_b32 s3, 65536, 0
  s_cselect_b32 s58, 0, 82944
  s_add_u32 s63, s63, s3
  s_add_u32 s63, s63, s58
  v_add_u32 v27, s63, v30
  s_mul_i32 s63, s55, 3072
  s_cmp_lt_u32 s55, 5
  s_cselect_b32 s3, 65536, 0
  s_cselect_b32 s58, 0, 82944
  s_add_u32 s63, s63, s3
  s_add_u32 s63, s63, s58
  v_add_u32 v240, s63, v30
  v_mov_b32 v28, 0x3f80
  v_mov_b32 v29, 0
  v_lshlrev_b32 v26, 3, v1
  ds_write_b64 v26, v[28:29] offset:31168
  v_and_b32 v2, 31, v1
  v_lshrrev_b32 v3, 5, v1
  s_lshl_b32 s63, s59, 5
  v_add_u32 v2, s63, v2
  v_lshlrev_b32 v19, 4, v2
  v_lshl_add_u32 v20, v3, 11, v19
  v_lshlrev_b32 v21, 3, v2
  v_lshl_add_u32 v22, v3, 10, v21
  v_lshl_add_u32 v23, v3, 3, v19
  v_mul_u32_u24 v24, 3072, v3
  v_add_u32 v24, v24, v21
  s_cmp_eq_u32 s60, 0
  s_cselect_b64 vcc, -1, 0
  v_cndmask_b32 v22, v23, v22, vcc
  v_add_u32 v24, 58368, v24
  v_add_u32 v23, 29056, v23
  v_cndmask_b32 v24, v23, v24, vcc
  s_mul_i32 s63, s60, 12288
  v_mul_u32_u24 v25, 6144, v3
  v_add3_u32 v25, v25, v19, s63
  s_mul_i32 s63, s60, 12544
  v_mul_u32_u24 v26, 6208, v3
  v_add3_u32 v26, v26, v19, s63
  s_lshl_b32 s63, s50, 4
  s_add_u32 s64, s63, s51
  s_mul_i32 s65, s64, 20480
  s_add_u32 s65, s65, 3014656
  s_lshl_b32 s63, s60, 12
  s_add_u32 s66, s65, s63
  s_add_u32 s67, s66, 10240
  s_mul_i32 s63, s60, 10240
  s_add_u32 s68, s65, s63
  s_add_u32 s68, s68, 8192
  s_lshl_b32 s64, s64, 3
  s_add_u32 s64, s64, s55
  s_waitcnt lgkmcnt(0)
  s_barrier
  ds_read_b128 v[188:191], v31 offset:0
  ds_read_b128 v[192:195], v31 offset:1024
  ds_read_b128 v[196:199], v31 offset:2048
  ds_read_b128 v[200:203], v31 offset:3072
  ds_read_b128 v[204:207], v31 offset:4096
  s_cmp_lt_u32 s55, 4
  s_cbranch_scc0 IF_64_else
  s_waitcnt lgkmcnt(4)
  v_pk_add_f32 v[188:189], v[188:189], v[132:133]
  v_pk_add_f32 v[190:191], v[190:191], v[134:135]
  s_waitcnt lgkmcnt(3)
  v_pk_add_f32 v[192:193], v[192:193], v[136:137]
  v_pk_add_f32 v[194:195], v[194:195], v[138:139]
  s_waitcnt lgkmcnt(2)
  v_pk_add_f32 v[196:197], v[196:197], v[140:141]
  v_pk_add_f32 v[198:199], v[198:199], v[142:143]
  s_waitcnt lgkmcnt(1)
  v_pk_add_f32 v[200:201], v[200:201], v[152:153]
  v_pk_add_f32 v[202:203], v[202:203], v[154:155]
  s_waitcnt lgkmcnt(0)
  v_pk_add_f32 v[204:205], v[204:205], v[156:157]
  v_pk_add_f32 v[206:207], v[206:207], v[158:159]
  s_branch IF_64_end
IF_64_else:
  s_waitcnt lgkmcnt(4)
  v_pk_add_f32 v[188:189], v[188:189], v[144:145]
  v_pk_add_f32 v[190:191], v[190:191], v[146:147]
  s_waitcnt lgkmcnt(3)
  v_pk_add_f32 v[192:193], v[192:193], v[148:149]
  v_pk_add_f32 v[194:195], v[194:195], v[150:151]
  s_waitcnt lgkmcnt(2)
  v_pk_add_f32 v[196:197], v[196:197], v[160:161]
  v_pk_add_f32 v[198:199], v[198:199], v[162:163]
  s_waitcnt lgkmcnt(1)
  v_pk_add_f32 v[200:201], v[200:201], v[164:165]
  v_pk_add_f32 v[202:203], v[202:203], v[166:167]
  s_waitcnt lgkmcnt(0)
  v_pk_add_f32 v[204:205], v[204:205], v[168:169]
  v_pk_add_f32 v[206:207], v[206:207], v[170:171]
IF_64_end:
  v_cvt_pk_bf16_f32 v214, v188, v189
  v_cvt_pk_bf16_f32 v215, v190, v191
  v_cvt_pk_bf16_f32 v216, v192, v193
  v_cvt_pk_bf16_f32 v217, v194, v195
  v_cvt_pk_bf16_f32 v218, v196, v197
  v_cvt_pk_bf16_f32 v219, v198, v199
  v_cvt_pk_bf16_f32 v220, v200, v201
  v_cvt_pk_bf16_f32 v221, v202, v203
  v_cvt_pk_bf16_f32 v222, v204, v205
  v_cvt_pk_bf16_f32 v223, v206, v207
  buffer_store_dwordx4 v[214:217], v20, s[44:47], s66 offen sc1
  buffer_store_dwordx4 v[220:223], v20, s[44:47], s67 offen sc1
  buffer_store_dwordx2 v[218:219], v22, s[44:47], s68 offen sc1
  ds_write_b128 v25, v[214:217] offset:35840
  ds_write_b128 v26, v[220:223] offset:4096
  ds_write_b64 v24, v[218:219]
  s_cmp_lt_u32 s55, 4
  s_cbranch_scc0 IF_65_else
  ds_write_b128 v27, v[124:127] offset:0
  ds_write_b128 v27, v[128:131] offset:1024
  ds_write_b128 v27, v[120:123] offset:2048
  s_branch IF_65_end
IF_65_else:
  ds_write_b128 v27, v[112:115] offset:0
  ds_write_b128 v27, v[116:119] offset:1024
  ds_write_b128 v27, v[120:123] offset:2048
IF_65_end:
  s_cmp_lt_u32 s55, 4
  s_cbranch_scc0 IF_66_else
  v_mov_b32 v80, v112
  v_mov_b32 v81, v113
  v_mov_b32 v82, v114
  v_mov_b32 v83, v115
  v_mov_b32 v84, v116
  v_mov_b32 v85, v117
  v_mov_b32 v86, v118
  v_mov_b32 v87, v119
  v_mov_b32 v88, v120
  v_mov_b32 v89, v121
  v_mov_b32 v90, v122
  v_mov_b32 v91, v123
  s_branch IF_66_end
IF_66_else:
  v_mov_b32 v80, v124
  v_mov_b32 v81, v125
  v_mov_b32 v82, v126
  v_mov_b32 v83, v127
  v_mov_b32 v84, v128
  v_mov_b32 v85, v129
  v_mov_b32 v86, v130
  v_mov_b32 v87, v131
  v_mov_b32 v88, v120
  v_mov_b32 v89, v121
  v_mov_b32 v90, v122
  v_mov_b32 v91, v123
IF_66_end:
  s_lshl_b32 s63, s64, 7
  s_add_u32 s63, s63, 131072
  v_mov_b32 v28, s54
  v_lshlrev_b32 v29, 26, v1
  v_and_b32 v29, 2147483648, v29
  v_lshl_or_b32 v29, v1, 2, v29
  s_waitcnt vmcnt(0)
  buffer_store_dword v28, v29, s[44:47], s63 offen sc1
  v_cmp_ne_u32 vcc, s54, v35
  s_cbranch_vccz IF_68_else
  s_mov_b32 s58, 1048576
LP_67:
  s_sleep 2
  buffer_load_dwordx2 v[34:35], v32, s[44:47], s8 offen sc1
  s_waitcnt vmcnt(0)
  v_cmp_ne_u32 vcc, s54, v35
  s_sub_u32 s58, s58, 1
  s_cselect_b64 vcc, 0, vcc
  s_cbranch_vccnz LP_67
IF_68_else:
  v_xor_b32 v34, s81, v34
  v_xor_b32 v35, s54, v35
  v_or_b32 v34, v34, v35
  v_cmp_ne_u32 vcc, 0, v34
  s_nop 0
  s_cmp_eq_u64 vcc, 0
  s_cselect_b32 s80, 1, 0
  s_cmp_lt_u32 s2, 160
  s_cbranch_scc0 IF_69_else
  s_add_u32 s62, s2, 80
  s_lshr_b32 s61, s62, 2
  v_lshlrev_b32 v16, 16, v16
  v_mul_f32 v44, 0xbfb8aa3b, v16
  v_lshlrev_b32 v17, 16, v17
  v_mul_f32 v45, 0xbfb8aa3b, v17
  v_lshlrev_b32 v18, 16, v18
  v_mul_f32 v46, 0xbfb8aa3b, v18
  v_exp_f32 v44, v44
  v_exp_f32 v45, v45
  v_exp_f32 v46, v46
  v_add_f32 v44, 1.0, v44
  v_add_f32 v45, 1.0, v45
  v_add_f32 v46, 1.0, v46
  v_rcp_f32 v44, v44
  v_rcp_f32 v45, v45
  v_rcp_f32 v46, v46
  v_mul_f32 v16, v16, v44
  v_mul_f32 v17, v17, v45
  v_mul_f32 v18, v18, v46
  v_cvt_pk_bf16_f32 v16, v16, v16
  v_cvt_pk_bf16_f32 v17, v17, v17
  v_cvt_pk_bf16_f32 v18, v18, v18
  v_lshlrev_b32 v16, 16, v16
  v_lshlrev_b32 v17, 16, v17
  v_lshlrev_b32 v18, 16, v18
  v_lshlrev_b32 v44, 16, v4
  v_and_b32 v45, s57, v4
  v_mul_f32 v48, v16, v44
  v_mul_f32 v49, v16, v45
  v_lshlrev_b32 v44, 16, v5
  v_and_b32 v45, s57, v5
  v_mul_f32 v50, v16, v44
  v_mul_f32 v51, v16, v45
  v_lshlrev_b32 v44, 16, v6
  v_and_b32 v45, s57, v6
  v_mul_f32 v52, v16, v44
  v_mul_f32 v53, v16, v45
  v_lshlrev_b32 v44, 16, v7
  v_and_b32 v45, s57, v7
  v_mul_f32 v54, v16, v44
  v_mul_f32 v55, v16, v45
  v_lshlrev_b32 v44, 16, v8
  v_and_b32 v45, s57, v8
  v_fmac_f32 v48, v17, v44
  v_fmac_f32 v49, v17, v45
  v_lshlrev_b32 v44, 16, v9
  v_and_b32 v45, s57, v9
  v_fmac_f32 v50, v17, v44
  v_fmac_f32 v51, v17, v45
  v_lshlrev_b32 v44, 16, v10
  v_and_b32 v45, s57, v10
  v_fmac_f32 v52, v17, v44
  v_fmac_f32 v53, v17, v45
  v_lshlrev_b32 v44, 16, v11
  v_and_b32 v45, s57, v11
  v_fmac_f32 v54, v17, v44
  v_fmac_f32 v55, v17, v45
  v_lshlrev_b32 v44, 16, v12
  v_and_b32 v45, s57, v12
  v_fmac_f32 v48, v18, v44
  v_fmac_f32 v49, v18, v45
  v_lshlrev_b32 v44, 16, v13
  v_and_b32 v45, s57, v13
  v_fmac_f32 v50, v18, v44
  v_fmac_f32 v51, v18, v45
  v_lshlrev_b32 v44, 16, v14
  v_and_b32 v45, s57, v14
  v_fmac_f32 v52, v18, v44
  v_fmac_f32 v53, v18, v45
  v_lshlrev_b32 v44, 16, v15
  v_and_b32 v45, s57, v15
  v_fmac_f32 v54, v18, v44
  v_fmac_f32 v55, v18, v45
  v_permlane32_swap_b32 v48, v52
  v_permlane32_swap_b32 v49, v53
  v_permlane32_swap_b32 v50, v54
  v_permlane32_swap_b32 v51, v55
  v_add_f32 v48, v48, v52
  v_add_f32 v49, v49, v53
  v_add_f32 v50, v50, v54
  v_add_f32 v51, v51, v55
  v_and_b32 v44, 7, v1
  v_lshrrev_b32 v45, 4, v1
  v_permlane16_swap_b32 v48, v50
  v_permlane16_swap_b32 v49, v51
  v_add_f32 v48, v48, v50
  v_add_f32 v49, v49, v51
  v_lshl_add_u32 v44, v44, 2, v45
  v_lshlrev_b32 v44, 3, v44
  s_lshl_b32 s63, s55, 8
  s_add_u32 s63, s63, 144384
  v_add_f32_dpp v48, v48, v48 row_ror:8 row_mask:0xf bank_mask:0xf
  v_add_f32_dpp v49, v49, v49 row_ror:8 row_mask:0xf bank_mask:0xf
  v_add_u32 v44, s63, v44
  ds_write_b64 v44, v[48:49]
IF_69_else:
  s_mov_b32 s78, -1
  v_mov_b32 v171, v3
  s_mul_i32 s68, s55, 7168
  s_add_u32 s68, s68, 140032
  s_lshl_b32 s67, s55, 8
  s_add_u32 s67, s67, s2
  s_sub_u32 s67, s67, 256
  s_cmp_lt_u32 s67, 320
  s_cbranch_scc0 IF_71_else
  s_mul_i32 s69, s67, 3277
  s_lshr_b32 s69, s69, 16
  s_mul_i32 s70, s69, 20
  s_sub_u32 s70, s67, s70
  s_mul_i32 s71, s70, 110592
  s_lshr_b32 s72, s69, 3
  s_mul_i32 s72, s72, 1728
  s_add_u32 s71, s71, s72
  s_and_b32 s69, s69, 7
  s_cmp_lt_u32 s69, 6
  s_cselect_b32 s72, 14, 12
  s_mul_i32 s69, s69, 224
  s_min_u32 s69, s69, 1536
  s_add_u32 s71, s71, s69
  v_add_u32 v2, 0, v1
  v_mul_u32_u24 v3, 4682, v2
  v_lshrrev_b32 v3, 16, v3
  v_mul_u32_u24 v4, 14, v3
  v_sub_u32 v4, v2, v4
  v_mul_u32_u24 v7, 3456, v3
  v_lshl_add_u32 v160, v4, 4, v7
  v_cmp_gt_u32 vcc, s72, v4
  v_mov_b32 v5, 2147483648
  s_nop 0
  v_cndmask_b32 v160, v5, v160, vcc
  s_add_u32 m0, s68, 0
  s_nop 0
  buffer_load_dwordx4 v160, s[16:19], s71 offen lds
  v_add_u32 v2, 64, v1
  v_mul_u32_u24 v3, 4682, v2
  v_lshrrev_b32 v3, 16, v3
  v_mul_u32_u24 v4, 14, v3
  v_sub_u32 v4, v2, v4
  v_mul_u32_u24 v7, 3456, v3
  v_lshl_add_u32 v161, v4, 4, v7
  v_cmp_gt_u32 vcc, s72, v4
  v_mov_b32 v5, 2147483648
  s_nop 0
  v_cndmask_b32 v161, v5, v161, vcc
  s_add_u32 m0, s68, 1024
  s_nop 0
  buffer_load_dwordx4 v161, s[16:19], s71 offen lds
  v_add_u32 v2, 128, v1
  v_mul_u32_u24 v3, 4682, v2
  v_lshrrev_b32 v3, 16, v3
  v_mul_u32_u24 v4, 14, v3
  v_sub_u32 v4, v2, v4
  v_mul_u32_u24 v7, 3456, v3
  v_lshl_add_u32 v162, v4, 4, v7
  v_cmp_gt_u32 vcc, s72, v4
  v_mov_b32 v5, 2147483648
  s_nop 0
  v_cndmask_b32 v162, v5, v162, vcc
  s_add_u32 m0, s68, 2048
  s_nop 0
  buffer_load_dwordx4 v162, s[16:19], s71 offen lds
  v_add_u32 v2, 192, v1
  v_mul_u32_u24 v3, 4682, v2
  v_lshrrev_b32 v3, 16, v3
  v_mul_u32_u24 v4, 14, v3
  v_sub_u32 v4, v2, v4
  v_mul_u32_u24 v7, 3456, v3
  v_lshl_add_u32 v163, v4, 4, v7
  v_cmp_gt_u32 vcc, s72, v4
  v_mov_b32 v5, 2147483648
  s_nop 0
  v_cndmask_b32 v163, v5, v163, vcc
  s_add_u32 m0, s68, 3072
  s_nop 0
  buffer_load_dwordx4 v163, s[16:19], s71 offen lds
  v_add_u32 v2, 256, v1
  v_mul_u32_u24 v3, 4682, v2
  v_lshrrev_b32 v3, 16, v3
  v_mul_u32_u24 v4, 14, v3
  v_sub_u32 v4, v2, v4
  v_mul_u32_u24 v7, 3456, v3
  v_lshl_add_u32 v164, v4, 4, v7
  v_cmp_gt_u32 vcc, s72, v4
  v_mov_b32 v5, 2147483648
  s_nop 0
  v_cndmask_b32 v164, v5, v164, vcc
  s_add_u32 m0, s68, 4096
  s_nop 0
  buffer_load_dwordx4 v164, s[16:19], s71 offen lds
  v_add_u32 v2, 320, v1
  v_mul_u32_u24 v3, 4682, v2
  v_lshrrev_b32 v3, 16, v3
  v_mul_u32_u24 v4, 14, v3
  v_sub_u32 v4, v2, v4
  v_mul_u32_u24 v7, 3456, v3
  v_lshl_add_u32 v165, v4, 4, v7
  v_cmp_gt_u32 vcc, s72, v4
  v_mov_b32 v5, 2147483648
  s_nop 0
  v_cndmask_b32 v165, v5, v165, vcc
  s_add_u32 m0, s68, 5120
  s_nop 0
  buffer_load_dwordx4 v165, s[16:19], s71 offen lds
  v_add_u32 v2, 384, v1
  v_mul_u32_u24 v3, 4682, v2
  v_lshrrev_b32 v3, 16, v3
  v_mul_u32_u24 v4, 14, v3
  v_sub_u32 v4, v2, v4
  v_mul_u32_u24 v7, 3456, v3
  v_lshl_add_u32 v166, v4, 4, v7
  v_cmp_gt_u32 vcc, s72, v4
  v_mov_b32 v5, 2147483648
  s_nop 0
  v_cndmask_b32 v166, v5, v166, vcc
  s_add_u32 m0, s68, 6144
  s_nop 0
  buffer_load_dwordx4 v166, s[16:19], s71 offen lds
  v_lshrrev_b32 v168, 2, v1
  v_mul_u32_u24 v168, 224, v168
  v_and_b32 v6, 3, v1
  v_lshl_add_u32 v168, v6, 3, v168
  v_add_u32 v168, s68, v168
  v_lshlrev_b32 v169, 4, v1
  s_mul_i32 s71, s67, 7168
  s_add_u32 s71, s71, 22265856
  s_add_u32 s69, s71, 4096
  s_waitcnt vmcnt(0)
  ds_read_b64_tr_b16 v[132:133], v168 offset:0
  ds_read_b64_tr_b16 v[134:135], v168 offset:3584
  ds_read_b64_tr_b16 v[136:137], v168 offset:32
  ds_read_b64_tr_b16 v[138:139], v168 offset:3616
  ds_read_b64_tr_b16 v[140:141], v168 offset:64
  ds_read_b64_tr_b16 v[142:143], v168 offset:3648
  ds_read_b64_tr_b16 v[144:145], v168 offset:96
  ds_read_b64_tr_b16 v[146:147], v168 offset:3680
  ds_read_b64_tr_b16 v[148:149], v168 offset:128
  ds_read_b64_tr_b16 v[150:151], v168 offset:3712
  ds_read_b64_tr_b16 v[152:153], v168 offset:160
  ds_read_b64_tr_b16 v[154:155], v168 offset:3744
  ds_read_b64_tr_b16 v[156:157], v168 offset:192
  ds_read_b64_tr_b16 v[158:159], v168 offset:3776
  s_waitcnt lgkmcnt(12)
  buffer_store_dwordx4 v[132:135], v169, s[44:47], s71 offen offset:0 sc1
  s_waitcnt lgkmcnt(10)
  buffer_store_dwordx4 v[136:139], v169, s[44:47], s71 offen offset:1024 sc1
  s_waitcnt lgkmcnt(8)
  buffer_store_dwordx4 v[140:143], v169, s[44:47], s71 offen offset:2048 sc1
  s_waitcnt lgkmcnt(6)
  buffer_store_dwordx4 v[144:147], v169, s[44:47], s71 offen offset:3072 sc1
  s_waitcnt lgkmcnt(4)
  buffer_store_dwordx4 v[148:151], v169, s[44:47], s69 offen offset:0 sc1
  s_waitcnt lgkmcnt(2)
  buffer_store_dwordx4 v[152:155], v169, s[44:47], s69 offen offset:1024 sc1
  s_waitcnt lgkmcnt(0)
  buffer_store_dwordx4 v[156:159], v169, s[44:47], s69 offen offset:2048 sc1
  s_add_u32 s78, s67, 160
  s_branch IF_71_end
IF_71_else:
  s_sub_u32 s67, s67, 320
  s_cmp_lt_u32 s67, 160
  s_cbranch_scc0 IF_70_else
  s_mul_i32 s69, s67, 3277
  s_lshr_b32 s69, s69, 16
  s_mul_i32 s70, s69, 20
  s_sub_u32 s70, s67, s70
  s_mul_i32 s71, s70, 40960
  s_mul_i32 s69, s69, 160
  s_add_u32 s71, s71, s69
  v_add_u32 v2, 0, v1
  v_mul_u32_u24 v3, 6554, v2
  v_lshrrev_b32 v3, 16, v3
  v_mul_u32_u24 v4, 10, v3
  v_sub_u32 v4, v2, v4
  v_lshrrev_b32 v5, 4, v3
  v_bfe_u32 v6, v3, 2, 2
  v_and_b32 v7, 3, v3
  v_lshl_add_u32 v7, v5, 2, v7
  v_lshl_add_u32 v7, v6, 3, v7
  v_mul_u32_u24 v7, 1280, v7
  v_lshl_add_u32 v160, v4, 4, v7
  s_add_u32 m0, s68, 0
  s_nop 0
  buffer_load_dwordx4 v160, s[12:15], s71 offen lds
  v_add_u32 v2, 64, v1
  v_mul_u32_u24 v3, 6554, v2
  v_lshrrev_b32 v3, 16, v3
  v_mul_u32_u24 v4, 10, v3
  v_sub_u32 v4, v2, v4
  v_lshrrev_b32 v5, 4, v3
  v_bfe_u32 v6, v3, 2, 2
  v_and_b32 v7, 3, v3
  v_lshl_add_u32 v7, v5, 2, v7
  v_lshl_add_u32 v7, v6, 3, v7
  v_mul_u32_u24 v7, 1280, v7
  v_lshl_add_u32 v161, v4, 4, v7
  s_add_u32 m0, s68, 1024
  s_nop 0
  buffer_load_dwordx4 v161, s[12:15], s71 offen lds
  v_add_u32 v2, 128, v1
  v_mul_u32_u24 v3, 6554, v2
  v_lshrrev_b32 v3, 16, v3
  v_mul_u32_u24 v4, 10, v3
  v_sub_u32 v4, v2, v4
  v_lshrrev_b32 v5, 4, v3
  v_bfe_u32 v6, v3, 2, 2
  v_and_b32 v7, 3, v3
  v_lshl_add_u32 v7, v5, 2, v7
  v_lshl_add_u32 v7, v6, 3, v7
  v_mul_u32_u24 v7, 1280, v7
  v_lshl_add_u32 v162, v4, 4, v7
  s_add_u32 m0, s68, 2048
  s_nop 0
  buffer_load_dwordx4 v162, s[12:15], s71 offen lds
  v_add_u32 v2, 192, v1
  v_mul_u32_u24 v3, 6554, v2
  v_lshrrev_b32 v3, 16, v3
  v_mul_u32_u24 v4, 10, v3
  v_sub_u32 v4, v2, v4
  v_lshrrev_b32 v5, 4, v3
  v_bfe_u32 v6, v3, 2, 2
  v_and_b32 v7, 3, v3
  v_lshl_add_u32 v7, v5, 2, v7
  v_lshl_add_u32 v7, v6, 3, v7
  v_mul_u32_u24 v7, 1280, v7
  v_lshl_add_u32 v163, v4, 4, v7
  s_add_u32 m0, s68, 3072
  s_nop 0
  buffer_load_dwordx4 v163, s[12:15], s71 offen lds
  v_add_u32 v2, 256, v1
  v_mul_u32_u24 v3, 6554, v2
  v_lshrrev_b32 v3, 16, v3
  v_mul_u32_u24 v4, 10, v3
  v_sub_u32 v4, v2, v4
  v_lshrrev_b32 v5, 4, v3
  v_bfe_u32 v6, v3, 2, 2
  v_and_b32 v7, 3, v3
  v_lshl_add_u32 v7, v5, 2, v7
  v_lshl_add_u32 v7, v6, 3, v7
  v_mul_u32_u24 v7, 1280, v7
  v_lshl_add_u32 v164, v4, 4, v7
  s_add_u32 m0, s68, 4096
  s_nop 0
  buffer_load_dwordx4 v164, s[12:15], s71 offen lds
  v_lshrrev_b32 v168, 2, v1
  v_mul_u32_u24 v168, 160, v168
  v_and_b32 v6, 3, v1
  v_lshl_add_u32 v168, v6, 3, v168
  v_add_u32 v168, s68, v168
  v_lshlrev_b32 v169, 4, v1
  s_mul_i32 s71, s67, 5120
  s_add_u32 s71, s71, 21446656
  s_add_u32 s69, s71, 4096
  s_waitcnt vmcnt(0)
  ds_read_b64_tr_b16 v[132:133], v168 offset:0
  ds_read_b64_tr_b16 v[134:135], v168 offset:2560
  ds_read_b64_tr_b16 v[136:137], v168 offset:32
  ds_read_b64_tr_b16 v[138:139], v168 offset:2592
  ds_read_b64_tr_b16 v[140:141], v168 offset:64
  ds_read_b64_tr_b16 v[142:143], v168 offset:2624
  ds_read_b64_tr_b16 v[144:145], v168 offset:96
  ds_read_b64_tr_b16 v[146:147], v168 offset:2656
  ds_read_b64_tr_b16 v[148:149], v168 offset:128
  ds_read_b64_tr_b16 v[150:151], v168 offset:2688
  s_waitcnt lgkmcnt(8)
  buffer_store_dwordx4 v[132:135], v169, s[44:47], s71 offen offset:0 sc1
  s_waitcnt lgkmcnt(6)
  buffer_store_dwordx4 v[136:139], v169, s[44:47], s71 offen offset:1024 sc1
  s_waitcnt lgkmcnt(4)
  buffer_store_dwordx4 v[140:143], v169, s[44:47], s71 offen offset:2048 sc1
  s_waitcnt lgkmcnt(2)
  buffer_store_dwordx4 v[144:147], v169, s[44:47], s71 offen offset:3072 sc1
  s_waitcnt lgkmcnt(0)
  buffer_store_dwordx4 v[148:151], v169, s[44:47], s69 offen offset:0 sc1
  s_lshl_b32 s63, s67, 7
  s_add_u32 s63, s63, 2228224
  v_mov_b32 v8, s54
  v_lshlrev_b32 v9, 26, v1
  v_and_b32 v9, 2147483648, v9
  v_lshl_or_b32 v9, v1, 2, v9
  s_waitcnt vmcnt(0)
  buffer_store_dword v8, v9, s[44:47], s63 offen sc1
IF_70_else:
IF_71_end:
  v_mov_b32 v3, v171
  s_lshl_b32 s63, s50, 2
  s_add_u32 s63, s63, s59
  s_sub_u32 s66, 8, s63
  s_max_i32 s66, s66, 0
  v_and_b32 v17, 31, v1
  v_lshlrev_b32 v15, 2, v3
  v_sub_u32 v17, v17, v15
  v_mov_b32 v15, 4048155338
  v_cmp_le_i32 vcc, 0, v17
  s_nop 1
  v_cndmask_b32 v32, v15, 0, vcc
  v_cndmask_b32 v48, 0, v15, vcc
  v_cmp_le_i32 vcc, 1, v17
  s_nop 1
  v_cndmask_b32 v33, v15, 0, vcc
  v_cndmask_b32 v49, 0, v15, vcc
  v_cmp_le_i32 vcc, 2, v17
  s_nop 1
  v_cndmask_b32 v34, v15, 0, vcc
  v_cndmask_b32 v50, 0, v15, vcc
  v_cmp_le_i32 vcc, 3, v17
  s_nop 1
  v_cndmask_b32 v35, v15, 0, vcc
  v_cndmask_b32 v51, 0, v15, vcc
  v_cmp_le_i32 vcc, 8, v17
  s_nop 1
  v_cndmask_b32 v36, v15, 0, vcc
  v_cndmask_b32 v52, 0, v15, vcc
  v_cmp_le_i32 vcc, 9, v17
  s_nop 1
  v_cndmask_b32 v37, v15, 0, vcc
  v_cndmask_b32 v53, 0, v15, vcc
  v_cmp_le_i32 vcc, 10, v17
  s_nop 1
  v_cndmask_b32 v38, v15, 0, vcc
  v_cndmask_b32 v54, 0, v15, vcc
  v_cmp_le_i32 vcc, 11, v17
  s_nop 1
  v_cndmask_b32 v39, v15, 0, vcc
  v_cndmask_b32 v55, 0, v15, vcc
  v_cmp_le_i32 vcc, 16, v17
  s_nop 1
  v_cndmask_b32 v40, v15, 0, vcc
  v_cndmask_b32 v56, 0, v15, vcc
  v_cmp_le_i32 vcc, 17, v17
  s_nop 1
  v_cndmask_b32 v41, v15, 0, vcc
  v_cndmask_b32 v57, 0, v15, vcc
  v_cmp_le_i32 vcc, 18, v17
  s_nop 1
  v_cndmask_b32 v42, v15, 0, vcc
  v_cndmask_b32 v58, 0, v15, vcc
  v_cmp_le_i32 vcc, 19, v17
  s_nop 1
  v_cndmask_b32 v43, v15, 0, vcc
  v_cndmask_b32 v59, 0, v15, vcc
  v_cmp_le_i32 vcc, 24, v17
  s_nop 1
  v_cndmask_b32 v44, v15, 0, vcc
  v_cndmask_b32 v60, 0, v15, vcc
  v_cmp_le_i32 vcc, 25, v17
  s_nop 1
  v_cndmask_b32 v45, v15, 0, vcc
  v_cndmask_b32 v61, 0, v15, vcc
  v_cmp_le_i32 vcc, 26, v17
  s_nop 1
  v_cndmask_b32 v46, v15, 0, vcc
  v_cndmask_b32 v62, 0, v15, vcc
  v_cmp_le_i32 vcc, 27, v17
  s_nop 1
  v_cndmask_b32 v47, v15, 0, vcc
  v_cndmask_b32 v63, 0, v15, vcc
  s_cmp_gt_u32 s66, 0
  s_cselect_b32 s63, 1065414985, 0x3f800000
  v_mov_b32 v98, s63
  v_mov_b32 v99, 0x3f80
  s_cmp_gt_u32 s66, 1
  s_cselect_b32 s63, 1065414985, 0x3f800000
  v_mov_b32 v102, s63
  v_mov_b32 v103, 0x3f80
  s_cmp_gt_u32 s66, 2
  s_cselect_b32 s63, 1065414985, 0x3f800000
  v_mov_b32 v106, s63
  v_mov_b32 v107, 0x3f80
  s_cmp_gt_u32 s66, 3
  s_cselect_b32 s63, 1065414985, 0x3f800000
  v_mov_b32 v110, s63
  v_mov_b32 v111, 0x3f80
  s_cmp_gt_u32 s66, 4
  s_cselect_b32 s63, 1065414985, 0x3f800000
  v_mov_b32 v114, s63
  v_mov_b32 v115, 0x3f80
  s_cmp_gt_u32 s66, 5
  s_cselect_b32 s63, 1065414985, 0x3f800000
  v_mov_b32 v118, s63
  v_mov_b32 v119, 0x3f80
  s_cmp_gt_u32 s66, 6
  s_cselect_b32 s63, 1065414985, 0x3f800000
  v_mov_b32 v122, s63
  v_mov_b32 v123, 0x3f80
  s_cmp_gt_u32 s66, 7
  s_cselect_b32 s63, 1065414985, 0x3f800000
  v_mov_b32 v126, s63
  v_mov_b32 v127, 0x3f80
  s_cmp_gt_u32 s66, 8
  s_cselect_b32 s63, 1065414985, 0x3f800000
  v_mov_b32 v130, s63
  v_mov_b32 v131, 0x3f80
  s_lshl_b32 s63, s59, 9
  s_mul_i32 s67, s60, 12288
  s_add_u32 s67, s67, s63
  v_and_b32 v22, 31, v1
  v_lshlrev_b32 v23, 4, v22
  v_mul_u32_u24 v24, 6144, v3
  v_add3_u32 v18, v23, v24, s67
  s_lshl_b32 s67, s59, 8
  v_lshlrev_b32 v23, 3, v22
  v_mul_u32_u24 v24, 3072, v3
  v_add3_u32 v19, v23, v24, s67
  v_bfe_u32 v22, v1, 2, 2
  v_lshl_add_u32 v22, v3, 2, v22
  v_lshlrev_b32 v22, 4, v22
  v_bfe_u32 v23, v1, 1, 1
  v_mul_u32_u24 v23, 6208, v23
  v_and_b32 v24, 1, v1
  v_lshl_add_u32 v23, v24, 3, v23
  s_mul_i32 s67, s60, 12544
  s_add_u32 s67, s67, s63
  v_add_u32 v23, s67, v23
  v_and_b32 v24, 19, v1
  v_cmp_eq_u32 vcc, 16, v24
  s_lshl_b32 s67, s60, 3
  s_add_u32 s67, s67, s63
  s_add_u32 s67, s67, 24960
  v_mov_b32 v25, s67
  v_cndmask_b32 v23, v23, v25, vcc
  v_cmp_lt_u32 vcc, 16, v24
  v_mov_b32 v25, 31168
  s_nop 0
  v_cndmask_b32 v23, v23, v25, vcc
  v_add_u32 v20, v23, v22
  v_mov_b32 v25, 0x200
  v_cndmask_b32 v21, v25, 0, vcc
  v_bfe_u32 v12, v1, 3, 1
  v_sub_u32 v12, s50, v12
  v_subrev_u32 v12, 1, v12
  v_cmp_gt_i32 vcc, 0, v12
  v_mov_b32 v13, s50
  s_nop 0
  v_cndmask_b32 v12, v12, v13, vcc
  v_lshlrev_b32 v12, 14, v12
  v_and_b32 v13, 7, v1
  v_lshl_add_u32 v12, v13, 7, v12
  s_lshl_b32 s63, s51, 10
  s_add_u32 s63, s63, 131072
  s_sub_u32 s67, s65, 655360
  s_cmp_ge_u32 s50, 2
  s_cselect_b32 s67, s67, 2147483648
  s_sub_u32 s68, s65, 327680
  s_cmp_ge_u32 s50, 1
  s_cselect_b32 s68, s68, 2147483648
  s_cmp_eq_u32 s60, 0
  s_cselect_b32 s69, s67, s68
  s_lshl_b32 s74, s59, 11
  s_add_u32 s69, s69, s74
  s_lshl_b32 s74, s60, 11
  s_mul_i32 s70, s59, 6144
  s_add_u32 s70, s70, s74
  s_lshr_b32 s75, s59, 1
  s_and_b32 s76, s59, 1
  s_mul_i32 s71, s75, 12544
  s_mul_i32 s77, s76, 6208
  s_add_u32 s71, s71, s77
  s_add_u32 s71, s71, s74
  s_cmp_eq_u32 s75, 0
  s_cselect_b32 s72, s67, s68
  s_lshl_b32 s77, s76, 10
  s_add_u32 s72, s72, s77
  s_mul_i32 s77, s60, 10240
  s_add_u32 s72, s72, s77
  s_add_u32 s72, s72, 8192
  s_mul_i32 s73, s76, 3072
  s_lshl_b32 s77, s75, 10
  s_add_u32 s73, s73, s77
  s_add_u32 s73, s73, 56320
  s_lshl_b32 s77, s59, 10
  s_add_u32 s77, s77, 24960
  s_cmp_eq_u32 s60, 0
  s_cselect_b32 s73, s73, s77
  s_cmp_eq_u32 s55, 7
  s_cbranch_scc0 IF_74_else
  buffer_load_dword v13, v12, s[44:47], s63 offen sc0 sc1
  s_waitcnt vmcnt(0)
  v_cmp_ne_u32 vcc, s54, v13
  s_cbranch_vccz IF_73_else
  s_mov_b32 s58, 1048576
LP_72:
  s_sleep 2
  s_mov_b64 exec, vcc
  buffer_load_dword v13, v12, s[44:47], s63 offen sc0 sc1
  s_waitcnt vmcnt(0)
  v_cmp_ne_u32 vcc, s54, v13
  s_sub_u32 s58, s58, 1
  s_cselect_b64 vcc, 0, vcc
  s_cbranch_vccnz LP_72
  s_mov_b64 exec, -1
IF_73_else:
IF_74_else:
  s_waitcnt lgkmcnt(0)
  s_barrier
  s_add_u32 m0, s70, 31744
  s_add_u32 s63, s69, 0
  buffer_load_dwordx4 v30, s[44:47], s63 offen sc1 lds
  s_add_u32 m0, s70, 32768
  s_add_u32 s63, s69, 1024
  buffer_load_dwordx4 v30, s[44:47], s63 offen sc1 lds
  s_add_u32 m0, s71, 0
  s_add_u32 s63, s69, 10240
  buffer_load_dwordx4 v30, s[44:47], s63 offen sc1 lds
  s_add_u32 m0, s71, 1024
  s_add_u32 s63, s69, 11264
  buffer_load_dwordx4 v30, s[44:47], s63 offen sc1 lds
  s_mov_b32 m0, s73
  s_nop 0
  buffer_load_dwordx4 v30, s[44:47], s72 offen sc1 lds
  ds_read_b128 v[176:179], v240 offset:0
  ds_read_b128 v[180:183], v240 offset:1024
  ds_read_b128 v[184:187], v240 offset:2048
  ds_read_b128 v[164:167], v18 offset:35840
  ds_read_b64 v[128:129], v19 offset:58368
  s_cmp_eq_u32 s55, 0
  s_cbranch_scc0 IF_76_else
  s_cmp_lt_u32 s2, 160
  s_cbranch_scc0 IF_75_else
  s_add_u32 s62, s2, 80
  s_lshr_b32 s61, s62, 2
  v_lshlrev_b32 v12, 2, v1
  v_add_u32 v13, 144384, v12
  ds_read_b32 v4, v13 offset:0
  ds_read_b32 v5, v13 offset:256
  ds_read_b32 v6, v13 offset:512
  ds_read_b32 v7, v13 offset:768
  ds_read_b32 v8, v13 offset:1024
  ds_read_b32 v9, v13 offset:1280
  ds_read_b32 v10, v13 offset:1536
  ds_read_b32 v11, v13 offset:1792
  s_lshl_b32 s63, s62, 9
  s_add_u32 s63, s63, 4096
  v_mul_u32_u24 v13, 3, v12
  v_add_u32 v14, 4, v13
  v_add_u32 v15, 8, v13
  v_lshlrev_b32 v12, 4, v1
  v_cmp_gt_u32 vcc, 22, v1
  s_waitcnt lgkmcnt(3)
  v_add_f32 v4, v4, v8
  s_waitcnt lgkmcnt(2)
  v_add_f32 v5, v5, v9
  s_waitcnt lgkmcnt(1)
  v_add_f32 v6, v6, v10
  s_waitcnt lgkmcnt(0)
  v_add_f32 v7, v7, v11
  v_mov_b32 v8, 2147483648
  v_add_f32 v4, v4, v5
  v_add_f32 v6, v6, v7
  v_cndmask_b32 v12, v8, v12, vcc
  v_add_f32 v8, v4, v6
  ds_bpermute_b32 v4, v13, v8
  ds_bpermute_b32 v5, v14, v8
  ds_bpermute_b32 v6, v15, v8
  v_mov_b32 v7, s54
  s_waitcnt lgkmcnt(0)
  buffer_store_dwordx4 v[4:7], v12, s[44:47], s63 offen sc1
IF_75_else:
IF_76_else:
  s_waitcnt lgkmcnt(4)
  v_pk_add_f32 v[176:177], v[176:177], v[80:81]
  v_pk_add_f32 v[178:179], v[178:179], v[82:83]
  s_waitcnt lgkmcnt(3)
  v_pk_add_f32 v[180:181], v[180:181], v[84:85]
  v_pk_add_f32 v[182:183], v[182:183], v[86:87]
  s_waitcnt lgkmcnt(2)
  v_pk_add_f32 v[184:185], v[184:185], v[88:89]
  v_pk_add_f32 v[186:187], v[186:187], v[90:91]
  v_mul_f32 v176, 0.3225964182229561, v176
  v_mul_f32 v177, 0.3225964182229561, v177
  v_mul_f32 v178, 0.3225964182229561, v178
  v_mul_f32 v179, 0.3225964182229561, v179
  v_mul_f32 v180, 0.3225964182229561, v180
  v_mul_f32 v181, 0.3225964182229561, v181
  v_mul_f32 v182, 0.3225964182229561, v182
  v_mul_f32 v183, 0.3225964182229561, v183
  v_mul_f32 v184, 0.3225964182229561, v184
  v_mul_f32 v185, 0.3225964182229561, v185
  v_mul_f32 v186, 0.3225964182229561, v186
  v_mul_f32 v187, 0.3225964182229561, v187
  v_cvt_pk_bf16_f32 v64, v176, v177
  v_cvt_pk_bf16_f32 v65, v178, v179
  v_cvt_pk_bf16_f32 v66, v180, v181
  v_cvt_pk_bf16_f32 v67, v182, v183
  v_cvt_pk_bf16_f32 v68, v184, v185
  v_cvt_pk_bf16_f32 v69, v186, v187
  v_cmp_eq_u32 vcc, s60, v3
  s_nop 1
  v_cndmask_b32 v68, 0, v68, vcc
  v_cndmask_b32 v69, 0, v69, vcc
  v_cmp_gt_u32 vcc, 32, v1
  v_mov_b32 v28, 0x3f80
  s_nop 0
  v_cndmask_b32 v70, 0, v28, vcc
  v_mov_b32 v71, 0
  s_waitcnt lgkmcnt(1)
  v_mfma_f32_32x32x16_bf16 v[192:207], v[164:167], v[64:67], v[32:47]
  s_waitcnt lgkmcnt(0)
  v_mfma_f32_32x32x16_bf16 v[192:207], v[128:131], v[68:71], v[192:207]
  v_mov_b32 v247, v20
  v_lshl_add_u32 v249, v21, 3, v20
  v_mov_b32 v248, 1568669696
  v_and_b32 v22, 31, v1
  v_bfe_u32 v23, v22, 2, 1
  v_lshrrev_b32 v24, 3, v22
  v_and_b32 v25, 3, v22
  v_lshl_add_u32 v24, v24, 2, v25
  v_lshlrev_b32 v24, 4, v24
  v_mul_u32_u24 v23, 20480, v23
  v_add_u32 v23, v23, v24
  s_lshl_b32 s73, s50, 2
  s_add_u32 s73, s73, s59
  s_mul_i32 s74, s73, 40960
  s_add_u32 s74, s74, 8257536
  s_mul_i32 s63, s51, 1280
  s_add_u32 s74, s74, s63
  s_mul_i32 s63, s60, 768
  s_add_u32 s75, s74, s63
  s_lshl_b32 s63, s60, 3
  s_add_u32 s74, s74, s63
  v_lshl_add_u32 v24, v3, 8, v23
  v_lshl_or_b32 v23, v3, 31, v23
  s_lshl_b32 s73, s73, 5
  s_lshl_b32 s63, s51, 1
  s_add_u32 s73, s73, s63
  s_add_u32 s73, s73, s60
  v_max_f32 v28, v192, v193
  v_max_f32 v29, v194, v195
  v_max3_f32 v28, v196, v197, v28
  v_max3_f32 v29, v198, v199, v29
  v_max3_f32 v28, v200, v201, v28
  v_max3_f32 v29, v202, v203, v29
  v_max3_f32 v28, v204, v205, v28
  v_max3_f32 v29, v206, v207, v29
  v_max_f32 v28, v28, v29
  v_mov_b32 v29, v28
  s_nop 1
  v_permlane32_swap_b32 v28, v29
  v_max_f32 v28, v28, v29
  v_sub_f32 v28, 0, v28
  v_cvt_pk_bf16_f32 v29, v28, v28
  v_and_b32 v29, s57, v29
  v_sub_f32 v28, v28, v29
  v_cvt_pk_bf16_f32 v28, v28, v28
  v_lshrrev_b32 v28, 16, v28
  v_or_b32 v29, 0x3f80, v29
  v_cmp_gt_u32 vcc, 32, v1
  s_nop 1
  v_cndmask_b32 v70, 0, v29, vcc
  v_cndmask_b32 v71, 0, v28, vcc
  ds_read_b64_tr_b16 v[168:169], v249 offset:0
  ds_read_b64_tr_b16 v[170:171], v249 offset:128
  ds_read_b64_tr_b16 v[172:173], v249 offset:256
  ds_read_b64_tr_b16 v[174:175], v249 offset:384
  v_mfma_f32_32x32x16_bf16 v[192:207], v[164:167], v[64:67], v[32:47]
  v_mfma_f32_32x32x16_bf16 v[192:207], v[128:131], v[68:71], v[192:207]
  s_nop 11
  v_exp_f32 v192, v192
  v_exp_f32 v193, v193
  v_exp_f32 v194, v194
  v_exp_f32 v195, v195
  v_exp_f32 v196, v196
  v_exp_f32 v197, v197
  v_exp_f32 v198, v198
  v_exp_f32 v199, v199
  v_cvt_pk_bf16_f32 v72, v192, v193
  v_cvt_pk_bf16_f32 v73, v194, v195
  v_cvt_pk_bf16_f32 v74, v196, v197
  v_cvt_pk_bf16_f32 v75, v198, v199
  v_exp_f32 v200, v200
  v_exp_f32 v201, v201
  s_waitcnt lgkmcnt(2)
  v_mfma_f32_32x32x16_bf16 v[224:239], v[168:171], v[72:75], 0
  v_exp_f32 v202, v202
  v_exp_f32 v203, v203
  v_exp_f32 v204, v204
  v_exp_f32 v205, v205
  v_exp_f32 v206, v206
  v_exp_f32 v207, v207
  v_cvt_pk_bf16_f32 v76, v200, v201
  v_cvt_pk_bf16_f32 v77, v202, v203
  v_cvt_pk_bf16_f32 v78, v204, v205
  v_cvt_pk_bf16_f32 v79, v206, v207
  s_waitcnt lgkmcnt(0)
  s_nop 0
  v_mfma_f32_32x32x16_bf16 v[224:239], v[172:175], v[76:79], v[224:239]
  s_mov_b32 s76, 0
  s_waitcnt vmcnt(0)
  s_cmp_lg_u32 s78, -1
  s_cbranch_scc0 IF_77_else
  s_lshl_b32 s63, s78, 7
  s_add_u32 s63, s63, 2228224
  v_mov_b32 v8, s54
  v_lshlrev_b32 v9, 26, v1
  v_and_b32 v9, 2147483648, v9
  v_lshl_or_b32 v9, v1, 2, v9
  buffer_store_dword v8, v9, s[44:47], s63 offen sc1
IF_77_else:
  s_barrier
  ds_read_b128 v[132:135], v18 offset:31744
  ds_read_b64 v[96:97], v19 offset:56320
  ds_read_b128 v[136:139], v18 offset:32256
  ds_read_b64 v[100:101], v19 offset:56576
  ds_read_b128 v[140:143], v18 offset:32768
  ds_read_b64 v[104:105], v19 offset:56832
  ds_read_b128 v[144:147], v18 offset:33280
  ds_read_b64 v[108:109], v19 offset:57088
  ds_read_b128 v[148:151], v18 offset:33792
  ds_read_b64 v[112:113], v19 offset:57344
  ds_read_b128 v[152:155], v18 offset:34304
  ds_read_b64 v[116:117], v19 offset:57600
  ds_read_b128 v[156:159], v18 offset:34816
  ds_read_b64 v[120:121], v19 offset:57856
  ds_read_b128 v[160:163], v18 offset:35328
  ds_read_b64 v[124:125], v19 offset:58112
  s_mov_b32 m0, 161536
  s_nop 0
  buffer_load_dword v24, s[44:47], s75 offen lds
  s_add_u32 s63, s74, 512
  buffer_load_dword v23, s[44:47], s63 offen lds
  s_cmp_eq_u32 s55, 3
  s_cbranch_scc0 IF_78_else
  s_lshl_b32 s3, s48, 5
  s_add_u32 s3, s3, s49
  v_lshlrev_b32 v27, 7, v1
  v_cmp_gt_u32 vcc, 8, v1
  v_mov_b32 v26, 2147483648
  s_nop 0
  v_cndmask_b32 v27, v26, v27, vcc
  s_mov_b32 m0, 161536
  s_mul_i32 s63, s3, 1024
  s_add_u32 s63, s63, 393216
  buffer_load_dword v27, s[44:47], s63 offen  lds
IF_78_else:
  s_cmp_eq_u32 s55, 4
  s_cbranch_scc0 IF_79_else
  s_lshl_b32 s3, s48, 5
  s_add_u32 s3, s3, s49
  v_lshlrev_b32 v27, 7, v1
  v_cmp_gt_u32 vcc, 4, v1
  v_mov_b32 v26, 2147483648
  s_nop 0
  v_cndmask_b32 v27, v26, v27, vcc
  s_mov_b32 m0, 161536
  s_mul_i32 s63, s3, 512
  s_add_u32 s63, s63, 655360
  buffer_load_dword v27, s[44:47], s63 offen  lds
IF_79_else:
  s_cmp_eq_u32 s55, 5
  s_cbranch_scc0 IF_80_else
  s_lshl_b32 s3, s48, 5
  s_add_u32 s3, s3, s49
  v_lshlrev_b32 v27, 7, v1
  v_cmp_gt_u32 vcc, 8, v1
  v_mov_b32 v26, 2147483648
  s_nop 0
  v_cndmask_b32 v27, v26, v27, vcc
  s_mov_b32 m0, 161536
  s_mul_i32 s63, s3, 1024
  s_add_u32 s63, s63, 1441792
  buffer_load_dword v27, s[44:47], s63 offen  lds
IF_80_else:
  s_cmp_eq_u32 s55, 6
  s_cbranch_scc0 IF_81_else
  s_lshl_b32 s3, s48, 5
  s_add_u32 s3, s3, s49
  v_lshlrev_b32 v27, 7, v1
  v_cmp_gt_u32 vcc, 8, v1
  v_mov_b32 v26, 2147483648
  s_nop 0
  v_cndmask_b32 v27, v26, v27, vcc
  s_mov_b32 m0, 161536
  s_mul_i32 s63, s3, 1024
  s_add_u32 s63, s63, 2490368
  buffer_load_dword v27, s[44:47], s63 offen  lds
IF_81_else:
  s_cmp_eq_u32 s55, 7
  s_cbranch_scc0 IF_82_else
  s_lshl_b32 s3, s48, 5
  s_add_u32 s3, s3, s49
  v_lshlrev_b32 v27, 7, v1
  v_cmp_gt_u32 vcc, 8, v1
  v_mov_b32 v26, 2147483648
  s_nop 0
  v_cndmask_b32 v27, v26, v27, vcc
  s_mov_b32 m0, 161536
  s_mul_i32 s63, s3, 1024
  s_add_u32 s63, s63, 2752512
  buffer_load_dword v27, s[44:47], s63 offen  lds
IF_82_else:
  s_cmp_eq_u32 s55, 1
  s_cbranch_scc0 IF_83_else
  s_lshl_b32 s3, s48, 5
  s_add_u32 s3, s3, s49
  s_lshl_b32 s3, s3, 2
  v_lshlrev_b32 v26, 7, v1
  s_mov_b32 m0, 161536
  s_mul_i32 s63, s3, 8192
  s_add_u32 s63, s63, 8192
  buffer_load_dword v26, s[20:23], s63 offen  lds
IF_83_else:
  s_cmp_eq_u32 s55, 2
  s_cbranch_scc0 IF_84_else
  s_lshl_b32 s3, s48, 5
  s_add_u32 s3, s3, s49
  s_lshl_b32 s3, s3, 2
  v_lshlrev_b32 v26, 7, v1
  s_mov_b32 m0, 161536
  s_mul_i32 s63, s3, 8192
  s_add_u32 s63, s63, 16384
  buffer_load_dword v26, s[20:23], s63 offen  lds
IF_84_else:
  s_cmp_eq_u32 s55, 3
  s_cbranch_scc0 IF_85_else
  s_lshl_b32 s3, s48, 5
  s_add_u32 s3, s3, s49
  s_lshl_b32 s3, s3, 2
  v_lshlrev_b32 v26, 7, v1
  s_mov_b32 m0, 161536
  s_mul_i32 s63, s3, 8192
  s_add_u32 s63, s63, 24576
  buffer_load_dword v26, s[20:23], s63 offen  lds
IF_85_else:
LP_88:
  s_cmp_lg_u32 s76, 0
  s_cbranch_scc0 IF_86_else
  v_and_b32 v70, 0xffff, v70
  v_mov_b32 v71, 0
  v_mov_b32 v20, v247
  s_waitcnt lgkmcnt(15)
  v_mfma_f32_32x32x16_bf16 v[192:207], v[132:135], v[64:67], v[48:63]
  s_waitcnt lgkmcnt(14)
  v_mfma_f32_32x32x16_bf16 v[192:207], v[96:99], v[68:71], v[192:207]
  s_waitcnt lgkmcnt(13)
  v_mfma_f32_32x32x16_bf16 v[208:223], v[136:139], v[64:67], 0
  s_waitcnt lgkmcnt(12)
  v_mfma_f32_32x32x16_bf16 v[208:223], v[100:103], v[68:71], v[208:223]
  s_nop 7
  v_max_f32 v28, v192, v193
  v_max_f32 v29, v194, v195
  v_max3_f32 v28, v196, v197, v28
  v_max3_f32 v29, v198, v199, v29
  v_max3_f32 v28, v200, v201, v28
  v_max3_f32 v29, v202, v203, v29
  v_max3_f32 v28, v204, v205, v28
  v_max3_f32 v29, v206, v207, v29
  s_waitcnt lgkmcnt(11)
  v_mfma_f32_32x32x16_bf16 v[192:207], v[140:143], v[64:67], 0
  s_waitcnt lgkmcnt(10)
  v_mfma_f32_32x32x16_bf16 v[192:207], v[104:107], v[68:71], v[192:207]
  v_max3_f32 v28, v208, v209, v28
  v_max3_f32 v29, v210, v211, v29
  v_max3_f32 v28, v212, v213, v28
  v_max3_f32 v29, v214, v215, v29
  v_max3_f32 v28, v216, v217, v28
  v_max3_f32 v29, v218, v219, v29
  v_max3_f32 v28, v220, v221, v28
  v_max3_f32 v29, v222, v223, v29
  s_waitcnt lgkmcnt(9)
  v_mfma_f32_32x32x16_bf16 v[208:223], v[144:147], v[64:67], 0
  s_waitcnt lgkmcnt(8)
  v_mfma_f32_32x32x16_bf16 v[208:223], v[108:111], v[68:71], v[208:223]
  v_max3_f32 v28, v192, v193, v28
  v_max3_f32 v29, v194, v195, v29
  v_max3_f32 v28, v196, v197, v28
  v_max3_f32 v29, v198, v199, v29
  v_max3_f32 v28, v200, v201, v28
  v_max3_f32 v29, v202, v203, v29
  v_max3_f32 v28, v204, v205, v28
  v_max3_f32 v29, v206, v207, v29
  s_waitcnt lgkmcnt(7)
  v_mfma_f32_32x32x16_bf16 v[192:207], v[148:151], v[64:67], 0
  s_waitcnt lgkmcnt(6)
  v_mfma_f32_32x32x16_bf16 v[192:207], v[112:115], v[68:71], v[192:207]
  v_max3_f32 v28, v208, v209, v28
  v_max3_f32 v29, v210, v211, v29
  v_max3_f32 v28, v212, v213, v28
  v_max3_f32 v29, v214, v215, v29
  v_max3_f32 v28, v216, v217, v28
  v_max3_f32 v29, v218, v219, v29
  v_max3_f32 v28, v220, v221, v28
  v_max3_f32 v29, v222, v223, v29
  s_waitcnt lgkmcnt(5)
  v_mfma_f32_32x32x16_bf16 v[208:223], v[152:155], v[64:67], 0
  s_waitcnt lgkmcnt(4)
  v_mfma_f32_32x32x16_bf16 v[208:223], v[116:119], v[68:71], v[208:223]
  v_max3_f32 v28, v192, v193, v28
  v_max3_f32 v29, v194, v195, v29
  v_max3_f32 v28, v196, v197, v28
  v_max3_f32 v29, v198, v199, v29
  v_max3_f32 v28, v200, v201, v28
  v_max3_f32 v29, v202, v203, v29
  v_max3_f32 v28, v204, v205, v28
  v_max3_f32 v29, v206, v207, v29
  s_waitcnt lgkmcnt(3)
  v_mfma_f32_32x32x16_bf16 v[192:207], v[156:159], v[64:67], 0
  s_waitcnt lgkmcnt(2)
  v_mfma_f32_32x32x16_bf16 v[192:207], v[120:123], v[68:71], v[192:207]
  v_max3_f32 v28, v208, v209, v28
  v_max3_f32 v29, v210, v211, v29
  v_max3_f32 v28, v212, v213, v28
  v_max3_f32 v29, v214, v215, v29
  v_max3_f32 v28, v216, v217, v28
  v_max3_f32 v29, v218, v219, v29
  v_max3_f32 v28, v220, v221, v28
  v_max3_f32 v29, v222, v223, v29
  s_waitcnt lgkmcnt(1)
  v_mfma_f32_32x32x16_bf16 v[208:223], v[160:163], v[64:67], 0
  s_waitcnt lgkmcnt(0)
  v_mfma_f32_32x32x16_bf16 v[208:223], v[124:127], v[68:71], v[208:223]
  v_max3_f32 v28, v192, v193, v28
  v_max3_f32 v29, v194, v195, v29
  v_max3_f32 v28, v196, v197, v28
  v_max3_f32 v29, v198, v199, v29
  v_max3_f32 v28, v200, v201, v28
  v_max3_f32 v29, v202, v203, v29
  v_max3_f32 v28, v204, v205, v28
  v_max3_f32 v29, v206, v207, v29
  v_mfma_f32_32x32x16_bf16 v[192:207], v[164:167], v[64:67], v[32:47]
  v_mfma_f32_32x32x16_bf16 v[192:207], v[128:131], v[68:71], v[192:207]
  s_nop 1
  v_max3_f32 v28, v208, v209, v28
  v_max3_f32 v29, v210, v211, v29
  v_max3_f32 v28, v212, v213, v28
  v_max3_f32 v29, v214, v215, v29
  v_max3_f32 v28, v216, v217, v28
  v_max3_f32 v29, v218, v219, v29
  v_max3_f32 v28, v220, v221, v28
  v_max3_f32 v29, v222, v223, v29
  s_nop 1
  v_max3_f32 v28, v192, v193, v28
  v_max3_f32 v29, v194, v195, v29
  v_max3_f32 v28, v196, v197, v28
  v_max3_f32 v29, v198, v199, v29
  v_max3_f32 v28, v200, v201, v28
  v_max3_f32 v29, v202, v203, v29
  v_max3_f32 v28, v204, v205, v28
  v_max3_f32 v29, v206, v207, v29
  v_max_f32 v28, v28, v29
  v_mov_b32 v29, v28
  s_nop 1
  v_permlane32_swap_b32 v28, v29
  v_max_f32 v28, v28, v29
  v_sub_f32 v28, 0, v28
  v_cvt_pk_bf16_f32 v29, v28, v28
  v_and_b32 v29, s57, v29
  v_sub_f32 v28, v28, v29
  v_cvt_pk_bf16_f32 v28, v28, v28
  v_lshrrev_b32 v28, 16, v28
  v_or_b32 v29, 0x3f80, v29
  v_cmp_gt_u32 vcc, 32, v1
  s_nop 1
  v_cndmask_b32 v70, 0, v29, vcc
  v_cndmask_b32 v71, 0, v28, vcc
  ds_read_b64_tr_b16 v[168:169], v249 offset:0
  ds_read_b64_tr_b16 v[170:171], v249 offset:128
  ds_read_b64_tr_b16 v[172:173], v249 offset:256
  ds_read_b64_tr_b16 v[174:175], v249 offset:384
  v_mfma_f32_32x32x16_bf16 v[192:207], v[164:167], v[64:67], v[32:47]
  v_mfma_f32_32x32x16_bf16 v[192:207], v[128:131], v[68:71], v[192:207]
  s_nop 11
  v_exp_f32 v192, v192
  v_exp_f32 v193, v193
  v_exp_f32 v194, v194
  v_exp_f32 v195, v195
  v_exp_f32 v196, v196
  v_exp_f32 v197, v197
  v_exp_f32 v198, v198
  v_exp_f32 v199, v199
  v_cvt_pk_bf16_f32 v72, v192, v193
  v_cvt_pk_bf16_f32 v73, v194, v195
  v_cvt_pk_bf16_f32 v74, v196, v197
  v_cvt_pk_bf16_f32 v75, v198, v199
  v_exp_f32 v200, v200
  v_exp_f32 v201, v201
  s_waitcnt lgkmcnt(2)
  v_mfma_f32_32x32x16_bf16 v[224:239], v[168:171], v[72:75], 0
  v_exp_f32 v202, v202
  v_exp_f32 v203, v203
  v_exp_f32 v204, v204
  v_exp_f32 v205, v205
  v_exp_f32 v206, v206
  v_exp_f32 v207, v207
  v_cvt_pk_bf16_f32 v76, v200, v201
  v_cvt_pk_bf16_f32 v77, v202, v203
  v_cvt_pk_bf16_f32 v78, v204, v205
  v_cvt_pk_bf16_f32 v79, v206, v207
  s_waitcnt lgkmcnt(0)
  s_nop 0
  v_mfma_f32_32x32x16_bf16 v[224:239], v[172:175], v[76:79], v[224:239]
IF_86_else:
  ds_read_b64_tr_b16 v[168:169], v20 offset:0
  ds_read_b64_tr_b16 v[170:171], v20 offset:128
  ds_read_b64_tr_b16 v[172:173], v20 offset:256
  ds_read_b64_tr_b16 v[174:175], v20 offset:384
  v_add_u32 v20, v20, v21
  s_waitcnt lgkmcnt(15)
  v_mfma_f32_32x32x16_bf16 v[192:207], v[132:135], v[64:67], v[48:63]
  v_mfma_f32_32x32x16_bf16 v[192:207], v[96:99], v[68:71], v[192:207]
  v_mfma_f32_32x32x16_bf16 v[208:223], v[136:139], v[64:67], 0
  s_nop 10
  v_exp_f32 v192, v192
  v_exp_f32 v193, v193
  v_exp_f32 v194, v194
  v_exp_f32 v195, v195
  v_mfma_f32_32x32x16_bf16 v[208:223], v[100:103], v[68:71], v[208:223]
  v_exp_f32 v196, v196
  v_exp_f32 v197, v197
  v_exp_f32 v198, v198
  v_exp_f32 v199, v199
  v_cvt_pk_bf16_f32 v72, v192, v193
  v_cvt_pk_bf16_f32 v73, v194, v195
  v_cvt_pk_bf16_f32 v74, v196, v197
  v_cvt_pk_bf16_f32 v75, v198, v199
  v_exp_f32 v200, v200
  v_exp_f32 v201, v201
  s_waitcnt lgkmcnt(2)
  v_mfma_f32_32x32x16_bf16 v[224:239], v[168:171], v[72:75], v[224:239]
  v_exp_f32 v202, v202
  v_exp_f32 v203, v203
  v_exp_f32 v204, v204
  v_exp_f32 v205, v205
  v_exp_f32 v206, v206
  v_exp_f32 v207, v207
  ds_read_b64_tr_b16 v[176:177], v20 offset:0
  ds_read_b64_tr_b16 v[178:179], v20 offset:128
  ds_read_b64_tr_b16 v[180:181], v20 offset:256
  ds_read_b64_tr_b16 v[182:183], v20 offset:384
  v_add_u32 v20, v20, v21
  v_cvt_pk_bf16_f32 v76, v200, v201
  v_cvt_pk_bf16_f32 v77, v202, v203
  v_cvt_pk_bf16_f32 v78, v204, v205
  v_cvt_pk_bf16_f32 v79, v206, v207
  s_waitcnt lgkmcnt(4)
  s_nop 0
  v_mfma_f32_32x32x16_bf16 v[224:239], v[172:175], v[76:79], v[224:239]
  v_mfma_f32_32x32x16_bf16 v[192:207], v[140:143], v[64:67], 0
  v_exp_f32 v208, v208
  v_exp_f32 v209, v209
  v_exp_f32 v210, v210
  v_exp_f32 v211, v211
  v_mfma_f32_32x32x16_bf16 v[192:207], v[104:107], v[68:71], v[192:207]
  v_exp_f32 v212, v212
  v_exp_f32 v213, v213
  v_exp_f32 v214, v214
  v_exp_f32 v215, v215
  v_cvt_pk_bf16_f32 v72, v208, v209
  v_cvt_pk_bf16_f32 v73, v210, v211
  v_cvt_pk_bf16_f32 v74, v212, v213
  v_cvt_pk_bf16_f32 v75, v214, v215
  v_exp_f32 v216, v216
  v_exp_f32 v217, v217
  s_waitcnt lgkmcnt(2)
  v_mfma_f32_32x32x16_bf16 v[224:239], v[176:179], v[72:75], v[224:239]
  v_exp_f32 v218, v218
  v_exp_f32 v219, v219
  v_exp_f32 v220, v220
  v_exp_f32 v221, v221
  v_exp_f32 v222, v222
  v_exp_f32 v223, v223
  ds_read_b64_tr_b16 v[168:169], v20 offset:0
  ds_read_b64_tr_b16 v[170:171], v20 offset:128
  ds_read_b64_tr_b16 v[172:173], v20 offset:256
  ds_read_b64_tr_b16 v[174:175], v20 offset:384
  v_add_u32 v20, v20, v21
  v_cvt_pk_bf16_f32 v76, v216, v217
  v_cvt_pk_bf16_f32 v77, v218, v219
  v_cvt_pk_bf16_f32 v78, v220, v221
  v_cvt_pk_bf16_f32 v79, v222, v223
  s_waitcnt lgkmcnt(4)
  s_nop 0
  v_mfma_f32_32x32x16_bf16 v[224:239], v[180:183], v[76:79], v[224:239]
  v_mfma_f32_32x32x16_bf16 v[208:223], v[144:147], v[64:67], 0
  v_exp_f32 v192, v192
  v_exp_f32 v193, v193
  v_exp_f32 v194, v194
  v_exp_f32 v195, v195
  v_mfma_f32_32x32x16_bf16 v[208:223], v[108:111], v[68:71], v[208:223]
  v_exp_f32 v196, v196
  v_exp_f32 v197, v197
  v_exp_f32 v198, v198
  v_exp_f32 v199, v199
  v_cvt_pk_bf16_f32 v72, v192, v193
  v_cvt_pk_bf16_f32 v73, v194, v195
  v_cvt_pk_bf16_f32 v74, v196, v197
  v_cvt_pk_bf16_f32 v75, v198, v199
  v_exp_f32 v200, v200
  v_exp_f32 v201, v201
  s_waitcnt lgkmcnt(2)
  v_mfma_f32_32x32x16_bf16 v[224:239], v[168:171], v[72:75], v[224:239]
  v_exp_f32 v202, v202
  v_exp_f32 v203, v203
  v_exp_f32 v204, v204
  v_exp_f32 v205, v205
  v_exp_f32 v206, v206
  v_exp_f32 v207, v207
  ds_read_b64_tr_b16 v[176:177], v20 offset:0
  ds_read_b64_tr_b16 v[178:179], v20 offset:128
  ds_read_b64_tr_b16 v[180:181], v20 offset:256
  ds_read_b64_tr_b16 v[182:183], v20 offset:384
  v_add_u32 v20, v20, v21
  v_cvt_pk_bf16_f32 v76, v200, v201
  v_cvt_pk_bf16_f32 v77, v202, v203
  v_cvt_pk_bf16_f32 v78, v204, v205
  v_cvt_pk_bf16_f32 v79, v206, v207
  s_waitcnt lgkmcnt(4)
  s_nop 0
  v_mfma_f32_32x32x16_bf16 v[224:239], v[172:175], v[76:79], v[224:239]
  v_mfma_f32_32x32x16_bf16 v[192:207], v[148:151], v[64:67], 0
  v_exp_f32 v208, v208
  v_exp_f32 v209, v209
  v_exp_f32 v210, v210
  v_exp_f32 v211, v211
  v_mfma_f32_32x32x16_bf16 v[192:207], v[112:115], v[68:71], v[192:207]
  v_exp_f32 v212, v212
  v_exp_f32 v213, v213
  v_exp_f32 v214, v214
  v_exp_f32 v215, v215
  v_cvt_pk_bf16_f32 v72, v208, v209
  v_cvt_pk_bf16_f32 v73, v210, v211
  v_cvt_pk_bf16_f32 v74, v212, v213
  v_cvt_pk_bf16_f32 v75, v214, v215
  v_exp_f32 v216, v216
  v_exp_f32 v217, v217
  s_waitcnt lgkmcnt(2)
  v_mfma_f32_32x32x16_bf16 v[224:239], v[176:179], v[72:75], v[224:239]
  v_exp_f32 v218, v218
  v_exp_f32 v219, v219
  v_exp_f32 v220, v220
  v_exp_f32 v221, v221
  v_exp_f32 v222, v222
  v_exp_f32 v223, v223
  ds_read_b64_tr_b16 v[168:169], v20 offset:0
  ds_read_b64_tr_b16 v[170:171], v20 offset:128
  ds_read_b64_tr_b16 v[172:173], v20 offset:256
  ds_read_b64_tr_b16 v[174:175], v20 offset:384
  v_add_u32 v20, v20, v21
  v_cvt_pk_bf16_f32 v76, v216, v217
  v_cvt_pk_bf16_f32 v77, v218, v219
  v_cvt_pk_bf16_f32 v78, v220, v221
  v_cvt_pk_bf16_f32 v79, v222, v223
  s_waitcnt lgkmcnt(4)
  s_nop 0
  v_mfma_f32_32x32x16_bf16 v[224:239], v[180:183], v[76:79], v[224:239]
  v_mfma_f32_32x32x16_bf16 v[208:223], v[152:155], v[64:67], 0
  v_exp_f32 v192, v192
  v_exp_f32 v193, v193
  v_exp_f32 v194, v194
  v_exp_f32 v195, v195
  v_mfma_f32_32x32x16_bf16 v[208:223], v[116:119], v[68:71], v[208:223]
  v_exp_f32 v196, v196
  v_exp_f32 v197, v197
  v_exp_f32 v198, v198
  v_exp_f32 v199, v199
  v_cvt_pk_bf16_f32 v72, v192, v193
  v_cvt_pk_bf16_f32 v73, v194, v195
  v_cvt_pk_bf16_f32 v74, v196, v197
  v_cvt_pk_bf16_f32 v75, v198, v199
  v_exp_f32 v200, v200
  v_exp_f32 v201, v201
  s_waitcnt lgkmcnt(2)
  v_mfma_f32_32x32x16_bf16 v[224:239], v[168:171], v[72:75], v[224:239]
  v_exp_f32 v202, v202
  v_exp_f32 v203, v203
  v_exp_f32 v204, v204
  v_exp_f32 v205, v205
  v_exp_f32 v206, v206
  v_exp_f32 v207, v207
  ds_read_b64_tr_b16 v[176:177], v20 offset:0
  ds_read_b64_tr_b16 v[178:179], v20 offset:128
  ds_read_b64_tr_b16 v[180:181], v20 offset:256
  ds_read_b64_tr_b16 v[182:183], v20 offset:384
  v_add_u32 v20, v20, v21
  v_cvt_pk_bf16_f32 v76, v200, v201
  v_cvt_pk_bf16_f32 v77, v202, v203
  v_cvt_pk_bf16_f32 v78, v204, v205
  v_cvt_pk_bf16_f32 v79, v206, v207
  s_waitcnt lgkmcnt(4)
  s_nop 0
  v_mfma_f32_32x32x16_bf16 v[224:239], v[172:175], v[76:79], v[224:239]
  v_mfma_f32_32x32x16_bf16 v[192:207], v[156:159], v[64:67], 0
  v_exp_f32 v208, v208
  v_exp_f32 v209, v209
  v_exp_f32 v210, v210
  v_exp_f32 v211, v211
  v_mfma_f32_32x32x16_bf16 v[192:207], v[120:123], v[68:71], v[192:207]
  v_exp_f32 v212, v212
  v_exp_f32 v213, v213
  v_exp_f32 v214, v214
  v_exp_f32 v215, v215
  v_cvt_pk_bf16_f32 v72, v208, v209
  v_cvt_pk_bf16_f32 v73, v210, v211
  v_cvt_pk_bf16_f32 v74, v212, v213
  v_cvt_pk_bf16_f32 v75, v214, v215
  v_exp_f32 v216, v216
  v_exp_f32 v217, v217
  s_waitcnt lgkmcnt(2)
  v_mfma_f32_32x32x16_bf16 v[224:239], v[176:179], v[72:75], v[224:239]
  v_exp_f32 v218, v218
  v_exp_f32 v219, v219
  v_exp_f32 v220, v220
  v_exp_f32 v221, v221
  v_exp_f32 v222, v222
  v_exp_f32 v223, v223
  ds_read_b64_tr_b16 v[168:169], v20 offset:0
  ds_read_b64_tr_b16 v[170:171], v20 offset:128
  ds_read_b64_tr_b16 v[172:173], v20 offset:256
  ds_read_b64_tr_b16 v[174:175], v20 offset:384
  v_add_u32 v20, v20, v21
  v_cvt_pk_bf16_f32 v76, v216, v217
  v_cvt_pk_bf16_f32 v77, v218, v219
  v_cvt_pk_bf16_f32 v78, v220, v221
  v_cvt_pk_bf16_f32 v79, v222, v223
  s_cmp_lt_u32 s55, 4
  s_cbranch_scc0 IF_87_else
  s_mul_i32 s69, s53, 5
  s_lshr_b32 s69, s69, 2
  s_add_u32 s69, s69, 20
  v_mul_u32_u24 v188, 2979, v0
  v_lshrrev_b32 v188, 16, v188
  v_mul_u32_u24 v189, 22, v188
  v_sub_u32 v189, v0, v189
  v_mul_u32_u24 v185, 12, v189
  v_lshl_add_u32 v185, v188, 8, v185
  v_add_u32 v185, 161792, v185
  v_lshrrev_b32 v184, 1, v188
  v_lshl_add_u32 v184, v184, 3, v188
  v_add_u32 v184, s69, v184
  v_min_u32 v184, 59, v184
  v_lshlrev_b32 v184, 11, v184
  v_lshl_add_u32 v184, v189, 4, v184
  v_cmp_gt_u32 vcc, 8, v188
  v_mov_b32 v190, 161536
  s_nop 0
  v_cndmask_b32 v184, 0, v184, vcc
  v_cndmask_b32 v185, v190, v185, vcc
  v_cmp_gt_u32 vcc, 21, v189
  s_nop 1
  v_cndmask_b32 v186, v190, v185, vcc
  v_lshrrev_b32 v188, 1, v188
  v_cmp_eq_u32 vcc, 2, v188
  s_nop 1
  v_cndmask_b32 v187, 0, 1.0, vcc
  s_mov_b32 s69, 4096
  buffer_load_dwordx4 v[80:83], v184, s[44:47], s69 offen offset:0 sc1
  buffer_load_dwordx4 v[84:87], v184, s[44:47], s69 offen offset:512 sc1
  buffer_load_dwordx4 v[88:91], v184, s[44:47], s69 offen offset:1024 sc1
  buffer_load_dwordx4 v[92:95], v184, s[44:47], s69 offen offset:1536 sc1
  v_min_u32 v246, 19, v1
  v_lshlrev_b32 v246, 7, v246
  s_mul_i32 s70, s53, 2560
  s_add_u32 s70, s70, 2228224
  buffer_load_dword v245, v246, s[44:47], s70 offen sc1
IF_87_else:
  s_waitcnt lgkmcnt(4)
  v_mfma_f32_32x32x16_bf16 v[224:239], v[180:183], v[76:79], v[224:239]
  v_mfma_f32_32x32x16_bf16 v[208:223], v[160:163], v[64:67], 0
  v_exp_f32 v192, v192
  v_exp_f32 v193, v193
  v_exp_f32 v194, v194
  v_exp_f32 v195, v195
  v_mfma_f32_32x32x16_bf16 v[208:223], v[124:127], v[68:71], v[208:223]
  v_exp_f32 v196, v196
  v_exp_f32 v197, v197
  v_exp_f32 v198, v198
  v_exp_f32 v199, v199
  v_cvt_pk_bf16_f32 v72, v192, v193
  v_cvt_pk_bf16_f32 v73, v194, v195
  v_cvt_pk_bf16_f32 v74, v196, v197
  v_cvt_pk_bf16_f32 v75, v198, v199
  v_exp_f32 v200, v200
  v_exp_f32 v201, v201
  s_waitcnt lgkmcnt(2)
  v_mfma_f32_32x32x16_bf16 v[224:239], v[168:171], v[72:75], v[224:239]
  v_exp_f32 v202, v202
  v_exp_f32 v203, v203
  v_exp_f32 v204, v204
  v_exp_f32 v205, v205
  v_exp_f32 v206, v206
  v_exp_f32 v207, v207
  ds_read_b64_tr_b16 v[176:177], v20 offset:0
  ds_read_b64_tr_b16 v[178:179], v20 offset:128
  ds_read_b64_tr_b16 v[180:181], v20 offset:256
  ds_read_b64_tr_b16 v[182:183], v20 offset:384
  v_add_u32 v20, v20, v21
  v_cvt_pk_bf16_f32 v76, v200, v201
  v_cvt_pk_bf16_f32 v77, v202, v203
  v_cvt_pk_bf16_f32 v78, v204, v205
  v_cvt_pk_bf16_f32 v79, v206, v207
  s_waitcnt lgkmcnt(4)
  s_nop 0
  v_mfma_f32_32x32x16_bf16 v[224:239], v[172:175], v[76:79], v[224:239]
  v_exp_f32 v208, v208
  v_exp_f32 v209, v209
  v_exp_f32 v210, v210
  v_exp_f32 v211, v211
  v_exp_f32 v212, v212
  v_exp_f32 v213, v213
  v_exp_f32 v214, v214
  v_exp_f32 v215, v215
  v_cvt_pk_bf16_f32 v72, v208, v209
  v_cvt_pk_bf16_f32 v73, v210, v211
  v_cvt_pk_bf16_f32 v74, v212, v213
  v_cvt_pk_bf16_f32 v75, v214, v215
  v_exp_f32 v216, v216
  v_exp_f32 v217, v217
  s_waitcnt lgkmcnt(2)
  v_mfma_f32_32x32x16_bf16 v[224:239], v[176:179], v[72:75], v[224:239]
  v_exp_f32 v218, v218
  v_exp_f32 v219, v219
  v_exp_f32 v220, v220
  v_exp_f32 v221, v221
  v_exp_f32 v222, v222
  v_exp_f32 v223, v223
  v_cvt_pk_bf16_f32 v76, v216, v217
  v_cvt_pk_bf16_f32 v77, v218, v219
  v_cvt_pk_bf16_f32 v78, v220, v221
  v_cvt_pk_bf16_f32 v79, v222, v223
  s_waitcnt lgkmcnt(0)
  s_nop 0
  v_mfma_f32_32x32x16_bf16 v[224:239], v[180:183], v[76:79], v[224:239]
  s_nop 11
  v_cmp_nle_f32 vcc, v236, v248
  s_nop 0
  s_cmp_lg_u64 vcc, 0
  s_cselect_b32 s63, 1, 0
  s_andn2_b32 s63, s63, s76
  s_mov_b32 s76, 1
  s_cbranch_scc1 LP_88
  v_rcp_f32 v28, v236
  s_nop 0
  v_mul_f32 v224, v224, v28
  v_mul_f32 v225, v225, v28
  v_mul_f32 v226, v226, v28
  v_mul_f32 v227, v227, v28
  v_mul_f32 v228, v228, v28
  v_mul_f32 v229, v229, v28
  v_mul_f32 v230, v230, v28
  v_mul_f32 v231, v231, v28
  v_mul_f32 v232, v232, v28
  v_mul_f32 v233, v233, v28
  v_mul_f32 v234, v234, v28
  v_mul_f32 v235, v235, v28
  v_cvt_pk_bf16_f32 v72, v224, v225
  v_cvt_pk_bf16_f32 v73, v226, v227
  v_cvt_pk_bf16_f32 v74, v228, v229
  v_cvt_pk_bf16_f32 v75, v230, v231
  v_cvt_pk_bf16_f32 v76, v232, v233
  v_cvt_pk_bf16_f32 v77, v234, v235
  s_cmp_lt_u32 s55, 4
  s_cbranch_scc1 IF_89_end
  s_setprio 2
IF_89_end:
  s_cmp_lg_u32 s80, 0
  s_cbranch_scc0 IF_238_else
  buffer_store_dwordx4 v[72:75], v24, s[44:47], s75 offen
  buffer_store_dwordx2 v[76:77], v23, s[44:47], s74 offen offset:512
  s_cmp_lt_u32 s55, 4
  s_cbranch_scc0 IF_94_else
  s_lshr_b32 s65, s59, 1
  s_lshl_b32 s65, s65, 5
  s_and_b32 s63, s59, 1
  s_lshl_b32 s63, s63, 2
  s_add_u32 s65, s65, s63
  s_lshl_b32 s63, s52, 6
  s_add_u32 s65, s65, s63
  v_bfe_u32 v235, v1, 2, 2
  v_and_b32 v2, 3, v1
  v_lshl_add_u32 v235, v235, 3, v2
  v_add_u32 v235, s65, v235
  v_mul_u32_u24 v235, 1280, v235
  v_lshrrev_b32 v2, 4, v1
  v_lshl_add_u32 v235, v2, 3, v235
  s_mul_i32 s65, s53, 160
  buffer_load_dwordx2 v[224:225], v235, s[4:7], s65 offen offset:0
  buffer_load_dwordx2 v[226:227], v235, s[4:7], s65 offen offset:32
  buffer_load_dwordx2 v[228:229], v235, s[4:7], s65 offen offset:64
  buffer_load_dwordx2 v[230:231], v235, s[4:7], s65 offen offset:96
  buffer_load_dwordx2 v[232:233], v235, s[4:7], s65 offen offset:128
  s_waitcnt vmcnt(7)
  v_cmp_ne_u32 vcc, s54, v245
  s_cbranch_vccz IF_91_else
  s_mov_b32 s58, 1048576
LP_90:
  s_sleep 2
  buffer_load_dword v245, v246, s[44:47], s70 offen sc1
  s_waitcnt vmcnt(0)
  v_cmp_ne_u32 vcc, s54, v245
  s_sub_u32 s58, s58, 1
  s_cselect_b64 vcc, 0, vcc
  s_cbranch_vccnz LP_90
IF_91_else:
  s_mul_i32 s66, s59, 5120
  s_mul_i32 s67, s53, 102400
  s_add_u32 s67, s67, s66
  s_add_u32 s63, s67, 21446656
  s_add_u32 m0, s66, 62464
  s_nop 0
  buffer_load_dwordx4 v30, s[44:47], s63 offen offset:0 sc1 lds
  s_add_u32 m0, s66, 62464
  s_nop 0
  buffer_load_dwordx4 v30, s[44:47], s63 offen offset:1024 sc1 lds
  s_add_u32 m0, s66, 62464
  s_nop 0
  buffer_load_dwordx4 v30, s[44:47], s63 offen offset:2048 sc1 lds
  s_add_u32 m0, s66, 62464
  s_nop 0
  buffer_load_dwordx4 v30, s[44:47], s63 offen offset:3072 sc1 lds
  s_add_u32 s63, s67, 21450752
  s_add_u32 m0, s66, 66560
  s_nop 0
  buffer_load_dwordx4 v30, s[44:47], s63 offen offset:0 sc1 lds
  s_lshl_b32 s63, s73, 7
  s_add_u32 s63, s63, 393216
  v_mov_b32 v236, s54
  v_lshlrev_b32 v237, 26, v1
  v_and_b32 v237, 2147483648, v237
  v_lshl_or_b32 v237, v1, 2, v237
  s_waitcnt vmcnt(10)
  buffer_store_dword v236, v237, s[44:47], s63 offen
  s_add_u32 s63, s67, 21467136
  s_add_u32 m0, s66, 82944
  s_nop 0
  buffer_load_dwordx4 v30, s[44:47], s63 offen offset:0 sc1 lds
  s_add_u32 m0, s66, 82944
  s_nop 0
  buffer_load_dwordx4 v30, s[44:47], s63 offen offset:1024 sc1 lds
  s_add_u32 m0, s66, 82944
  s_nop 0
  buffer_load_dwordx4 v30, s[44:47], s63 offen offset:2048 sc1 lds
  s_add_u32 m0, s66, 82944
  s_nop 0
  buffer_load_dwordx4 v30, s[44:47], s63 offen offset:3072 sc1 lds
  s_add_u32 s63, s67, 21471232
  s_add_u32 m0, s66, 87040
  s_nop 0
  buffer_load_dwordx4 v30, s[44:47], s63 offen offset:0 sc1 lds
  v_xor_b32 v188, s54, v83
  v_xor_b32 v189, s54, v87
  v_xor_b32 v190, s54, v91
  v_xor_b32 v191, s54, v95
  v_or3_b32 v188, v188, v189, v190
  v_or_b32 v188, v188, v191
  v_cmp_ne_u32 vcc, 0, v188
  s_cbranch_vccz IF_93_else
  s_mov_b32 s58, 1048576
LP_92:
  s_sleep 2
  s_mov_b32 s65, 4096
  buffer_load_dwordx4 v[80:83], v184, s[44:47], s65 offen offset:0 sc1
  buffer_load_dwordx4 v[84:87], v184, s[44:47], s65 offen offset:512 sc1
  buffer_load_dwordx4 v[88:91], v184, s[44:47], s65 offen offset:1024 sc1
  buffer_load_dwordx4 v[92:95], v184, s[44:47], s65 offen offset:1536 sc1
  s_waitcnt vmcnt(3)
  v_xor_b32 v188, s54, v83
  s_waitcnt vmcnt(2)
  v_xor_b32 v189, s54, v87
  s_waitcnt vmcnt(1)
  v_xor_b32 v190, s54, v91
  s_waitcnt vmcnt(0)
  v_xor_b32 v191, s54, v95
  v_or3_b32 v188, v188, v189, v190
  v_or_b32 v188, v188, v191
  v_cmp_ne_u32 vcc, 0, v188
  s_sub_u32 s58, s58, 1
  s_cselect_b64 vcc, 0, vcc
  s_cbranch_vccnz LP_92
IF_93_else:
  v_add_f32 v80, v80, v84
  v_add_f32 v88, v88, v92
  v_add_f32 v81, v81, v85
  v_add_f32 v89, v89, v93
  v_add_f32 v82, v82, v86
  v_add_f32 v90, v90, v94
  v_add_f32 v80, v80, v88
  v_add_f32 v81, v81, v89
  v_add_f32 v82, v82, v90
  v_cvt_pk_bf16_f32 v84, v80, v81
  v_cvt_pk_bf16_f32 v85, v82, v82
  v_lshlrev_b32 v80, 16, v84
  v_and_b32 v81, s57, v84
  v_lshlrev_b32 v82, 16, v85
  v_add_f32 v80, v80, v187
  v_add_f32 v81, v81, v187
  v_add_f32 v82, v82, v187
  v_cvt_pk_bf16_f32 v84, v80, v81
  v_cvt_pk_bf16_f32 v85, v82, v82
  v_lshlrev_b32 v80, 16, v84
  v_and_b32 v81, s57, v84
  v_lshlrev_b32 v82, 16, v85
  ds_write_b32 v185, v80
  ds_write2_b32 v186, v81, v82 offset0:1 offset1:2
  s_waitcnt vmcnt(0)
  s_branch IF_94_end
IF_94_else:
  s_lshl_b32 s63, s73, 7
  s_add_u32 s63, s63, 393216
  v_mov_b32 v236, s54
  v_lshlrev_b32 v237, 26, v1
  v_and_b32 v237, 2147483648, v237
  v_lshl_or_b32 v237, v1, 2, v237
  s_waitcnt vmcnt(0)
  buffer_store_dword v236, v237, s[44:47], s63 offen
  s_setprio 0
  s_lshl_b32 s65, s56, 3
  s_add_u32 s65, s65, s53
  s_mul_i32 s65, s65, 20
  s_mul_i32 s70, s59, 7168
  s_mul_i32 s69, s65, 7168
  s_add_u32 s69, s69, s70
  s_add_u32 s65, s65, 160
  v_min_u32 v20, 19, v1
  v_lshlrev_b32 v20, 7, v20
  s_lshl_b32 s65, s65, 7
  s_add_u32 s71, s65, 2228224
  buffer_load_dword v21, v20, s[44:47], s71 offen sc1
IF_94_end:
  s_waitcnt lgkmcnt(0)
  s_barrier
  s_cmp_lt_u32 s55, 4
  s_cbranch_scc0 IF_111_else
  v_lshlrev_b32 v239, 4, v1
  v_add_u32 v237, 62464, v239
  v_add_u32 v238, 123904, v239
  s_lshl_b32 s66, s52, 2
  s_add_u32 s66, s66, s59
  s_mul_i32 s67, s66, 20480
  s_add_u32 s67, s67, 8257536
  ds_read_b128 v[144:147], v237 offset:0
  ds_read_b128 v[148:151], v237 offset:1024
  ds_read_b128 v[152:155], v237 offset:2048
  ds_read_b128 v[156:159], v237 offset:3072
  ds_read_b128 v[160:163], v237 offset:4096
  ds_read_b128 v[164:167], v237 offset:5120
  ds_read_b128 v[168:171], v237 offset:6144
  ds_read_b128 v[172:175], v237 offset:7168
  ds_read_b128 v[176:179], v237 offset:8192
  ds_read_b128 v[180:183], v237 offset:9216
  s_mul_i32 s63, s53, 5
  s_and_b32 s63, s63, 3
  s_lshl_b32 s63, s63, 6
  s_add_u32 s63, s63, 161792
  v_and_b32 v234, 48, v1
  v_add_u32 v234, s63, v234
  ds_read_b128 v[4:7], v234 offset:0
  ds_read_b128 v[8:11], v234 offset:64
  ds_read_b128 v[12:15], v234 offset:128
  ds_read_b128 v[16:19], v234 offset:192
  ds_read_b128 v[20:23], v234 offset:256
  ds_read_b128 v[24:27], v234 offset:512
  ds_read_b128 v[28:31], v234 offset:576
  ds_read_b128 v[32:35], v234 offset:640
  ds_read_b128 v[36:39], v234 offset:704
  ds_read_b128 v[40:43], v234 offset:768
  ds_read_b128 v[44:47], v234 offset:1024
  ds_read_b128 v[48:51], v234 offset:1088
  ds_read_b128 v[52:55], v234 offset:1152
  ds_read_b128 v[56:59], v234 offset:1216
  ds_read_b128 v[60:63], v234 offset:1280
  s_lshr_b32 s65, s66, 1
  s_lshl_b32 s65, s65, 5
  v_and_b32 v240, 31, v1
  v_lshlrev_b32 v240, 7, v240
  s_lshl_b32 s63, s65, 7
  s_add_u32 s63, s63, 393216
  buffer_load_dword v241, v240, s[44:47], s63 offen sc1
  s_waitcnt vmcnt(0)
  v_cmp_ne_u32 vcc, s54, v241
  s_cbranch_vccz IF_96_else
  s_mov_b32 s58, 1048576
LP_95:
  s_sleep 2
  buffer_load_dword v241, v240, s[44:47], s63 offen sc1
  s_waitcnt vmcnt(0)
  v_cmp_ne_u32 vcc, s54, v241
  s_sub_u32 s58, s58, 1
  s_cselect_b64 vcc, 0, vcc
  s_cbranch_vccnz LP_95
IF_96_else:
  buffer_load_dwordx4 v[64:67], v239, s[44:47], s67 offen offset:0 sc1
  buffer_load_dwordx4 v[68:71], v239, s[44:47], s67 offen offset:1024 sc1
  buffer_load_dwordx4 v[72:75], v239, s[44:47], s67 offen offset:2048 sc1
  buffer_load_dwordx4 v[76:79], v239, s[44:47], s67 offen offset:3072 sc1
  s_waitcnt vmcnt(3) lgkmcnt(15)
  v_mfma_f32_16x16x32_bf16 v[204:207], v[144:147], v[64:67], 0
  ds_read_b128 v[184:187], v237 offset:10240
  v_mfma_f32_16x16x32_bf16 v[208:211], v[148:151], v[64:67], 0
  ds_read_b128 v[188:191], v237 offset:11264
  s_add_u32 s67, s67, 4096
  buffer_load_dwordx4 v[80:83], v239, s[44:47], s67 offen offset:0 sc1
  v_mfma_f32_16x16x32_bf16 v[212:215], v[152:155], v[64:67], 0
  ds_read_b128 v[192:195], v237 offset:12288
  v_mfma_f32_16x16x32_bf16 v[216:219], v[156:159], v[64:67], 0
  ds_read_b128 v[196:199], v237 offset:13312
  buffer_load_dwordx4 v[84:87], v239, s[44:47], s67 offen offset:1024 sc1
  v_mfma_f32_16x16x32_bf16 v[220:223], v[160:163], v[64:67], 0
  ds_read_b128 v[200:203], v237 offset:14336
  s_waitcnt vmcnt(4)
  v_mfma_f32_16x16x32_bf16 v[204:207], v[164:167], v[68:71], v[204:207]
  ds_read_b128 v[144:147], v237 offset:15360
  v_mfma_f32_16x16x32_bf16 v[208:211], v[168:171], v[68:71], v[208:211]
  ds_read_b128 v[148:151], v237 offset:16384
  buffer_load_dwordx4 v[88:91], v239, s[44:47], s67 offen offset:2048 sc1
  v_mfma_f32_16x16x32_bf16 v[212:215], v[172:175], v[68:71], v[212:215]
  ds_read_b128 v[152:155], v237 offset:17408
  v_mfma_f32_16x16x32_bf16 v[216:219], v[176:179], v[68:71], v[216:219]
  ds_read_b128 v[156:159], v237 offset:18432
  buffer_load_dwordx4 v[92:95], v239, s[44:47], s67 offen offset:3072 sc1
  v_mfma_f32_16x16x32_bf16 v[220:223], v[180:183], v[68:71], v[220:223]
  ds_read_b128 v[160:163], v237 offset:19456
  s_waitcnt vmcnt(5) lgkmcnt(9)
  v_mfma_f32_16x16x32_bf16 v[204:207], v[184:187], v[72:75], v[204:207]
  ds_read_b128 v[164:167], v237 offset:20480
  s_waitcnt lgkmcnt(9)
  v_mfma_f32_16x16x32_bf16 v[208:211], v[188:191], v[72:75], v[208:211]
  ds_read_b128 v[168:171], v237 offset:21504
  s_add_u32 s67, s67, 4096
  buffer_load_dwordx4 v[96:99], v239, s[44:47], s67 offen offset:0 sc1
  s_waitcnt lgkmcnt(9)
  v_mfma_f32_16x16x32_bf16 v[212:215], v[192:195], v[72:75], v[212:215]
  ds_read_b128 v[172:175], v237 offset:22528
  s_waitcnt lgkmcnt(9)
  v_mfma_f32_16x16x32_bf16 v[216:219], v[196:199], v[72:75], v[216:219]
  ds_read_b128 v[176:179], v237 offset:23552
  buffer_load_dwordx4 v[100:103], v239, s[44:47], s67 offen offset:1024 sc1
  s_waitcnt lgkmcnt(9)
  v_mfma_f32_16x16x32_bf16 v[220:223], v[200:203], v[72:75], v[220:223]
  ds_read_b128 v[180:183], v237 offset:24576
  s_waitcnt vmcnt(6) lgkmcnt(9)
  v_mfma_f32_16x16x32_bf16 v[204:207], v[144:147], v[76:79], v[204:207]
  ds_read_b128 v[184:187], v237 offset:25600
  s_waitcnt lgkmcnt(9)
  v_mfma_f32_16x16x32_bf16 v[208:211], v[148:151], v[76:79], v[208:211]
  ds_read_b128 v[188:191], v237 offset:26624
  buffer_load_dwordx4 v[104:107], v239, s[44:47], s67 offen offset:2048 sc1
  s_waitcnt lgkmcnt(9)
  v_mfma_f32_16x16x32_bf16 v[212:215], v[152:155], v[76:79], v[212:215]
  ds_read_b128 v[192:195], v237 offset:27648
  s_waitcnt lgkmcnt(9)
  v_mfma_f32_16x16x32_bf16 v[216:219], v[156:159], v[76:79], v[216:219]
  ds_read_b128 v[196:199], v237 offset:28672
  buffer_load_dwordx4 v[108:111], v239, s[44:47], s67 offen offset:3072 sc1
  s_waitcnt lgkmcnt(9)
  v_mfma_f32_16x16x32_bf16 v[220:223], v[160:163], v[76:79], v[220:223]
  ds_read_b128 v[200:203], v237 offset:29696
  s_waitcnt vmcnt(7) lgkmcnt(9)
  v_mfma_f32_16x16x32_bf16 v[204:207], v[164:167], v[80:83], v[204:207]
  ds_read_b128 v[144:147], v237 offset:30720
  s_waitcnt lgkmcnt(9)
  v_mfma_f32_16x16x32_bf16 v[208:211], v[168:171], v[80:83], v[208:211]
  ds_read_b128 v[148:151], v237 offset:31744
  s_add_u32 s67, s67, 4096
  buffer_load_dwordx4 v[112:115], v239, s[44:47], s67 offen offset:0 sc1
  s_waitcnt lgkmcnt(9)
  v_mfma_f32_16x16x32_bf16 v[212:215], v[172:175], v[80:83], v[212:215]
  ds_read_b128 v[152:155], v237 offset:32768
  s_waitcnt lgkmcnt(9)
  v_mfma_f32_16x16x32_bf16 v[216:219], v[176:179], v[80:83], v[216:219]
  ds_read_b128 v[156:159], v237 offset:33792
  buffer_load_dwordx4 v[116:119], v239, s[44:47], s67 offen offset:1024 sc1
  s_waitcnt lgkmcnt(9)
  v_mfma_f32_16x16x32_bf16 v[220:223], v[180:183], v[80:83], v[220:223]
  ds_read_b128 v[160:163], v237 offset:34816
  s_waitcnt vmcnt(8) lgkmcnt(9)
  v_mfma_f32_16x16x32_bf16 v[204:207], v[184:187], v[84:87], v[204:207]
  ds_read_b128 v[164:167], v237 offset:35840
  s_waitcnt lgkmcnt(9)
  v_mfma_f32_16x16x32_bf16 v[208:211], v[188:191], v[84:87], v[208:211]
  ds_read_b128 v[168:171], v237 offset:36864
  buffer_load_dwordx4 v[120:123], v239, s[44:47], s67 offen offset:2048 sc1
  s_waitcnt lgkmcnt(9)
  v_mfma_f32_16x16x32_bf16 v[212:215], v[192:195], v[84:87], v[212:215]
  ds_read_b128 v[172:175], v237 offset:37888
  s_waitcnt lgkmcnt(9)
  v_mfma_f32_16x16x32_bf16 v[216:219], v[196:199], v[84:87], v[216:219]
  ds_read_b128 v[176:179], v237 offset:38912
  s_waitcnt lgkmcnt(9)
  v_mfma_f32_16x16x32_bf16 v[220:223], v[200:203], v[84:87], v[220:223]
  ds_read_b128 v[180:183], v237 offset:39936
  s_barrier
  s_waitcnt vmcnt(8) lgkmcnt(9)
  v_mfma_f32_16x16x32_bf16 v[204:207], v[144:147], v[88:91], v[204:207]
  ds_read_b128 v[184:187], v237 offset:40960
  s_waitcnt lgkmcnt(9)
  v_mfma_f32_16x16x32_bf16 v[208:211], v[148:151], v[88:91], v[208:211]
  ds_read_b128 v[188:191], v237 offset:41984
  buffer_load_dwordx4 v[124:127], v239, s[44:47], s67 offen offset:3072 sc1
  s_waitcnt lgkmcnt(9)
  v_mfma_f32_16x16x32_bf16 v[212:215], v[152:155], v[88:91], v[212:215]
  ds_read_b128 v[192:195], v237 offset:43008
  s_waitcnt lgkmcnt(9)
  v_mfma_f32_16x16x32_bf16 v[216:219], v[156:159], v[88:91], v[216:219]
  ds_read_b128 v[196:199], v237 offset:44032
  s_waitcnt lgkmcnt(9)
  v_mfma_f32_16x16x32_bf16 v[220:223], v[160:163], v[88:91], v[220:223]
  ds_read_b128 v[200:203], v237 offset:45056
  s_waitcnt vmcnt(8) lgkmcnt(9)
  v_mfma_f32_16x16x32_bf16 v[204:207], v[164:167], v[92:95], v[204:207]
  ds_read_b128 v[144:147], v237 offset:46080
  s_waitcnt lgkmcnt(9)
  v_mfma_f32_16x16x32_bf16 v[208:211], v[168:171], v[92:95], v[208:211]
  ds_read_b128 v[148:151], v237 offset:47104
  s_add_u32 s67, s67, 4096
  buffer_load_dwordx4 v[128:131], v239, s[44:47], s67 offen offset:0 sc1
  s_waitcnt lgkmcnt(9)
  v_mfma_f32_16x16x32_bf16 v[212:215], v[172:175], v[92:95], v[212:215]
  ds_read_b128 v[152:155], v237 offset:48128
  s_waitcnt lgkmcnt(9)
  v_mfma_f32_16x16x32_bf16 v[216:219], v[176:179], v[92:95], v[216:219]
  ds_read_b128 v[156:159], v237 offset:49152
  s_waitcnt lgkmcnt(9)
  v_mfma_f32_16x16x32_bf16 v[220:223], v[180:183], v[92:95], v[220:223]
  ds_read_b128 v[160:163], v237 offset:50176
  s_waitcnt vmcnt(8) lgkmcnt(9)
  v_mfma_f32_16x16x32_bf16 v[204:207], v[184:187], v[96:99], v[204:207]
  ds_read_b128 v[164:167], v237 offset:51200
  s_waitcnt lgkmcnt(9)
  v_mfma_f32_16x16x32_bf16 v[208:211], v[188:191], v[96:99], v[208:211]
  ds_read_b128 v[168:171], v237 offset:52224
  buffer_load_dwordx4 v[132:135], v239, s[44:47], s67 offen offset:1024 sc1
  s_waitcnt lgkmcnt(9)
  v_mfma_f32_16x16x32_bf16 v[212:215], v[192:195], v[96:99], v[212:215]
  ds_read_b128 v[172:175], v237 offset:53248
  s_waitcnt lgkmcnt(9)
  v_mfma_f32_16x16x32_bf16 v[216:219], v[196:199], v[96:99], v[216:219]
  ds_read_b128 v[176:179], v237 offset:54272
  s_waitcnt lgkmcnt(9)
  v_mfma_f32_16x16x32_bf16 v[220:223], v[200:203], v[96:99], v[220:223]
  ds_read_b128 v[180:183], v237 offset:55296
  s_waitcnt vmcnt(8) lgkmcnt(9)
  v_mfma_f32_16x16x32_bf16 v[204:207], v[144:147], v[100:103], v[204:207]
  ds_read_b128 v[184:187], v237 offset:56320
  s_waitcnt lgkmcnt(9)
  v_mfma_f32_16x16x32_bf16 v[208:211], v[148:151], v[100:103], v[208:211]
  ds_read_b128 v[188:191], v237 offset:57344
  buffer_load_dwordx4 v[136:139], v239, s[44:47], s67 offen offset:2048 sc1
  s_waitcnt lgkmcnt(9)
  v_mfma_f32_16x16x32_bf16 v[212:215], v[152:155], v[100:103], v[212:215]
  ds_read_b128 v[192:195], v237 offset:58368
  s_waitcnt lgkmcnt(9)
  v_mfma_f32_16x16x32_bf16 v[216:219], v[156:159], v[100:103], v[216:219]
  ds_read_b128 v[196:199], v237 offset:59392
  s_waitcnt lgkmcnt(9)
  v_mfma_f32_16x16x32_bf16 v[220:223], v[160:163], v[100:103], v[220:223]
  ds_read_b128 v[200:203], v237 offset:60416
  s_barrier
  s_waitcnt vmcnt(8) lgkmcnt(9)
  v_mfma_f32_16x16x32_bf16 v[204:207], v[164:167], v[104:107], v[204:207]
  ds_read_b128 v[144:147], v238 offset:0
  s_waitcnt lgkmcnt(9)
  v_mfma_f32_16x16x32_bf16 v[208:211], v[168:171], v[104:107], v[208:211]
  ds_read_b128 v[148:151], v238 offset:1024
  buffer_load_dwordx4 v[140:143], v239, s[44:47], s67 offen offset:3072 sc1
  s_waitcnt lgkmcnt(9)
  v_mfma_f32_16x16x32_bf16 v[212:215], v[172:175], v[104:107], v[212:215]
  ds_read_b128 v[152:155], v238 offset:2048
  s_waitcnt lgkmcnt(9)
  v_mfma_f32_16x16x32_bf16 v[216:219], v[176:179], v[104:107], v[216:219]
  ds_read_b128 v[156:159], v238 offset:3072
  s_waitcnt lgkmcnt(9)
  v_mfma_f32_16x16x32_bf16 v[220:223], v[180:183], v[104:107], v[220:223]
  ds_read_b128 v[160:163], v238 offset:4096
  s_waitcnt vmcnt(8) lgkmcnt(9)
  v_mfma_f32_16x16x32_bf16 v[204:207], v[184:187], v[108:111], v[204:207]
  ds_read_b128 v[164:167], v238 offset:5120
  s_waitcnt lgkmcnt(9)
  v_mfma_f32_16x16x32_bf16 v[208:211], v[188:191], v[108:111], v[208:211]
  ds_read_b128 v[168:171], v238 offset:6144
  s_waitcnt lgkmcnt(9)
  v_mfma_f32_16x16x32_bf16 v[212:215], v[192:195], v[108:111], v[212:215]
  ds_read_b128 v[172:175], v238 offset:7168
  s_waitcnt lgkmcnt(9)
  v_mfma_f32_16x16x32_bf16 v[216:219], v[196:199], v[108:111], v[216:219]
  ds_read_b128 v[176:179], v238 offset:8192
  s_waitcnt lgkmcnt(9)
  v_mfma_f32_16x16x32_bf16 v[220:223], v[200:203], v[108:111], v[220:223]
  ds_read_b128 v[180:183], v238 offset:9216
  s_waitcnt vmcnt(7) lgkmcnt(9)
  v_mfma_f32_16x16x32_bf16 v[204:207], v[144:147], v[112:115], v[204:207]
  ds_read_b128 v[184:187], v238 offset:10240
  s_waitcnt lgkmcnt(9)
  v_mfma_f32_16x16x32_bf16 v[208:211], v[148:151], v[112:115], v[208:211]
  ds_read_b128 v[188:191], v238 offset:11264
  s_waitcnt lgkmcnt(9)
  v_mfma_f32_16x16x32_bf16 v[212:215], v[152:155], v[112:115], v[212:215]
  ds_read_b128 v[192:195], v238 offset:12288
  s_waitcnt lgkmcnt(9)
  v_mfma_f32_16x16x32_bf16 v[216:219], v[156:159], v[112:115], v[216:219]
  ds_read_b128 v[196:199], v238 offset:13312
  s_waitcnt lgkmcnt(9)
  v_mfma_f32_16x16x32_bf16 v[220:223], v[160:163], v[112:115], v[220:223]
  ds_read_b128 v[200:203], v238 offset:14336
  s_waitcnt vmcnt(6) lgkmcnt(9)
  v_mfma_f32_16x16x32_bf16 v[204:207], v[164:167], v[116:119], v[204:207]
  ds_read_b128 v[144:147], v238 offset:15360
  s_waitcnt lgkmcnt(9)
  v_mfma_f32_16x16x32_bf16 v[208:211], v[168:171], v[116:119], v[208:211]
  ds_read_b128 v[148:151], v238 offset:16384
  s_waitcnt lgkmcnt(9)
  v_mfma_f32_16x16x32_bf16 v[212:215], v[172:175], v[116:119], v[212:215]
  ds_read_b128 v[152:155], v238 offset:17408
  s_waitcnt lgkmcnt(9)
  v_mfma_f32_16x16x32_bf16 v[216:219], v[176:179], v[116:119], v[216:219]
  ds_read_b128 v[156:159], v238 offset:18432
  s_waitcnt lgkmcnt(9)
  v_mfma_f32_16x16x32_bf16 v[220:223], v[180:183], v[116:119], v[220:223]
  ds_read_b128 v[160:163], v238 offset:19456
  s_waitcnt vmcnt(5) lgkmcnt(9)
  v_mfma_f32_16x16x32_bf16 v[204:207], v[184:187], v[120:123], v[204:207]
  ds_read_b128 v[164:167], v238 offset:20480
  s_waitcnt lgkmcnt(9)
  v_mfma_f32_16x16x32_bf16 v[208:211], v[188:191], v[120:123], v[208:211]
  ds_read_b128 v[168:171], v238 offset:21504
  s_waitcnt lgkmcnt(9)
  v_mfma_f32_16x16x32_bf16 v[212:215], v[192:195], v[120:123], v[212:215]
  ds_read_b128 v[172:175], v238 offset:22528
  s_waitcnt lgkmcnt(9)
  v_mfma_f32_16x16x32_bf16 v[216:219], v[196:199], v[120:123], v[216:219]
  ds_read_b128 v[176:179], v238 offset:23552
  s_waitcnt lgkmcnt(9)
  v_mfma_f32_16x16x32_bf16 v[220:223], v[200:203], v[120:123], v[220:223]
  ds_read_b128 v[180:183], v238 offset:24576
  s_waitcnt vmcnt(4) lgkmcnt(9)
  v_mfma_f32_16x16x32_bf16 v[204:207], v[144:147], v[124:127], v[204:207]
  ds_read_b128 v[184:187], v238 offset:25600
  s_waitcnt lgkmcnt(9)
  v_mfma_f32_16x16x32_bf16 v[208:211], v[148:151], v[124:127], v[208:211]
  ds_read_b128 v[188:191], v238 offset:26624
  s_waitcnt lgkmcnt(9)
  v_mfma_f32_16x16x32_bf16 v[212:215], v[152:155], v[124:127], v[212:215]
  ds_read_b128 v[192:195], v238 offset:27648
  s_waitcnt lgkmcnt(9)
  v_mfma_f32_16x16x32_bf16 v[216:219], v[156:159], v[124:127], v[216:219]
  ds_read_b128 v[196:199], v238 offset:28672
  s_waitcnt lgkmcnt(9)
  v_mfma_f32_16x16x32_bf16 v[220:223], v[160:163], v[124:127], v[220:223]
  ds_read_b128 v[200:203], v238 offset:29696
  s_waitcnt vmcnt(3) lgkmcnt(9)
  v_mfma_f32_16x16x32_bf16 v[204:207], v[164:167], v[128:131], v[204:207]
  ds_read_b128 v[144:147], v238 offset:30720
  s_waitcnt lgkmcnt(9)
  v_mfma_f32_16x16x32_bf16 v[208:211], v[168:171], v[128:131], v[208:211]
  ds_read_b128 v[148:151], v238 offset:31744
  s_waitcnt lgkmcnt(9)
  v_mfma_f32_16x16x32_bf16 v[212:215], v[172:175], v[128:131], v[212:215]
  ds_read_b128 v[152:155], v238 offset:32768
  s_waitcnt lgkmcnt(9)
  v_mfma_f32_16x16x32_bf16 v[216:219], v[176:179], v[128:131], v[216:219]
  ds_read_b128 v[156:159], v238 offset:33792
  s_waitcnt lgkmcnt(9)
  v_mfma_f32_16x16x32_bf16 v[220:223], v[180:183], v[128:131], v[220:223]
  ds_read_b128 v[160:163], v238 offset:34816
  s_waitcnt vmcnt(2) lgkmcnt(9)
  v_mfma_f32_16x16x32_bf16 v[204:207], v[184:187], v[132:135], v[204:207]
  ds_read_b128 v[164:167], v239 offset:0
  s_waitcnt lgkmcnt(9)
  v_mfma_f32_16x16x32_bf16 v[208:211], v[188:191], v[132:135], v[208:211]
  ds_read_b128 v[168:171], v239 offset:1024
  s_waitcnt lgkmcnt(9)
  v_mfma_f32_16x16x32_bf16 v[212:215], v[192:195], v[132:135], v[212:215]
  ds_read_b128 v[172:175], v239 offset:2048
  s_waitcnt lgkmcnt(9)
  v_mfma_f32_16x16x32_bf16 v[216:219], v[196:199], v[132:135], v[216:219]
  ds_read_b128 v[176:179], v239 offset:3072
  s_waitcnt lgkmcnt(9)
  v_mfma_f32_16x16x32_bf16 v[220:223], v[200:203], v[132:135], v[220:223]
  ds_read_b128 v[180:183], v239 offset:4096
  s_waitcnt vmcnt(1) lgkmcnt(9)
  v_mfma_f32_16x16x32_bf16 v[204:207], v[144:147], v[136:139], v[204:207]
  s_waitcnt lgkmcnt(8)
  v_mfma_f32_16x16x32_bf16 v[208:211], v[148:151], v[136:139], v[208:211]
  s_waitcnt lgkmcnt(7)
  v_mfma_f32_16x16x32_bf16 v[212:215], v[152:155], v[136:139], v[212:215]
  s_waitcnt lgkmcnt(6)
  v_mfma_f32_16x16x32_bf16 v[216:219], v[156:159], v[136:139], v[216:219]
  s_waitcnt lgkmcnt(5)
  v_mfma_f32_16x16x32_bf16 v[220:223], v[160:163], v[136:139], v[220:223]
  s_waitcnt vmcnt(0) lgkmcnt(4)
  v_mfma_f32_16x16x32_bf16 v[204:207], v[164:167], v[140:143], v[204:207]
  s_waitcnt lgkmcnt(3)
  v_mfma_f32_16x16x32_bf16 v[208:211], v[168:171], v[140:143], v[208:211]
  s_waitcnt lgkmcnt(2)
  v_mfma_f32_16x16x32_bf16 v[212:215], v[172:175], v[140:143], v[212:215]
  s_waitcnt lgkmcnt(1)
  v_mfma_f32_16x16x32_bf16 v[216:219], v[176:179], v[140:143], v[216:219]
  s_waitcnt lgkmcnt(0)
  v_mfma_f32_16x16x32_bf16 v[220:223], v[180:183], v[140:143], v[220:223]
  v_lshlrev_b32 v240, 16, v224
  v_and_b32 v241, s57, v224
  v_fmac_f32 v240, v4, v204
  v_fmac_f32 v241, v5, v205
  v_cvt_pk_bf16_f32 v246, v240, v241
  v_lshlrev_b32 v242, 16, v225
  v_and_b32 v243, s57, v225
  v_fmac_f32 v242, v6, v206
  v_fmac_f32 v243, v7, v207
  v_cvt_pk_bf16_f32 v247, v242, v243
  v_lshlrev_b32 v240, 16, v226
  v_and_b32 v241, s57, v226
  v_fmac_f32 v240, v8, v208
  v_fmac_f32 v241, v9, v209
  v_cvt_pk_bf16_f32 v248, v240, v241
  v_lshlrev_b32 v242, 16, v227
  v_and_b32 v243, s57, v227
  v_fmac_f32 v242, v10, v210
  v_fmac_f32 v243, v11, v211
  v_cvt_pk_bf16_f32 v249, v242, v243
  v_lshlrev_b32 v240, 16, v228
  v_and_b32 v241, s57, v228
  v_fmac_f32 v240, v12, v212
  v_fmac_f32 v241, v13, v213
  v_cvt_pk_bf16_f32 v250, v240, v241
  v_lshlrev_b32 v242, 16, v229
  v_and_b32 v243, s57, v229
  v_fmac_f32 v242, v14, v214
  v_fmac_f32 v243, v15, v215
  v_cvt_pk_bf16_f32 v251, v242, v243
  v_lshlrev_b32 v240, 16, v230
  v_and_b32 v241, s57, v230
  v_fmac_f32 v240, v16, v216
  v_fmac_f32 v241, v17, v217
  v_cvt_pk_bf16_f32 v252, v240, v241
  v_lshlrev_b32 v242, 16, v231
  v_and_b32 v243, s57, v231
  v_fmac_f32 v242, v18, v218
  v_fmac_f32 v243, v19, v219
  v_cvt_pk_bf16_f32 v253, v242, v243
  v_lshlrev_b32 v240, 16, v232
  v_and_b32 v241, s57, v232
  v_fmac_f32 v240, v20, v220
  v_fmac_f32 v241, v21, v221
  v_cvt_pk_bf16_f32 v254, v240, v241
  v_lshlrev_b32 v242, 16, v233
  v_and_b32 v243, s57, v233
  v_fmac_f32 v242, v22, v222
  v_fmac_f32 v243, v23, v223
  v_cvt_pk_bf16_f32 v255, v242, v243
  s_mov_b32 s65, 0x3f803f80
  v_mov_b32 v64, 0
  v_mov_b32 v65, 0
  v_dot2c_f32_bf16 v64, s65, v246
  v_dot2c_f32_bf16 v65, v246, v246
  v_dot2c_f32_bf16 v64, s65, v247
  v_dot2c_f32_bf16 v65, v247, v247
  v_dot2c_f32_bf16 v64, s65, v248
  v_dot2c_f32_bf16 v65, v248, v248
  v_dot2c_f32_bf16 v64, s65, v249
  v_dot2c_f32_bf16 v65, v249, v249
  v_dot2c_f32_bf16 v64, s65, v250
  v_dot2c_f32_bf16 v65, v250, v250
  v_dot2c_f32_bf16 v64, s65, v251
  v_dot2c_f32_bf16 v65, v251, v251
  v_dot2c_f32_bf16 v64, s65, v252
  v_dot2c_f32_bf16 v65, v252, v252
  v_dot2c_f32_bf16 v64, s65, v253
  v_dot2c_f32_bf16 v65, v253, v253
  v_dot2c_f32_bf16 v64, s65, v254
  v_dot2c_f32_bf16 v65, v254, v254
  v_dot2c_f32_bf16 v64, s65, v255
  v_dot2c_f32_bf16 v65, v255, v255
  s_lshl_b32 s68, s66, 11
  s_add_u32 s68, s68, 2490368
  s_lshl_b32 s65, s53, 8
  s_add_u32 s65, s65, s68
  v_cmp_gt_u32 vcc, 16, v1
  v_mov_b32 v70, 2147483648
  s_nop 0
  v_cndmask_b32 v70, v70, v239, vcc
  v_mov_b32 v66, s54
  v_mov_b32 v67, s54
  v_mov_b32 v68, v64
  v_mov_b32 v69, v65
  s_nop 0
  v_permlane16_swap_b32 v64, v68
  v_permlane16_swap_b32 v65, v69
  v_add_f32 v64, v64, v68
  v_add_f32 v65, v65, v69
  v_mov_b32 v68, v64
  v_mov_b32 v69, v65
  s_nop 0
  v_permlane32_swap_b32 v64, v68
  v_permlane32_swap_b32 v65, v69
  v_add_f32 v64, v64, v68
  v_add_f32 v65, v65, v69
  buffer_store_dwordx4 v[64:67], v70, s[44:47], s65 offen
  v_and_b32 v71, 15, v1
  v_lshlrev_b32 v71, 4, v71
  v_lshrrev_b32 v72, 4, v1
  v_lshl_add_u32 v71, v72, 9, v71
  v_lshlrev_b32 v96, 16, v246
  v_and_b32 v97, s57, v246
  v_lshlrev_b32 v98, 16, v247
  v_and_b32 v99, s57, v247
  v_lshlrev_b32 v100, 16, v248
  v_and_b32 v101, s57, v248
  v_lshlrev_b32 v102, 16, v249
  v_and_b32 v103, s57, v249
  v_lshlrev_b32 v104, 16, v250
  v_and_b32 v105, s57, v250
  v_lshlrev_b32 v106, 16, v251
  v_and_b32 v107, s57, v251
  v_lshlrev_b32 v108, 16, v252
  v_and_b32 v109, s57, v252
  v_lshlrev_b32 v110, 16, v253
  v_and_b32 v111, s57, v253
  v_lshlrev_b32 v112, 16, v254
  v_and_b32 v113, s57, v254
  v_lshlrev_b32 v114, 16, v255
  v_and_b32 v115, s57, v255
  s_mul_i32 s65, s53, 5
  s_lshr_b32 s65, s65, 1
  s_lshl_b32 s65, s65, 10
  s_mul_i32 s67, s66, 20480
  s_add_u32 s67, s67, 8257536
  s_add_u32 s67, s67, s65
  v_lshlrev_b32 v73, 3, v1
  buffer_load_dwordx4 v[76:79], v71, s[44:47], s68 offen sc1
  buffer_load_dwordx4 v[80:83], v71, s[44:47], s68 offen offset:256 sc1
  s_waitcnt vmcnt(1)
  v_xor_b32 v74, s54, v78
  s_waitcnt vmcnt(0)
  v_xor_b32 v75, s54, v82
  v_or_b32 v74, v74, v75
  v_cmp_ne_u32 vcc, 0, v74
  s_cbranch_vccz IF_98_else
  s_mov_b32 s58, 1048576
LP_97:
  s_sleep 2
  buffer_load_dwordx4 v[76:79], v71, s[44:47], s68 offen sc1
  buffer_load_dwordx4 v[80:83], v71, s[44:47], s68 offen offset:256 sc1
  s_waitcnt vmcnt(1)
  v_xor_b32 v74, s54, v78
  s_waitcnt vmcnt(0)
  v_xor_b32 v75, s54, v82
  v_or_b32 v74, v74, v75
  v_cmp_ne_u32 vcc, 0, v74
  s_sub_u32 s58, s58, 1
  s_cselect_b64 vcc, 0, vcc
  s_cbranch_vccnz LP_97
IF_98_else:
  v_add_f32 v64, v76, v80
  v_add_f32 v66, v77, v81
  v_mov_b32 v68, v64
  v_mov_b32 v69, v66
  s_nop 0
  v_permlane16_swap_b32 v64, v68
  v_permlane16_swap_b32 v66, v69
  v_add_f32 v64, v64, v68
  v_add_f32 v66, v66, v69
  v_mov_b32 v68, v64
  v_mov_b32 v69, v66
  s_nop 0
  v_permlane32_swap_b32 v64, v68
  v_permlane32_swap_b32 v66, v69
  v_add_f32 v64, v64, v68
  v_add_f32 v66, v66, v69
  v_mul_f32 v64, 0.0015625, v64
  v_mul_f32 v68, v64, v64
  v_mul_f32 v66, 0.0015625, v66
  v_sub_f32 v66, v66, v68
  v_max_f32 v66, 0, v66
  v_add_f32 v66, 0x3727c5ac, v66
  v_rsq_f32 v66, v66
  s_nop 0
  v_mul_f32 v64, v64, v66
  v_sub_f32 v64, 0, v64
  v_pk_fma_f32 v[96:97], v[96:97], v[66:67], v[64:65] op_sel_hi:[1,0,0]
  v_pk_fma_f32 v[96:97], v[96:97], v[44:45], v[24:25]
  v_cvt_pk_bf16_f32 v120, v96, v97
  v_pk_fma_f32 v[98:99], v[98:99], v[66:67], v[64:65] op_sel_hi:[1,0,0]
  v_pk_fma_f32 v[98:99], v[98:99], v[46:47], v[26:27]
  v_cvt_pk_bf16_f32 v121, v98, v99
  v_pk_fma_f32 v[100:101], v[100:101], v[66:67], v[64:65] op_sel_hi:[1,0,0]
  v_pk_fma_f32 v[100:101], v[100:101], v[48:49], v[28:29]
  v_cvt_pk_bf16_f32 v122, v100, v101
  v_pk_fma_f32 v[102:103], v[102:103], v[66:67], v[64:65] op_sel_hi:[1,0,0]
  v_pk_fma_f32 v[102:103], v[102:103], v[50:51], v[30:31]
  v_cvt_pk_bf16_f32 v123, v102, v103
  v_pk_fma_f32 v[104:105], v[104:105], v[66:67], v[64:65] op_sel_hi:[1,0,0]
  v_pk_fma_f32 v[104:105], v[104:105], v[52:53], v[32:33]
  v_cvt_pk_bf16_f32 v124, v104, v105
  v_pk_fma_f32 v[106:107], v[106:107], v[66:67], v[64:65] op_sel_hi:[1,0,0]
  v_pk_fma_f32 v[106:107], v[106:107], v[54:55], v[34:35]
  v_cvt_pk_bf16_f32 v125, v106, v107
  v_pk_fma_f32 v[108:109], v[108:109], v[66:67], v[64:65] op_sel_hi:[1,0,0]
  v_pk_fma_f32 v[108:109], v[108:109], v[56:57], v[36:37]
  v_cvt_pk_bf16_f32 v126, v108, v109
  v_pk_fma_f32 v[110:111], v[110:111], v[66:67], v[64:65] op_sel_hi:[1,0,0]
  v_pk_fma_f32 v[110:111], v[110:111], v[58:59], v[38:39]
  v_cvt_pk_bf16_f32 v127, v110, v111
  v_pk_fma_f32 v[112:113], v[112:113], v[66:67], v[64:65] op_sel_hi:[1,0,0]
  v_pk_fma_f32 v[112:113], v[112:113], v[60:61], v[40:41]
  v_cvt_pk_bf16_f32 v128, v112, v113
  v_pk_fma_f32 v[114:115], v[114:115], v[66:67], v[64:65] op_sel_hi:[1,0,0]
  v_pk_fma_f32 v[114:115], v[114:115], v[62:63], v[42:43]
  v_cvt_pk_bf16_f32 v129, v114, v115
  s_bitcmp0_b32 s53, 0
  s_cbranch_scc0 IF_99_else
  buffer_store_dwordx4 v[120:123], v239, s[44:47], s67 offen
  buffer_store_dwordx4 v[124:127], v239, s[44:47], s67 offen offset:1024
  buffer_store_dwordx2 v[128:129], v73, s[44:47], s67 offen offset:2048
  s_branch IF_99_end
IF_99_else:
  buffer_store_dwordx2 v[120:121], v73, s[44:47], s67 offen offset:512
  buffer_store_dwordx4 v[122:125], v239, s[44:47], s67 offen offset:1024
  buffer_store_dwordx4 v[126:129], v239, s[44:47], s67 offen offset:2048
IF_99_end:
  s_lshl_b32 s65, s66, 3
  s_add_u32 s65, s65, s53
  s_lshl_b32 s63, s65, 7
  s_add_u32 s63, s63, 655360
  v_mov_b32 v64, s54
  v_lshlrev_b32 v65, 26, v1
  v_and_b32 v65, 2147483648, v65
  v_lshl_or_b32 v65, v1, 2, v65
  s_waitcnt vmcnt(0)
  buffer_store_dword v64, v65, s[44:47], s63 offen
  s_barrier
  v_add_u32 v232, 5120, v239
  v_add_u32 v233, 69632, v239
  v_add_u32 v234, 134144, v239
  v_lshlrev_b32 v238, 3, v1
  s_lshl_b32 s65, s50, 2
  s_add_u32 s65, s65, s59
  s_mul_i32 s66, s65, 40960
  s_add_u32 s66, s66, 8257536
  s_add_u32 s67, s66, 20480
  s_lshl_b32 s65, s65, 4
  v_and_b32 v240, 15, v1
  v_lshlrev_b32 v240, 7, v240
  s_lshl_b32 s63, s65, 7
  s_add_u32 s63, s63, 655360
  buffer_load_dword v241, v240, s[44:47], s63 offen sc1
  s_waitcnt vmcnt(0)
  v_cmp_ne_u32 vcc, s54, v241
  s_cbranch_vccz IF_101_else
  s_mov_b32 s58, 1048576
LP_100:
  s_sleep 2
  buffer_load_dword v241, v240, s[44:47], s63 offen sc1
  s_waitcnt vmcnt(0)
  v_cmp_ne_u32 vcc, s54, v241
  s_sub_u32 s58, s58, 1
  s_cselect_b64 vcc, 0, vcc
  s_cbranch_vccnz LP_100
IF_101_else:
  buffer_load_dwordx4 v[116:119], v239, s[44:47], s66 offen offset:0 sc1
  buffer_load_dwordx4 v[120:123], v239, s[44:47], s67 offen offset:0 sc1
  buffer_load_dwordx4 v[124:127], v239, s[44:47], s66 offen offset:1024 sc1
  buffer_load_dwordx4 v[128:131], v239, s[44:47], s67 offen offset:1024 sc1
  buffer_load_dwordx2 v[132:133], v238, s[44:47], s66 offen offset:2048 sc1
  buffer_load_dwordx2 v[134:135], v238, s[44:47], s66 offen offset:2560 sc1
  buffer_load_dwordx2 v[136:137], v238, s[44:47], s67 offen offset:2048 sc1
  buffer_load_dwordx2 v[138:139], v238, s[44:47], s67 offen offset:2560 sc1
  s_barrier
  s_cmp_eq_u32 s56, 1
  s_cbranch_scc0 IF_102_else
  ds_read_b128 v[60:63], v232 offset:0
  ds_read_b128 v[64:67], v232 offset:1024
  ds_read_b128 v[68:71], v232 offset:2048
  ds_read_b128 v[72:75], v232 offset:3072
  ds_read_b128 v[76:79], v232 offset:4096
  ds_read_b128 v[80:83], v232 offset:5120
  ds_read_b128 v[84:87], v232 offset:6144
  s_waitcnt vmcnt(7) lgkmcnt(6)
  v_mfma_f32_16x16x32_bf16 v[4:7], v[116:119], v[60:63], 0
  ds_read_b128 v[88:91], v232 offset:7168
  s_waitcnt vmcnt(6)
  v_mfma_f32_16x16x32_bf16 v[32:35], v[120:123], v[60:63], 0
  s_waitcnt lgkmcnt(6)
  v_mfma_f32_16x16x32_bf16 v[8:11], v[116:119], v[64:67], 0
  ds_read_b128 v[92:95], v232 offset:8192
  v_mfma_f32_16x16x32_bf16 v[36:39], v[120:123], v[64:67], 0
  s_waitcnt lgkmcnt(6)
  v_mfma_f32_16x16x32_bf16 v[12:15], v[116:119], v[68:71], 0
  ds_read_b128 v[96:99], v232 offset:9216
  v_mfma_f32_16x16x32_bf16 v[40:43], v[120:123], v[68:71], 0
  buffer_load_dwordx4 v[140:143], v239, s[44:47], s66 offen offset:3072 sc1
  buffer_load_dwordx4 v[144:147], v239, s[44:47], s67 offen offset:3072 sc1
  s_waitcnt lgkmcnt(6)
  v_mfma_f32_16x16x32_bf16 v[16:19], v[116:119], v[72:75], 0
  ds_read_b128 v[100:103], v232 offset:10240
  v_mfma_f32_16x16x32_bf16 v[44:47], v[120:123], v[72:75], 0
  s_waitcnt lgkmcnt(6)
  v_mfma_f32_16x16x32_bf16 v[20:23], v[116:119], v[76:79], 0
  ds_read_b128 v[104:107], v232 offset:11264
  v_mfma_f32_16x16x32_bf16 v[48:51], v[120:123], v[76:79], 0
  s_waitcnt lgkmcnt(6)
  v_mfma_f32_16x16x32_bf16 v[24:27], v[116:119], v[80:83], 0
  ds_read_b128 v[108:111], v232 offset:12288
  v_mfma_f32_16x16x32_bf16 v[52:55], v[120:123], v[80:83], 0
  s_add_u32 s66, s66, 4096
  buffer_load_dwordx4 v[148:151], v239, s[44:47], s66 offen offset:0 sc1
  s_add_u32 s67, s67, 4096
  buffer_load_dwordx4 v[152:155], v239, s[44:47], s67 offen offset:0 sc1
  s_waitcnt lgkmcnt(6)
  v_mfma_f32_16x16x32_bf16 v[28:31], v[116:119], v[84:87], 0
  ds_read_b128 v[112:115], v232 offset:13312
  v_mfma_f32_16x16x32_bf16 v[56:59], v[120:123], v[84:87], 0
  s_waitcnt vmcnt(9) lgkmcnt(6)
  v_mfma_f32_16x16x32_bf16 v[4:7], v[124:127], v[88:91], v[4:7]
  ds_read_b128 v[60:63], v232 offset:14336
  s_waitcnt vmcnt(8)
  v_mfma_f32_16x16x32_bf16 v[32:35], v[128:131], v[88:91], v[32:35]
  s_waitcnt lgkmcnt(6)
  v_mfma_f32_16x16x32_bf16 v[8:11], v[124:127], v[92:95], v[8:11]
  ds_read_b128 v[64:67], v232 offset:15360
  v_mfma_f32_16x16x32_bf16 v[36:39], v[128:131], v[92:95], v[36:39]
  s_waitcnt lgkmcnt(6)
  v_mfma_f32_16x16x32_bf16 v[12:15], v[124:127], v[96:99], v[12:15]
  ds_read_b128 v[68:71], v232 offset:16384
  v_mfma_f32_16x16x32_bf16 v[40:43], v[128:131], v[96:99], v[40:43]
  buffer_load_dwordx4 v[156:159], v239, s[44:47], s66 offen offset:1024 sc1
  buffer_load_dwordx4 v[160:163], v239, s[44:47], s67 offen offset:1024 sc1
  s_waitcnt lgkmcnt(6)
  v_mfma_f32_16x16x32_bf16 v[16:19], v[124:127], v[100:103], v[16:19]
  ds_read_b128 v[72:75], v232 offset:17408
  v_mfma_f32_16x16x32_bf16 v[44:47], v[128:131], v[100:103], v[44:47]
  s_waitcnt lgkmcnt(6)
  v_mfma_f32_16x16x32_bf16 v[20:23], v[124:127], v[104:107], v[20:23]
  ds_read_b128 v[76:79], v232 offset:18432
  v_mfma_f32_16x16x32_bf16 v[48:51], v[128:131], v[104:107], v[48:51]
  s_waitcnt lgkmcnt(6)
  v_mfma_f32_16x16x32_bf16 v[24:27], v[124:127], v[108:111], v[24:27]
  ds_read_b128 v[80:83], v232 offset:19456
  v_mfma_f32_16x16x32_bf16 v[52:55], v[128:131], v[108:111], v[52:55]
  buffer_load_dwordx4 v[164:167], v239, s[44:47], s66 offen offset:2048 sc1
  buffer_load_dwordx4 v[168:171], v239, s[44:47], s67 offen offset:2048 sc1
  s_waitcnt lgkmcnt(6)
  v_mfma_f32_16x16x32_bf16 v[28:31], v[124:127], v[112:115], v[28:31]
  ds_read_b128 v[84:87], v232 offset:20480
  v_mfma_f32_16x16x32_bf16 v[56:59], v[128:131], v[112:115], v[56:59]
  s_waitcnt vmcnt(10) lgkmcnt(6)
  v_mfma_f32_16x16x32_bf16 v[4:7], v[132:135], v[60:63], v[4:7]
  ds_read_b128 v[88:91], v232 offset:21504
  s_waitcnt vmcnt(8)
  v_mfma_f32_16x16x32_bf16 v[32:35], v[136:139], v[60:63], v[32:35]
  s_waitcnt lgkmcnt(6)
  v_mfma_f32_16x16x32_bf16 v[8:11], v[132:135], v[64:67], v[8:11]
  ds_read_b128 v[92:95], v232 offset:22528
  v_mfma_f32_16x16x32_bf16 v[36:39], v[136:139], v[64:67], v[36:39]
  s_waitcnt lgkmcnt(6)
  v_mfma_f32_16x16x32_bf16 v[12:15], v[132:135], v[68:71], v[12:15]
  ds_read_b128 v[96:99], v232 offset:23552
  v_mfma_f32_16x16x32_bf16 v[40:43], v[136:139], v[68:71], v[40:43]
  buffer_load_dwordx2 v[172:173], v238, s[44:47], s66 offen offset:3072 sc1
  buffer_load_dwordx2 v[174:175], v238, s[44:47], s66 offen offset:3584 sc1
  buffer_load_dwordx2 v[176:177], v238, s[44:47], s67 offen offset:3072 sc1
  buffer_load_dwordx2 v[178:179], v238, s[44:47], s67 offen offset:3584 sc1
  s_waitcnt lgkmcnt(6)
  v_mfma_f32_16x16x32_bf16 v[16:19], v[132:135], v[72:75], v[16:19]
  ds_read_b128 v[100:103], v232 offset:24576
  v_mfma_f32_16x16x32_bf16 v[44:47], v[136:139], v[72:75], v[44:47]
  s_waitcnt lgkmcnt(6)
  v_mfma_f32_16x16x32_bf16 v[20:23], v[132:135], v[76:79], v[20:23]
  ds_read_b128 v[104:107], v232 offset:25600
  v_mfma_f32_16x16x32_bf16 v[48:51], v[136:139], v[76:79], v[48:51]
  s_waitcnt lgkmcnt(6)
  v_mfma_f32_16x16x32_bf16 v[24:27], v[132:135], v[80:83], v[24:27]
  ds_read_b128 v[108:111], v232 offset:26624
  v_mfma_f32_16x16x32_bf16 v[52:55], v[136:139], v[80:83], v[52:55]
  s_add_u32 s66, s66, 4096
  buffer_load_dwordx4 v[180:183], v239, s[44:47], s66 offen offset:0 sc1
  s_add_u32 s67, s67, 4096
  buffer_load_dwordx4 v[184:187], v239, s[44:47], s67 offen offset:0 sc1
  s_waitcnt lgkmcnt(6)
  v_mfma_f32_16x16x32_bf16 v[28:31], v[132:135], v[84:87], v[28:31]
  ds_read_b128 v[112:115], v232 offset:27648
  v_mfma_f32_16x16x32_bf16 v[56:59], v[136:139], v[84:87], v[56:59]
  s_waitcnt vmcnt(13) lgkmcnt(6)
  v_mfma_f32_16x16x32_bf16 v[4:7], v[140:143], v[88:91], v[4:7]
  ds_read_b128 v[60:63], v232 offset:28672
  s_waitcnt vmcnt(12)
  v_mfma_f32_16x16x32_bf16 v[32:35], v[144:147], v[88:91], v[32:35]
  s_waitcnt lgkmcnt(6)
  v_mfma_f32_16x16x32_bf16 v[8:11], v[140:143], v[92:95], v[8:11]
  ds_read_b128 v[64:67], v232 offset:29696
  v_mfma_f32_16x16x32_bf16 v[36:39], v[144:147], v[92:95], v[36:39]
  s_waitcnt lgkmcnt(6)
  v_mfma_f32_16x16x32_bf16 v[12:15], v[140:143], v[96:99], v[12:15]
  ds_read_b128 v[68:71], v232 offset:30720
  v_mfma_f32_16x16x32_bf16 v[40:43], v[144:147], v[96:99], v[40:43]
  buffer_load_dwordx4 v[188:191], v239, s[44:47], s66 offen offset:1024 sc1
  buffer_load_dwordx4 v[192:195], v239, s[44:47], s67 offen offset:1024 sc1
  s_waitcnt lgkmcnt(6)
  v_mfma_f32_16x16x32_bf16 v[16:19], v[140:143], v[100:103], v[16:19]
  ds_read_b128 v[72:75], v232 offset:31744
  v_mfma_f32_16x16x32_bf16 v[44:47], v[144:147], v[100:103], v[44:47]
  s_waitcnt lgkmcnt(6)
  v_mfma_f32_16x16x32_bf16 v[20:23], v[140:143], v[104:107], v[20:23]
  ds_read_b128 v[76:79], v232 offset:32768
  v_mfma_f32_16x16x32_bf16 v[48:51], v[144:147], v[104:107], v[48:51]
  s_waitcnt lgkmcnt(6)
  v_mfma_f32_16x16x32_bf16 v[24:27], v[140:143], v[108:111], v[24:27]
  ds_read_b128 v[80:83], v232 offset:33792
  v_mfma_f32_16x16x32_bf16 v[52:55], v[144:147], v[108:111], v[52:55]
  buffer_load_dwordx4 v[196:199], v239, s[44:47], s66 offen offset:2048 sc1
  buffer_load_dwordx4 v[200:203], v239, s[44:47], s67 offen offset:2048 sc1
  s_waitcnt lgkmcnt(6)
  v_mfma_f32_16x16x32_bf16 v[28:31], v[140:143], v[112:115], v[28:31]
  ds_read_b128 v[84:87], v232 offset:34816
  v_mfma_f32_16x16x32_bf16 v[56:59], v[144:147], v[112:115], v[56:59]
  s_waitcnt vmcnt(15) lgkmcnt(6)
  v_mfma_f32_16x16x32_bf16 v[4:7], v[148:151], v[60:63], v[4:7]
  ds_read_b128 v[88:91], v232 offset:35840
  s_waitcnt vmcnt(14)
  v_mfma_f32_16x16x32_bf16 v[32:35], v[152:155], v[60:63], v[32:35]
  s_waitcnt lgkmcnt(6)
  v_mfma_f32_16x16x32_bf16 v[8:11], v[148:151], v[64:67], v[8:11]
  ds_read_b128 v[92:95], v232 offset:36864
  v_mfma_f32_16x16x32_bf16 v[36:39], v[152:155], v[64:67], v[36:39]
  s_waitcnt lgkmcnt(6)
  v_mfma_f32_16x16x32_bf16 v[12:15], v[148:151], v[68:71], v[12:15]
  ds_read_b128 v[96:99], v232 offset:37888
  v_mfma_f32_16x16x32_bf16 v[40:43], v[152:155], v[68:71], v[40:43]
  buffer_load_dwordx4 v[204:207], v239, s[44:47], s66 offen offset:3072 sc1
  buffer_load_dwordx4 v[208:211], v239, s[44:47], s67 offen offset:3072 sc1
  s_waitcnt lgkmcnt(6)
  v_mfma_f32_16x16x32_bf16 v[16:19], v[148:151], v[72:75], v[16:19]
  ds_read_b128 v[100:103], v232 offset:38912
  v_mfma_f32_16x16x32_bf16 v[44:47], v[152:155], v[72:75], v[44:47]
  s_waitcnt lgkmcnt(6)
  v_mfma_f32_16x16x32_bf16 v[20:23], v[148:151], v[76:79], v[20:23]
  ds_read_b128 v[104:107], v232 offset:39936
  v_mfma_f32_16x16x32_bf16 v[48:51], v[152:155], v[76:79], v[48:51]
  s_waitcnt lgkmcnt(6)
  v_mfma_f32_16x16x32_bf16 v[24:27], v[148:151], v[80:83], v[24:27]
  ds_read_b128 v[108:111], v232 offset:40960
  v_mfma_f32_16x16x32_bf16 v[52:55], v[152:155], v[80:83], v[52:55]
  s_waitcnt lgkmcnt(6)
  v_mfma_f32_16x16x32_bf16 v[28:31], v[148:151], v[84:87], v[28:31]
  ds_read_b128 v[112:115], v232 offset:41984
  v_mfma_f32_16x16x32_bf16 v[56:59], v[152:155], v[84:87], v[56:59]
  s_waitcnt vmcnt(15) lgkmcnt(6)
  v_mfma_f32_16x16x32_bf16 v[4:7], v[156:159], v[88:91], v[4:7]
  ds_read_b128 v[60:63], v232 offset:43008
  s_waitcnt vmcnt(14)
  v_mfma_f32_16x16x32_bf16 v[32:35], v[160:163], v[88:91], v[32:35]
  s_waitcnt lgkmcnt(6)
  v_mfma_f32_16x16x32_bf16 v[8:11], v[156:159], v[92:95], v[8:11]
  ds_read_b128 v[64:67], v232 offset:44032
  v_mfma_f32_16x16x32_bf16 v[36:39], v[160:163], v[92:95], v[36:39]
  s_waitcnt lgkmcnt(6)
  v_mfma_f32_16x16x32_bf16 v[12:15], v[156:159], v[96:99], v[12:15]
  ds_read_b128 v[68:71], v232 offset:45056
  v_mfma_f32_16x16x32_bf16 v[40:43], v[160:163], v[96:99], v[40:43]
  s_add_u32 s66, s66, 4096
  buffer_load_dwordx2 v[116:117], v238, s[44:47], s66 offen offset:0 sc1
  buffer_load_dwordx2 v[118:119], v238, s[44:47], s66 offen offset:512 sc1
  s_add_u32 s67, s67, 4096
  buffer_load_dwordx2 v[120:121], v238, s[44:47], s67 offen offset:0 sc1
  buffer_load_dwordx2 v[122:123], v238, s[44:47], s67 offen offset:512 sc1
  s_waitcnt lgkmcnt(6)
  v_mfma_f32_16x16x32_bf16 v[16:19], v[156:159], v[100:103], v[16:19]
  ds_read_b128 v[72:75], v232 offset:46080
  v_mfma_f32_16x16x32_bf16 v[44:47], v[160:163], v[100:103], v[44:47]
  s_waitcnt lgkmcnt(6)
  v_mfma_f32_16x16x32_bf16 v[20:23], v[156:159], v[104:107], v[20:23]
  ds_read_b128 v[76:79], v232 offset:47104
  v_mfma_f32_16x16x32_bf16 v[48:51], v[160:163], v[104:107], v[48:51]
  s_waitcnt lgkmcnt(6)
  v_mfma_f32_16x16x32_bf16 v[24:27], v[156:159], v[108:111], v[24:27]
  ds_read_b128 v[80:83], v232 offset:48128
  v_mfma_f32_16x16x32_bf16 v[52:55], v[160:163], v[108:111], v[52:55]
  s_waitcnt lgkmcnt(6)
  v_mfma_f32_16x16x32_bf16 v[28:31], v[156:159], v[112:115], v[28:31]
  ds_read_b128 v[84:87], v232 offset:49152
  v_mfma_f32_16x16x32_bf16 v[56:59], v[160:163], v[112:115], v[56:59]
  s_waitcnt vmcnt(17) lgkmcnt(6)
  v_mfma_f32_16x16x32_bf16 v[4:7], v[164:167], v[60:63], v[4:7]
  ds_read_b128 v[88:91], v232 offset:50176
  s_waitcnt vmcnt(16)
  v_mfma_f32_16x16x32_bf16 v[32:35], v[168:171], v[60:63], v[32:35]
  s_waitcnt lgkmcnt(6)
  v_mfma_f32_16x16x32_bf16 v[8:11], v[164:167], v[64:67], v[8:11]
  ds_read_b128 v[92:95], v232 offset:51200
  v_mfma_f32_16x16x32_bf16 v[36:39], v[168:171], v[64:67], v[36:39]
  s_waitcnt lgkmcnt(6)
  v_mfma_f32_16x16x32_bf16 v[12:15], v[164:167], v[68:71], v[12:15]
  ds_read_b128 v[96:99], v232 offset:52224
  v_mfma_f32_16x16x32_bf16 v[40:43], v[168:171], v[68:71], v[40:43]
  buffer_load_dwordx4 v[124:127], v239, s[44:47], s66 offen offset:1024 sc1
  buffer_load_dwordx4 v[128:131], v239, s[44:47], s67 offen offset:1024 sc1
  s_waitcnt lgkmcnt(6)
  v_mfma_f32_16x16x32_bf16 v[16:19], v[164:167], v[72:75], v[16:19]
  ds_read_b128 v[100:103], v232 offset:53248
  v_mfma_f32_16x16x32_bf16 v[44:47], v[168:171], v[72:75], v[44:47]
  s_waitcnt lgkmcnt(6)
  v_mfma_f32_16x16x32_bf16 v[20:23], v[164:167], v[76:79], v[20:23]
  ds_read_b128 v[104:107], v232 offset:54272
  v_mfma_f32_16x16x32_bf16 v[48:51], v[168:171], v[76:79], v[48:51]
  s_waitcnt lgkmcnt(6)
  v_mfma_f32_16x16x32_bf16 v[24:27], v[164:167], v[80:83], v[24:27]
  ds_read_b128 v[108:111], v232 offset:55296
  v_mfma_f32_16x16x32_bf16 v[52:55], v[168:171], v[80:83], v[52:55]
  s_waitcnt lgkmcnt(6)
  v_mfma_f32_16x16x32_bf16 v[28:31], v[164:167], v[84:87], v[28:31]
  ds_read_b128 v[112:115], v232 offset:56320
  v_mfma_f32_16x16x32_bf16 v[56:59], v[168:171], v[84:87], v[56:59]
  s_waitcnt vmcnt(16) lgkmcnt(6)
  v_mfma_f32_16x16x32_bf16 v[4:7], v[172:175], v[88:91], v[4:7]
  ds_read_b128 v[60:63], v232 offset:57344
  s_waitcnt vmcnt(14)
  v_mfma_f32_16x16x32_bf16 v[32:35], v[176:179], v[88:91], v[32:35]
  s_waitcnt lgkmcnt(6)
  v_mfma_f32_16x16x32_bf16 v[8:11], v[172:175], v[92:95], v[8:11]
  ds_read_b128 v[64:67], v232 offset:58368
  v_mfma_f32_16x16x32_bf16 v[36:39], v[176:179], v[92:95], v[36:39]
  s_waitcnt lgkmcnt(6)
  v_mfma_f32_16x16x32_bf16 v[12:15], v[172:175], v[96:99], v[12:15]
  ds_read_b128 v[68:71], v232 offset:59392
  v_mfma_f32_16x16x32_bf16 v[40:43], v[176:179], v[96:99], v[40:43]
  buffer_load_dwordx4 v[132:135], v239, s[44:47], s66 offen offset:2048 sc1
  buffer_load_dwordx4 v[136:139], v239, s[44:47], s67 offen offset:2048 sc1
  s_waitcnt lgkmcnt(6)
  v_mfma_f32_16x16x32_bf16 v[16:19], v[172:175], v[100:103], v[16:19]
  ds_read_b128 v[72:75], v232 offset:60416
  v_mfma_f32_16x16x32_bf16 v[44:47], v[176:179], v[100:103], v[44:47]
  s_waitcnt lgkmcnt(6)
  v_mfma_f32_16x16x32_bf16 v[20:23], v[172:175], v[104:107], v[20:23]
  ds_read_b128 v[76:79], v232 offset:61440
  v_mfma_f32_16x16x32_bf16 v[48:51], v[176:179], v[104:107], v[48:51]
  s_waitcnt lgkmcnt(6)
  v_mfma_f32_16x16x32_bf16 v[24:27], v[172:175], v[108:111], v[24:27]
  ds_read_b128 v[80:83], v232 offset:62464
  v_mfma_f32_16x16x32_bf16 v[52:55], v[176:179], v[108:111], v[52:55]
  s_waitcnt lgkmcnt(6)
  v_mfma_f32_16x16x32_bf16 v[28:31], v[172:175], v[112:115], v[28:31]
  ds_read_b128 v[84:87], v232 offset:63488
  v_mfma_f32_16x16x32_bf16 v[56:59], v[176:179], v[112:115], v[56:59]
  s_waitcnt vmcnt(15) lgkmcnt(6)
  v_mfma_f32_16x16x32_bf16 v[4:7], v[180:183], v[60:63], v[4:7]
  ds_read_b128 v[88:91], v233 offset:0
  s_waitcnt vmcnt(14)
  v_mfma_f32_16x16x32_bf16 v[32:35], v[184:187], v[60:63], v[32:35]
  s_waitcnt lgkmcnt(6)
  v_mfma_f32_16x16x32_bf16 v[8:11], v[180:183], v[64:67], v[8:11]
  ds_read_b128 v[92:95], v233 offset:1024
  v_mfma_f32_16x16x32_bf16 v[36:39], v[184:187], v[64:67], v[36:39]
  s_waitcnt lgkmcnt(6)
  v_mfma_f32_16x16x32_bf16 v[12:15], v[180:183], v[68:71], v[12:15]
  ds_read_b128 v[96:99], v233 offset:2048
  v_mfma_f32_16x16x32_bf16 v[40:43], v[184:187], v[68:71], v[40:43]
  buffer_load_dwordx4 v[140:143], v239, s[44:47], s66 offen offset:3072 sc1
  buffer_load_dwordx4 v[144:147], v239, s[44:47], s67 offen offset:3072 sc1
  s_waitcnt lgkmcnt(6)
  v_mfma_f32_16x16x32_bf16 v[16:19], v[180:183], v[72:75], v[16:19]
  ds_read_b128 v[100:103], v233 offset:3072
  v_mfma_f32_16x16x32_bf16 v[44:47], v[184:187], v[72:75], v[44:47]
  s_waitcnt lgkmcnt(6)
  v_mfma_f32_16x16x32_bf16 v[20:23], v[180:183], v[76:79], v[20:23]
  ds_read_b128 v[104:107], v233 offset:4096
  v_mfma_f32_16x16x32_bf16 v[48:51], v[184:187], v[76:79], v[48:51]
  s_waitcnt lgkmcnt(6)
  v_mfma_f32_16x16x32_bf16 v[24:27], v[180:183], v[80:83], v[24:27]
  ds_read_b128 v[108:111], v233 offset:5120
  v_mfma_f32_16x16x32_bf16 v[52:55], v[184:187], v[80:83], v[52:55]
  s_waitcnt lgkmcnt(6)
  v_mfma_f32_16x16x32_bf16 v[28:31], v[180:183], v[84:87], v[28:31]
  ds_read_b128 v[112:115], v233 offset:6144
  v_mfma_f32_16x16x32_bf16 v[56:59], v[184:187], v[84:87], v[56:59]
  s_waitcnt vmcnt(15) lgkmcnt(6)
  v_mfma_f32_16x16x32_bf16 v[4:7], v[188:191], v[88:91], v[4:7]
  ds_read_b128 v[60:63], v233 offset:7168
  s_waitcnt vmcnt(14)
  v_mfma_f32_16x16x32_bf16 v[32:35], v[192:195], v[88:91], v[32:35]
  s_waitcnt lgkmcnt(6)
  v_mfma_f32_16x16x32_bf16 v[8:11], v[188:191], v[92:95], v[8:11]
  ds_read_b128 v[64:67], v233 offset:8192
  v_mfma_f32_16x16x32_bf16 v[36:39], v[192:195], v[92:95], v[36:39]
  s_waitcnt lgkmcnt(6)
  v_mfma_f32_16x16x32_bf16 v[12:15], v[188:191], v[96:99], v[12:15]
  ds_read_b128 v[68:71], v233 offset:9216
  v_mfma_f32_16x16x32_bf16 v[40:43], v[192:195], v[96:99], v[40:43]
  s_add_u32 s66, s66, 4096
  buffer_load_dwordx4 v[148:151], v239, s[44:47], s66 offen offset:0 sc1
  s_add_u32 s67, s67, 4096
  buffer_load_dwordx4 v[152:155], v239, s[44:47], s67 offen offset:0 sc1
  s_waitcnt lgkmcnt(6)
  v_mfma_f32_16x16x32_bf16 v[16:19], v[188:191], v[100:103], v[16:19]
  ds_read_b128 v[72:75], v233 offset:10240
  v_mfma_f32_16x16x32_bf16 v[44:47], v[192:195], v[100:103], v[44:47]
  s_waitcnt lgkmcnt(6)
  v_mfma_f32_16x16x32_bf16 v[20:23], v[188:191], v[104:107], v[20:23]
  ds_read_b128 v[76:79], v233 offset:11264
  v_mfma_f32_16x16x32_bf16 v[48:51], v[192:195], v[104:107], v[48:51]
  s_waitcnt lgkmcnt(6)
  v_mfma_f32_16x16x32_bf16 v[24:27], v[188:191], v[108:111], v[24:27]
  ds_read_b128 v[80:83], v233 offset:12288
  v_mfma_f32_16x16x32_bf16 v[52:55], v[192:195], v[108:111], v[52:55]
  s_waitcnt lgkmcnt(6)
  v_mfma_f32_16x16x32_bf16 v[28:31], v[188:191], v[112:115], v[28:31]
  ds_read_b128 v[84:87], v233 offset:13312
  v_mfma_f32_16x16x32_bf16 v[56:59], v[192:195], v[112:115], v[56:59]
  s_waitcnt vmcnt(15) lgkmcnt(6)
  v_mfma_f32_16x16x32_bf16 v[4:7], v[196:199], v[60:63], v[4:7]
  ds_read_b128 v[88:91], v233 offset:14336
  s_waitcnt vmcnt(14)
  v_mfma_f32_16x16x32_bf16 v[32:35], v[200:203], v[60:63], v[32:35]
  s_waitcnt lgkmcnt(6)
  v_mfma_f32_16x16x32_bf16 v[8:11], v[196:199], v[64:67], v[8:11]
  ds_read_b128 v[92:95], v233 offset:15360
  v_mfma_f32_16x16x32_bf16 v[36:39], v[200:203], v[64:67], v[36:39]
  s_waitcnt lgkmcnt(6)
  v_mfma_f32_16x16x32_bf16 v[12:15], v[196:199], v[68:71], v[12:15]
  ds_read_b128 v[96:99], v233 offset:16384
  v_mfma_f32_16x16x32_bf16 v[40:43], v[200:203], v[68:71], v[40:43]
  buffer_load_dwordx2 v[156:157], v238, s[44:47], s66 offen offset:1024 sc1
  buffer_load_dwordx2 v[158:159], v238, s[44:47], s66 offen offset:1536 sc1
  buffer_load_dwordx2 v[160:161], v238, s[44:47], s67 offen offset:1024 sc1
  buffer_load_dwordx2 v[162:163], v238, s[44:47], s67 offen offset:1536 sc1
  s_waitcnt lgkmcnt(6)
  v_mfma_f32_16x16x32_bf16 v[16:19], v[196:199], v[72:75], v[16:19]
  ds_read_b128 v[100:103], v233 offset:17408
  v_mfma_f32_16x16x32_bf16 v[44:47], v[200:203], v[72:75], v[44:47]
  s_waitcnt lgkmcnt(6)
  v_mfma_f32_16x16x32_bf16 v[20:23], v[196:199], v[76:79], v[20:23]
  ds_read_b128 v[104:107], v233 offset:18432
  v_mfma_f32_16x16x32_bf16 v[48:51], v[200:203], v[76:79], v[48:51]
  s_waitcnt lgkmcnt(6)
  v_mfma_f32_16x16x32_bf16 v[24:27], v[196:199], v[80:83], v[24:27]
  ds_read_b128 v[108:111], v233 offset:19456
  v_mfma_f32_16x16x32_bf16 v[52:55], v[200:203], v[80:83], v[52:55]
  s_waitcnt lgkmcnt(6)
  v_mfma_f32_16x16x32_bf16 v[28:31], v[196:199], v[84:87], v[28:31]
  ds_read_b128 v[112:115], v233 offset:20480
  v_mfma_f32_16x16x32_bf16 v[56:59], v[200:203], v[84:87], v[56:59]
  s_barrier
  s_waitcnt vmcnt(17) lgkmcnt(6)
  v_mfma_f32_16x16x32_bf16 v[4:7], v[204:207], v[88:91], v[4:7]
  ds_read_b128 v[60:63], v233 offset:21504
  s_waitcnt vmcnt(16)
  v_mfma_f32_16x16x32_bf16 v[32:35], v[208:211], v[88:91], v[32:35]
  s_waitcnt lgkmcnt(6)
  v_mfma_f32_16x16x32_bf16 v[8:11], v[204:207], v[92:95], v[8:11]
  ds_read_b128 v[64:67], v233 offset:22528
  v_mfma_f32_16x16x32_bf16 v[36:39], v[208:211], v[92:95], v[36:39]
  s_waitcnt lgkmcnt(6)
  v_mfma_f32_16x16x32_bf16 v[12:15], v[204:207], v[96:99], v[12:15]
  ds_read_b128 v[68:71], v233 offset:23552
  v_mfma_f32_16x16x32_bf16 v[40:43], v[208:211], v[96:99], v[40:43]
  buffer_load_dwordx4 v[164:167], v239, s[44:47], s66 offen offset:2048 sc1
  buffer_load_dwordx4 v[168:171], v239, s[44:47], s67 offen offset:2048 sc1
  s_waitcnt lgkmcnt(6)
  v_mfma_f32_16x16x32_bf16 v[16:19], v[204:207], v[100:103], v[16:19]
  ds_read_b128 v[72:75], v233 offset:24576
  v_mfma_f32_16x16x32_bf16 v[44:47], v[208:211], v[100:103], v[44:47]
  s_waitcnt lgkmcnt(6)
  v_mfma_f32_16x16x32_bf16 v[20:23], v[204:207], v[104:107], v[20:23]
  ds_read_b128 v[76:79], v233 offset:25600
  v_mfma_f32_16x16x32_bf16 v[48:51], v[208:211], v[104:107], v[48:51]
  s_waitcnt lgkmcnt(6)
  v_mfma_f32_16x16x32_bf16 v[24:27], v[204:207], v[108:111], v[24:27]
  ds_read_b128 v[80:83], v233 offset:26624
  v_mfma_f32_16x16x32_bf16 v[52:55], v[208:211], v[108:111], v[52:55]
  s_waitcnt lgkmcnt(6)
  v_mfma_f32_16x16x32_bf16 v[28:31], v[204:207], v[112:115], v[28:31]
  ds_read_b128 v[84:87], v233 offset:27648
  v_mfma_f32_16x16x32_bf16 v[56:59], v[208:211], v[112:115], v[56:59]
  s_waitcnt vmcnt(16) lgkmcnt(6)
  v_mfma_f32_16x16x32_bf16 v[4:7], v[116:119], v[60:63], v[4:7]
  ds_read_b128 v[88:91], v233 offset:28672
  s_waitcnt vmcnt(14)
  v_mfma_f32_16x16x32_bf16 v[32:35], v[120:123], v[60:63], v[32:35]
  s_waitcnt lgkmcnt(6)
  v_mfma_f32_16x16x32_bf16 v[8:11], v[116:119], v[64:67], v[8:11]
  ds_read_b128 v[92:95], v233 offset:29696
  v_mfma_f32_16x16x32_bf16 v[36:39], v[120:123], v[64:67], v[36:39]
  s_waitcnt lgkmcnt(6)
  v_mfma_f32_16x16x32_bf16 v[12:15], v[116:119], v[68:71], v[12:15]
  ds_read_b128 v[96:99], v233 offset:30720
  v_mfma_f32_16x16x32_bf16 v[40:43], v[120:123], v[68:71], v[40:43]
  buffer_load_dwordx4 v[172:175], v239, s[44:47], s66 offen offset:3072 sc1
  buffer_load_dwordx4 v[176:179], v239, s[44:47], s67 offen offset:3072 sc1
  s_waitcnt lgkmcnt(6)
  v_mfma_f32_16x16x32_bf16 v[16:19], v[116:119], v[72:75], v[16:19]
  ds_read_b128 v[100:103], v233 offset:31744
  v_mfma_f32_16x16x32_bf16 v[44:47], v[120:123], v[72:75], v[44:47]
  s_waitcnt lgkmcnt(6)
  v_mfma_f32_16x16x32_bf16 v[20:23], v[116:119], v[76:79], v[20:23]
  ds_read_b128 v[104:107], v233 offset:32768
  v_mfma_f32_16x16x32_bf16 v[48:51], v[120:123], v[76:79], v[48:51]
  s_waitcnt lgkmcnt(6)
  v_mfma_f32_16x16x32_bf16 v[24:27], v[116:119], v[80:83], v[24:27]
  ds_read_b128 v[108:111], v233 offset:33792
  v_mfma_f32_16x16x32_bf16 v[52:55], v[120:123], v[80:83], v[52:55]
  s_waitcnt lgkmcnt(6)
  v_mfma_f32_16x16x32_bf16 v[28:31], v[116:119], v[84:87], v[28:31]
  ds_read_b128 v[112:115], v233 offset:34816
  v_mfma_f32_16x16x32_bf16 v[56:59], v[120:123], v[84:87], v[56:59]
  s_barrier
  s_waitcnt vmcnt(15) lgkmcnt(6)
  v_mfma_f32_16x16x32_bf16 v[4:7], v[124:127], v[88:91], v[4:7]
  ds_read_b128 v[60:63], v233 offset:35840
  s_waitcnt vmcnt(14)
  v_mfma_f32_16x16x32_bf16 v[32:35], v[128:131], v[88:91], v[32:35]
  s_waitcnt lgkmcnt(6)
  v_mfma_f32_16x16x32_bf16 v[8:11], v[124:127], v[92:95], v[8:11]
  ds_read_b128 v[64:67], v233 offset:36864
  v_mfma_f32_16x16x32_bf16 v[36:39], v[128:131], v[92:95], v[36:39]
  s_waitcnt lgkmcnt(6)
  v_mfma_f32_16x16x32_bf16 v[12:15], v[124:127], v[96:99], v[12:15]
  ds_read_b128 v[68:71], v233 offset:37888
  v_mfma_f32_16x16x32_bf16 v[40:43], v[128:131], v[96:99], v[40:43]
  s_waitcnt lgkmcnt(6)
  v_mfma_f32_16x16x32_bf16 v[16:19], v[124:127], v[100:103], v[16:19]
  ds_read_b128 v[72:75], v233 offset:38912
  v_mfma_f32_16x16x32_bf16 v[44:47], v[128:131], v[100:103], v[44:47]
  s_waitcnt lgkmcnt(6)
  v_mfma_f32_16x16x32_bf16 v[20:23], v[124:127], v[104:107], v[20:23]
  ds_read_b128 v[76:79], v233 offset:39936
  v_mfma_f32_16x16x32_bf16 v[48:51], v[128:131], v[104:107], v[48:51]
  s_waitcnt lgkmcnt(6)
  v_mfma_f32_16x16x32_bf16 v[24:27], v[124:127], v[108:111], v[24:27]
  ds_read_b128 v[80:83], v233 offset:40960
  v_mfma_f32_16x16x32_bf16 v[52:55], v[128:131], v[108:111], v[52:55]
  s_waitcnt lgkmcnt(6)
  v_mfma_f32_16x16x32_bf16 v[28:31], v[124:127], v[112:115], v[28:31]
  ds_read_b128 v[84:87], v233 offset:41984
  v_mfma_f32_16x16x32_bf16 v[56:59], v[128:131], v[112:115], v[56:59]
  s_waitcnt vmcnt(13) lgkmcnt(6)
  v_mfma_f32_16x16x32_bf16 v[4:7], v[132:135], v[60:63], v[4:7]
  ds_read_b128 v[88:91], v233 offset:43008
  s_waitcnt vmcnt(12)
  v_mfma_f32_16x16x32_bf16 v[32:35], v[136:139], v[60:63], v[32:35]
  s_waitcnt lgkmcnt(6)
  v_mfma_f32_16x16x32_bf16 v[8:11], v[132:135], v[64:67], v[8:11]
  ds_read_b128 v[92:95], v233 offset:44032
  v_mfma_f32_16x16x32_bf16 v[36:39], v[136:139], v[64:67], v[36:39]
  s_waitcnt lgkmcnt(6)
  v_mfma_f32_16x16x32_bf16 v[12:15], v[132:135], v[68:71], v[12:15]
  ds_read_b128 v[96:99], v233 offset:45056
  v_mfma_f32_16x16x32_bf16 v[40:43], v[136:139], v[68:71], v[40:43]
  s_waitcnt lgkmcnt(6)
  v_mfma_f32_16x16x32_bf16 v[16:19], v[132:135], v[72:75], v[16:19]
  ds_read_b128 v[100:103], v233 offset:46080
  v_mfma_f32_16x16x32_bf16 v[44:47], v[136:139], v[72:75], v[44:47]
  s_waitcnt lgkmcnt(6)
  v_mfma_f32_16x16x32_bf16 v[20:23], v[132:135], v[76:79], v[20:23]
  ds_read_b128 v[104:107], v233 offset:47104
  v_mfma_f32_16x16x32_bf16 v[48:51], v[136:139], v[76:79], v[48:51]
  s_waitcnt lgkmcnt(6)
  v_mfma_f32_16x16x32_bf16 v[24:27], v[132:135], v[80:83], v[24:27]
  ds_read_b128 v[108:111], v233 offset:48128
  v_mfma_f32_16x16x32_bf16 v[52:55], v[136:139], v[80:83], v[52:55]
  s_waitcnt lgkmcnt(6)
  v_mfma_f32_16x16x32_bf16 v[28:31], v[132:135], v[84:87], v[28:31]
  ds_read_b128 v[112:115], v233 offset:49152
  v_mfma_f32_16x16x32_bf16 v[56:59], v[136:139], v[84:87], v[56:59]
  s_waitcnt vmcnt(11) lgkmcnt(6)
  v_mfma_f32_16x16x32_bf16 v[4:7], v[140:143], v[88:91], v[4:7]
  ds_read_b128 v[60:63], v233 offset:50176
  s_waitcnt vmcnt(10)
  v_mfma_f32_16x16x32_bf16 v[32:35], v[144:147], v[88:91], v[32:35]
  s_waitcnt lgkmcnt(6)
  v_mfma_f32_16x16x32_bf16 v[8:11], v[140:143], v[92:95], v[8:11]
  ds_read_b128 v[64:67], v233 offset:51200
  v_mfma_f32_16x16x32_bf16 v[36:39], v[144:147], v[92:95], v[36:39]
  s_waitcnt lgkmcnt(6)
  v_mfma_f32_16x16x32_bf16 v[12:15], v[140:143], v[96:99], v[12:15]
  ds_read_b128 v[68:71], v233 offset:52224
  v_mfma_f32_16x16x32_bf16 v[40:43], v[144:147], v[96:99], v[40:43]
  s_waitcnt lgkmcnt(6)
  v_mfma_f32_16x16x32_bf16 v[16:19], v[140:143], v[100:103], v[16:19]
  ds_read_b128 v[72:75], v233 offset:53248
  v_mfma_f32_16x16x32_bf16 v[44:47], v[144:147], v[100:103], v[44:47]
  s_waitcnt lgkmcnt(6)
  v_mfma_f32_16x16x32_bf16 v[20:23], v[140:143], v[104:107], v[20:23]
  ds_read_b128 v[76:79], v233 offset:54272
  v_mfma_f32_16x16x32_bf16 v[48:51], v[144:147], v[104:107], v[48:51]
  s_waitcnt lgkmcnt(6)
  v_mfma_f32_16x16x32_bf16 v[24:27], v[140:143], v[108:111], v[24:27]
  ds_read_b128 v[80:83], v233 offset:55296
  v_mfma_f32_16x16x32_bf16 v[52:55], v[144:147], v[108:111], v[52:55]
  s_waitcnt lgkmcnt(6)
  v_mfma_f32_16x16x32_bf16 v[28:31], v[140:143], v[112:115], v[28:31]
  ds_read_b128 v[84:87], v233 offset:56320
  v_mfma_f32_16x16x32_bf16 v[56:59], v[144:147], v[112:115], v[56:59]
  s_waitcnt vmcnt(9) lgkmcnt(6)
  v_mfma_f32_16x16x32_bf16 v[4:7], v[148:151], v[60:63], v[4:7]
  ds_read_b128 v[88:91], v233 offset:57344
  s_waitcnt vmcnt(8)
  v_mfma_f32_16x16x32_bf16 v[32:35], v[152:155], v[60:63], v[32:35]
  s_waitcnt lgkmcnt(6)
  v_mfma_f32_16x16x32_bf16 v[8:11], v[148:151], v[64:67], v[8:11]
  ds_read_b128 v[92:95], v233 offset:58368
  v_mfma_f32_16x16x32_bf16 v[36:39], v[152:155], v[64:67], v[36:39]
  s_waitcnt lgkmcnt(6)
  v_mfma_f32_16x16x32_bf16 v[12:15], v[148:151], v[68:71], v[12:15]
  ds_read_b128 v[96:99], v233 offset:59392
  v_mfma_f32_16x16x32_bf16 v[40:43], v[152:155], v[68:71], v[40:43]
  s_waitcnt lgkmcnt(6)
  v_mfma_f32_16x16x32_bf16 v[16:19], v[148:151], v[72:75], v[16:19]
  ds_read_b128 v[100:103], v233 offset:60416
  v_mfma_f32_16x16x32_bf16 v[44:47], v[152:155], v[72:75], v[44:47]
  s_waitcnt lgkmcnt(6)
  v_mfma_f32_16x16x32_bf16 v[20:23], v[148:151], v[76:79], v[20:23]
  ds_read_b128 v[104:107], v233 offset:61440
  v_mfma_f32_16x16x32_bf16 v[48:51], v[152:155], v[76:79], v[48:51]
  s_waitcnt lgkmcnt(6)
  v_mfma_f32_16x16x32_bf16 v[24:27], v[148:151], v[80:83], v[24:27]
  ds_read_b128 v[108:111], v233 offset:62464
  v_mfma_f32_16x16x32_bf16 v[52:55], v[152:155], v[80:83], v[52:55]
  s_waitcnt lgkmcnt(6)
  v_mfma_f32_16x16x32_bf16 v[28:31], v[148:151], v[84:87], v[28:31]
  ds_read_b128 v[112:115], v233 offset:63488
  v_mfma_f32_16x16x32_bf16 v[56:59], v[152:155], v[84:87], v[56:59]
  s_waitcnt vmcnt(6) lgkmcnt(6)
  v_mfma_f32_16x16x32_bf16 v[4:7], v[156:159], v[88:91], v[4:7]
  ds_read_b128 v[60:63], v234 offset:0
  s_waitcnt vmcnt(4)
  v_mfma_f32_16x16x32_bf16 v[32:35], v[160:163], v[88:91], v[32:35]
  s_waitcnt lgkmcnt(6)
  v_mfma_f32_16x16x32_bf16 v[8:11], v[156:159], v[92:95], v[8:11]
  ds_read_b128 v[64:67], v234 offset:1024
  v_mfma_f32_16x16x32_bf16 v[36:39], v[160:163], v[92:95], v[36:39]
  s_waitcnt lgkmcnt(6)
  v_mfma_f32_16x16x32_bf16 v[12:15], v[156:159], v[96:99], v[12:15]
  ds_read_b128 v[68:71], v234 offset:2048
  v_mfma_f32_16x16x32_bf16 v[40:43], v[160:163], v[96:99], v[40:43]
  s_waitcnt lgkmcnt(6)
  v_mfma_f32_16x16x32_bf16 v[16:19], v[156:159], v[100:103], v[16:19]
  ds_read_b128 v[72:75], v234 offset:3072
  v_mfma_f32_16x16x32_bf16 v[44:47], v[160:163], v[100:103], v[44:47]
  s_waitcnt lgkmcnt(6)
  v_mfma_f32_16x16x32_bf16 v[20:23], v[156:159], v[104:107], v[20:23]
  ds_read_b128 v[76:79], v234 offset:4096
  v_mfma_f32_16x16x32_bf16 v[48:51], v[160:163], v[104:107], v[48:51]
  s_waitcnt lgkmcnt(6)
  v_mfma_f32_16x16x32_bf16 v[24:27], v[156:159], v[108:111], v[24:27]
  ds_read_b128 v[80:83], v234 offset:5120
  v_mfma_f32_16x16x32_bf16 v[52:55], v[160:163], v[108:111], v[52:55]
  s_waitcnt lgkmcnt(6)
  v_mfma_f32_16x16x32_bf16 v[28:31], v[156:159], v[112:115], v[28:31]
  ds_read_b128 v[84:87], v234 offset:6144
  v_mfma_f32_16x16x32_bf16 v[56:59], v[160:163], v[112:115], v[56:59]
  s_waitcnt vmcnt(3) lgkmcnt(6)
  v_mfma_f32_16x16x32_bf16 v[4:7], v[164:167], v[60:63], v[4:7]
  ds_read_b128 v[88:91], v234 offset:7168
  s_waitcnt vmcnt(2)
  v_mfma_f32_16x16x32_bf16 v[32:35], v[168:171], v[60:63], v[32:35]
  s_waitcnt lgkmcnt(6)
  v_mfma_f32_16x16x32_bf16 v[8:11], v[164:167], v[64:67], v[8:11]
  ds_read_b128 v[92:95], v234 offset:8192
  v_mfma_f32_16x16x32_bf16 v[36:39], v[168:171], v[64:67], v[36:39]
  s_waitcnt lgkmcnt(6)
  v_mfma_f32_16x16x32_bf16 v[12:15], v[164:167], v[68:71], v[12:15]
  ds_read_b128 v[96:99], v234 offset:9216
  v_mfma_f32_16x16x32_bf16 v[40:43], v[168:171], v[68:71], v[40:43]
  s_waitcnt lgkmcnt(6)
  v_mfma_f32_16x16x32_bf16 v[16:19], v[164:167], v[72:75], v[16:19]
  ds_read_b128 v[100:103], v234 offset:10240
  v_mfma_f32_16x16x32_bf16 v[44:47], v[168:171], v[72:75], v[44:47]
  s_waitcnt lgkmcnt(6)
  v_mfma_f32_16x16x32_bf16 v[20:23], v[164:167], v[76:79], v[20:23]
  ds_read_b128 v[104:107], v234 offset:11264
  v_mfma_f32_16x16x32_bf16 v[48:51], v[168:171], v[76:79], v[48:51]
  s_waitcnt lgkmcnt(6)
  v_mfma_f32_16x16x32_bf16 v[24:27], v[164:167], v[80:83], v[24:27]
  ds_read_b128 v[108:111], v234 offset:12288
  v_mfma_f32_16x16x32_bf16 v[52:55], v[168:171], v[80:83], v[52:55]
  s_waitcnt lgkmcnt(6)
  v_mfma_f32_16x16x32_bf16 v[28:31], v[164:167], v[84:87], v[28:31]
  ds_read_b128 v[112:115], v234 offset:13312
  v_mfma_f32_16x16x32_bf16 v[56:59], v[168:171], v[84:87], v[56:59]
  s_waitcnt vmcnt(1) lgkmcnt(6)
  v_mfma_f32_16x16x32_bf16 v[4:7], v[172:175], v[88:91], v[4:7]
  s_waitcnt vmcnt(0)
  v_mfma_f32_16x16x32_bf16 v[32:35], v[176:179], v[88:91], v[32:35]
  s_waitcnt lgkmcnt(5)
  v_mfma_f32_16x16x32_bf16 v[8:11], v[172:175], v[92:95], v[8:11]
  v_mfma_f32_16x16x32_bf16 v[36:39], v[176:179], v[92:95], v[36:39]
  s_waitcnt lgkmcnt(4)
  v_mfma_f32_16x16x32_bf16 v[12:15], v[172:175], v[96:99], v[12:15]
  v_mfma_f32_16x16x32_bf16 v[40:43], v[176:179], v[96:99], v[40:43]
  s_waitcnt lgkmcnt(3)
  v_mfma_f32_16x16x32_bf16 v[16:19], v[172:175], v[100:103], v[16:19]
  v_mfma_f32_16x16x32_bf16 v[44:47], v[176:179], v[100:103], v[44:47]
  s_waitcnt lgkmcnt(2)
  v_mfma_f32_16x16x32_bf16 v[20:23], v[172:175], v[104:107], v[20:23]
  v_mfma_f32_16x16x32_bf16 v[48:51], v[176:179], v[104:107], v[48:51]
  s_waitcnt lgkmcnt(1)
  v_mfma_f32_16x16x32_bf16 v[24:27], v[172:175], v[108:111], v[24:27]
  v_mfma_f32_16x16x32_bf16 v[52:55], v[176:179], v[108:111], v[52:55]
  s_waitcnt lgkmcnt(0)
  v_mfma_f32_16x16x32_bf16 v[28:31], v[172:175], v[112:115], v[28:31]
  v_mfma_f32_16x16x32_bf16 v[56:59], v[176:179], v[112:115], v[56:59]
  s_branch IF_102_end
IF_102_else:
  ds_read_b128 v[60:63], v232 offset:0
  ds_read_b128 v[64:67], v232 offset:1024
  ds_read_b128 v[68:71], v232 offset:2048
  ds_read_b128 v[72:75], v232 offset:3072
  ds_read_b128 v[76:79], v232 offset:4096
  ds_read_b128 v[80:83], v232 offset:5120
  ds_read_b128 v[84:87], v232 offset:6144
  s_waitcnt vmcnt(7) lgkmcnt(6)
  v_mfma_f32_16x16x32_bf16 v[4:7], v[60:63], v[116:119], 0
  ds_read_b128 v[88:91], v232 offset:7168
  s_waitcnt vmcnt(6)
  v_mfma_f32_16x16x32_bf16 v[32:35], v[60:63], v[120:123], 0
  s_waitcnt lgkmcnt(6)
  v_mfma_f32_16x16x32_bf16 v[8:11], v[64:67], v[116:119], 0
  ds_read_b128 v[92:95], v232 offset:8192
  v_mfma_f32_16x16x32_bf16 v[36:39], v[64:67], v[120:123], 0
  s_waitcnt lgkmcnt(6)
  v_mfma_f32_16x16x32_bf16 v[12:15], v[68:71], v[116:119], 0
  ds_read_b128 v[96:99], v232 offset:9216
  v_mfma_f32_16x16x32_bf16 v[40:43], v[68:71], v[120:123], 0
  buffer_load_dwordx4 v[140:143], v239, s[44:47], s66 offen offset:3072 sc1
  buffer_load_dwordx4 v[144:147], v239, s[44:47], s67 offen offset:3072 sc1
  s_waitcnt lgkmcnt(6)
  v_mfma_f32_16x16x32_bf16 v[16:19], v[72:75], v[116:119], 0
  ds_read_b128 v[100:103], v232 offset:10240
  v_mfma_f32_16x16x32_bf16 v[44:47], v[72:75], v[120:123], 0
  s_waitcnt lgkmcnt(6)
  v_mfma_f32_16x16x32_bf16 v[20:23], v[76:79], v[116:119], 0
  ds_read_b128 v[104:107], v232 offset:11264
  v_mfma_f32_16x16x32_bf16 v[48:51], v[76:79], v[120:123], 0
  s_waitcnt lgkmcnt(6)
  v_mfma_f32_16x16x32_bf16 v[24:27], v[80:83], v[116:119], 0
  ds_read_b128 v[108:111], v232 offset:12288
  v_mfma_f32_16x16x32_bf16 v[52:55], v[80:83], v[120:123], 0
  s_add_u32 s66, s66, 4096
  buffer_load_dwordx4 v[148:151], v239, s[44:47], s66 offen offset:0 sc1
  s_add_u32 s67, s67, 4096
  buffer_load_dwordx4 v[152:155], v239, s[44:47], s67 offen offset:0 sc1
  s_waitcnt lgkmcnt(6)
  v_mfma_f32_16x16x32_bf16 v[28:31], v[84:87], v[116:119], 0
  ds_read_b128 v[112:115], v232 offset:13312
  v_mfma_f32_16x16x32_bf16 v[56:59], v[84:87], v[120:123], 0
  s_waitcnt vmcnt(9) lgkmcnt(6)
  v_mfma_f32_16x16x32_bf16 v[4:7], v[88:91], v[124:127], v[4:7]
  ds_read_b128 v[60:63], v232 offset:14336
  s_waitcnt vmcnt(8)
  v_mfma_f32_16x16x32_bf16 v[32:35], v[88:91], v[128:131], v[32:35]
  s_waitcnt lgkmcnt(6)
  v_mfma_f32_16x16x32_bf16 v[8:11], v[92:95], v[124:127], v[8:11]
  ds_read_b128 v[64:67], v232 offset:15360
  v_mfma_f32_16x16x32_bf16 v[36:39], v[92:95], v[128:131], v[36:39]
  s_waitcnt lgkmcnt(6)
  v_mfma_f32_16x16x32_bf16 v[12:15], v[96:99], v[124:127], v[12:15]
  ds_read_b128 v[68:71], v232 offset:16384
  v_mfma_f32_16x16x32_bf16 v[40:43], v[96:99], v[128:131], v[40:43]
  buffer_load_dwordx4 v[156:159], v239, s[44:47], s66 offen offset:1024 sc1
  buffer_load_dwordx4 v[160:163], v239, s[44:47], s67 offen offset:1024 sc1
  s_waitcnt lgkmcnt(6)
  v_mfma_f32_16x16x32_bf16 v[16:19], v[100:103], v[124:127], v[16:19]
  ds_read_b128 v[72:75], v232 offset:17408
  v_mfma_f32_16x16x32_bf16 v[44:47], v[100:103], v[128:131], v[44:47]
  s_waitcnt lgkmcnt(6)
  v_mfma_f32_16x16x32_bf16 v[20:23], v[104:107], v[124:127], v[20:23]
  ds_read_b128 v[76:79], v232 offset:18432
  v_mfma_f32_16x16x32_bf16 v[48:51], v[104:107], v[128:131], v[48:51]
  s_waitcnt lgkmcnt(6)
  v_mfma_f32_16x16x32_bf16 v[24:27], v[108:111], v[124:127], v[24:27]
  ds_read_b128 v[80:83], v232 offset:19456
  v_mfma_f32_16x16x32_bf16 v[52:55], v[108:111], v[128:131], v[52:55]
  buffer_load_dwordx4 v[164:167], v239, s[44:47], s66 offen offset:2048 sc1
  buffer_load_dwordx4 v[168:171], v239, s[44:47], s67 offen offset:2048 sc1
  s_waitcnt lgkmcnt(6)
  v_mfma_f32_16x16x32_bf16 v[28:31], v[112:115], v[124:127], v[28:31]
  ds_read_b128 v[84:87], v232 offset:20480
  v_mfma_f32_16x16x32_bf16 v[56:59], v[112:115], v[128:131], v[56:59]
  s_waitcnt vmcnt(10) lgkmcnt(6)
  v_mfma_f32_16x16x32_bf16 v[4:7], v[60:63], v[132:135], v[4:7]
  ds_read_b128 v[88:91], v232 offset:21504
  s_waitcnt vmcnt(8)
  v_mfma_f32_16x16x32_bf16 v[32:35], v[60:63], v[136:139], v[32:35]
  s_waitcnt lgkmcnt(6)
  v_mfma_f32_16x16x32_bf16 v[8:11], v[64:67], v[132:135], v[8:11]
  ds_read_b128 v[92:95], v232 offset:22528
  v_mfma_f32_16x16x32_bf16 v[36:39], v[64:67], v[136:139], v[36:39]
  s_waitcnt lgkmcnt(6)
  v_mfma_f32_16x16x32_bf16 v[12:15], v[68:71], v[132:135], v[12:15]
  ds_read_b128 v[96:99], v232 offset:23552
  v_mfma_f32_16x16x32_bf16 v[40:43], v[68:71], v[136:139], v[40:43]
  buffer_load_dwordx2 v[172:173], v238, s[44:47], s66 offen offset:3072 sc1
  buffer_load_dwordx2 v[174:175], v238, s[44:47], s66 offen offset:3584 sc1
  buffer_load_dwordx2 v[176:177], v238, s[44:47], s67 offen offset:3072 sc1
  buffer_load_dwordx2 v[178:179], v238, s[44:47], s67 offen offset:3584 sc1
  s_waitcnt lgkmcnt(6)
  v_mfma_f32_16x16x32_bf16 v[16:19], v[72:75], v[132:135], v[16:19]
  ds_read_b128 v[100:103], v232 offset:24576
  v_mfma_f32_16x16x32_bf16 v[44:47], v[72:75], v[136:139], v[44:47]
  s_waitcnt lgkmcnt(6)
  v_mfma_f32_16x16x32_bf16 v[20:23], v[76:79], v[132:135], v[20:23]
  ds_read_b128 v[104:107], v232 offset:25600
  v_mfma_f32_16x16x32_bf16 v[48:51], v[76:79], v[136:139], v[48:51]
  s_waitcnt lgkmcnt(6)
  v_mfma_f32_16x16x32_bf16 v[24:27], v[80:83], v[132:135], v[24:27]
  ds_read_b128 v[108:111], v232 offset:26624
  v_mfma_f32_16x16x32_bf16 v[52:55], v[80:83], v[136:139], v[52:55]
  s_add_u32 s66, s66, 4096
  buffer_load_dwordx4 v[180:183], v239, s[44:47], s66 offen offset:0 sc1
  s_add_u32 s67, s67, 4096
  buffer_load_dwordx4 v[184:187], v239, s[44:47], s67 offen offset:0 sc1
  s_waitcnt lgkmcnt(6)
  v_mfma_f32_16x16x32_bf16 v[28:31], v[84:87], v[132:135], v[28:31]
  ds_read_b128 v[112:115], v232 offset:27648
  v_mfma_f32_16x16x32_bf16 v[56:59], v[84:87], v[136:139], v[56:59]
  s_waitcnt vmcnt(13) lgkmcnt(6)
  v_mfma_f32_16x16x32_bf16 v[4:7], v[88:91], v[140:143], v[4:7]
  ds_read_b128 v[60:63], v232 offset:28672
  s_waitcnt vmcnt(12)
  v_mfma_f32_16x16x32_bf16 v[32:35], v[88:91], v[144:147], v[32:35]
  s_waitcnt lgkmcnt(6)
  v_mfma_f32_16x16x32_bf16 v[8:11], v[92:95], v[140:143], v[8:11]
  ds_read_b128 v[64:67], v232 offset:29696
  v_mfma_f32_16x16x32_bf16 v[36:39], v[92:95], v[144:147], v[36:39]
  s_waitcnt lgkmcnt(6)
  v_mfma_f32_16x16x32_bf16 v[12:15], v[96:99], v[140:143], v[12:15]
  ds_read_b128 v[68:71], v232 offset:30720
  v_mfma_f32_16x16x32_bf16 v[40:43], v[96:99], v[144:147], v[40:43]
  buffer_load_dwordx4 v[188:191], v239, s[44:47], s66 offen offset:1024 sc1
  buffer_load_dwordx4 v[192:195], v239, s[44:47], s67 offen offset:1024 sc1
  s_waitcnt lgkmcnt(6)
  v_mfma_f32_16x16x32_bf16 v[16:19], v[100:103], v[140:143], v[16:19]
  ds_read_b128 v[72:75], v232 offset:31744
  v_mfma_f32_16x16x32_bf16 v[44:47], v[100:103], v[144:147], v[44:47]
  s_waitcnt lgkmcnt(6)
  v_mfma_f32_16x16x32_bf16 v[20:23], v[104:107], v[140:143], v[20:23]
  ds_read_b128 v[76:79], v232 offset:32768
  v_mfma_f32_16x16x32_bf16 v[48:51], v[104:107], v[144:147], v[48:51]
  s_waitcnt lgkmcnt(6)
  v_mfma_f32_16x16x32_bf16 v[24:27], v[108:111], v[140:143], v[24:27]
  ds_read_b128 v[80:83], v232 offset:33792
  v_mfma_f32_16x16x32_bf16 v[52:55], v[108:111], v[144:147], v[52:55]
  buffer_load_dwordx4 v[196:199], v239, s[44:47], s66 offen offset:2048 sc1
  buffer_load_dwordx4 v[200:203], v239, s[44:47], s67 offen offset:2048 sc1
  s_waitcnt lgkmcnt(6)
  v_mfma_f32_16x16x32_bf16 v[28:31], v[112:115], v[140:143], v[28:31]
  ds_read_b128 v[84:87], v232 offset:34816
  v_mfma_f32_16x16x32_bf16 v[56:59], v[112:115], v[144:147], v[56:59]
  s_waitcnt vmcnt(15) lgkmcnt(6)
  v_mfma_f32_16x16x32_bf16 v[4:7], v[60:63], v[148:151], v[4:7]
  ds_read_b128 v[88:91], v232 offset:35840
  s_waitcnt vmcnt(14)
  v_mfma_f32_16x16x32_bf16 v[32:35], v[60:63], v[152:155], v[32:35]
  s_waitcnt lgkmcnt(6)
  v_mfma_f32_16x16x32_bf16 v[8:11], v[64:67], v[148:151], v[8:11]
  ds_read_b128 v[92:95], v232 offset:36864
  v_mfma_f32_16x16x32_bf16 v[36:39], v[64:67], v[152:155], v[36:39]
  s_waitcnt lgkmcnt(6)
  v_mfma_f32_16x16x32_bf16 v[12:15], v[68:71], v[148:151], v[12:15]
  ds_read_b128 v[96:99], v232 offset:37888
  v_mfma_f32_16x16x32_bf16 v[40:43], v[68:71], v[152:155], v[40:43]
  buffer_load_dwordx4 v[204:207], v239, s[44:47], s66 offen offset:3072 sc1
  buffer_load_dwordx4 v[208:211], v239, s[44:47], s67 offen offset:3072 sc1
  s_waitcnt lgkmcnt(6)
  v_mfma_f32_16x16x32_bf16 v[16:19], v[72:75], v[148:151], v[16:19]
  ds_read_b128 v[100:103], v232 offset:38912
  v_mfma_f32_16x16x32_bf16 v[44:47], v[72:75], v[152:155], v[44:47]
  s_waitcnt lgkmcnt(6)
  v_mfma_f32_16x16x32_bf16 v[20:23], v[76:79], v[148:151], v[20:23]
  ds_read_b128 v[104:107], v232 offset:39936
  v_mfma_f32_16x16x32_bf16 v[48:51], v[76:79], v[152:155], v[48:51]
  s_waitcnt lgkmcnt(6)
  v_mfma_f32_16x16x32_bf16 v[24:27], v[80:83], v[148:151], v[24:27]
  ds_read_b128 v[108:111], v232 offset:40960
  v_mfma_f32_16x16x32_bf16 v[52:55], v[80:83], v[152:155], v[52:55]
  s_waitcnt lgkmcnt(6)
  v_mfma_f32_16x16x32_bf16 v[28:31], v[84:87], v[148:151], v[28:31]
  ds_read_b128 v[112:115], v232 offset:41984
  v_mfma_f32_16x16x32_bf16 v[56:59], v[84:87], v[152:155], v[56:59]
  s_waitcnt vmcnt(15) lgkmcnt(6)
  v_mfma_f32_16x16x32_bf16 v[4:7], v[88:91], v[156:159], v[4:7]
  ds_read_b128 v[60:63], v232 offset:43008
  s_waitcnt vmcnt(14)
  v_mfma_f32_16x16x32_bf16 v[32:35], v[88:91], v[160:163], v[32:35]
  s_waitcnt lgkmcnt(6)
  v_mfma_f32_16x16x32_bf16 v[8:11], v[92:95], v[156:159], v[8:11]
  ds_read_b128 v[64:67], v232 offset:44032
  v_mfma_f32_16x16x32_bf16 v[36:39], v[92:95], v[160:163], v[36:39]
  s_waitcnt lgkmcnt(6)
  v_mfma_f32_16x16x32_bf16 v[12:15], v[96:99], v[156:159], v[12:15]
  ds_read_b128 v[68:71], v232 offset:45056
  v_mfma_f32_16x16x32_bf16 v[40:43], v[96:99], v[160:163], v[40:43]
  s_add_u32 s66, s66, 4096
  buffer_load_dwordx2 v[116:117], v238, s[44:47], s66 offen offset:0 sc1
  buffer_load_dwordx2 v[118:119], v238, s[44:47], s66 offen offset:512 sc1
  s_add_u32 s67, s67, 4096
  buffer_load_dwordx2 v[120:121], v238, s[44:47], s67 offen offset:0 sc1
  buffer_load_dwordx2 v[122:123], v238, s[44:47], s67 offen offset:512 sc1
  s_waitcnt lgkmcnt(6)
  v_mfma_f32_16x16x32_bf16 v[16:19], v[100:103], v[156:159], v[16:19]
  ds_read_b128 v[72:75], v232 offset:46080
  v_mfma_f32_16x16x32_bf16 v[44:47], v[100:103], v[160:163], v[44:47]
  s_waitcnt lgkmcnt(6)
  v_mfma_f32_16x16x32_bf16 v[20:23], v[104:107], v[156:159], v[20:23]
  ds_read_b128 v[76:79], v232 offset:47104
  v_mfma_f32_16x16x32_bf16 v[48:51], v[104:107], v[160:163], v[48:51]
  s_waitcnt lgkmcnt(6)
  v_mfma_f32_16x16x32_bf16 v[24:27], v[108:111], v[156:159], v[24:27]
  ds_read_b128 v[80:83], v232 offset:48128
  v_mfma_f32_16x16x32_bf16 v[52:55], v[108:111], v[160:163], v[52:55]
  s_waitcnt lgkmcnt(6)
  v_mfma_f32_16x16x32_bf16 v[28:31], v[112:115], v[156:159], v[28:31]
  ds_read_b128 v[84:87], v232 offset:49152
  v_mfma_f32_16x16x32_bf16 v[56:59], v[112:115], v[160:163], v[56:59]
  s_waitcnt vmcnt(17) lgkmcnt(6)
  v_mfma_f32_16x16x32_bf16 v[4:7], v[60:63], v[164:167], v[4:7]
  ds_read_b128 v[88:91], v232 offset:50176
  s_waitcnt vmcnt(16)
  v_mfma_f32_16x16x32_bf16 v[32:35], v[60:63], v[168:171], v[32:35]
  s_waitcnt lgkmcnt(6)
  v_mfma_f32_16x16x32_bf16 v[8:11], v[64:67], v[164:167], v[8:11]
  ds_read_b128 v[92:95], v232 offset:51200
  v_mfma_f32_16x16x32_bf16 v[36:39], v[64:67], v[168:171], v[36:39]
  s_waitcnt lgkmcnt(6)
  v_mfma_f32_16x16x32_bf16 v[12:15], v[68:71], v[164:167], v[12:15]
  ds_read_b128 v[96:99], v232 offset:52224
  v_mfma_f32_16x16x32_bf16 v[40:43], v[68:71], v[168:171], v[40:43]
  buffer_load_dwordx4 v[124:127], v239, s[44:47], s66 offen offset:1024 sc1
  buffer_load_dwordx4 v[128:131], v239, s[44:47], s67 offen offset:1024 sc1
  s_waitcnt lgkmcnt(6)
  v_mfma_f32_16x16x32_bf16 v[16:19], v[72:75], v[164:167], v[16:19]
  ds_read_b128 v[100:103], v232 offset:53248
  v_mfma_f32_16x16x32_bf16 v[44:47], v[72:75], v[168:171], v[44:47]
  s_waitcnt lgkmcnt(6)
  v_mfma_f32_16x16x32_bf16 v[20:23], v[76:79], v[164:167], v[20:23]
  ds_read_b128 v[104:107], v232 offset:54272
  v_mfma_f32_16x16x32_bf16 v[48:51], v[76:79], v[168:171], v[48:51]
  s_waitcnt lgkmcnt(6)
  v_mfma_f32_16x16x32_bf16 v[24:27], v[80:83], v[164:167], v[24:27]
  ds_read_b128 v[108:111], v232 offset:55296
  v_mfma_f32_16x16x32_bf16 v[52:55], v[80:83], v[168:171], v[52:55]
  s_waitcnt lgkmcnt(6)
  v_mfma_f32_16x16x32_bf16 v[28:31], v[84:87], v[164:167], v[28:31]
  ds_read_b128 v[112:115], v232 offset:56320
  v_mfma_f32_16x16x32_bf16 v[56:59], v[84:87], v[168:171], v[56:59]
  s_waitcnt vmcnt(16) lgkmcnt(6)
  v_mfma_f32_16x16x32_bf16 v[4:7], v[88:91], v[172:175], v[4:7]
  ds_read_b128 v[60:63], v232 offset:57344
  s_waitcnt vmcnt(14)
  v_mfma_f32_16x16x32_bf16 v[32:35], v[88:91], v[176:179], v[32:35]
  s_waitcnt lgkmcnt(6)
  v_mfma_f32_16x16x32_bf16 v[8:11], v[92:95], v[172:175], v[8:11]
  ds_read_b128 v[64:67], v232 offset:58368
  v_mfma_f32_16x16x32_bf16 v[36:39], v[92:95], v[176:179], v[36:39]
  s_waitcnt lgkmcnt(6)
  v_mfma_f32_16x16x32_bf16 v[12:15], v[96:99], v[172:175], v[12:15]
  ds_read_b128 v[68:71], v232 offset:59392
  v_mfma_f32_16x16x32_bf16 v[40:43], v[96:99], v[176:179], v[40:43]
  buffer_load_dwordx4 v[132:135], v239, s[44:47], s66 offen offset:2048 sc1
  buffer_load_dwordx4 v[136:139], v239, s[44:47], s67 offen offset:2048 sc1
  s_waitcnt lgkmcnt(6)
  v_mfma_f32_16x16x32_bf16 v[16:19], v[100:103], v[172:175], v[16:19]
  ds_read_b128 v[72:75], v232 offset:60416
  v_mfma_f32_16x16x32_bf16 v[44:47], v[100:103], v[176:179], v[44:47]
  s_waitcnt lgkmcnt(6)
  v_mfma_f32_16x16x32_bf16 v[20:23], v[104:107], v[172:175], v[20:23]
  ds_read_b128 v[76:79], v232 offset:61440
  v_mfma_f32_16x16x32_bf16 v[48:51], v[104:107], v[176:179], v[48:51]
  s_waitcnt lgkmcnt(6)
  v_mfma_f32_16x16x32_bf16 v[24:27], v[108:111], v[172:175], v[24:27]
  ds_read_b128 v[80:83], v232 offset:62464
  v_mfma_f32_16x16x32_bf16 v[52:55], v[108:111], v[176:179], v[52:55]
  s_waitcnt lgkmcnt(6)
  v_mfma_f32_16x16x32_bf16 v[28:31], v[112:115], v[172:175], v[28:31]
  ds_read_b128 v[84:87], v232 offset:63488
  v_mfma_f32_16x16x32_bf16 v[56:59], v[112:115], v[176:179], v[56:59]
  s_waitcnt vmcnt(15) lgkmcnt(6)
  v_mfma_f32_16x16x32_bf16 v[4:7], v[60:63], v[180:183], v[4:7]
  ds_read_b128 v[88:91], v233 offset:0
  s_waitcnt vmcnt(14)
  v_mfma_f32_16x16x32_bf16 v[32:35], v[60:63], v[184:187], v[32:35]
  s_waitcnt lgkmcnt(6)
  v_mfma_f32_16x16x32_bf16 v[8:11], v[64:67], v[180:183], v[8:11]
  ds_read_b128 v[92:95], v233 offset:1024
  v_mfma_f32_16x16x32_bf16 v[36:39], v[64:67], v[184:187], v[36:39]
  s_waitcnt lgkmcnt(6)
  v_mfma_f32_16x16x32_bf16 v[12:15], v[68:71], v[180:183], v[12:15]
  ds_read_b128 v[96:99], v233 offset:2048
  v_mfma_f32_16x16x32_bf16 v[40:43], v[68:71], v[184:187], v[40:43]
  buffer_load_dwordx4 v[140:143], v239, s[44:47], s66 offen offset:3072 sc1
  buffer_load_dwordx4 v[144:147], v239, s[44:47], s67 offen offset:3072 sc1
  s_waitcnt lgkmcnt(6)
  v_mfma_f32_16x16x32_bf16 v[16:19], v[72:75], v[180:183], v[16:19]
  ds_read_b128 v[100:103], v233 offset:3072
  v_mfma_f32_16x16x32_bf16 v[44:47], v[72:75], v[184:187], v[44:47]
  s_waitcnt lgkmcnt(6)
  v_mfma_f32_16x16x32_bf16 v[20:23], v[76:79], v[180:183], v[20:23]
  ds_read_b128 v[104:107], v233 offset:4096
  v_mfma_f32_16x16x32_bf16 v[48:51], v[76:79], v[184:187], v[48:51]
  s_waitcnt lgkmcnt(6)
  v_mfma_f32_16x16x32_bf16 v[24:27], v[80:83], v[180:183], v[24:27]
  ds_read_b128 v[108:111], v233 offset:5120
  v_mfma_f32_16x16x32_bf16 v[52:55], v[80:83], v[184:187], v[52:55]
  s_waitcnt lgkmcnt(6)
  v_mfma_f32_16x16x32_bf16 v[28:31], v[84:87], v[180:183], v[28:31]
  ds_read_b128 v[112:115], v233 offset:6144
  v_mfma_f32_16x16x32_bf16 v[56:59], v[84:87], v[184:187], v[56:59]
  s_waitcnt vmcnt(15) lgkmcnt(6)
  v_mfma_f32_16x16x32_bf16 v[4:7], v[88:91], v[188:191], v[4:7]
  ds_read_b128 v[60:63], v233 offset:7168
  s_waitcnt vmcnt(14)
  v_mfma_f32_16x16x32_bf16 v[32:35], v[88:91], v[192:195], v[32:35]
  s_waitcnt lgkmcnt(6)
  v_mfma_f32_16x16x32_bf16 v[8:11], v[92:95], v[188:191], v[8:11]
  ds_read_b128 v[64:67], v233 offset:8192
  v_mfma_f32_16x16x32_bf16 v[36:39], v[92:95], v[192:195], v[36:39]
  s_waitcnt lgkmcnt(6)
  v_mfma_f32_16x16x32_bf16 v[12:15], v[96:99], v[188:191], v[12:15]
  ds_read_b128 v[68:71], v233 offset:9216
  v_mfma_f32_16x16x32_bf16 v[40:43], v[96:99], v[192:195], v[40:43]
  s_add_u32 s66, s66, 4096
  buffer_load_dwordx4 v[148:151], v239, s[44:47], s66 offen offset:0 sc1
  s_add_u32 s67, s67, 4096
  buffer_load_dwordx4 v[152:155], v239, s[44:47], s67 offen offset:0 sc1
  s_waitcnt lgkmcnt(6)
  v_mfma_f32_16x16x32_bf16 v[16:19], v[100:103], v[188:191], v[16:19]
  ds_read_b128 v[72:75], v233 offset:10240
  v_mfma_f32_16x16x32_bf16 v[44:47], v[100:103], v[192:195], v[44:47]
  s_waitcnt lgkmcnt(6)
  v_mfma_f32_16x16x32_bf16 v[20:23], v[104:107], v[188:191], v[20:23]
  ds_read_b128 v[76:79], v233 offset:11264
  v_mfma_f32_16x16x32_bf16 v[48:51], v[104:107], v[192:195], v[48:51]
  s_waitcnt lgkmcnt(6)
  v_mfma_f32_16x16x32_bf16 v[24:27], v[108:111], v[188:191], v[24:27]
  ds_read_b128 v[80:83], v233 offset:12288
  v_mfma_f32_16x16x32_bf16 v[52:55], v[108:111], v[192:195], v[52:55]
  s_waitcnt lgkmcnt(6)
  v_mfma_f32_16x16x32_bf16 v[28:31], v[112:115], v[188:191], v[28:31]
  ds_read_b128 v[84:87], v233 offset:13312
  v_mfma_f32_16x16x32_bf16 v[56:59], v[112:115], v[192:195], v[56:59]
  s_waitcnt vmcnt(15) lgkmcnt(6)
  v_mfma_f32_16x16x32_bf16 v[4:7], v[60:63], v[196:199], v[4:7]
  ds_read_b128 v[88:91], v233 offset:14336
  s_waitcnt vmcnt(14)
  v_mfma_f32_16x16x32_bf16 v[32:35], v[60:63], v[200:203], v[32:35]
  s_waitcnt lgkmcnt(6)
  v_mfma_f32_16x16x32_bf16 v[8:11], v[64:67], v[196:199], v[8:11]
  ds_read_b128 v[92:95], v233 offset:15360
  v_mfma_f32_16x16x32_bf16 v[36:39], v[64:67], v[200:203], v[36:39]
  s_waitcnt lgkmcnt(6)
  v_mfma_f32_16x16x32_bf16 v[12:15], v[68:71], v[196:199], v[12:15]
  ds_read_b128 v[96:99], v233 offset:16384
  v_mfma_f32_16x16x32_bf16 v[40:43], v[68:71], v[200:203], v[40:43]
  buffer_load_dwordx2 v[156:157], v238, s[44:47], s66 offen offset:1024 sc1
  buffer_load_dwordx2 v[158:159], v238, s[44:47], s66 offen offset:1536 sc1
  buffer_load_dwordx2 v[160:161], v238, s[44:47], s67 offen offset:1024 sc1
  buffer_load_dwordx2 v[162:163], v238, s[44:47], s67 offen offset:1536 sc1
  s_waitcnt lgkmcnt(6)
  v_mfma_f32_16x16x32_bf16 v[16:19], v[72:75], v[196:199], v[16:19]
  ds_read_b128 v[100:103], v233 offset:17408
  v_mfma_f32_16x16x32_bf16 v[44:47], v[72:75], v[200:203], v[44:47]
  s_waitcnt lgkmcnt(6)
  v_mfma_f32_16x16x32_bf16 v[20:23], v[76:79], v[196:199], v[20:23]
  ds_read_b128 v[104:107], v233 offset:18432
  v_mfma_f32_16x16x32_bf16 v[48:51], v[76:79], v[200:203], v[48:51]
  s_waitcnt lgkmcnt(6)
  v_mfma_f32_16x16x32_bf16 v[24:27], v[80:83], v[196:199], v[24:27]
  ds_read_b128 v[108:111], v233 offset:19456
  v_mfma_f32_16x16x32_bf16 v[52:55], v[80:83], v[200:203], v[52:55]
  s_waitcnt lgkmcnt(6)
  v_mfma_f32_16x16x32_bf16 v[28:31], v[84:87], v[196:199], v[28:31]
  ds_read_b128 v[112:115], v233 offset:20480
  v_mfma_f32_16x16x32_bf16 v[56:59], v[84:87], v[200:203], v[56:59]
  s_barrier
  s_waitcnt vmcnt(17) lgkmcnt(6)
  v_mfma_f32_16x16x32_bf16 v[4:7], v[88:91], v[204:207], v[4:7]
  ds_read_b128 v[60:63], v233 offset:21504
  s_waitcnt vmcnt(16)
  v_mfma_f32_16x16x32_bf16 v[32:35], v[88:91], v[208:211], v[32:35]
  s_waitcnt lgkmcnt(6)
  v_mfma_f32_16x16x32_bf16 v[8:11], v[92:95], v[204:207], v[8:11]
  ds_read_b128 v[64:67], v233 offset:22528
  v_mfma_f32_16x16x32_bf16 v[36:39], v[92:95], v[208:211], v[36:39]
  s_waitcnt lgkmcnt(6)
  v_mfma_f32_16x16x32_bf16 v[12:15], v[96:99], v[204:207], v[12:15]
  ds_read_b128 v[68:71], v233 offset:23552
  v_mfma_f32_16x16x32_bf16 v[40:43], v[96:99], v[208:211], v[40:43]
  buffer_load_dwordx4 v[164:167], v239, s[44:47], s66 offen offset:2048 sc1
  buffer_load_dwordx4 v[168:171], v239, s[44:47], s67 offen offset:2048 sc1
  s_waitcnt lgkmcnt(6)
  v_mfma_f32_16x16x32_bf16 v[16:19], v[100:103], v[204:207], v[16:19]
  ds_read_b128 v[72:75], v233 offset:24576
  v_mfma_f32_16x16x32_bf16 v[44:47], v[100:103], v[208:211], v[44:47]
  s_waitcnt lgkmcnt(6)
  v_mfma_f32_16x16x32_bf16 v[20:23], v[104:107], v[204:207], v[20:23]
  ds_read_b128 v[76:79], v233 offset:25600
  v_mfma_f32_16x16x32_bf16 v[48:51], v[104:107], v[208:211], v[48:51]
  s_waitcnt lgkmcnt(6)
  v_mfma_f32_16x16x32_bf16 v[24:27], v[108:111], v[204:207], v[24:27]
  ds_read_b128 v[80:83], v233 offset:26624
  v_mfma_f32_16x16x32_bf16 v[52:55], v[108:111], v[208:211], v[52:55]
  s_waitcnt lgkmcnt(6)
  v_mfma_f32_16x16x32_bf16 v[28:31], v[112:115], v[204:207], v[28:31]
  ds_read_b128 v[84:87], v233 offset:27648
  v_mfma_f32_16x16x32_bf16 v[56:59], v[112:115], v[208:211], v[56:59]
  s_waitcnt vmcnt(16) lgkmcnt(6)
  v_mfma_f32_16x16x32_bf16 v[4:7], v[60:63], v[116:119], v[4:7]
  ds_read_b128 v[88:91], v233 offset:28672
  s_waitcnt vmcnt(14)
  v_mfma_f32_16x16x32_bf16 v[32:35], v[60:63], v[120:123], v[32:35]
  s_waitcnt lgkmcnt(6)
  v_mfma_f32_16x16x32_bf16 v[8:11], v[64:67], v[116:119], v[8:11]
  ds_read_b128 v[92:95], v233 offset:29696
  v_mfma_f32_16x16x32_bf16 v[36:39], v[64:67], v[120:123], v[36:39]
  s_waitcnt lgkmcnt(6)
  v_mfma_f32_16x16x32_bf16 v[12:15], v[68:71], v[116:119], v[12:15]
  ds_read_b128 v[96:99], v233 offset:30720
  v_mfma_f32_16x16x32_bf16 v[40:43], v[68:71], v[120:123], v[40:43]
  buffer_load_dwordx4 v[172:175], v239, s[44:47], s66 offen offset:3072 sc1
  buffer_load_dwordx4 v[176:179], v239, s[44:47], s67 offen offset:3072 sc1
  s_waitcnt lgkmcnt(6)
  v_mfma_f32_16x16x32_bf16 v[16:19], v[72:75], v[116:119], v[16:19]
  ds_read_b128 v[100:103], v233 offset:31744
  v_mfma_f32_16x16x32_bf16 v[44:47], v[72:75], v[120:123], v[44:47]
  s_waitcnt lgkmcnt(6)
  v_mfma_f32_16x16x32_bf16 v[20:23], v[76:79], v[116:119], v[20:23]
  ds_read_b128 v[104:107], v233 offset:32768
  v_mfma_f32_16x16x32_bf16 v[48:51], v[76:79], v[120:123], v[48:51]
  s_waitcnt lgkmcnt(6)
  v_mfma_f32_16x16x32_bf16 v[24:27], v[80:83], v[116:119], v[24:27]
  ds_read_b128 v[108:111], v233 offset:33792
  v_mfma_f32_16x16x32_bf16 v[52:55], v[80:83], v[120:123], v[52:55]
  s_waitcnt lgkmcnt(6)
  v_mfma_f32_16x16x32_bf16 v[28:31], v[84:87], v[116:119], v[28:31]
  ds_read_b128 v[112:115], v233 offset:34816
  v_mfma_f32_16x16x32_bf16 v[56:59], v[84:87], v[120:123], v[56:59]
  s_barrier
  s_waitcnt vmcnt(15) lgkmcnt(6)
  v_mfma_f32_16x16x32_bf16 v[4:7], v[88:91], v[124:127], v[4:7]
  ds_read_b128 v[60:63], v233 offset:35840
  s_waitcnt vmcnt(14)
  v_mfma_f32_16x16x32_bf16 v[32:35], v[88:91], v[128:131], v[32:35]
  s_waitcnt lgkmcnt(6)
  v_mfma_f32_16x16x32_bf16 v[8:11], v[92:95], v[124:127], v[8:11]
  ds_read_b128 v[64:67], v233 offset:36864
  v_mfma_f32_16x16x32_bf16 v[36:39], v[92:95], v[128:131], v[36:39]
  s_waitcnt lgkmcnt(6)
  v_mfma_f32_16x16x32_bf16 v[12:15], v[96:99], v[124:127], v[12:15]
  ds_read_b128 v[68:71], v233 offset:37888
  v_mfma_f32_16x16x32_bf16 v[40:43], v[96:99], v[128:131], v[40:43]
  s_waitcnt lgkmcnt(6)
  v_mfma_f32_16x16x32_bf16 v[16:19], v[100:103], v[124:127], v[16:19]
  ds_read_b128 v[72:75], v233 offset:38912
  v_mfma_f32_16x16x32_bf16 v[44:47], v[100:103], v[128:131], v[44:47]
  s_waitcnt lgkmcnt(6)
  v_mfma_f32_16x16x32_bf16 v[20:23], v[104:107], v[124:127], v[20:23]
  ds_read_b128 v[76:79], v233 offset:39936
  v_mfma_f32_16x16x32_bf16 v[48:51], v[104:107], v[128:131], v[48:51]
  s_waitcnt lgkmcnt(6)
  v_mfma_f32_16x16x32_bf16 v[24:27], v[108:111], v[124:127], v[24:27]
  ds_read_b128 v[80:83], v233 offset:40960
  v_mfma_f32_16x16x32_bf16 v[52:55], v[108:111], v[128:131], v[52:55]
  s_waitcnt lgkmcnt(6)
  v_mfma_f32_16x16x32_bf16 v[28:31], v[112:115], v[124:127], v[28:31]
  ds_read_b128 v[84:87], v233 offset:41984
  v_mfma_f32_16x16x32_bf16 v[56:59], v[112:115], v[128:131], v[56:59]
  s_waitcnt vmcnt(13) lgkmcnt(6)
  v_mfma_f32_16x16x32_bf16 v[4:7], v[60:63], v[132:135], v[4:7]
  ds_read_b128 v[88:91], v233 offset:43008
  s_waitcnt vmcnt(12)
  v_mfma_f32_16x16x32_bf16 v[32:35], v[60:63], v[136:139], v[32:35]
  s_waitcnt lgkmcnt(6)
  v_mfma_f32_16x16x32_bf16 v[8:11], v[64:67], v[132:135], v[8:11]
  ds_read_b128 v[92:95], v233 offset:44032
  v_mfma_f32_16x16x32_bf16 v[36:39], v[64:67], v[136:139], v[36:39]
  s_waitcnt lgkmcnt(6)
  v_mfma_f32_16x16x32_bf16 v[12:15], v[68:71], v[132:135], v[12:15]
  ds_read_b128 v[96:99], v233 offset:45056
  v_mfma_f32_16x16x32_bf16 v[40:43], v[68:71], v[136:139], v[40:43]
  s_waitcnt lgkmcnt(6)
  v_mfma_f32_16x16x32_bf16 v[16:19], v[72:75], v[132:135], v[16:19]
  ds_read_b128 v[100:103], v233 offset:46080
  v_mfma_f32_16x16x32_bf16 v[44:47], v[72:75], v[136:139], v[44:47]
  s_waitcnt lgkmcnt(6)
  v_mfma_f32_16x16x32_bf16 v[20:23], v[76:79], v[132:135], v[20:23]
  ds_read_b128 v[104:107], v233 offset:47104
  v_mfma_f32_16x16x32_bf16 v[48:51], v[76:79], v[136:139], v[48:51]
  s_waitcnt lgkmcnt(6)
  v_mfma_f32_16x16x32_bf16 v[24:27], v[80:83], v[132:135], v[24:27]
  ds_read_b128 v[108:111], v233 offset:48128
  v_mfma_f32_16x16x32_bf16 v[52:55], v[80:83], v[136:139], v[52:55]
  s_waitcnt lgkmcnt(6)
  v_mfma_f32_16x16x32_bf16 v[28:31], v[84:87], v[132:135], v[28:31]
  ds_read_b128 v[112:115], v233 offset:49152
  v_mfma_f32_16x16x32_bf16 v[56:59], v[84:87], v[136:139], v[56:59]
  s_waitcnt vmcnt(11) lgkmcnt(6)
  v_mfma_f32_16x16x32_bf16 v[4:7], v[88:91], v[140:143], v[4:7]
  ds_read_b128 v[60:63], v233 offset:50176
  s_waitcnt vmcnt(10)
  v_mfma_f32_16x16x32_bf16 v[32:35], v[88:91], v[144:147], v[32:35]
  s_waitcnt lgkmcnt(6)
  v_mfma_f32_16x16x32_bf16 v[8:11], v[92:95], v[140:143], v[8:11]
  ds_read_b128 v[64:67], v233 offset:51200
  v_mfma_f32_16x16x32_bf16 v[36:39], v[92:95], v[144:147], v[36:39]
  s_waitcnt lgkmcnt(6)
  v_mfma_f32_16x16x32_bf16 v[12:15], v[96:99], v[140:143], v[12:15]
  ds_read_b128 v[68:71], v233 offset:52224
  v_mfma_f32_16x16x32_bf16 v[40:43], v[96:99], v[144:147], v[40:43]
  s_waitcnt lgkmcnt(6)
  v_mfma_f32_16x16x32_bf16 v[16:19], v[100:103], v[140:143], v[16:19]
  ds_read_b128 v[72:75], v233 offset:53248
  v_mfma_f32_16x16x32_bf16 v[44:47], v[100:103], v[144:147], v[44:47]
  s_waitcnt lgkmcnt(6)
  v_mfma_f32_16x16x32_bf16 v[20:23], v[104:107], v[140:143], v[20:23]
  ds_read_b128 v[76:79], v233 offset:54272
  v_mfma_f32_16x16x32_bf16 v[48:51], v[104:107], v[144:147], v[48:51]
  s_waitcnt lgkmcnt(6)
  v_mfma_f32_16x16x32_bf16 v[24:27], v[108:111], v[140:143], v[24:27]
  ds_read_b128 v[80:83], v233 offset:55296
  v_mfma_f32_16x16x32_bf16 v[52:55], v[108:111], v[144:147], v[52:55]
  s_waitcnt lgkmcnt(6)
  v_mfma_f32_16x16x32_bf16 v[28:31], v[112:115], v[140:143], v[28:31]
  ds_read_b128 v[84:87], v233 offset:56320
  v_mfma_f32_16x16x32_bf16 v[56:59], v[112:115], v[144:147], v[56:59]
  s_waitcnt vmcnt(9) lgkmcnt(6)
  v_mfma_f32_16x16x32_bf16 v[4:7], v[60:63], v[148:151], v[4:7]
  ds_read_b128 v[88:91], v233 offset:57344
  s_waitcnt vmcnt(8)
  v_mfma_f32_16x16x32_bf16 v[32:35], v[60:63], v[152:155], v[32:35]
  s_waitcnt lgkmcnt(6)
  v_mfma_f32_16x16x32_bf16 v[8:11], v[64:67], v[148:151], v[8:11]
  ds_read_b128 v[92:95], v233 offset:58368
  v_mfma_f32_16x16x32_bf16 v[36:39], v[64:67], v[152:155], v[36:39]
  s_waitcnt lgkmcnt(6)
  v_mfma_f32_16x16x32_bf16 v[12:15], v[68:71], v[148:151], v[12:15]
  ds_read_b128 v[96:99], v233 offset:59392
  v_mfma_f32_16x16x32_bf16 v[40:43], v[68:71], v[152:155], v[40:43]
  s_waitcnt lgkmcnt(6)
  v_mfma_f32_16x16x32_bf16 v[16:19], v[72:75], v[148:151], v[16:19]
  ds_read_b128 v[100:103], v233 offset:60416
  v_mfma_f32_16x16x32_bf16 v[44:47], v[72:75], v[152:155], v[44:47]
  s_waitcnt lgkmcnt(6)
  v_mfma_f32_16x16x32_bf16 v[20:23], v[76:79], v[148:151], v[20:23]
  ds_read_b128 v[104:107], v233 offset:61440
  v_mfma_f32_16x16x32_bf16 v[48:51], v[76:79], v[152:155], v[48:51]
  s_waitcnt lgkmcnt(6)
  v_mfma_f32_16x16x32_bf16 v[24:27], v[80:83], v[148:151], v[24:27]
  ds_read_b128 v[108:111], v233 offset:62464
  v_mfma_f32_16x16x32_bf16 v[52:55], v[80:83], v[152:155], v[52:55]
  s_waitcnt lgkmcnt(6)
  v_mfma_f32_16x16x32_bf16 v[28:31], v[84:87], v[148:151], v[28:31]
  ds_read_b128 v[112:115], v233 offset:63488
  v_mfma_f32_16x16x32_bf16 v[56:59], v[84:87], v[152:155], v[56:59]
  s_waitcnt vmcnt(6) lgkmcnt(6)
  v_mfma_f32_16x16x32_bf16 v[4:7], v[88:91], v[156:159], v[4:7]
  ds_read_b128 v[60:63], v234 offset:0
  s_waitcnt vmcnt(4)
  v_mfma_f32_16x16x32_bf16 v[32:35], v[88:91], v[160:163], v[32:35]
  s_waitcnt lgkmcnt(6)
  v_mfma_f32_16x16x32_bf16 v[8:11], v[92:95], v[156:159], v[8:11]
  ds_read_b128 v[64:67], v234 offset:1024
  v_mfma_f32_16x16x32_bf16 v[36:39], v[92:95], v[160:163], v[36:39]
  s_waitcnt lgkmcnt(6)
  v_mfma_f32_16x16x32_bf16 v[12:15], v[96:99], v[156:159], v[12:15]
  ds_read_b128 v[68:71], v234 offset:2048
  v_mfma_f32_16x16x32_bf16 v[40:43], v[96:99], v[160:163], v[40:43]
  s_waitcnt lgkmcnt(6)
  v_mfma_f32_16x16x32_bf16 v[16:19], v[100:103], v[156:159], v[16:19]
  ds_read_b128 v[72:75], v234 offset:3072
  v_mfma_f32_16x16x32_bf16 v[44:47], v[100:103], v[160:163], v[44:47]
  s_waitcnt lgkmcnt(6)
  v_mfma_f32_16x16x32_bf16 v[20:23], v[104:107], v[156:159], v[20:23]
  ds_read_b128 v[76:79], v234 offset:4096
  v_mfma_f32_16x16x32_bf16 v[48:51], v[104:107], v[160:163], v[48:51]
  s_waitcnt lgkmcnt(6)
  v_mfma_f32_16x16x32_bf16 v[24:27], v[108:111], v[156:159], v[24:27]
  ds_read_b128 v[80:83], v234 offset:5120
  v_mfma_f32_16x16x32_bf16 v[52:55], v[108:111], v[160:163], v[52:55]
  s_waitcnt lgkmcnt(6)
  v_mfma_f32_16x16x32_bf16 v[28:31], v[112:115], v[156:159], v[28:31]
  ds_read_b128 v[84:87], v234 offset:6144
  v_mfma_f32_16x16x32_bf16 v[56:59], v[112:115], v[160:163], v[56:59]
  s_waitcnt vmcnt(3) lgkmcnt(6)
  v_mfma_f32_16x16x32_bf16 v[4:7], v[60:63], v[164:167], v[4:7]
  ds_read_b128 v[88:91], v234 offset:7168
  s_waitcnt vmcnt(2)
  v_mfma_f32_16x16x32_bf16 v[32:35], v[60:63], v[168:171], v[32:35]
  s_waitcnt lgkmcnt(6)
  v_mfma_f32_16x16x32_bf16 v[8:11], v[64:67], v[164:167], v[8:11]
  ds_read_b128 v[92:95], v234 offset:8192
  v_mfma_f32_16x16x32_bf16 v[36:39], v[64:67], v[168:171], v[36:39]
  s_waitcnt lgkmcnt(6)
  v_mfma_f32_16x16x32_bf16 v[12:15], v[68:71], v[164:167], v[12:15]
  ds_read_b128 v[96:99], v234 offset:9216
  v_mfma_f32_16x16x32_bf16 v[40:43], v[68:71], v[168:171], v[40:43]
  s_waitcnt lgkmcnt(6)
  v_mfma_f32_16x16x32_bf16 v[16:19], v[72:75], v[164:167], v[16:19]
  ds_read_b128 v[100:103], v234 offset:10240
  v_mfma_f32_16x16x32_bf16 v[44:47], v[72:75], v[168:171], v[44:47]
  s_waitcnt lgkmcnt(6)
  v_mfma_f32_16x16x32_bf16 v[20:23], v[76:79], v[164:167], v[20:23]
  ds_read_b128 v[104:107], v234 offset:11264
  v_mfma_f32_16x16x32_bf16 v[48:51], v[76:79], v[168:171], v[48:51]
  s_waitcnt lgkmcnt(6)
  v_mfma_f32_16x16x32_bf16 v[24:27], v[80:83], v[164:167], v[24:27]
  ds_read_b128 v[108:111], v234 offset:12288
  v_mfma_f32_16x16x32_bf16 v[52:55], v[80:83], v[168:171], v[52:55]
  s_waitcnt lgkmcnt(6)
  v_mfma_f32_16x16x32_bf16 v[28:31], v[84:87], v[164:167], v[28:31]
  ds_read_b128 v[112:115], v234 offset:13312
  v_mfma_f32_16x16x32_bf16 v[56:59], v[84:87], v[168:171], v[56:59]
  s_waitcnt vmcnt(1) lgkmcnt(6)
  v_mfma_f32_16x16x32_bf16 v[4:7], v[88:91], v[172:175], v[4:7]
  s_waitcnt vmcnt(0)
  v_mfma_f32_16x16x32_bf16 v[32:35], v[88:91], v[176:179], v[32:35]
  s_waitcnt lgkmcnt(5)
  v_mfma_f32_16x16x32_bf16 v[8:11], v[92:95], v[172:175], v[8:11]
  v_mfma_f32_16x16x32_bf16 v[36:39], v[92:95], v[176:179], v[36:39]
  s_waitcnt lgkmcnt(4)
  v_mfma_f32_16x16x32_bf16 v[12:15], v[96:99], v[172:175], v[12:15]
  v_mfma_f32_16x16x32_bf16 v[40:43], v[96:99], v[176:179], v[40:43]
  s_waitcnt lgkmcnt(3)
  v_mfma_f32_16x16x32_bf16 v[16:19], v[100:103], v[172:175], v[16:19]
  v_mfma_f32_16x16x32_bf16 v[44:47], v[100:103], v[176:179], v[44:47]
  s_waitcnt lgkmcnt(2)
  v_mfma_f32_16x16x32_bf16 v[20:23], v[104:107], v[172:175], v[20:23]
  v_mfma_f32_16x16x32_bf16 v[48:51], v[104:107], v[176:179], v[48:51]
  s_waitcnt lgkmcnt(1)
  v_mfma_f32_16x16x32_bf16 v[24:27], v[108:111], v[172:175], v[24:27]
  v_mfma_f32_16x16x32_bf16 v[52:55], v[108:111], v[176:179], v[52:55]
  s_waitcnt lgkmcnt(0)
  v_mfma_f32_16x16x32_bf16 v[28:31], v[112:115], v[172:175], v[28:31]
  v_mfma_f32_16x16x32_bf16 v[56:59], v[112:115], v[176:179], v[56:59]
IF_102_end:
  s_barrier
  s_branch IF_111_end
IF_111_else:
  s_mul_i32 s66, s59, 5120
  s_mul_i32 s67, s53, 102400
  s_add_u32 s67, s67, s66
  s_add_u32 s63, s67, 21487616
  s_add_u32 m0, s66, 103424
  s_nop 0
  buffer_load_dwordx4 v30, s[44:47], s63 offen offset:0 sc1 lds
  s_add_u32 m0, s66, 103424
  s_nop 0
  buffer_load_dwordx4 v30, s[44:47], s63 offen offset:1024 sc1 lds
  s_add_u32 m0, s66, 103424
  s_nop 0
  buffer_load_dwordx4 v30, s[44:47], s63 offen offset:2048 sc1 lds
  s_add_u32 m0, s66, 103424
  s_nop 0
  buffer_load_dwordx4 v30, s[44:47], s63 offen offset:3072 sc1 lds
  s_add_u32 s63, s67, 21491712
  s_add_u32 m0, s66, 107520
  s_nop 0
  buffer_load_dwordx4 v30, s[44:47], s63 offen offset:0 sc1 lds
  s_add_u32 s63, s67, 21508096
  s_add_u32 m0, s66, 123904
  s_nop 0
  buffer_load_dwordx4 v30, s[44:47], s63 offen offset:0 sc1 lds
  s_add_u32 m0, s66, 123904
  s_nop 0
  buffer_load_dwordx4 v30, s[44:47], s63 offen offset:1024 sc1 lds
  s_add_u32 m0, s66, 123904
  s_nop 0
  buffer_load_dwordx4 v30, s[44:47], s63 offen offset:2048 sc1 lds
  s_add_u32 m0, s66, 123904
  s_nop 0
  buffer_load_dwordx4 v30, s[44:47], s63 offen offset:3072 sc1 lds
  s_add_u32 s63, s67, 21512192
  s_add_u32 m0, s66, 128000
  s_nop 0
  buffer_load_dwordx4 v30, s[44:47], s63 offen offset:0 sc1 lds
  s_cmp_eq_u32 s59, 3
  s_cselect_b32 s66, 4294822912, s66
  s_add_u32 s63, s67, 21528576
  s_add_u32 m0, s66, 144384
  s_nop 0
  buffer_load_dwordx4 v30, s[44:47], s63 offen offset:0 sc1 lds
  s_add_u32 m0, s66, 144384
  s_nop 0
  buffer_load_dwordx4 v30, s[44:47], s63 offen offset:1024 sc1 lds
  s_add_u32 m0, s66, 144384
  s_nop 0
  buffer_load_dwordx4 v30, s[44:47], s63 offen offset:2048 sc1 lds
  s_add_u32 m0, s66, 144384
  s_nop 0
  buffer_load_dwordx4 v30, s[44:47], s63 offen offset:3072 sc1 lds
  s_add_u32 s63, s67, 21532672
  s_add_u32 m0, s66, 148480
  s_nop 0
  buffer_load_dwordx4 v30, s[44:47], s63 offen offset:0 sc1 lds
  s_waitcnt vmcnt(15)
  v_cmp_ne_u32 vcc, s54, v21
  s_cbranch_vccz IF_104_else
  s_mov_b32 s58, 1048576
LP_103:
  s_sleep 2
  buffer_load_dword v21, v20, s[44:47], s71 offen sc1
  s_waitcnt vmcnt(0)
  v_cmp_ne_u32 vcc, s54, v21
  s_sub_u32 s58, s58, 1
  s_cselect_b64 vcc, 0, vcc
  s_cbranch_vccnz LP_103
IF_104_else:
  s_add_u32 s63, s69, 22265856
  s_add_u32 m0, s70, 5120
  s_nop 0
  buffer_load_dwordx4 v30, s[44:47], s63 offen offset:0 sc1 lds
  s_add_u32 m0, s70, 5120
  s_nop 0
  buffer_load_dwordx4 v30, s[44:47], s63 offen offset:1024 sc1 lds
  s_add_u32 m0, s70, 5120
  s_nop 0
  buffer_load_dwordx4 v30, s[44:47], s63 offen offset:2048 sc1 lds
  s_add_u32 m0, s70, 5120
  s_nop 0
  buffer_load_dwordx4 v30, s[44:47], s63 offen offset:3072 sc1 lds
  s_add_u32 s63, s69, 22269952
  s_add_u32 m0, s70, 9216
  s_nop 0
  buffer_load_dwordx4 v30, s[44:47], s63 offen offset:0 sc1 lds
  s_add_u32 m0, s70, 9216
  s_nop 0
  buffer_load_dwordx4 v30, s[44:47], s63 offen offset:1024 sc1 lds
  s_add_u32 m0, s70, 9216
  s_nop 0
  buffer_load_dwordx4 v30, s[44:47], s63 offen offset:2048 sc1 lds
  s_waitcnt vmcnt(17)
  s_barrier
  s_waitcnt vmcnt(7)
  s_barrier
  s_add_u32 s63, s69, 22294528
  s_add_u32 m0, s70, 33792
  s_nop 0
  buffer_load_dwordx4 v30, s[44:47], s63 offen offset:0 sc1 lds
  s_add_u32 m0, s70, 33792
  s_nop 0
  buffer_load_dwordx4 v30, s[44:47], s63 offen offset:1024 sc1 lds
  s_add_u32 m0, s70, 33792
  s_nop 0
  buffer_load_dwordx4 v30, s[44:47], s63 offen offset:2048 sc1 lds
  s_add_u32 m0, s70, 33792
  s_nop 0
  buffer_load_dwordx4 v30, s[44:47], s63 offen offset:3072 sc1 lds
  s_add_u32 s63, s69, 22298624
  s_add_u32 m0, s70, 37888
  s_nop 0
  buffer_load_dwordx4 v30, s[44:47], s63 offen offset:0 sc1 lds
  s_add_u32 m0, s70, 37888
  s_nop 0
  buffer_load_dwordx4 v30, s[44:47], s63 offen offset:1024 sc1 lds
  s_add_u32 m0, s70, 37888
  s_nop 0
  buffer_load_dwordx4 v30, s[44:47], s63 offen offset:2048 sc1 lds
  s_add_u32 s63, s69, 22323200
  s_add_u32 m0, s70, 62464
  s_nop 0
  buffer_load_dwordx4 v30, s[44:47], s63 offen offset:0 sc1 lds
  s_add_u32 m0, s70, 62464
  s_nop 0
  buffer_load_dwordx4 v30, s[44:47], s63 offen offset:1024 sc1 lds
  s_add_u32 m0, s70, 62464
  s_nop 0
  buffer_load_dwordx4 v30, s[44:47], s63 offen offset:2048 sc1 lds
  s_add_u32 m0, s70, 62464
  s_nop 0
  buffer_load_dwordx4 v30, s[44:47], s63 offen offset:3072 sc1 lds
  s_add_u32 s63, s69, 22327296
  s_add_u32 m0, s70, 66560
  s_nop 0
  buffer_load_dwordx4 v30, s[44:47], s63 offen offset:0 sc1 lds
  s_add_u32 m0, s70, 66560
  s_nop 0
  buffer_load_dwordx4 v30, s[44:47], s63 offen offset:1024 sc1 lds
  s_add_u32 m0, s70, 66560
  s_nop 0
  buffer_load_dwordx4 v30, s[44:47], s63 offen offset:2048 sc1 lds
  s_cmp_lt_u32 s59, 3
  s_cbranch_scc0 IF_105_else
  s_add_u32 s63, s69, 22351872
  s_add_u32 m0, s70, 91136
  s_nop 0
  buffer_load_dwordx4 v30, s[44:47], s63 offen offset:0 sc1 lds
  s_add_u32 m0, s70, 91136
  s_nop 0
  buffer_load_dwordx4 v30, s[44:47], s63 offen offset:1024 sc1 lds
  s_add_u32 m0, s70, 91136
  s_nop 0
  buffer_load_dwordx4 v30, s[44:47], s63 offen offset:2048 sc1 lds
  s_add_u32 m0, s70, 91136
  s_nop 0
  buffer_load_dwordx4 v30, s[44:47], s63 offen offset:3072 sc1 lds
  s_add_u32 s63, s69, 22355968
  s_add_u32 m0, s70, 95232
  s_nop 0
  buffer_load_dwordx4 v30, s[44:47], s63 offen offset:0 sc1 lds
  s_add_u32 m0, s70, 95232
  s_nop 0
  buffer_load_dwordx4 v30, s[44:47], s63 offen offset:1024 sc1 lds
  s_add_u32 m0, s70, 95232
  s_nop 0
  buffer_load_dwordx4 v30, s[44:47], s63 offen offset:2048 sc1 lds
IF_105_else:
  s_barrier
  s_add_u32 s63, s69, 22373376
  s_add_u32 m0, s70, 112640
  s_nop 0
  buffer_load_dwordx4 v30, s[44:47], s63 offen offset:0 sc1 lds
  s_add_u32 m0, s70, 112640
  s_nop 0
  buffer_load_dwordx4 v30, s[44:47], s63 offen offset:1024 sc1 lds
  s_add_u32 m0, s70, 112640
  s_nop 0
  buffer_load_dwordx4 v30, s[44:47], s63 offen offset:2048 sc1 lds
  s_add_u32 m0, s70, 112640
  s_nop 0
  buffer_load_dwordx4 v30, s[44:47], s63 offen offset:3072 sc1 lds
  s_add_u32 s63, s69, 22377472
  s_add_u32 m0, s70, 116736
  s_nop 0
  buffer_load_dwordx4 v30, s[44:47], s63 offen offset:0 sc1 lds
  s_add_u32 m0, s70, 116736
  s_nop 0
  buffer_load_dwordx4 v30, s[44:47], s63 offen offset:1024 sc1 lds
  s_add_u32 m0, s70, 116736
  s_nop 0
  buffer_load_dwordx4 v30, s[44:47], s63 offen offset:2048 sc1 lds
  s_cmp_lt_u32 s59, 1
  s_cbranch_scc0 IF_106_else
  s_add_u32 s63, s69, 22402048
  s_add_u32 m0, s70, 141312
  s_nop 0
  buffer_load_dwordx4 v30, s[44:47], s63 offen offset:0 sc1 lds
  s_add_u32 m0, s70, 141312
  s_nop 0
  buffer_load_dwordx4 v30, s[44:47], s63 offen offset:1024 sc1 lds
  s_add_u32 m0, s70, 141312
  s_nop 0
  buffer_load_dwordx4 v30, s[44:47], s63 offen offset:2048 sc1 lds
  s_add_u32 m0, s70, 141312
  s_nop 0
  buffer_load_dwordx4 v30, s[44:47], s63 offen offset:3072 sc1 lds
  s_add_u32 s63, s69, 22406144
  s_add_u32 m0, s70, 145408
  s_nop 0
  buffer_load_dwordx4 v30, s[44:47], s63 offen offset:0 sc1 lds
  s_add_u32 m0, s70, 145408
  s_nop 0
  buffer_load_dwordx4 v30, s[44:47], s63 offen offset:1024 sc1 lds
  s_add_u32 m0, s70, 145408
  s_nop 0
  buffer_load_dwordx4 v30, s[44:47], s63 offen offset:2048 sc1 lds
IF_106_else:
  s_cmp_eq_u32 s55, 4
  s_cbranch_scc0 IF_107_else
  s_waitcnt vmcnt(21)
IF_107_else:
  s_bitcmp1_b32 0xe0, s55
  s_cbranch_scc0 IF_108_else
  s_waitcnt vmcnt(7)
IF_108_else:
  s_barrier
  s_waitcnt vmcnt(0)
  s_barrier
  v_mov_b32 v56, 0
  v_mov_b32 v57, 0
  s_cmp_eq_u32 s55, 5
  s_cbranch_scc0 IF_110_else
  s_cmp_lt_u32 s2, 216
  s_cbranch_scc0 IF_109_else
  s_mov_b32 s67, 149504
  s_mul_i32 s71, s2, 2428
  s_lshr_b32 s71, s71, 16
  s_mul_i32 s72, s71, 27
  s_sub_u32 s72, s2, s72
  s_mul_i32 s74, s72, 86
  s_lshr_b32 s74, s74, 8
  s_min_u32 s74, s74, 6
  s_lshl_b32 s74, s74, 4
  s_lshl_b32 s73, s72, 5
  s_add_u32 s73, s73, s74
  s_mul_i32 s74, s72, 224
  s_sub_u32 s74, s74, 5280
  s_cmp_ge_u32 s72, 24
  s_cselect_b32 s73, s74, s73
  s_cselect_b32 s74, 122880, 0
  s_mul_i32 s73, s73, 1280
  s_mul_i32 s71, s71, 160
  s_add_u32 s73, s73, s71
  v_add_u32 v2, 0, v1
  v_mul_u32_u24 v3, 6554, v2
  v_lshrrev_b32 v3, 16, v3
  v_mul_u32_u24 v4, 10, v3
  v_sub_u32 v4, v2, v4
  v_mul_u32_u24 v7, 1280, v3
  v_lshrrev_b32 v5, 4, v3
  v_mad_u32_u24 v7, v5, s74, v7
  v_lshl_add_u32 v48, v4, 4, v7
  s_add_u32 m0, s67, 0
  s_nop 0
  buffer_load_dwordx4 v48, s[28:31], s73 offen lds
  v_add_u32 v2, 64, v1
  v_mul_u32_u24 v3, 6554, v2
  v_lshrrev_b32 v3, 16, v3
  v_mul_u32_u24 v4, 10, v3
  v_sub_u32 v4, v2, v4
  v_mul_u32_u24 v7, 1280, v3
  v_lshrrev_b32 v5, 4, v3
  v_mad_u32_u24 v7, v5, s74, v7
  v_lshl_add_u32 v49, v4, 4, v7
  s_add_u32 m0, s67, 1024
  s_nop 0
  buffer_load_dwordx4 v49, s[28:31], s73 offen lds
  v_add_u32 v2, 128, v1
  v_mul_u32_u24 v3, 6554, v2
  v_lshrrev_b32 v3, 16, v3
  v_mul_u32_u24 v4, 10, v3
  v_sub_u32 v4, v2, v4
  v_mul_u32_u24 v7, 1280, v3
  v_lshrrev_b32 v5, 4, v3
  v_mad_u32_u24 v7, v5, s74, v7
  v_lshl_add_u32 v50, v4, 4, v7
  s_add_u32 m0, s67, 2048
  s_nop 0
  buffer_load_dwordx4 v50, s[28:31], s73 offen lds
  v_add_u32 v2, 192, v1
  v_mul_u32_u24 v3, 6554, v2
  v_lshrrev_b32 v3, 16, v3
  v_mul_u32_u24 v4, 10, v3
  v_sub_u32 v4, v2, v4
  v_mul_u32_u24 v7, 1280, v3
  v_lshrrev_b32 v5, 4, v3
  v_mad_u32_u24 v7, v5, s74, v7
  v_lshl_add_u32 v51, v4, 4, v7
  s_add_u32 m0, s67, 3072
  s_nop 0
  buffer_load_dwordx4 v51, s[28:31], s73 offen lds
  v_add_u32 v2, 256, v1
  v_mul_u32_u24 v3, 6554, v2
  v_lshrrev_b32 v3, 16, v3
  v_mul_u32_u24 v4, 10, v3
  v_sub_u32 v4, v2, v4
  v_mul_u32_u24 v7, 1280, v3
  v_lshrrev_b32 v5, 4, v3
  v_mad_u32_u24 v7, v5, s74, v7
  v_lshl_add_u32 v52, v4, 4, v7
  s_add_u32 m0, s67, 4096
  s_nop 0
  buffer_load_dwordx4 v52, s[28:31], s73 offen lds
  v_lshrrev_b32 v56, 2, v1
  v_mul_u32_u24 v56, 160, v56
  v_and_b32 v6, 3, v1
  v_lshl_add_u32 v56, v6, 3, v56
  v_add_u32 v56, s67, v56
  v_lshlrev_b32 v57, 4, v1
  s_mul_i32 s73, s2, 5120
  s_add_u32 s73, s73, 24559616
  s_add_u32 s71, s73, 4096
IF_109_else:
IF_110_else:
  s_barrier
  v_lshrrev_b32 v4, 3, v1
  v_lshrrev_b32 v5, 5, v1
  v_and_b32 v4, 3, v4
  v_lshl_add_u32 v4, v5, 3, v4
  v_lshlrev_b32 v4, 12, v4
  v_lshrrev_b32 v5, 4, v1
  v_and_b32 v6, 7, v1
  v_xor_b32 v5, v5, v6
  v_xor_b32 v6, 4, v5
  v_lshl_add_u32 v8, v5, 4, v4
  v_lshl_add_u32 v9, v6, 4, v4
  s_lshl_b32 s65, s52, 18
  s_lshl_b32 s63, s59, 9
  s_add_u32 s65, s65, s63
  s_lshl_b32 s66, s59, 14
  s_add_u32 s76, s53, 0
  s_and_b32 s76, s76, 3
  s_lshl_b32 s76, s76, 7
  s_add_u32 s77, s53, 1
  s_and_b32 s77, s77, 3
  s_lshl_b32 s77, s77, 7
  s_add_u32 s78, s53, 2
  s_and_b32 s78, s78, 3
  s_lshl_b32 s78, s78, 7
  s_add_u32 s79, s53, 3
  s_and_b32 s79, s79, 3
  s_lshl_b32 s79, s79, 7
  s_add_u32 s64, s65, s76
  s_add_u32 m0, s66, 5120
  s_add_u32 s63, s64, 2048
  buffer_load_dwordx4 v8, s[20:23], s63 offen  lds
  s_add_u32 m0, s66, 6144
  s_add_u32 s63, s64, 67584
  buffer_load_dwordx4 v9, s[20:23], s63 offen  lds
  s_add_u32 m0, s66, 7168
  s_add_u32 s63, s64, 18432
  buffer_load_dwordx4 v8, s[20:23], s63 offen  lds
  s_add_u32 m0, s66, 8192
  s_add_u32 s63, s64, 83968
  buffer_load_dwordx4 v9, s[20:23], s63 offen  lds
  s_add_u32 m0, s66, 9216
  s_add_u32 s63, s64, 133120
  buffer_load_dwordx4 v8, s[20:23], s63 offen  lds
  s_add_u32 m0, s66, 10240
  s_add_u32 s63, s64, 198656
  buffer_load_dwordx4 v9, s[20:23], s63 offen  lds
  s_add_u32 m0, s66, 11264
  s_add_u32 s63, s64, 149504
  buffer_load_dwordx4 v8, s[20:23], s63 offen  lds
  s_add_u32 m0, s66, 12288
  s_add_u32 s63, s64, 215040
  buffer_load_dwordx4 v9, s[20:23], s63 offen  lds
  s_add_u32 s64, s65, s77
  s_add_u32 m0, s66, 13312
  s_add_u32 s63, s64, 2048
  buffer_load_dwordx4 v8, s[20:23], s63 offen  lds
  s_add_u32 m0, s66, 14336
  s_add_u32 s63, s64, 67584
  buffer_load_dwordx4 v9, s[20:23], s63 offen  lds
  s_add_u32 m0, s66, 15360
  s_add_u32 s63, s64, 18432
  buffer_load_dwordx4 v8, s[20:23], s63 offen  lds
  s_add_u32 m0, s66, 16384
  s_add_u32 s63, s64, 83968
  buffer_load_dwordx4 v9, s[20:23], s63 offen  lds
  s_add_u32 m0, s66, 17408
  s_add_u32 s63, s64, 133120
  buffer_load_dwordx4 v8, s[20:23], s63 offen  lds
  s_add_u32 m0, s66, 18432
  s_add_u32 s63, s64, 198656
  buffer_load_dwordx4 v9, s[20:23], s63 offen  lds
  s_add_u32 m0, s66, 19456
  s_add_u32 s63, s64, 149504
  buffer_load_dwordx4 v8, s[20:23], s63 offen  lds
  s_add_u32 m0, s66, 20480
  s_add_u32 s63, s64, 215040
  buffer_load_dwordx4 v9, s[20:23], s63 offen  lds
  s_barrier
IF_111_end:
  s_cmp_lt_u32 s55, 4
  s_cbranch_scc0 IF_121_else
  v_mov_b32 v108, -0.1029432395800235
  v_mov_b32 v109, -0.1029432395800235
  v_mov_b32 v110, -2.302208198144325
  v_mov_b32 v111, -2.302208198144325
  v_mov_b32 v112, 1.0
  v_mov_b32 v113, 1.0
  v_and_b32 v2, 15, v1
  v_lshrrev_b32 v3, 1, v2
  v_lshrrev_b32 v116, 4, v1
  v_xor_b32 v116, v116, v3
  v_xor_b32 v117, 4, v116
  v_lshlrev_b32 v2, 7, v2
  s_lshl_b32 s63, s59, 14
  s_add_u32 s63, s63, 5120
  v_add_u32 v2, s63, v2
  v_lshl_add_u32 v116, v116, 4, v2
  v_lshl_add_u32 v117, v117, 4, v2
  v_lshlrev_b32 v114, 4, v1
  v_lshlrev_b32 v115, 3, v1
  v_pk_mul_f32 v[60:61], v[4:5], v[4:5]
  v_pk_mul_f32 v[62:63], v[6:7], v[6:7]
  v_pk_mul_f32 v[64:65], v[8:9], v[8:9]
  v_pk_mul_f32 v[66:67], v[10:11], v[10:11]
  v_pk_fma_f32 v[60:61], v[60:61], v[108:109], v[110:111]
  v_pk_fma_f32 v[62:63], v[62:63], v[108:109], v[110:111]
  v_pk_fma_f32 v[64:65], v[64:65], v[108:109], v[110:111]
  v_pk_fma_f32 v[66:67], v[66:67], v[108:109], v[110:111]
  v_pk_mul_f32 v[60:61], v[60:61], v[4:5]
  v_pk_mul_f32 v[62:63], v[62:63], v[6:7]
  v_pk_mul_f32 v[64:65], v[64:65], v[8:9]
  v_pk_mul_f32 v[66:67], v[66:67], v[10:11]
  v_exp_f32 v60, v60
  v_exp_f32 v61, v61
  v_exp_f32 v62, v62
  v_exp_f32 v63, v63
  v_exp_f32 v64, v64
  v_exp_f32 v65, v65
  v_exp_f32 v66, v66
  v_exp_f32 v67, v67
  v_pk_add_f32 v[60:61], v[60:61], v[112:113]
  v_pk_add_f32 v[62:63], v[62:63], v[112:113]
  v_pk_add_f32 v[64:65], v[64:65], v[112:113]
  v_pk_add_f32 v[66:67], v[66:67], v[112:113]
  v_rcp_f32 v60, v60
  v_rcp_f32 v61, v61
  v_rcp_f32 v62, v62
  v_rcp_f32 v63, v63
  v_rcp_f32 v64, v64
  v_rcp_f32 v65, v65
  v_rcp_f32 v66, v66
  v_rcp_f32 v67, v67
  v_pk_mul_f32 v[4:5], v[4:5], v[60:61]
  v_pk_mul_f32 v[6:7], v[6:7], v[62:63]
  v_pk_mul_f32 v[8:9], v[8:9], v[64:65]
  v_pk_mul_f32 v[10:11], v[10:11], v[66:67]
  v_pk_mul_f32 v[60:61], v[12:13], v[12:13]
  v_pk_mul_f32 v[62:63], v[14:15], v[14:15]
  v_pk_mul_f32 v[64:65], v[16:17], v[16:17]
  v_pk_mul_f32 v[66:67], v[18:19], v[18:19]
  v_pk_fma_f32 v[60:61], v[60:61], v[108:109], v[110:111]
  v_pk_fma_f32 v[62:63], v[62:63], v[108:109], v[110:111]
  v_pk_fma_f32 v[64:65], v[64:65], v[108:109], v[110:111]
  v_pk_fma_f32 v[66:67], v[66:67], v[108:109], v[110:111]
  v_pk_mul_f32 v[60:61], v[60:61], v[12:13]
  v_pk_mul_f32 v[62:63], v[62:63], v[14:15]
  v_pk_mul_f32 v[64:65], v[64:65], v[16:17]
  v_pk_mul_f32 v[66:67], v[66:67], v[18:19]
  v_exp_f32 v60, v60
  v_exp_f32 v61, v61
  v_exp_f32 v62, v62
  v_exp_f32 v63, v63
  v_exp_f32 v64, v64
  v_exp_f32 v65, v65
  v_exp_f32 v66, v66
  v_exp_f32 v67, v67
  v_pk_add_f32 v[60:61], v[60:61], v[112:113]
  v_pk_add_f32 v[62:63], v[62:63], v[112:113]
  v_pk_add_f32 v[64:65], v[64:65], v[112:113]
  v_pk_add_f32 v[66:67], v[66:67], v[112:113]
  v_rcp_f32 v60, v60
  v_rcp_f32 v61, v61
  v_rcp_f32 v62, v62
  v_rcp_f32 v63, v63
  v_rcp_f32 v64, v64
  v_rcp_f32 v65, v65
  v_rcp_f32 v66, v66
  v_rcp_f32 v67, v67
  v_pk_mul_f32 v[12:13], v[12:13], v[60:61]
  v_pk_mul_f32 v[14:15], v[14:15], v[62:63]
  v_pk_mul_f32 v[16:17], v[16:17], v[64:65]
  v_pk_mul_f32 v[18:19], v[18:19], v[66:67]
  v_pk_mul_f32 v[60:61], v[20:21], v[20:21]
  v_pk_mul_f32 v[62:63], v[22:23], v[22:23]
  v_pk_mul_f32 v[64:65], v[24:25], v[24:25]
  v_pk_mul_f32 v[66:67], v[26:27], v[26:27]
  v_pk_fma_f32 v[60:61], v[60:61], v[108:109], v[110:111]
  v_pk_fma_f32 v[62:63], v[62:63], v[108:109], v[110:111]
  v_pk_fma_f32 v[64:65], v[64:65], v[108:109], v[110:111]
  v_pk_fma_f32 v[66:67], v[66:67], v[108:109], v[110:111]
  v_pk_mul_f32 v[60:61], v[60:61], v[20:21]
  v_pk_mul_f32 v[62:63], v[62:63], v[22:23]
  v_pk_mul_f32 v[64:65], v[64:65], v[24:25]
  v_pk_mul_f32 v[66:67], v[66:67], v[26:27]
  v_exp_f32 v60, v60
  v_exp_f32 v61, v61
  v_exp_f32 v62, v62
  v_exp_f32 v63, v63
  v_exp_f32 v64, v64
  v_exp_f32 v65, v65
  v_exp_f32 v66, v66
  v_exp_f32 v67, v67
  v_pk_add_f32 v[60:61], v[60:61], v[112:113]
  v_pk_add_f32 v[62:63], v[62:63], v[112:113]
  v_pk_add_f32 v[64:65], v[64:65], v[112:113]
  v_pk_add_f32 v[66:67], v[66:67], v[112:113]
  v_rcp_f32 v60, v60
  v_rcp_f32 v61, v61
  v_rcp_f32 v62, v62
  v_rcp_f32 v63, v63
  v_rcp_f32 v64, v64
  v_rcp_f32 v65, v65
  v_rcp_f32 v66, v66
  v_rcp_f32 v67, v67
  v_pk_mul_f32 v[20:21], v[20:21], v[60:61]
  v_pk_mul_f32 v[22:23], v[22:23], v[62:63]
  v_pk_mul_f32 v[24:25], v[24:25], v[64:65]
  v_pk_mul_f32 v[26:27], v[26:27], v[66:67]
  v_pk_mul_f32 v[60:61], v[28:29], v[28:29]
  v_pk_mul_f32 v[62:63], v[30:31], v[30:31]
  v_pk_mul_f32 v[64:65], v[32:33], v[32:33]
  v_pk_mul_f32 v[66:67], v[34:35], v[34:35]
  v_pk_fma_f32 v[60:61], v[60:61], v[108:109], v[110:111]
  v_pk_fma_f32 v[62:63], v[62:63], v[108:109], v[110:111]
  v_pk_fma_f32 v[64:65], v[64:65], v[108:109], v[110:111]
  v_pk_fma_f32 v[66:67], v[66:67], v[108:109], v[110:111]
  v_pk_mul_f32 v[60:61], v[60:61], v[28:29]
  v_pk_mul_f32 v[62:63], v[62:63], v[30:31]
  v_pk_mul_f32 v[64:65], v[64:65], v[32:33]
  v_pk_mul_f32 v[66:67], v[66:67], v[34:35]
  v_exp_f32 v60, v60
  v_exp_f32 v61, v61
  v_exp_f32 v62, v62
  v_exp_f32 v63, v63
  v_exp_f32 v64, v64
  v_exp_f32 v65, v65
  v_exp_f32 v66, v66
  v_exp_f32 v67, v67
  v_pk_add_f32 v[60:61], v[60:61], v[112:113]
  v_pk_add_f32 v[62:63], v[62:63], v[112:113]
  v_pk_add_f32 v[64:65], v[64:65], v[112:113]
  v_pk_add_f32 v[66:67], v[66:67], v[112:113]
  v_rcp_f32 v60, v60
  v_rcp_f32 v61, v61
  v_rcp_f32 v62, v62
  v_rcp_f32 v63, v63
  v_rcp_f32 v64, v64
  v_rcp_f32 v65, v65
  v_rcp_f32 v66, v66
  v_rcp_f32 v67, v67
  v_pk_mul_f32 v[28:29], v[28:29], v[60:61]
  v_pk_mul_f32 v[30:31], v[30:31], v[62:63]
  v_pk_mul_f32 v[32:33], v[32:33], v[64:65]
  v_pk_mul_f32 v[34:35], v[34:35], v[66:67]
  v_pk_mul_f32 v[60:61], v[36:37], v[36:37]
  v_pk_mul_f32 v[62:63], v[38:39], v[38:39]
  v_pk_mul_f32 v[64:65], v[40:41], v[40:41]
  v_pk_mul_f32 v[66:67], v[42:43], v[42:43]
  v_pk_fma_f32 v[60:61], v[60:61], v[108:109], v[110:111]
  v_pk_fma_f32 v[62:63], v[62:63], v[108:109], v[110:111]
  v_pk_fma_f32 v[64:65], v[64:65], v[108:109], v[110:111]
  v_pk_fma_f32 v[66:67], v[66:67], v[108:109], v[110:111]
  v_pk_mul_f32 v[60:61], v[60:61], v[36:37]
  v_pk_mul_f32 v[62:63], v[62:63], v[38:39]
  v_pk_mul_f32 v[64:65], v[64:65], v[40:41]
  v_pk_mul_f32 v[66:67], v[66:67], v[42:43]
  v_exp_f32 v60, v60
  v_exp_f32 v61, v61
  v_exp_f32 v62, v62
  v_exp_f32 v63, v63
  v_exp_f32 v64, v64
  v_exp_f32 v65, v65
  v_exp_f32 v66, v66
  v_exp_f32 v67, v67
  v_pk_add_f32 v[60:61], v[60:61], v[112:113]
  v_pk_add_f32 v[62:63], v[62:63], v[112:113]
  v_pk_add_f32 v[64:65], v[64:65], v[112:113]
  v_pk_add_f32 v[66:67], v[66:67], v[112:113]
  v_rcp_f32 v60, v60
  v_rcp_f32 v61, v61
  v_rcp_f32 v62, v62
  v_rcp_f32 v63, v63
  v_rcp_f32 v64, v64
  v_rcp_f32 v65, v65
  v_rcp_f32 v66, v66
  v_rcp_f32 v67, v67
  v_pk_mul_f32 v[36:37], v[36:37], v[60:61]
  v_pk_mul_f32 v[38:39], v[38:39], v[62:63]
  v_pk_mul_f32 v[40:41], v[40:41], v[64:65]
  v_pk_mul_f32 v[42:43], v[42:43], v[66:67]
  v_pk_mul_f32 v[60:61], v[44:45], v[44:45]
  v_pk_mul_f32 v[62:63], v[46:47], v[46:47]
  v_pk_mul_f32 v[64:65], v[48:49], v[48:49]
  v_pk_mul_f32 v[66:67], v[50:51], v[50:51]
  v_pk_fma_f32 v[60:61], v[60:61], v[108:109], v[110:111]
  v_pk_fma_f32 v[62:63], v[62:63], v[108:109], v[110:111]
  v_pk_fma_f32 v[64:65], v[64:65], v[108:109], v[110:111]
  v_pk_fma_f32 v[66:67], v[66:67], v[108:109], v[110:111]
  v_pk_mul_f32 v[60:61], v[60:61], v[44:45]
  v_pk_mul_f32 v[62:63], v[62:63], v[46:47]
  v_pk_mul_f32 v[64:65], v[64:65], v[48:49]
  v_pk_mul_f32 v[66:67], v[66:67], v[50:51]
  v_exp_f32 v60, v60
  v_exp_f32 v61, v61
  v_exp_f32 v62, v62
  v_exp_f32 v63, v63
  v_exp_f32 v64, v64
  v_exp_f32 v65, v65
  v_exp_f32 v66, v66
  v_exp_f32 v67, v67
  v_pk_add_f32 v[60:61], v[60:61], v[112:113]
  v_pk_add_f32 v[62:63], v[62:63], v[112:113]
  v_pk_add_f32 v[64:65], v[64:65], v[112:113]
  v_pk_add_f32 v[66:67], v[66:67], v[112:113]
  v_rcp_f32 v60, v60
  v_rcp_f32 v61, v61
  v_rcp_f32 v62, v62
  v_rcp_f32 v63, v63
  v_rcp_f32 v64, v64
  v_rcp_f32 v65, v65
  v_rcp_f32 v66, v66
  v_rcp_f32 v67, v67
  v_pk_mul_f32 v[44:45], v[44:45], v[60:61]
  v_pk_mul_f32 v[46:47], v[46:47], v[62:63]
  v_pk_mul_f32 v[48:49], v[48:49], v[64:65]
  v_pk_mul_f32 v[50:51], v[50:51], v[66:67]
  v_pk_mul_f32 v[60:61], v[52:53], v[52:53]
  v_pk_mul_f32 v[62:63], v[54:55], v[54:55]
  v_pk_mul_f32 v[64:65], v[56:57], v[56:57]
  v_pk_mul_f32 v[66:67], v[58:59], v[58:59]
  v_pk_fma_f32 v[60:61], v[60:61], v[108:109], v[110:111]
  v_pk_fma_f32 v[62:63], v[62:63], v[108:109], v[110:111]
  v_pk_fma_f32 v[64:65], v[64:65], v[108:109], v[110:111]
  v_pk_fma_f32 v[66:67], v[66:67], v[108:109], v[110:111]
  v_pk_mul_f32 v[60:61], v[60:61], v[52:53]
  v_pk_mul_f32 v[62:63], v[62:63], v[54:55]
  v_pk_mul_f32 v[64:65], v[64:65], v[56:57]
  v_pk_mul_f32 v[66:67], v[66:67], v[58:59]
  v_exp_f32 v60, v60
  v_exp_f32 v61, v61
  v_exp_f32 v62, v62
  v_exp_f32 v63, v63
  v_exp_f32 v64, v64
  v_exp_f32 v65, v65
  v_exp_f32 v66, v66
  v_exp_f32 v67, v67
  v_pk_add_f32 v[60:61], v[60:61], v[112:113]
  v_pk_add_f32 v[62:63], v[62:63], v[112:113]
  v_pk_add_f32 v[64:65], v[64:65], v[112:113]
  v_pk_add_f32 v[66:67], v[66:67], v[112:113]
  v_rcp_f32 v60, v60
  v_rcp_f32 v61, v61
  v_rcp_f32 v62, v62
  v_rcp_f32 v63, v63
  v_rcp_f32 v64, v64
  v_rcp_f32 v65, v65
  v_rcp_f32 v66, v66
  v_rcp_f32 v67, v67
  v_pk_mul_f32 v[52:53], v[52:53], v[60:61]
  v_pk_mul_f32 v[54:55], v[54:55], v[62:63]
  v_pk_mul_f32 v[56:57], v[56:57], v[64:65]
  v_pk_mul_f32 v[58:59], v[58:59], v[66:67]
  s_lshl_b32 s65, s50, 2
  s_add_u32 s65, s65, s59
  s_cmp_eq_u32 s56, 1
  s_cbranch_scc0 IF_114_else
  v_pk_mul_f32 v[68:69], v[4:5], v[4:5]
  v_pk_mul_f32 v[70:71], v[6:7], v[6:7]
  v_pk_mul_f32 v[72:73], v[32:33], v[32:33]
  v_pk_mul_f32 v[74:75], v[34:35], v[34:35]
  v_pk_fma_f32 v[68:69], v[8:9], v[8:9], v[68:69]
  v_pk_add_f32 v[60:61], v[8:9], v[4:5]
  v_pk_fma_f32 v[70:71], v[10:11], v[10:11], v[70:71]
  v_pk_add_f32 v[62:63], v[10:11], v[6:7]
  v_pk_fma_f32 v[72:73], v[36:37], v[36:37], v[72:73]
  v_pk_add_f32 v[64:65], v[36:37], v[32:33]
  v_pk_fma_f32 v[74:75], v[38:39], v[38:39], v[74:75]
  v_pk_add_f32 v[66:67], v[38:39], v[34:35]
  v_pk_fma_f32 v[68:69], v[12:13], v[12:13], v[68:69]
  v_pk_add_f32 v[60:61], v[12:13], v[60:61]
  v_pk_fma_f32 v[70:71], v[14:15], v[14:15], v[70:71]
  v_pk_add_f32 v[62:63], v[14:15], v[62:63]
  v_pk_fma_f32 v[72:73], v[40:41], v[40:41], v[72:73]
  v_pk_add_f32 v[64:65], v[40:41], v[64:65]
  v_pk_fma_f32 v[74:75], v[42:43], v[42:43], v[74:75]
  v_pk_add_f32 v[66:67], v[42:43], v[66:67]
  v_pk_fma_f32 v[68:69], v[16:17], v[16:17], v[68:69]
  v_pk_add_f32 v[60:61], v[16:17], v[60:61]
  v_pk_fma_f32 v[70:71], v[18:19], v[18:19], v[70:71]
  v_pk_add_f32 v[62:63], v[18:19], v[62:63]
  v_pk_fma_f32 v[72:73], v[44:45], v[44:45], v[72:73]
  v_pk_add_f32 v[64:65], v[44:45], v[64:65]
  v_pk_fma_f32 v[74:75], v[46:47], v[46:47], v[74:75]
  v_pk_add_f32 v[66:67], v[46:47], v[66:67]
  v_pk_fma_f32 v[68:69], v[20:21], v[20:21], v[68:69]
  v_pk_add_f32 v[60:61], v[20:21], v[60:61]
  v_pk_fma_f32 v[70:71], v[22:23], v[22:23], v[70:71]
  v_pk_add_f32 v[62:63], v[22:23], v[62:63]
  v_pk_fma_f32 v[72:73], v[48:49], v[48:49], v[72:73]
  v_pk_add_f32 v[64:65], v[48:49], v[64:65]
  v_pk_fma_f32 v[74:75], v[50:51], v[50:51], v[74:75]
  v_pk_add_f32 v[66:67], v[50:51], v[66:67]
  v_pk_fma_f32 v[68:69], v[24:25], v[24:25], v[68:69]
  v_pk_add_f32 v[60:61], v[24:25], v[60:61]
  v_pk_fma_f32 v[70:71], v[26:27], v[26:27], v[70:71]
  v_pk_add_f32 v[62:63], v[26:27], v[62:63]
  v_pk_fma_f32 v[72:73], v[52:53], v[52:53], v[72:73]
  v_pk_add_f32 v[64:65], v[52:53], v[64:65]
  v_pk_fma_f32 v[74:75], v[54:55], v[54:55], v[74:75]
  v_pk_add_f32 v[66:67], v[54:55], v[66:67]
  v_pk_fma_f32 v[68:69], v[28:29], v[28:29], v[68:69]
  v_pk_add_f32 v[60:61], v[28:29], v[60:61]
  v_pk_fma_f32 v[70:71], v[30:31], v[30:31], v[70:71]
  v_pk_add_f32 v[62:63], v[30:31], v[62:63]
  v_pk_fma_f32 v[72:73], v[56:57], v[56:57], v[72:73]
  v_pk_add_f32 v[64:65], v[56:57], v[64:65]
  v_pk_fma_f32 v[74:75], v[58:59], v[58:59], v[74:75]
  v_pk_add_f32 v[66:67], v[58:59], v[66:67]
  v_add_f32_dpp v76, v60, v60 row_ror:8 row_mask:0xf bank_mask:0x3
  v_add_f32_dpp v77, v61, v61 row_ror:8 row_mask:0xf bank_mask:0x3
  v_add_f32_dpp v78, v62, v62 row_ror:8 row_mask:0xf bank_mask:0x3
  v_add_f32_dpp v79, v63, v63 row_ror:8 row_mask:0xf bank_mask:0x3
  v_add_f32_dpp v80, v68, v68 row_ror:8 row_mask:0xf bank_mask:0x3
  v_add_f32_dpp v81, v69, v69 row_ror:8 row_mask:0xf bank_mask:0x3
  v_add_f32_dpp v82, v70, v70 row_ror:8 row_mask:0xf bank_mask:0x3
  v_add_f32_dpp v83, v71, v71 row_ror:8 row_mask:0xf bank_mask:0x3
  v_add_f32_dpp v76, v64, v64 row_ror:8 row_mask:0xf bank_mask:0xc
  v_add_f32_dpp v77, v65, v65 row_ror:8 row_mask:0xf bank_mask:0xc
  v_add_f32_dpp v78, v66, v66 row_ror:8 row_mask:0xf bank_mask:0xc
  v_add_f32_dpp v79, v67, v67 row_ror:8 row_mask:0xf bank_mask:0xc
  v_add_f32_dpp v80, v72, v72 row_ror:8 row_mask:0xf bank_mask:0xc
  v_add_f32_dpp v81, v73, v73 row_ror:8 row_mask:0xf bank_mask:0xc
  v_add_f32_dpp v82, v74, v74 row_ror:8 row_mask:0xf bank_mask:0xc
  v_add_f32_dpp v83, v75, v75 row_ror:8 row_mask:0xf bank_mask:0xc
  v_add_f32_dpp v84, v76, v76 row_half_mirror row_mask:0xf bank_mask:0x5
  v_add_f32_dpp v85, v77, v77 row_half_mirror row_mask:0xf bank_mask:0x5
  v_add_f32_dpp v86, v80, v80 row_half_mirror row_mask:0xf bank_mask:0x5
  v_add_f32_dpp v87, v81, v81 row_half_mirror row_mask:0xf bank_mask:0x5
  v_add_f32_dpp v84, v78, v78 row_half_mirror row_mask:0xf bank_mask:0xa
  v_add_f32_dpp v85, v79, v79 row_half_mirror row_mask:0xf bank_mask:0xa
  v_add_f32_dpp v86, v82, v82 row_half_mirror row_mask:0xf bank_mask:0xa
  v_add_f32_dpp v87, v83, v83 row_half_mirror row_mask:0xf bank_mask:0xa
  v_add_f32_dpp v84, v84, v84 quad_perm:[2,3,0,1] row_mask:0xf bank_mask:0xf
  v_add_f32_dpp v85, v85, v85 quad_perm:[2,3,0,1] row_mask:0xf bank_mask:0xf
  v_add_f32_dpp v86, v86, v86 quad_perm:[2,3,0,1] row_mask:0xf bank_mask:0xf
  v_add_f32_dpp v87, v87, v87 quad_perm:[2,3,0,1] row_mask:0xf bank_mask:0xf
  v_add_f32_dpp v84, v84, v84 quad_perm:[1,0,3,2] row_mask:0xf bank_mask:0xf
  v_add_f32_dpp v85, v85, v85 quad_perm:[1,0,3,2] row_mask:0xf bank_mask:0xf
  v_add_f32_dpp v86, v86, v86 quad_perm:[1,0,3,2] row_mask:0xf bank_mask:0xf
  v_add_f32_dpp v87, v87, v87 quad_perm:[1,0,3,2] row_mask:0xf bank_mask:0xf
  v_and_b32 v2, 1, v1
  v_cmp_eq_u32 vcc, 1, v2
  s_nop 1
  v_cndmask_b32 v88, v84, v85, vcc
  v_cndmask_b32 v89, v86, v87, vcc
  v_mov_b32 v90, s54
  v_mov_b32 v91, s54
  v_lshrrev_b32 v3, 2, v1
  v_lshl_add_u32 v3, v3, 1, v2
  v_lshlrev_b32 v3, 4, v3
  v_bfe_u32 v2, v1, 1, 1
  v_lshl_or_b32 v3, v2, 31, v3
  s_lshl_b32 s66, s65, 12
  s_add_u32 s66, s66, 2752512
  s_lshl_b32 s63, s53, 9
  s_add_u32 s63, s63, s66
  buffer_store_dwordx4 v[88:91], v3, s[44:47], s63 offen
  v_and_b32 v2, 31, v1
  v_lshlrev_b32 v3, 4, v2
  v_lshrrev_b32 v76, 5, v1
  v_lshl_add_u32 v3, v76, 11, v3
  s_lshl_b32 s63, s59, 8
  s_add_u32 s63, s63, 148480
  v_lshlrev_b32 v2, 3, v2
  v_add_u32 v2, s63, v2
  v_lshrrev_b32 v77, 4, v1
  v_lshlrev_b32 v77, 6, v77
  v_add_u32 v77, s63, v77
  buffer_load_dwordx4 v[60:63], v3, s[44:47], s66 offen offset:0 sc1
  buffer_load_dwordx4 v[64:67], v3, s[44:47], s66 offen offset:512 sc1
  buffer_load_dwordx4 v[68:71], v3, s[44:47], s66 offen offset:1024 sc1
  buffer_load_dwordx4 v[72:75], v3, s[44:47], s66 offen offset:1536 sc1
  s_waitcnt vmcnt(3)
  v_xor_b32 v78, s54, v62
  s_waitcnt vmcnt(2)
  v_xor_b32 v79, s54, v66
  s_waitcnt vmcnt(1)
  v_xor_b32 v80, s54, v70
  s_waitcnt vmcnt(0)
  v_xor_b32 v81, s54, v74
  v_or3_b32 v78, v78, v79, v80
  v_or_b32 v78, v78, v81
  v_cmp_ne_u32 vcc, 0, v78
  s_cbranch_vccz IF_113_else
  s_mov_b32 s58, 1048576
LP_112:
  s_sleep 2
  buffer_load_dwordx4 v[60:63], v3, s[44:47], s66 offen offset:0 sc1
  buffer_load_dwordx4 v[64:67], v3, s[44:47], s66 offen offset:512 sc1
  buffer_load_dwordx4 v[68:71], v3, s[44:47], s66 offen offset:1024 sc1
  buffer_load_dwordx4 v[72:75], v3, s[44:47], s66 offen offset:1536 sc1
  s_waitcnt vmcnt(3)
  v_xor_b32 v78, s54, v62
  s_waitcnt vmcnt(2)
  v_xor_b32 v79, s54, v66
  s_waitcnt vmcnt(1)
  v_xor_b32 v80, s54, v70
  s_waitcnt vmcnt(0)
  v_xor_b32 v81, s54, v74
  v_or3_b32 v78, v78, v79, v80
  v_or_b32 v78, v78, v81
  v_cmp_ne_u32 vcc, 0, v78
  s_sub_u32 s58, s58, 1
  s_cselect_b64 vcc, 0, vcc
  s_cbranch_vccnz LP_112
IF_113_else:
  s_setprio 2
  v_pk_add_f32 v[60:61], v[60:61], v[64:65]
  v_pk_add_f32 v[68:69], v[68:69], v[72:73]
  v_pk_add_f32 v[60:61], v[60:61], v[68:69]
  v_mov_b32 v62, v60
  v_mov_b32 v63, v61
  s_nop 0
  v_permlane32_swap_b32 v60, v62
  v_permlane32_swap_b32 v61, v63
  v_add_f32 v65, v60, v62
  v_add_f32 v64, v61, v63
  v_mul_f32 v65, 0.0011574074074074073, v65
  v_mul_f32 v66, v65, v65
  v_mul_f32 v64, 0.0011574074074074073, v64
  v_sub_f32 v64, v64, v66
  v_max_f32 v64, 0, v64
  v_add_f32 v64, 0x3727c5ac, v64
  v_rsq_f32 v64, v64
  s_nop 0
  v_mul_f32 v65, v65, v64
  v_sub_f32 v65, 0, v65
  ds_write_b64 v2, v[64:65]
  s_waitcnt lgkmcnt(0)
  ds_read_b128 v[60:63], v77 offset:0
  ds_read_b128 v[64:67], v77 offset:16
  ds_read_b128 v[68:71], v77 offset:32
  ds_read_b128 v[72:75], v77 offset:48
  s_mul_i32 s66, s53, 458752
  s_lshl_b32 s63, s65, 10
  s_add_u32 s66, s66, s63
  s_add_u32 s66, s66, 15073280
  s_waitcnt lgkmcnt(3)
  v_fma_f32 v4, v4, v60, v61
  v_fma_f32 v5, v5, v62, v63
  s_waitcnt lgkmcnt(2)
  v_fma_f32 v6, v6, v64, v65
  v_fma_f32 v7, v7, v66, v67
  v_cvt_pk_bf16_f32 v76, v4, v5
  v_cvt_pk_bf16_f32 v77, v6, v7
  s_waitcnt lgkmcnt(1)
  v_fma_f32 v32, v32, v68, v69
  v_fma_f32 v33, v33, v70, v71
  s_waitcnt lgkmcnt(0)
  v_fma_f32 v34, v34, v72, v73
  v_fma_f32 v35, v35, v74, v75
  v_cvt_pk_bf16_f32 v78, v32, v33
  v_cvt_pk_bf16_f32 v79, v34, v35
  buffer_store_dwordx4 v[76:79], v114, s[44:47], s66 offen sc1
  s_add_u32 s66, s66, 65536
  v_fma_f32 v8, v8, v60, v61
  v_fma_f32 v9, v9, v62, v63
  v_fma_f32 v10, v10, v64, v65
  v_fma_f32 v11, v11, v66, v67
  v_cvt_pk_bf16_f32 v80, v8, v9
  v_cvt_pk_bf16_f32 v81, v10, v11
  v_fma_f32 v36, v36, v68, v69
  v_fma_f32 v37, v37, v70, v71
  v_fma_f32 v38, v38, v72, v73
  v_fma_f32 v39, v39, v74, v75
  v_cvt_pk_bf16_f32 v82, v36, v37
  v_cvt_pk_bf16_f32 v83, v38, v39
  buffer_store_dwordx4 v[80:83], v114, s[44:47], s66 offen sc1
  s_add_u32 s66, s66, 65536
  v_fma_f32 v12, v12, v60, v61
  v_fma_f32 v13, v13, v62, v63
  v_fma_f32 v14, v14, v64, v65
  v_fma_f32 v15, v15, v66, v67
  v_cvt_pk_bf16_f32 v84, v12, v13
  v_cvt_pk_bf16_f32 v85, v14, v15
  v_fma_f32 v40, v40, v68, v69
  v_fma_f32 v41, v41, v70, v71
  v_fma_f32 v42, v42, v72, v73
  v_fma_f32 v43, v43, v74, v75
  v_cvt_pk_bf16_f32 v86, v40, v41
  v_cvt_pk_bf16_f32 v87, v42, v43
  buffer_store_dwordx4 v[84:87], v114, s[44:47], s66 offen sc1
  s_add_u32 s66, s66, 65536
  v_fma_f32 v16, v16, v60, v61
  v_fma_f32 v17, v17, v62, v63
  v_fma_f32 v18, v18, v64, v65
  v_fma_f32 v19, v19, v66, v67
  v_cvt_pk_bf16_f32 v88, v16, v17
  v_cvt_pk_bf16_f32 v89, v18, v19
  v_fma_f32 v44, v44, v68, v69
  v_fma_f32 v45, v45, v70, v71
  v_fma_f32 v46, v46, v72, v73
  v_fma_f32 v47, v47, v74, v75
  v_cvt_pk_bf16_f32 v90, v44, v45
  v_cvt_pk_bf16_f32 v91, v46, v47
  buffer_store_dwordx4 v[88:91], v114, s[44:47], s66 offen sc1
  s_add_u32 s66, s66, 65536
  v_fma_f32 v20, v20, v60, v61
  v_fma_f32 v21, v21, v62, v63
  v_fma_f32 v22, v22, v64, v65
  v_fma_f32 v23, v23, v66, v67
  v_cvt_pk_bf16_f32 v92, v20, v21
  v_cvt_pk_bf16_f32 v93, v22, v23
  v_fma_f32 v48, v48, v68, v69
  v_fma_f32 v49, v49, v70, v71
  v_fma_f32 v50, v50, v72, v73
  v_fma_f32 v51, v51, v74, v75
  v_cvt_pk_bf16_f32 v94, v48, v49
  v_cvt_pk_bf16_f32 v95, v50, v51
  buffer_store_dwordx4 v[92:95], v114, s[44:47], s66 offen sc1
  s_add_u32 s66, s66, 65536
  v_fma_f32 v24, v24, v60, v61
  v_fma_f32 v25, v25, v62, v63
  v_fma_f32 v26, v26, v64, v65
  v_fma_f32 v27, v27, v66, v67
  v_cvt_pk_bf16_f32 v96, v24, v25
  v_cvt_pk_bf16_f32 v97, v26, v27
  v_fma_f32 v52, v52, v68, v69
  v_fma_f32 v53, v53, v70, v71
  v_fma_f32 v54, v54, v72, v73
  v_fma_f32 v55, v55, v74, v75
  v_cvt_pk_bf16_f32 v98, v52, v53
  v_cvt_pk_bf16_f32 v99, v54, v55
  buffer_store_dwordx4 v[96:99], v114, s[44:47], s66 offen sc1
  s_add_u32 s66, s66, 65536
  v_fma_f32 v28, v28, v60, v61
  v_fma_f32 v29, v29, v62, v63
  v_fma_f32 v30, v30, v64, v65
  v_fma_f32 v31, v31, v66, v67
  v_cvt_pk_bf16_f32 v100, v28, v29
  v_cvt_pk_bf16_f32 v101, v30, v31
  v_fma_f32 v56, v56, v68, v69
  v_fma_f32 v57, v57, v70, v71
  v_fma_f32 v58, v58, v72, v73
  v_fma_f32 v59, v59, v74, v75
  v_cvt_pk_bf16_f32 v102, v56, v57
  v_cvt_pk_bf16_f32 v103, v58, v59
  buffer_store_dwordx4 v[100:103], v114, s[44:47], s66 offen sc1
  s_barrier
  s_lshl_b32 s66, s53, 6
  s_add_u32 s66, s66, s65
  s_lshl_b32 s63, s66, 7
  s_add_u32 s63, s63, 1179648
  v_mov_b32 v60, s54
  v_lshlrev_b32 v61, 26, v1
  v_and_b32 v61, 2147483648, v61
  v_lshl_or_b32 v61, v1, 2, v61
  s_waitcnt vmcnt(0)
  buffer_store_dword v60, v61, s[44:47], s63 offen sc1
  s_branch IF_114_end
IF_114_else:
  v_cvt_pk_bf16_f32 v60, v4, v5
  v_cvt_pk_bf16_f32 v61, v6, v7
  v_cvt_pk_bf16_f32 v62, v8, v9
  v_cvt_pk_bf16_f32 v63, v10, v11
  v_cvt_pk_bf16_f32 v64, v12, v13
  v_cvt_pk_bf16_f32 v65, v14, v15
  v_cvt_pk_bf16_f32 v66, v16, v17
  v_cvt_pk_bf16_f32 v67, v18, v19
  v_cvt_pk_bf16_f32 v68, v20, v21
  v_cvt_pk_bf16_f32 v69, v22, v23
  v_cvt_pk_bf16_f32 v70, v24, v25
  v_cvt_pk_bf16_f32 v71, v26, v27
  v_cvt_pk_bf16_f32 v72, v28, v29
  v_cvt_pk_bf16_f32 v73, v30, v31
  v_cvt_pk_bf16_f32 v74, v32, v33
  v_cvt_pk_bf16_f32 v75, v34, v35
  v_cvt_pk_bf16_f32 v76, v36, v37
  v_cvt_pk_bf16_f32 v77, v38, v39
  v_cvt_pk_bf16_f32 v78, v40, v41
  v_cvt_pk_bf16_f32 v79, v42, v43
  v_cvt_pk_bf16_f32 v80, v44, v45
  v_cvt_pk_bf16_f32 v81, v46, v47
  v_cvt_pk_bf16_f32 v82, v48, v49
  v_cvt_pk_bf16_f32 v83, v50, v51
  v_cvt_pk_bf16_f32 v84, v52, v53
  v_cvt_pk_bf16_f32 v85, v54, v55
  v_cvt_pk_bf16_f32 v86, v56, v57
  v_cvt_pk_bf16_f32 v87, v58, v59
  s_lshl_b32 s66, s65, 16
  s_lshl_b32 s63, s53, 12
  s_add_u32 s66, s66, s63
  s_add_u32 s66, s66, 10878976
  buffer_store_dwordx4 v[60:63], v114, s[44:47], s66 offen offset:0 sc1
  buffer_store_dwordx4 v[64:67], v114, s[44:47], s66 offen offset:1024 sc1
  buffer_store_dwordx4 v[68:71], v114, s[44:47], s66 offen offset:2048 sc1
  buffer_store_dwordx2 v[72:73], v115, s[44:47], s66 offen offset:3072 sc1
  s_add_u32 s66, s66, 32768
  buffer_store_dwordx4 v[74:77], v114, s[44:47], s66 offen offset:0 sc1
  buffer_store_dwordx4 v[78:81], v114, s[44:47], s66 offen offset:1024 sc1
  buffer_store_dwordx4 v[82:85], v114, s[44:47], s66 offen offset:2048 sc1
  buffer_store_dwordx2 v[86:87], v115, s[44:47], s66 offen offset:3072 sc1
  s_lshl_b32 s66, s65, 3
  s_add_u32 s66, s66, s53
  s_barrier
  s_lshl_b32 s63, s66, 7
  s_add_u32 s63, s63, 917504
  v_mov_b32 v90, s54
  v_lshlrev_b32 v91, 26, v1
  v_and_b32 v91, 2147483648, v91
  v_lshl_or_b32 v91, v1, 2, v91
  s_waitcnt vmcnt(0)
  buffer_store_dword v90, v91, s[44:47], s63 offen sc1
IF_114_end:
  s_setprio 0
  s_barrier
  ds_read_b128 v[182:185], v116 offset:0
  ds_read_b128 v[186:189], v116 offset:2048
  ds_read_b128 v[190:193], v116 offset:4096
  ds_read_b128 v[194:197], v116 offset:6144
  ds_read_b128 v[198:201], v117 offset:0
  ds_read_b128 v[202:205], v117 offset:2048
  ds_read_b128 v[206:209], v117 offset:4096
  ds_read_b128 v[210:213], v117 offset:6144
  ds_read_b128 v[214:217], v116 offset:8192
  ds_read_b128 v[218:221], v116 offset:10240
  ds_read_b128 v[222:225], v116 offset:12288
  ds_read_b128 v[226:229], v116 offset:14336
  ds_read_b128 v[230:233], v117 offset:8192
  ds_read_b128 v[234:237], v117 offset:10240
  ds_read_b128 v[238:241], v117 offset:12288
  ds_read_b128 v[242:245], v117 offset:14336
  v_add_u32 v116, 65536, v116
  v_add_u32 v117, 65536, v117
  ds_read_b128 v[118:121], v116 offset:0
  ds_read_b128 v[122:125], v116 offset:2048
  ds_read_b128 v[126:129], v116 offset:4096
  ds_read_b128 v[130:133], v116 offset:6144
  ds_read_b128 v[134:137], v117 offset:0
  ds_read_b128 v[138:141], v117 offset:2048
  ds_read_b128 v[142:145], v117 offset:4096
  ds_read_b128 v[146:149], v117 offset:6144
  ds_read_b128 v[150:153], v116 offset:8192
  ds_read_b128 v[154:157], v116 offset:10240
  ds_read_b128 v[158:161], v116 offset:12288
  ds_read_b128 v[162:165], v116 offset:14336
  ds_read_b128 v[166:169], v117 offset:8192
  ds_read_b128 v[170:173], v117 offset:10240
  ds_read_b128 v[174:177], v117 offset:12288
  ds_read_b128 v[178:181], v117 offset:14336
  s_waitcnt lgkmcnt(0)
  s_barrier
  s_branch IF_121_end
IF_121_else:
  s_add_u32 s64, s65, s76
  s_add_u32 m0, s66, 70656
  s_add_u32 s63, s64, 0
  buffer_load_dwordx4 v8, s[20:23], s63 offen  lds
  s_add_u32 m0, s66, 71680
  s_add_u32 s63, s64, 65536
  buffer_load_dwordx4 v9, s[20:23], s63 offen  lds
  s_add_u32 m0, s66, 72704
  s_add_u32 s63, s64, 16384
  buffer_load_dwordx4 v8, s[20:23], s63 offen  lds
  s_add_u32 m0, s66, 73728
  s_add_u32 s63, s64, 81920
  buffer_load_dwordx4 v9, s[20:23], s63 offen  lds
  s_add_u32 m0, s66, 74752
  s_add_u32 s63, s64, 131072
  buffer_load_dwordx4 v8, s[20:23], s63 offen  lds
  s_add_u32 m0, s66, 75776
  s_add_u32 s63, s64, 196608
  buffer_load_dwordx4 v9, s[20:23], s63 offen  lds
  s_add_u32 m0, s66, 76800
  s_add_u32 s63, s64, 147456
  buffer_load_dwordx4 v8, s[20:23], s63 offen  lds
  s_add_u32 m0, s66, 77824
  s_add_u32 s63, s64, 212992
  buffer_load_dwordx4 v9, s[20:23], s63 offen  lds
  s_add_u32 s64, s65, s77
  s_add_u32 m0, s66, 78848
  s_add_u32 s63, s64, 0
  buffer_load_dwordx4 v8, s[20:23], s63 offen  lds
  s_add_u32 m0, s66, 79872
  s_add_u32 s63, s64, 65536
  buffer_load_dwordx4 v9, s[20:23], s63 offen  lds
  s_add_u32 m0, s66, 80896
  s_add_u32 s63, s64, 16384
  buffer_load_dwordx4 v8, s[20:23], s63 offen  lds
  s_add_u32 m0, s66, 81920
  s_add_u32 s63, s64, 81920
  buffer_load_dwordx4 v9, s[20:23], s63 offen  lds
  s_add_u32 m0, s66, 82944
  s_add_u32 s63, s64, 131072
  buffer_load_dwordx4 v8, s[20:23], s63 offen  lds
  s_add_u32 m0, s66, 83968
  s_add_u32 s63, s64, 196608
  buffer_load_dwordx4 v9, s[20:23], s63 offen  lds
  s_add_u32 m0, s66, 84992
  s_add_u32 s63, s64, 147456
  buffer_load_dwordx4 v8, s[20:23], s63 offen  lds
  s_add_u32 m0, s66, 86016
  s_add_u32 s63, s64, 212992
  buffer_load_dwordx4 v9, s[20:23], s63 offen  lds
  v_and_b32 v2, 15, v1
  v_lshrrev_b32 v3, 1, v2
  v_lshrrev_b32 v116, 4, v1
  v_xor_b32 v116, v116, v3
  v_xor_b32 v117, 4, v116
  v_lshlrev_b32 v2, 7, v2
  s_lshl_b32 s63, s59, 14
  s_add_u32 s63, s63, 5120
  v_add_u32 v2, s63, v2
  v_lshl_add_u32 v116, v116, 4, v2
  v_lshl_add_u32 v117, v117, 4, v2
  s_cmp_eq_u32 s55, 5
  s_cbranch_scc0 IF_116_else
  s_cmp_lt_u32 s2, 216
  s_cbranch_scc0 IF_115_else
  s_waitcnt vmcnt(32)
  ds_read_b64_tr_b16 v[20:21], v56 offset:0
  ds_read_b64_tr_b16 v[22:23], v56 offset:2560
  ds_read_b64_tr_b16 v[24:25], v56 offset:32
  ds_read_b64_tr_b16 v[26:27], v56 offset:2592
  ds_read_b64_tr_b16 v[28:29], v56 offset:64
  ds_read_b64_tr_b16 v[30:31], v56 offset:2624
  ds_read_b64_tr_b16 v[32:33], v56 offset:96
  ds_read_b64_tr_b16 v[34:35], v56 offset:2656
  ds_read_b64_tr_b16 v[36:37], v56 offset:128
  ds_read_b64_tr_b16 v[38:39], v56 offset:2688
  s_waitcnt lgkmcnt(8)
  buffer_store_dwordx4 v[20:23], v57, s[44:47], s73 offen offset:0 sc1
  s_waitcnt lgkmcnt(6)
  buffer_store_dwordx4 v[24:27], v57, s[44:47], s73 offen offset:1024 sc1
  s_waitcnt lgkmcnt(4)
  buffer_store_dwordx4 v[28:31], v57, s[44:47], s73 offen offset:2048 sc1
  s_waitcnt lgkmcnt(2)
  buffer_store_dwordx4 v[32:35], v57, s[44:47], s73 offen offset:3072 sc1
  s_waitcnt lgkmcnt(0)
  buffer_store_dwordx4 v[36:39], v57, s[44:47], s71 offen offset:0 sc1
IF_115_else:
IF_116_else:
  s_waitcnt vmcnt(24)
  ds_read_b128 v[118:121], v116 offset:0
  ds_read_b128 v[122:125], v116 offset:2048
  ds_read_b128 v[126:129], v116 offset:4096
  ds_read_b128 v[130:133], v116 offset:6144
  ds_read_b128 v[134:137], v117 offset:0
  ds_read_b128 v[138:141], v117 offset:2048
  ds_read_b128 v[142:145], v117 offset:4096
  ds_read_b128 v[146:149], v117 offset:6144
  s_waitcnt lgkmcnt(0)
  s_add_u32 s64, s65, s78
  s_add_u32 m0, s66, 5120
  s_add_u32 s63, s64, 2048
  buffer_load_dwordx4 v8, s[20:23], s63 offen  lds
  s_add_u32 m0, s66, 6144
  s_add_u32 s63, s64, 67584
  buffer_load_dwordx4 v9, s[20:23], s63 offen  lds
  s_add_u32 m0, s66, 7168
  s_add_u32 s63, s64, 18432
  buffer_load_dwordx4 v8, s[20:23], s63 offen  lds
  s_add_u32 m0, s66, 8192
  s_add_u32 s63, s64, 83968
  buffer_load_dwordx4 v9, s[20:23], s63 offen  lds
  s_add_u32 m0, s66, 9216
  s_add_u32 s63, s64, 133120
  buffer_load_dwordx4 v8, s[20:23], s63 offen  lds
  s_add_u32 m0, s66, 10240
  s_add_u32 s63, s64, 198656
  buffer_load_dwordx4 v9, s[20:23], s63 offen  lds
  s_add_u32 m0, s66, 11264
  s_add_u32 s63, s64, 149504
  buffer_load_dwordx4 v8, s[20:23], s63 offen  lds
  s_add_u32 m0, s66, 12288
  s_add_u32 s63, s64, 215040
  buffer_load_dwordx4 v9, s[20:23], s63 offen  lds
  s_waitcnt vmcnt(24)
  ds_read_b128 v[150:153], v116 offset:8192
  ds_read_b128 v[154:157], v116 offset:10240
  ds_read_b128 v[158:161], v116 offset:12288
  ds_read_b128 v[162:165], v116 offset:14336
  ds_read_b128 v[166:169], v117 offset:8192
  ds_read_b128 v[170:173], v117 offset:10240
  ds_read_b128 v[174:177], v117 offset:12288
  ds_read_b128 v[178:181], v117 offset:14336
  s_waitcnt lgkmcnt(0)
  s_cmp_eq_u32 s55, 5
  s_cbranch_scc0 IF_118_else
  s_cmp_lt_u32 s2, 216
  s_cbranch_scc0 IF_117_else
  s_add_u32 s67, s2, 480
  s_lshl_b32 s63, s67, 7
  s_add_u32 s63, s63, 2228224
  v_mov_b32 v10, s54
  v_lshlrev_b32 v11, 26, v1
  v_and_b32 v11, 2147483648, v11
  v_lshl_or_b32 v11, v1, 2, v11
  s_waitcnt vmcnt(8)
  buffer_store_dword v10, v11, s[44:47], s63 offen sc1
IF_117_else:
IF_118_else:
  s_barrier
  s_add_u32 s64, s65, s79
  s_add_u32 m0, s66, 13312
  s_add_u32 s63, s64, 2048
  buffer_load_dwordx4 v8, s[20:23], s63 offen  lds
  s_add_u32 m0, s66, 14336
  s_add_u32 s63, s64, 67584
  buffer_load_dwordx4 v9, s[20:23], s63 offen  lds
  s_add_u32 m0, s66, 15360
  s_add_u32 s63, s64, 18432
  buffer_load_dwordx4 v8, s[20:23], s63 offen  lds
  s_add_u32 m0, s66, 16384
  s_add_u32 s63, s64, 83968
  buffer_load_dwordx4 v9, s[20:23], s63 offen  lds
  s_add_u32 m0, s66, 17408
  s_add_u32 s63, s64, 133120
  buffer_load_dwordx4 v8, s[20:23], s63 offen  lds
  s_add_u32 m0, s66, 18432
  s_add_u32 s63, s64, 198656
  buffer_load_dwordx4 v9, s[20:23], s63 offen  lds
  s_add_u32 m0, s66, 19456
  s_add_u32 s63, s64, 149504
  buffer_load_dwordx4 v8, s[20:23], s63 offen  lds
  s_add_u32 m0, s66, 20480
  s_add_u32 s63, s64, 215040
  buffer_load_dwordx4 v9, s[20:23], s63 offen  lds
  s_waitcnt vmcnt(8)
  ds_read_b128 v[182:185], v116 offset:0
  ds_read_b128 v[186:189], v116 offset:2048
  ds_read_b128 v[190:193], v116 offset:4096
  ds_read_b128 v[194:197], v116 offset:6144
  ds_read_b128 v[198:201], v117 offset:0
  ds_read_b128 v[202:205], v117 offset:2048
  ds_read_b128 v[206:209], v117 offset:4096
  ds_read_b128 v[210:213], v117 offset:6144
  s_waitcnt lgkmcnt(0)
  s_add_u32 s64, s65, s78
  s_add_u32 m0, s66, 5120
  s_add_u32 s63, s64, 0
  buffer_load_dwordx4 v8, s[20:23], s63 offen  lds
  s_add_u32 m0, s66, 6144
  s_add_u32 s63, s64, 65536
  buffer_load_dwordx4 v9, s[20:23], s63 offen  lds
  s_add_u32 m0, s66, 7168
  s_add_u32 s63, s64, 16384
  buffer_load_dwordx4 v8, s[20:23], s63 offen  lds
  s_add_u32 m0, s66, 8192
  s_add_u32 s63, s64, 81920
  buffer_load_dwordx4 v9, s[20:23], s63 offen  lds
  s_add_u32 m0, s66, 9216
  s_add_u32 s63, s64, 131072
  buffer_load_dwordx4 v8, s[20:23], s63 offen  lds
  s_add_u32 m0, s66, 10240
  s_add_u32 s63, s64, 196608
  buffer_load_dwordx4 v9, s[20:23], s63 offen  lds
  s_add_u32 m0, s66, 11264
  s_add_u32 s63, s64, 147456
  buffer_load_dwordx4 v8, s[20:23], s63 offen  lds
  s_add_u32 m0, s66, 12288
  s_add_u32 s63, s64, 212992
  buffer_load_dwordx4 v9, s[20:23], s63 offen  lds
  s_waitcnt vmcnt(8)
  ds_read_b128 v[214:217], v116 offset:8192
  ds_read_b128 v[218:221], v116 offset:10240
  ds_read_b128 v[222:225], v116 offset:12288
  ds_read_b128 v[226:229], v116 offset:14336
  ds_read_b128 v[230:233], v117 offset:8192
  ds_read_b128 v[234:237], v117 offset:10240
  ds_read_b128 v[238:241], v117 offset:12288
  ds_read_b128 v[242:245], v117 offset:14336
  s_waitcnt lgkmcnt(0)
  s_add_u32 s64, s65, s79
  s_add_u32 m0, s66, 13312
  s_add_u32 s63, s64, 0
  buffer_load_dwordx4 v8, s[20:23], s63 offen  lds
  s_add_u32 m0, s66, 14336
  s_add_u32 s63, s64, 65536
  buffer_load_dwordx4 v9, s[20:23], s63 offen  lds
  s_add_u32 m0, s66, 15360
  s_add_u32 s63, s64, 16384
  buffer_load_dwordx4 v8, s[20:23], s63 offen  lds
  s_add_u32 m0, s66, 16384
  s_add_u32 s63, s64, 81920
  buffer_load_dwordx4 v9, s[20:23], s63 offen  lds
  s_add_u32 m0, s66, 17408
  s_add_u32 s63, s64, 131072
  buffer_load_dwordx4 v8, s[20:23], s63 offen  lds
  s_add_u32 m0, s66, 18432
  s_add_u32 s63, s64, 196608
  buffer_load_dwordx4 v9, s[20:23], s63 offen  lds
  s_add_u32 m0, s66, 19456
  s_add_u32 s63, s64, 147456
  buffer_load_dwordx4 v8, s[20:23], s63 offen  lds
  s_add_u32 m0, s66, 20480
  s_add_u32 s63, s64, 212992
  buffer_load_dwordx4 v9, s[20:23], s63 offen  lds
  v_min_u32 v108, 26, v1
  v_lshlrev_b32 v108, 7, v108
  s_mul_i32 s75, s53, 3456
  s_add_u32 s75, s75, 2289664
  buffer_load_dword v109, v108, s[44:47], s75 offen sc1
  s_waitcnt vmcnt(0)
  v_cmp_ne_u32 vcc, s54, v109
  s_cbranch_vccz IF_120_else
  s_mov_b32 s58, 1048576
LP_119:
  s_sleep 2
  buffer_load_dword v109, v108, s[44:47], s75 offen sc1
  s_waitcnt vmcnt(0)
  v_cmp_ne_u32 vcc, s54, v109
  s_sub_u32 s58, s58, 1
  s_cselect_b64 vcc, 0, vcc
  s_cbranch_vccnz LP_119
IF_120_else:
  s_barrier
  s_barrier
  v_lshlrev_b32 v114, 4, v1
  s_mov_b32 s74, 46080
  s_cmp_eq_u32 s59, 1
  s_cselect_b32 s74, 51200, s74
  s_cmp_eq_u32 s59, 2
  s_cselect_b32 s74, 61440, s74
  s_cmp_eq_u32 s59, 3
  s_cselect_b32 s74, 66560, s74
  s_mul_i32 s73, s53, 138240
  s_add_u32 s73, s74, s73
  s_add_u32 s63, s73, 24559616
  s_add_u32 m0, s74, 23552
  s_nop 0
  buffer_load_dwordx4 v114, s[44:47], s63 offen offset:0 sc1 lds
  s_add_u32 m0, s74, 23552
  s_nop 0
  buffer_load_dwordx4 v114, s[44:47], s63 offen offset:1024 sc1 lds
  s_add_u32 m0, s74, 23552
  s_nop 0
  buffer_load_dwordx4 v114, s[44:47], s63 offen offset:2048 sc1 lds
  s_add_u32 m0, s74, 23552
  s_nop 0
  buffer_load_dwordx4 v114, s[44:47], s63 offen offset:3072 sc1 lds
  s_add_u32 s63, s73, 24563712
  s_add_u32 m0, s74, 27648
  s_nop 0
  buffer_load_dwordx4 v114, s[44:47], s63 offen offset:0 sc1 lds
  s_mov_b32 s74, 76800
  s_cmp_eq_u32 s59, 1
  s_cselect_b32 s74, 81920, s74
  s_cmp_eq_u32 s59, 2
  s_cselect_b32 s74, 92160, s74
  s_cmp_eq_u32 s59, 3
  s_cselect_b32 s74, 97280, s74
  s_mul_i32 s73, s53, 138240
  s_add_u32 s73, s74, s73
  s_add_u32 s63, s73, 24559616
  s_add_u32 m0, s74, 23552
  s_nop 0
  buffer_load_dwordx4 v114, s[44:47], s63 offen offset:0 sc1 lds
  s_add_u32 m0, s74, 23552
  s_nop 0
  buffer_load_dwordx4 v114, s[44:47], s63 offen offset:1024 sc1 lds
  s_add_u32 m0, s74, 23552
  s_nop 0
  buffer_load_dwordx4 v114, s[44:47], s63 offen offset:2048 sc1 lds
  s_add_u32 m0, s74, 23552
  s_nop 0
  buffer_load_dwordx4 v114, s[44:47], s63 offen offset:3072 sc1 lds
  s_add_u32 s63, s73, 24563712
  s_add_u32 m0, s74, 27648
  s_nop 0
  buffer_load_dwordx4 v114, s[44:47], s63 offen offset:0 sc1 lds
  s_mov_b32 s74, 107520
  s_cmp_eq_u32 s59, 1
  s_cselect_b32 s74, 112640, s74
  s_cmp_eq_u32 s59, 2
  s_cselect_b32 s74, 56320, s74
  s_cmp_eq_u32 s59, 3
  s_cselect_b32 s74, 71680, s74
  s_mul_i32 s73, s53, 138240
  s_add_u32 s73, s74, s73
  s_add_u32 s63, s73, 24559616
  s_add_u32 m0, s74, 23552
  s_nop 0
  buffer_load_dwordx4 v114, s[44:47], s63 offen offset:0 sc1 lds
  s_add_u32 m0, s74, 23552
  s_nop 0
  buffer_load_dwordx4 v114, s[44:47], s63 offen offset:1024 sc1 lds
  s_add_u32 m0, s74, 23552
  s_nop 0
  buffer_load_dwordx4 v114, s[44:47], s63 offen offset:2048 sc1 lds
  s_add_u32 m0, s74, 23552
  s_nop 0
  buffer_load_dwordx4 v114, s[44:47], s63 offen offset:3072 sc1 lds
  s_add_u32 s63, s73, 24563712
  s_add_u32 m0, s74, 27648
  s_nop 0
  buffer_load_dwordx4 v114, s[44:47], s63 offen offset:0 sc1 lds
IF_121_end:
  v_lshlrev_b32 v114, 4, v1
  v_lshlrev_b32 v115, 3, v1
  s_lshl_b32 s66, s52, 2
  s_add_u32 s66, s66, s59
  s_lshr_b32 s68, s59, 1
  s_lshl_b32 s68, s68, 5
  s_and_b32 s63, s59, 1
  s_lshl_b32 s63, s63, 2
  s_add_u32 s68, s68, s63
  s_lshl_b32 s63, s52, 6
  s_add_u32 s68, s68, s63
  v_bfe_u32 v105, v1, 2, 2
  v_and_b32 v2, 3, v1
  v_lshl_add_u32 v105, v105, 3, v2
  v_add_u32 v105, s68, v105
  v_mul_u32_u24 v105, 2, v105
  buffer_load_ushort v104, v105, s[24:27], 0 offen
  s_lshl_b32 s63, s55, 12
  v_add_u32 v106, s63, v114
  s_lshl_b32 s63, s59, 10
  v_add_u32 v107, s63, v114
  s_and_b32 s65, s53, 7
  s_mul_i32 s65, s65, 458752
  s_and_b32 s63, s55, 7
  s_lshl_b32 s63, s63, 13
  s_add_u32 s65, s65, s63
  s_add_u32 s65, s65, 15073280
  s_lshl_b32 s67, s66, 3
  s_add_u32 s67, s67, s53
  s_lshl_b32 s67, s67, 12
  s_add_u32 s67, s67, 10878976
  s_lshl_b32 s68, s60, 11
  s_sub_u32 s67, s67, s68
  s_add_u32 s67, s67, 2048
  v_and_b32 v2, 7, v1
  s_lshl_b32 s63, s53, 6
  s_lshl_b32 s68, s55, 3
  s_add_u32 s63, s63, s68
  s_add_u32 s63, s63, 8192
  v_add_u32 v2, s63, v2
  s_lshr_b32 s63, s66, 1
  s_lshl_b32 s63, s63, 3
  s_add_u32 s63, s63, s53
  s_add_u32 s63, s63, 6144
  v_mov_b32 v3, s63
  v_cmp_gt_u32 vcc, 8, v1
  s_nop 1
  v_cndmask_b32 v2, v3, v2, vcc
  v_lshlrev_b32 v2, 7, v2
  s_mov_b32 s63, 131072
  buffer_load_dword v3, v2, s[44:47], s63 offen sc1
  s_waitcnt vmcnt(0)
  v_cmp_ne_u32 vcc, s54, v3
  s_cbranch_vccz IF_123_else
  s_mov_b32 s58, 1048576
LP_122:
  s_sleep 2
  buffer_load_dword v3, v2, s[44:47], s63 offen sc1
  s_waitcnt vmcnt(0)
  v_cmp_ne_u32 vcc, s54, v3
  s_sub_u32 s58, s58, 1
  s_cselect_b64 vcc, 0, vcc
  s_cbranch_vccnz LP_122
IF_123_else:
  s_add_u32 s76, s53, 0
  s_and_b32 s76, s76, 3
  s_lshl_b32 s76, s76, 11
  s_add_u32 s77, s53, 1
  s_and_b32 s77, s77, 3
  s_lshl_b32 s77, s77, 11
  s_add_u32 s78, s53, 2
  s_and_b32 s78, s78, 3
  s_lshl_b32 s78, s78, 11
  s_add_u32 s79, s53, 3
  s_and_b32 s79, s79, 3
  s_lshl_b32 s79, s79, 11
  s_add_u32 s74, s65, s76
  buffer_load_dwordx4 v[4:7], v114, s[44:47], s74 offen offset:0 sc1
  buffer_load_dwordx4 v[8:11], v114, s[44:47], s74 offen offset:1024 sc1
  s_add_u32 s74, s65, s77
  buffer_load_dwordx4 v[12:15], v114, s[44:47], s74 offen offset:0 sc1
  buffer_load_dwordx4 v[16:19], v114, s[44:47], s74 offen offset:1024 sc1
  s_add_u32 s74, s65, s78
  buffer_load_dwordx4 v[20:23], v114, s[44:47], s74 offen offset:0 sc1
  buffer_load_dwordx4 v[24:27], v114, s[44:47], s74 offen offset:1024 sc1
  s_add_u32 s74, s65, s79
  buffer_load_dwordx4 v[28:31], v114, s[44:47], s74 offen offset:0 sc1
  buffer_load_dwordx4 v[32:35], v114, s[44:47], s74 offen offset:1024 sc1
  s_add_u32 s65, s65, 65536
  s_add_u32 s74, s65, s76
  buffer_load_dwordx4 v[36:39], v114, s[44:47], s74 offen offset:0 sc1
  buffer_load_dwordx4 v[40:43], v114, s[44:47], s74 offen offset:1024 sc1
  buffer_load_dwordx4 v[84:87], v114, s[44:47], s67 offen sc1
  s_cmp_lt_u32 s55, 4
  s_cbranch_scc0 IF_124_else
  buffer_load_dwordx2 v[88:89], v115, s[44:47], s67 offen offset:1024 sc1
  s_branch IF_124_end
IF_124_else:
  buffer_load_dwordx4 v[88:91], v114, s[44:47], s67 offen offset:1024 sc1
IF_124_end:
  v_lshlrev_b32 v104, 16, v104
  s_mul_i32 s69, s66, 27648
  s_add_u32 s69, s69, 3014656
  s_mul_i32 s63, s53, 3072
  s_add_u32 s70, s69, s63
  s_lshl_b32 s71, s53, 9
  s_add_u32 s71, s71, 24576
  s_add_u32 s71, s71, s69
  s_cmp_lt_u32 s53, 6
  s_cselect_b32 s71, s71, 2147483648
  s_lshl_b32 s72, s66, 4
  s_lshl_b32 s63, s53, 1
  s_add_u32 s72, s72, s63
  s_xor_b32 s63, s60, 1
  s_add_u32 s72, s72, s63
  s_waitcnt vmcnt(11)
  v_mfma_f32_16x16x32_bf16 v[44:47], v[4:7], v[118:121], 0
  v_mfma_f32_16x16x32_bf16 v[48:51], v[4:7], v[122:125], 0
  v_mfma_f32_16x16x32_bf16 v[52:55], v[4:7], v[126:129], 0
  v_mfma_f32_16x16x32_bf16 v[56:59], v[4:7], v[130:133], 0
  s_add_u32 s74, s65, s77
  buffer_load_dwordx4 v[4:7], v114, s[44:47], s74 offen offset:0 sc1
  s_waitcnt vmcnt(11)
  v_mfma_f32_16x16x32_bf16 v[44:47], v[8:11], v[134:137], v[44:47]
  v_mfma_f32_16x16x32_bf16 v[48:51], v[8:11], v[138:141], v[48:51]
  v_mfma_f32_16x16x32_bf16 v[52:55], v[8:11], v[142:145], v[52:55]
  v_mfma_f32_16x16x32_bf16 v[56:59], v[8:11], v[146:149], v[56:59]
  buffer_load_dwordx4 v[8:11], v114, s[44:47], s74 offen offset:1024 sc1
  s_waitcnt vmcnt(11)
  v_mfma_f32_16x16x32_bf16 v[44:47], v[12:15], v[150:153], v[44:47]
  v_mfma_f32_16x16x32_bf16 v[48:51], v[12:15], v[154:157], v[48:51]
  v_mfma_f32_16x16x32_bf16 v[52:55], v[12:15], v[158:161], v[52:55]
  v_mfma_f32_16x16x32_bf16 v[56:59], v[12:15], v[162:165], v[56:59]
  s_add_u32 s74, s65, s78
  buffer_load_dwordx4 v[12:15], v114, s[44:47], s74 offen offset:0 sc1
  s_waitcnt vmcnt(11)
  v_mfma_f32_16x16x32_bf16 v[44:47], v[16:19], v[166:169], v[44:47]
  v_mfma_f32_16x16x32_bf16 v[48:51], v[16:19], v[170:173], v[48:51]
  v_mfma_f32_16x16x32_bf16 v[52:55], v[16:19], v[174:177], v[52:55]
  v_mfma_f32_16x16x32_bf16 v[56:59], v[16:19], v[178:181], v[56:59]
  buffer_load_dwordx4 v[16:19], v114, s[44:47], s74 offen offset:1024 sc1
  s_waitcnt vmcnt(11)
  v_mfma_f32_16x16x32_bf16 v[44:47], v[20:23], v[182:185], v[44:47]
  v_mfma_f32_16x16x32_bf16 v[48:51], v[20:23], v[186:189], v[48:51]
  v_mfma_f32_16x16x32_bf16 v[52:55], v[20:23], v[190:193], v[52:55]
  v_mfma_f32_16x16x32_bf16 v[56:59], v[20:23], v[194:197], v[56:59]
  s_add_u32 s74, s65, s79
  buffer_load_dwordx4 v[20:23], v114, s[44:47], s74 offen offset:0 sc1
  s_waitcnt vmcnt(11)
  v_mfma_f32_16x16x32_bf16 v[44:47], v[24:27], v[198:201], v[44:47]
  v_mfma_f32_16x16x32_bf16 v[48:51], v[24:27], v[202:205], v[48:51]
  v_mfma_f32_16x16x32_bf16 v[52:55], v[24:27], v[206:209], v[52:55]
  v_mfma_f32_16x16x32_bf16 v[56:59], v[24:27], v[210:213], v[56:59]
  buffer_load_dwordx4 v[24:27], v114, s[44:47], s74 offen offset:1024 sc1
  s_waitcnt vmcnt(11)
  v_mfma_f32_16x16x32_bf16 v[44:47], v[28:31], v[214:217], v[44:47]
  v_mfma_f32_16x16x32_bf16 v[48:51], v[28:31], v[218:221], v[48:51]
  v_mfma_f32_16x16x32_bf16 v[52:55], v[28:31], v[222:225], v[52:55]
  v_mfma_f32_16x16x32_bf16 v[56:59], v[28:31], v[226:229], v[56:59]
  s_add_u32 s65, s65, 65536
  s_add_u32 s74, s65, s76
  buffer_load_dwordx4 v[28:31], v114, s[44:47], s74 offen offset:0 sc1
  s_waitcnt vmcnt(11)
  v_mfma_f32_16x16x32_bf16 v[44:47], v[32:35], v[230:233], v[44:47]
  v_mfma_f32_16x16x32_bf16 v[48:51], v[32:35], v[234:237], v[48:51]
  v_mfma_f32_16x16x32_bf16 v[52:55], v[32:35], v[238:241], v[52:55]
  v_mfma_f32_16x16x32_bf16 v[56:59], v[32:35], v[242:245], v[56:59]
  buffer_load_dwordx4 v[32:35], v114, s[44:47], s74 offen offset:1024 sc1
  s_waitcnt vmcnt(11)
  v_mfma_f32_16x16x32_bf16 v[60:63], v[36:39], v[118:121], 0
  v_mfma_f32_16x16x32_bf16 v[64:67], v[36:39], v[122:125], 0
  v_mfma_f32_16x16x32_bf16 v[68:71], v[36:39], v[126:129], 0
  v_mfma_f32_16x16x32_bf16 v[72:75], v[36:39], v[130:133], 0
  s_add_u32 s74, s65, s77
  buffer_load_dwordx4 v[36:39], v114, s[44:47], s74 offen offset:0 sc1
  s_waitcnt vmcnt(11)
  v_mfma_f32_16x16x32_bf16 v[60:63], v[40:43], v[134:137], v[60:63]
  ds_write_b128 v106, v[44:47] offset:0
  v_mfma_f32_16x16x32_bf16 v[64:67], v[40:43], v[138:141], v[64:67]
  ds_write_b128 v106, v[48:51] offset:1024
  v_mfma_f32_16x16x32_bf16 v[68:71], v[40:43], v[142:145], v[68:71]
  ds_write_b128 v106, v[52:55] offset:2048
  v_mfma_f32_16x16x32_bf16 v[72:75], v[40:43], v[146:149], v[72:75]
  ds_write_b128 v106, v[56:59] offset:3072
  buffer_load_dwordx4 v[40:43], v114, s[44:47], s74 offen offset:1024 sc1
  s_waitcnt vmcnt(9)
  v_mfma_f32_16x16x32_bf16 v[60:63], v[4:7], v[150:153], v[60:63]
  v_mfma_f32_16x16x32_bf16 v[64:67], v[4:7], v[154:157], v[64:67]
  v_mfma_f32_16x16x32_bf16 v[68:71], v[4:7], v[158:161], v[68:71]
  v_mfma_f32_16x16x32_bf16 v[72:75], v[4:7], v[162:165], v[72:75]
  s_add_u32 s74, s65, s78
  buffer_load_dwordx4 v[4:7], v114, s[44:47], s74 offen offset:0 sc1
  s_waitcnt lgkmcnt(0)
  s_barrier
  s_waitcnt vmcnt(9)
  v_mfma_f32_16x16x32_bf16 v[60:63], v[8:11], v[166:169], v[60:63]
  v_mfma_f32_16x16x32_bf16 v[64:67], v[8:11], v[170:173], v[64:67]
  v_mfma_f32_16x16x32_bf16 v[68:71], v[8:11], v[174:177], v[68:71]
  v_mfma_f32_16x16x32_bf16 v[72:75], v[8:11], v[178:181], v[72:75]
  buffer_load_dwordx4 v[8:11], v114, s[44:47], s74 offen offset:1024 sc1
  s_waitcnt vmcnt(9)
  v_mfma_f32_16x16x32_bf16 v[60:63], v[12:15], v[182:185], v[60:63]
  v_mfma_f32_16x16x32_bf16 v[64:67], v[12:15], v[186:189], v[64:67]
  v_mfma_f32_16x16x32_bf16 v[68:71], v[12:15], v[190:193], v[68:71]
  v_mfma_f32_16x16x32_bf16 v[72:75], v[12:15], v[194:197], v[72:75]
  s_add_u32 s74, s65, s79
  buffer_load_dwordx4 v[12:15], v114, s[44:47], s74 offen offset:0 sc1
  s_cmp_lt_u32 s55, 4
  s_cbranch_scc1 IF_125_end
  ds_read_b128 v[100:103], v107 offset:0
  ds_read_b128 v[76:79], v107 offset:4096
  ds_read_b128 v[80:83], v107 offset:8192
IF_125_end:
  s_waitcnt vmcnt(9)
  v_mfma_f32_16x16x32_bf16 v[60:63], v[16:19], v[198:201], v[60:63]
  v_mfma_f32_16x16x32_bf16 v[64:67], v[16:19], v[202:205], v[64:67]
  v_mfma_f32_16x16x32_bf16 v[68:71], v[16:19], v[206:209], v[68:71]
  v_mfma_f32_16x16x32_bf16 v[72:75], v[16:19], v[210:213], v[72:75]
  buffer_load_dwordx4 v[16:19], v114, s[44:47], s74 offen offset:1024 sc1
  s_cmp_lt_u32 s55, 4
  s_cbranch_scc1 IF_126_end
  s_waitcnt lgkmcnt(1)
  v_add_f32 v100, v100, v76
  v_add_f32 v101, v101, v77
  v_add_f32 v102, v102, v78
  v_add_f32 v103, v103, v79
  s_waitcnt lgkmcnt(0)
  v_add_f32 v100, v100, v80
  v_add_f32 v101, v101, v81
  v_add_f32 v102, v102, v82
  v_add_f32 v103, v103, v83
  ds_read_b128 v[76:79], v107 offset:12288
  ds_read_b128 v[80:83], v107 offset:16384
IF_126_end:
  s_waitcnt vmcnt(9)
  v_mfma_f32_16x16x32_bf16 v[60:63], v[20:23], v[214:217], v[60:63]
  v_mfma_f32_16x16x32_bf16 v[64:67], v[20:23], v[218:221], v[64:67]
  v_mfma_f32_16x16x32_bf16 v[68:71], v[20:23], v[222:225], v[68:71]
  v_mfma_f32_16x16x32_bf16 v[72:75], v[20:23], v[226:229], v[72:75]
  s_add_u32 s65, s65, 65536
  s_add_u32 s74, s65, s76
  buffer_load_dwordx4 v[20:23], v114, s[44:47], s74 offen offset:0 sc1
  s_cmp_lt_u32 s55, 4
  s_cbranch_scc1 IF_127_end
  s_waitcnt lgkmcnt(1)
  v_add_f32 v100, v100, v76
  v_add_f32 v101, v101, v77
  v_add_f32 v102, v102, v78
  v_add_f32 v103, v103, v79
  s_waitcnt lgkmcnt(0)
  v_add_f32 v100, v100, v80
  v_add_f32 v101, v101, v81
  v_add_f32 v102, v102, v82
  v_add_f32 v103, v103, v83
  ds_read_b128 v[76:79], v107 offset:20480
  ds_read_b128 v[80:83], v107 offset:24576
IF_127_end:
  s_waitcnt vmcnt(9)
  v_mfma_f32_16x16x32_bf16 v[60:63], v[24:27], v[230:233], v[60:63]
  v_mfma_f32_16x16x32_bf16 v[64:67], v[24:27], v[234:237], v[64:67]
  v_mfma_f32_16x16x32_bf16 v[68:71], v[24:27], v[238:241], v[68:71]
  v_mfma_f32_16x16x32_bf16 v[72:75], v[24:27], v[242:245], v[72:75]
  buffer_load_dwordx4 v[24:27], v114, s[44:47], s74 offen offset:1024 sc1
  s_cmp_lt_u32 s55, 4
  s_cbranch_scc1 IF_128_end
  s_waitcnt lgkmcnt(1)
  v_add_f32 v100, v100, v76
  v_add_f32 v101, v101, v77
  v_add_f32 v102, v102, v78
  v_add_f32 v103, v103, v79
  s_waitcnt lgkmcnt(0)
  v_add_f32 v100, v100, v80
  v_add_f32 v101, v101, v81
  v_add_f32 v102, v102, v82
  v_add_f32 v103, v103, v83
  ds_read_b128 v[76:79], v107 offset:28672
  v_lshlrev_b32 v80, 16, v84
  v_and_b32 v81, s57, v84
  v_lshlrev_b32 v82, 16, v85
  v_and_b32 v83, s57, v85
IF_128_end:
  s_waitcnt vmcnt(9)
  v_mfma_f32_16x16x32_bf16 v[44:47], v[28:31], v[118:121], 0
  v_mfma_f32_16x16x32_bf16 v[48:51], v[28:31], v[122:125], 0
  v_mfma_f32_16x16x32_bf16 v[52:55], v[28:31], v[126:129], 0
  v_mfma_f32_16x16x32_bf16 v[56:59], v[28:31], v[130:133], 0
  s_add_u32 s74, s65, s77
  buffer_load_dwordx4 v[28:31], v114, s[44:47], s74 offen offset:0 sc1
  s_cmp_lt_u32 s55, 4
  s_cbranch_scc1 IF_129_end
  s_waitcnt lgkmcnt(0)
  v_add_f32 v100, v100, v76
  v_add_f32 v101, v101, v77
  v_add_f32 v102, v102, v78
  v_add_f32 v103, v103, v79
  v_add_f32 v100, v100, v104
  v_mul_f32 v100, v100, v80
  v_add_f32 v101, v101, v104
  v_mul_f32 v101, v101, v81
  v_add_f32 v102, v102, v104
  v_mul_f32 v102, v102, v82
  v_add_f32 v103, v103, v104
  v_mul_f32 v103, v103, v83
  v_cvt_pk_bf16_f32 v92, v100, v101
  v_cvt_pk_bf16_f32 v93, v102, v103
IF_129_end:
  s_waitcnt vmcnt(9)
  v_mfma_f32_16x16x32_bf16 v[44:47], v[32:35], v[134:137], v[44:47]
  ds_write_b128 v106, v[60:63] offset:32768
  v_mfma_f32_16x16x32_bf16 v[48:51], v[32:35], v[138:141], v[48:51]
  ds_write_b128 v106, v[64:67] offset:33792
  v_mfma_f32_16x16x32_bf16 v[52:55], v[32:35], v[142:145], v[52:55]
  ds_write_b128 v106, v[68:71] offset:34816
  v_mfma_f32_16x16x32_bf16 v[56:59], v[32:35], v[146:149], v[56:59]
  ds_write_b128 v106, v[72:75] offset:35840
  buffer_load_dwordx4 v[32:35], v114, s[44:47], s74 offen offset:1024 sc1
  s_waitcnt vmcnt(9)
  v_mfma_f32_16x16x32_bf16 v[44:47], v[36:39], v[150:153], v[44:47]
  v_mfma_f32_16x16x32_bf16 v[48:51], v[36:39], v[154:157], v[48:51]
  v_mfma_f32_16x16x32_bf16 v[52:55], v[36:39], v[158:161], v[52:55]
  v_mfma_f32_16x16x32_bf16 v[56:59], v[36:39], v[162:165], v[56:59]
  s_add_u32 s74, s65, s78
  buffer_load_dwordx4 v[36:39], v114, s[44:47], s74 offen offset:0 sc1
  s_mov_b32 m0, 161536
  v_and_b32 v2, 15, v1
  v_lshlrev_b32 v2, 7, v2
  s_cmp_lt_u32 s55, 4
  s_cbranch_scc0 IF_130_else
  v_and_b32 v2, 0x380, v2
  s_add_u32 s63, s70, 2048
  buffer_load_dword v2, s[44:47], s63 offen lds
  v_and_b32 v2, 0x180, v2
  buffer_load_dword v2, s[44:47], s71 offen lds
  s_branch IF_130_end
IF_130_else:
  buffer_load_dword v2, s[44:47], s70 offen lds
IF_130_end:
  s_waitcnt lgkmcnt(0)
  s_barrier
  s_waitcnt vmcnt(10)
  v_mfma_f32_16x16x32_bf16 v[44:47], v[40:43], v[166:169], v[44:47]
  v_mfma_f32_16x16x32_bf16 v[48:51], v[40:43], v[170:173], v[48:51]
  v_mfma_f32_16x16x32_bf16 v[52:55], v[40:43], v[174:177], v[52:55]
  v_mfma_f32_16x16x32_bf16 v[56:59], v[40:43], v[178:181], v[56:59]
  buffer_load_dwordx4 v[40:43], v114, s[44:47], s74 offen offset:1024 sc1
  s_waitcnt vmcnt(10)
  v_mfma_f32_16x16x32_bf16 v[44:47], v[4:7], v[182:185], v[44:47]
  v_mfma_f32_16x16x32_bf16 v[48:51], v[4:7], v[186:189], v[48:51]
  v_mfma_f32_16x16x32_bf16 v[52:55], v[4:7], v[190:193], v[52:55]
  v_mfma_f32_16x16x32_bf16 v[56:59], v[4:7], v[194:197], v[56:59]
  s_add_u32 s74, s65, s79
  buffer_load_dwordx4 v[4:7], v114, s[44:47], s74 offen offset:0 sc1
  s_cmp_lt_u32 s55, 4
  s_cbranch_scc1 IF_131_end
  ds_read_b128 v[100:103], v107 offset:32768
  ds_read_b128 v[76:79], v107 offset:36864
  ds_read_b128 v[80:83], v107 offset:40960
IF_131_end:
  s_waitcnt vmcnt(10)
  v_mfma_f32_16x16x32_bf16 v[44:47], v[8:11], v[198:201], v[44:47]
  v_mfma_f32_16x16x32_bf16 v[48:51], v[8:11], v[202:205], v[48:51]
  v_mfma_f32_16x16x32_bf16 v[52:55], v[8:11], v[206:209], v[52:55]
  v_mfma_f32_16x16x32_bf16 v[56:59], v[8:11], v[210:213], v[56:59]
  buffer_load_dwordx4 v[8:11], v114, s[44:47], s74 offen offset:1024 sc1
  s_cmp_lt_u32 s55, 4
  s_cbranch_scc1 IF_132_end
  s_waitcnt lgkmcnt(1)
  v_add_f32 v100, v100, v76
  v_add_f32 v101, v101, v77
  v_add_f32 v102, v102, v78
  v_add_f32 v103, v103, v79
  s_waitcnt lgkmcnt(0)
  v_add_f32 v100, v100, v80
  v_add_f32 v101, v101, v81
  v_add_f32 v102, v102, v82
  v_add_f32 v103, v103, v83
  ds_read_b128 v[76:79], v107 offset:45056
  ds_read_b128 v[80:83], v107 offset:49152
IF_132_end:
  s_waitcnt vmcnt(10)
  v_mfma_f32_16x16x32_bf16 v[44:47], v[12:15], v[214:217], v[44:47]
  v_mfma_f32_16x16x32_bf16 v[48:51], v[12:15], v[218:221], v[48:51]
  v_mfma_f32_16x16x32_bf16 v[52:55], v[12:15], v[222:225], v[52:55]
  v_mfma_f32_16x16x32_bf16 v[56:59], v[12:15], v[226:229], v[56:59]
  s_add_u32 s65, s65, 65536
  s_add_u32 s74, s65, s76
  buffer_load_dwordx4 v[12:15], v114, s[44:47], s74 offen offset:0 sc1
  s_cmp_lt_u32 s55, 4
  s_cbranch_scc1 IF_133_end
  s_waitcnt lgkmcnt(1)
  v_add_f32 v100, v100, v76
  v_add_f32 v101, v101, v77
  v_add_f32 v102, v102, v78
  v_add_f32 v103, v103, v79
  s_waitcnt lgkmcnt(0)
  v_add_f32 v100, v100, v80
  v_add_f32 v101, v101, v81
  v_add_f32 v102, v102, v82
  v_add_f32 v103, v103, v83
  ds_read_b128 v[76:79], v107 offset:53248
  ds_read_b128 v[80:83], v107 offset:57344
IF_133_end:
  s_waitcnt vmcnt(10)
  v_mfma_f32_16x16x32_bf16 v[44:47], v[16:19], v[230:233], v[44:47]
  v_mfma_f32_16x16x32_bf16 v[48:51], v[16:19], v[234:237], v[48:51]
  v_mfma_f32_16x16x32_bf16 v[52:55], v[16:19], v[238:241], v[52:55]
  v_mfma_f32_16x16x32_bf16 v[56:59], v[16:19], v[242:245], v[56:59]
  buffer_load_dwordx4 v[16:19], v114, s[44:47], s74 offen offset:1024 sc1
  s_cmp_lt_u32 s55, 4
  s_cbranch_scc1 IF_134_end
  s_waitcnt lgkmcnt(1)
  v_add_f32 v100, v100, v76
  v_add_f32 v101, v101, v77
  v_add_f32 v102, v102, v78
  v_add_f32 v103, v103, v79
  s_waitcnt lgkmcnt(0)
  v_add_f32 v100, v100, v80
  v_add_f32 v101, v101, v81
  v_add_f32 v102, v102, v82
  v_add_f32 v103, v103, v83
  ds_read_b128 v[76:79], v107 offset:61440
  v_lshlrev_b32 v80, 16, v86
  v_and_b32 v81, s57, v86
  v_lshlrev_b32 v82, 16, v87
  v_and_b32 v83, s57, v87
IF_134_end:
  s_waitcnt vmcnt(10)
  v_mfma_f32_16x16x32_bf16 v[60:63], v[20:23], v[118:121], 0
  v_mfma_f32_16x16x32_bf16 v[64:67], v[20:23], v[122:125], 0
  v_mfma_f32_16x16x32_bf16 v[68:71], v[20:23], v[126:129], 0
  v_mfma_f32_16x16x32_bf16 v[72:75], v[20:23], v[130:133], 0
  s_add_u32 s74, s65, s77
  buffer_load_dwordx4 v[20:23], v114, s[44:47], s74 offen offset:0 sc1
  s_cmp_lt_u32 s55, 4
  s_cbranch_scc1 IF_135_end
  s_waitcnt lgkmcnt(0)
  v_add_f32 v100, v100, v76
  v_add_f32 v101, v101, v77
  v_add_f32 v102, v102, v78
  v_add_f32 v103, v103, v79
  v_add_f32 v100, v100, v104
  v_mul_f32 v100, v100, v80
  v_add_f32 v101, v101, v104
  v_mul_f32 v101, v101, v81
  v_add_f32 v102, v102, v104
  v_mul_f32 v102, v102, v82
  v_add_f32 v103, v103, v104
  v_mul_f32 v103, v103, v83
  v_cvt_pk_bf16_f32 v94, v100, v101
  v_cvt_pk_bf16_f32 v95, v102, v103
IF_135_end:
  s_waitcnt vmcnt(10)
  v_mfma_f32_16x16x32_bf16 v[60:63], v[24:27], v[134:137], v[60:63]
  ds_write_b128 v106, v[44:47] offset:0
  v_mfma_f32_16x16x32_bf16 v[64:67], v[24:27], v[138:141], v[64:67]
  ds_write_b128 v106, v[48:51] offset:1024
  v_mfma_f32_16x16x32_bf16 v[68:71], v[24:27], v[142:145], v[68:71]
  ds_write_b128 v106, v[52:55] offset:2048
  v_mfma_f32_16x16x32_bf16 v[72:75], v[24:27], v[146:149], v[72:75]
  ds_write_b128 v106, v[56:59] offset:3072
  buffer_load_dwordx4 v[24:27], v114, s[44:47], s74 offen offset:1024 sc1
  s_waitcnt vmcnt(10)
  v_mfma_f32_16x16x32_bf16 v[60:63], v[28:31], v[150:153], v[60:63]
  v_mfma_f32_16x16x32_bf16 v[64:67], v[28:31], v[154:157], v[64:67]
  v_mfma_f32_16x16x32_bf16 v[68:71], v[28:31], v[158:161], v[68:71]
  v_mfma_f32_16x16x32_bf16 v[72:75], v[28:31], v[162:165], v[72:75]
  s_add_u32 s74, s65, s78
  buffer_load_dwordx4 v[28:31], v114, s[44:47], s74 offen offset:0 sc1
  s_waitcnt lgkmcnt(0)
  s_barrier
  s_waitcnt vmcnt(10)
  v_mfma_f32_16x16x32_bf16 v[60:63], v[32:35], v[166:169], v[60:63]
  v_mfma_f32_16x16x32_bf16 v[64:67], v[32:35], v[170:173], v[64:67]
  v_mfma_f32_16x16x32_bf16 v[68:71], v[32:35], v[174:177], v[68:71]
  v_mfma_f32_16x16x32_bf16 v[72:75], v[32:35], v[178:181], v[72:75]
  buffer_load_dwordx4 v[32:35], v114, s[44:47], s74 offen offset:1024 sc1
  s_waitcnt vmcnt(10)
  v_mfma_f32_16x16x32_bf16 v[60:63], v[36:39], v[182:185], v[60:63]
  v_mfma_f32_16x16x32_bf16 v[64:67], v[36:39], v[186:189], v[64:67]
  v_mfma_f32_16x16x32_bf16 v[68:71], v[36:39], v[190:193], v[68:71]
  v_mfma_f32_16x16x32_bf16 v[72:75], v[36:39], v[194:197], v[72:75]
  s_add_u32 s74, s65, s79
  buffer_load_dwordx4 v[36:39], v114, s[44:47], s74 offen offset:0 sc1
  s_cmp_lt_u32 s55, 4
  s_cbranch_scc1 IF_136_end
  ds_read_b128 v[100:103], v107 offset:0
  ds_read_b128 v[76:79], v107 offset:4096
  ds_read_b128 v[80:83], v107 offset:8192
IF_136_end:
  s_waitcnt vmcnt(9)
  v_mfma_f32_16x16x32_bf16 v[60:63], v[40:43], v[198:201], v[60:63]
  v_mfma_f32_16x16x32_bf16 v[64:67], v[40:43], v[202:205], v[64:67]
  v_mfma_f32_16x16x32_bf16 v[68:71], v[40:43], v[206:209], v[68:71]
  v_mfma_f32_16x16x32_bf16 v[72:75], v[40:43], v[210:213], v[72:75]
  buffer_load_dwordx4 v[40:43], v114, s[44:47], s74 offen offset:1024 sc1
  s_cmp_lt_u32 s55, 4
  s_cbranch_scc1 IF_137_end
  s_waitcnt lgkmcnt(1)
  v_add_f32 v100, v100, v76
  v_add_f32 v101, v101, v77
  v_add_f32 v102, v102, v78
  v_add_f32 v103, v103, v79
  s_waitcnt lgkmcnt(0)
  v_add_f32 v100, v100, v80
  v_add_f32 v101, v101, v81
  v_add_f32 v102, v102, v82
  v_add_f32 v103, v103, v83
  ds_read_b128 v[76:79], v107 offset:12288
  ds_read_b128 v[80:83], v107 offset:16384
IF_137_end:
  s_waitcnt vmcnt(9)
  v_mfma_f32_16x16x32_bf16 v[60:63], v[4:7], v[214:217], v[60:63]
  v_mfma_f32_16x16x32_bf16 v[64:67], v[4:7], v[218:221], v[64:67]
  v_mfma_f32_16x16x32_bf16 v[68:71], v[4:7], v[222:225], v[68:71]
  v_mfma_f32_16x16x32_bf16 v[72:75], v[4:7], v[226:229], v[72:75]
  s_add_u32 s65, s65, 65536
  s_add_u32 s74, s65, s76
  buffer_load_dwordx4 v[4:7], v114, s[44:47], s74 offen offset:0 sc1
  s_cmp_lt_u32 s55, 4
  s_cbranch_scc1 IF_138_end
  s_waitcnt lgkmcnt(1)
  v_add_f32 v100, v100, v76
  v_add_f32 v101, v101, v77
  v_add_f32 v102, v102, v78
  v_add_f32 v103, v103, v79
  s_waitcnt lgkmcnt(0)
  v_add_f32 v100, v100, v80
  v_add_f32 v101, v101, v81
  v_add_f32 v102, v102, v82
  v_add_f32 v103, v103, v83
  ds_read_b128 v[76:79], v107 offset:20480
  ds_read_b128 v[80:83], v107 offset:24576
IF_138_end:
  s_waitcnt vmcnt(9)
  v_mfma_f32_16x16x32_bf16 v[60:63], v[8:11], v[230:233], v[60:63]
  v_mfma_f32_16x16x32_bf16 v[64:67], v[8:11], v[234:237], v[64:67]
  v_mfma_f32_16x16x32_bf16 v[68:71], v[8:11], v[238:241], v[68:71]
  v_mfma_f32_16x16x32_bf16 v[72:75], v[8:11], v[242:245], v[72:75]
  buffer_load_dwordx4 v[8:11], v114, s[44:47], s74 offen offset:1024 sc1
  s_cmp_lt_u32 s55, 4
  s_cbranch_scc1 IF_139_end
  s_waitcnt lgkmcnt(1)
  v_add_f32 v100, v100, v76
  v_add_f32 v101, v101, v77
  v_add_f32 v102, v102, v78
  v_add_f32 v103, v103, v79
  s_waitcnt lgkmcnt(0)
  v_add_f32 v100, v100, v80
  v_add_f32 v101, v101, v81
  v_add_f32 v102, v102, v82
  v_add_f32 v103, v103, v83
  ds_read_b128 v[76:79], v107 offset:28672
  v_lshlrev_b32 v80, 16, v88
  v_and_b32 v81, s57, v88
  v_lshlrev_b32 v82, 16, v89
  v_and_b32 v83, s57, v89
IF_139_end:
  s_waitcnt vmcnt(9)
  v_mfma_f32_16x16x32_bf16 v[44:47], v[12:15], v[118:121], 0
  v_mfma_f32_16x16x32_bf16 v[48:51], v[12:15], v[122:125], 0
  v_mfma_f32_16x16x32_bf16 v[52:55], v[12:15], v[126:129], 0
  v_mfma_f32_16x16x32_bf16 v[56:59], v[12:15], v[130:133], 0
  s_add_u32 s74, s65, s77
  buffer_load_dwordx4 v[12:15], v114, s[44:47], s74 offen offset:0 sc1
  s_cmp_lt_u32 s55, 4
  s_cbranch_scc1 IF_140_end
  s_waitcnt lgkmcnt(0)
  v_add_f32 v100, v100, v76
  v_add_f32 v101, v101, v77
  v_add_f32 v102, v102, v78
  v_add_f32 v103, v103, v79
  v_add_f32 v100, v100, v104
  v_mul_f32 v100, v100, v80
  v_add_f32 v101, v101, v104
  v_mul_f32 v101, v101, v81
  v_add_f32 v102, v102, v104
  v_mul_f32 v102, v102, v82
  v_add_f32 v103, v103, v104
  v_mul_f32 v103, v103, v83
  v_cvt_pk_bf16_f32 v96, v100, v101
  v_cvt_pk_bf16_f32 v97, v102, v103
IF_140_end:
  s_waitcnt vmcnt(9)
  v_mfma_f32_16x16x32_bf16 v[44:47], v[16:19], v[134:137], v[44:47]
  ds_write_b128 v106, v[60:63] offset:32768
  v_mfma_f32_16x16x32_bf16 v[48:51], v[16:19], v[138:141], v[48:51]
  ds_write_b128 v106, v[64:67] offset:33792
  v_mfma_f32_16x16x32_bf16 v[52:55], v[16:19], v[142:145], v[52:55]
  ds_write_b128 v106, v[68:71] offset:34816
  v_mfma_f32_16x16x32_bf16 v[56:59], v[16:19], v[146:149], v[56:59]
  ds_write_b128 v106, v[72:75] offset:35840
  buffer_load_dwordx4 v[16:19], v114, s[44:47], s74 offen offset:1024 sc1
  s_waitcnt vmcnt(9)
  v_mfma_f32_16x16x32_bf16 v[44:47], v[20:23], v[150:153], v[44:47]
  v_mfma_f32_16x16x32_bf16 v[48:51], v[20:23], v[154:157], v[48:51]
  v_mfma_f32_16x16x32_bf16 v[52:55], v[20:23], v[158:161], v[52:55]
  v_mfma_f32_16x16x32_bf16 v[56:59], v[20:23], v[162:165], v[56:59]
  s_add_u32 s74, s65, s78
  buffer_load_dwordx4 v[20:23], v114, s[44:47], s74 offen offset:0 sc1
  s_waitcnt lgkmcnt(0)
  s_barrier
  s_waitcnt vmcnt(9)
  v_mfma_f32_16x16x32_bf16 v[44:47], v[24:27], v[166:169], v[44:47]
  v_mfma_f32_16x16x32_bf16 v[48:51], v[24:27], v[170:173], v[48:51]
  v_mfma_f32_16x16x32_bf16 v[52:55], v[24:27], v[174:177], v[52:55]
  v_mfma_f32_16x16x32_bf16 v[56:59], v[24:27], v[178:181], v[56:59]
  buffer_load_dwordx4 v[24:27], v114, s[44:47], s74 offen offset:1024 sc1
  s_waitcnt vmcnt(9)
  v_mfma_f32_16x16x32_bf16 v[44:47], v[28:31], v[182:185], v[44:47]
  v_mfma_f32_16x16x32_bf16 v[48:51], v[28:31], v[186:189], v[48:51]
  v_mfma_f32_16x16x32_bf16 v[52:55], v[28:31], v[190:193], v[52:55]
  v_mfma_f32_16x16x32_bf16 v[56:59], v[28:31], v[194:197], v[56:59]
  s_add_u32 s74, s65, s79
  buffer_load_dwordx4 v[28:31], v114, s[44:47], s74 offen offset:0 sc1
  s_cmp_lt_u32 s55, 4
  s_cbranch_scc1 IF_141_end
  ds_read_b128 v[100:103], v107 offset:32768
  ds_read_b128 v[76:79], v107 offset:36864
  ds_read_b128 v[80:83], v107 offset:40960
IF_141_end:
  s_waitcnt vmcnt(9)
  v_mfma_f32_16x16x32_bf16 v[44:47], v[32:35], v[198:201], v[44:47]
  v_mfma_f32_16x16x32_bf16 v[48:51], v[32:35], v[202:205], v[48:51]
  v_mfma_f32_16x16x32_bf16 v[52:55], v[32:35], v[206:209], v[52:55]
  v_mfma_f32_16x16x32_bf16 v[56:59], v[32:35], v[210:213], v[56:59]
  buffer_load_dwordx4 v[32:35], v114, s[44:47], s74 offen offset:1024 sc1
  s_cmp_lt_u32 s55, 4
  s_cbranch_scc1 IF_142_end
  s_waitcnt lgkmcnt(1)
  v_add_f32 v100, v100, v76
  v_add_f32 v101, v101, v77
  v_add_f32 v102, v102, v78
  v_add_f32 v103, v103, v79
  s_waitcnt lgkmcnt(0)
  v_add_f32 v100, v100, v80
  v_add_f32 v101, v101, v81
  v_add_f32 v102, v102, v82
  v_add_f32 v103, v103, v83
  ds_read_b128 v[76:79], v107 offset:45056
  ds_read_b128 v[80:83], v107 offset:49152
IF_142_end:
  s_waitcnt vmcnt(9)
  v_mfma_f32_16x16x32_bf16 v[44:47], v[36:39], v[214:217], v[44:47]
  v_mfma_f32_16x16x32_bf16 v[48:51], v[36:39], v[218:221], v[48:51]
  v_mfma_f32_16x16x32_bf16 v[52:55], v[36:39], v[222:225], v[52:55]
  v_mfma_f32_16x16x32_bf16 v[56:59], v[36:39], v[226:229], v[56:59]
  s_add_u32 s65, s65, 65536
  s_cmp_lt_u32 s53, 6
  s_cselect_b32 s65, s65, 2147483648
  s_add_u32 s74, s65, s76
  buffer_load_dwordx4 v[36:39], v114, s[44:47], s74 offen offset:0 sc1
  s_cmp_lt_u32 s55, 4
  s_cbranch_scc1 IF_143_end
  s_waitcnt lgkmcnt(1)
  v_add_f32 v100, v100, v76
  v_add_f32 v101, v101, v77
  v_add_f32 v102, v102, v78
  v_add_f32 v103, v103, v79
  s_waitcnt lgkmcnt(0)
  v_add_f32 v100, v100, v80
  v_add_f32 v101, v101, v81
  v_add_f32 v102, v102, v82
  v_add_f32 v103, v103, v83
  ds_read_b128 v[76:79], v107 offset:53248
  ds_read_b128 v[80:83], v107 offset:57344
IF_143_end:
  s_waitcnt vmcnt(9)
  v_mfma_f32_16x16x32_bf16 v[44:47], v[40:43], v[230:233], v[44:47]
  v_mfma_f32_16x16x32_bf16 v[48:51], v[40:43], v[234:237], v[48:51]
  v_mfma_f32_16x16x32_bf16 v[52:55], v[40:43], v[238:241], v[52:55]
  v_mfma_f32_16x16x32_bf16 v[56:59], v[40:43], v[242:245], v[56:59]
  buffer_load_dwordx4 v[40:43], v114, s[44:47], s74 offen offset:1024 sc1
  s_cmp_lt_u32 s55, 4
  s_cbranch_scc1 IF_144_end
  s_waitcnt lgkmcnt(1)
  v_add_f32 v100, v100, v76
  v_add_f32 v101, v101, v77
  v_add_f32 v102, v102, v78
  v_add_f32 v103, v103, v79
  s_waitcnt lgkmcnt(0)
  v_add_f32 v100, v100, v80
  v_add_f32 v101, v101, v81
  v_add_f32 v102, v102, v82
  v_add_f32 v103, v103, v83
  ds_read_b128 v[76:79], v107 offset:61440
  v_lshlrev_b32 v80, 16, v90
  v_and_b32 v81, s57, v90
  v_lshlrev_b32 v82, 16, v91
  v_and_b32 v83, s57, v91
IF_144_end:
  s_waitcnt vmcnt(9)
  v_mfma_f32_16x16x32_bf16 v[60:63], v[4:7], v[118:121], 0
  v_mfma_f32_16x16x32_bf16 v[64:67], v[4:7], v[122:125], 0
  v_mfma_f32_16x16x32_bf16 v[68:71], v[4:7], v[126:129], 0
  v_mfma_f32_16x16x32_bf16 v[72:75], v[4:7], v[130:133], 0
  s_add_u32 s74, s65, s77
  buffer_load_dwordx4 v[4:7], v114, s[44:47], s74 offen offset:0 sc1
  s_cmp_lt_u32 s55, 4
  s_cbranch_scc1 IF_145_end
  s_waitcnt lgkmcnt(0)
  v_add_f32 v100, v100, v76
  v_add_f32 v101, v101, v77
  v_add_f32 v102, v102, v78
  v_add_f32 v103, v103, v79
  v_add_f32 v100, v100, v104
  v_mul_f32 v100, v100, v80
  v_add_f32 v101, v101, v104
  v_mul_f32 v101, v101, v81
  v_add_f32 v102, v102, v104
  v_mul_f32 v102, v102, v82
  v_add_f32 v103, v103, v104
  v_mul_f32 v103, v103, v83
  v_cvt_pk_bf16_f32 v98, v100, v101
  v_cvt_pk_bf16_f32 v99, v102, v103
  buffer_store_dwordx4 v[92:95], v114, s[44:47], s70 offen
  buffer_store_dwordx4 v[96:99], v114, s[44:47], s70 offen offset:1024
IF_145_end:
  s_waitcnt vmcnt(9)
  v_mfma_f32_16x16x32_bf16 v[60:63], v[8:11], v[134:137], v[60:63]
  ds_write_b128 v106, v[44:47] offset:0
  v_mfma_f32_16x16x32_bf16 v[64:67], v[8:11], v[138:141], v[64:67]
  ds_write_b128 v106, v[48:51] offset:1024
  v_mfma_f32_16x16x32_bf16 v[68:71], v[8:11], v[142:145], v[68:71]
  ds_write_b128 v106, v[52:55] offset:2048
  v_mfma_f32_16x16x32_bf16 v[72:75], v[8:11], v[146:149], v[72:75]
  ds_write_b128 v106, v[56:59] offset:3072
  buffer_load_dwordx4 v[8:11], v114, s[44:47], s74 offen offset:1024 sc1
  s_waitcnt vmcnt(9)
  v_mfma_f32_16x16x32_bf16 v[60:63], v[12:15], v[150:153], v[60:63]
  v_mfma_f32_16x16x32_bf16 v[64:67], v[12:15], v[154:157], v[64:67]
  v_mfma_f32_16x16x32_bf16 v[68:71], v[12:15], v[158:161], v[68:71]
  v_mfma_f32_16x16x32_bf16 v[72:75], v[12:15], v[162:165], v[72:75]
  s_add_u32 s74, s65, s78
  buffer_load_dwordx4 v[12:15], v114, s[44:47], s74 offen offset:0 sc1
  s_waitcnt lgkmcnt(0)
  s_barrier
  s_waitcnt vmcnt(9)
  v_mfma_f32_16x16x32_bf16 v[60:63], v[16:19], v[166:169], v[60:63]
  v_mfma_f32_16x16x32_bf16 v[64:67], v[16:19], v[170:173], v[64:67]
  v_mfma_f32_16x16x32_bf16 v[68:71], v[16:19], v[174:177], v[68:71]
  v_mfma_f32_16x16x32_bf16 v[72:75], v[16:19], v[178:181], v[72:75]
  buffer_load_dwordx4 v[16:19], v114, s[44:47], s74 offen offset:1024 sc1
  s_waitcnt vmcnt(9)
  v_mfma_f32_16x16x32_bf16 v[60:63], v[20:23], v[182:185], v[60:63]
  v_mfma_f32_16x16x32_bf16 v[64:67], v[20:23], v[186:189], v[64:67]
  v_mfma_f32_16x16x32_bf16 v[68:71], v[20:23], v[190:193], v[68:71]
  v_mfma_f32_16x16x32_bf16 v[72:75], v[20:23], v[194:197], v[72:75]
  s_add_u32 s74, s65, s79
  buffer_load_dwordx4 v[20:23], v114, s[44:47], s74 offen offset:0 sc1
  s_cmp_lt_u32 s55, 4
  s_cbranch_scc0 IF_146_else
  ds_read_b128 v[100:103], v107 offset:0
  ds_read_b128 v[76:79], v107 offset:4096
  ds_read_b128 v[80:83], v107 offset:8192
IF_146_else:
  s_waitcnt vmcnt(9)
  v_mfma_f32_16x16x32_bf16 v[60:63], v[24:27], v[198:201], v[60:63]
  v_mfma_f32_16x16x32_bf16 v[64:67], v[24:27], v[202:205], v[64:67]
  v_mfma_f32_16x16x32_bf16 v[68:71], v[24:27], v[206:209], v[68:71]
  v_mfma_f32_16x16x32_bf16 v[72:75], v[24:27], v[210:213], v[72:75]
  buffer_load_dwordx4 v[24:27], v114, s[44:47], s74 offen offset:1024 sc1
  s_cmp_lt_u32 s55, 4
  s_cbranch_scc0 IF_147_else
  s_waitcnt lgkmcnt(1)
  v_add_f32 v100, v100, v76
  v_add_f32 v101, v101, v77
  v_add_f32 v102, v102, v78
  v_add_f32 v103, v103, v79
  s_waitcnt lgkmcnt(0)
  v_add_f32 v100, v100, v80
  v_add_f32 v101, v101, v81
  v_add_f32 v102, v102, v82
  v_add_f32 v103, v103, v83
  ds_read_b128 v[76:79], v107 offset:12288
  ds_read_b128 v[80:83], v107 offset:16384
IF_147_else:
  s_waitcnt vmcnt(9)
  v_mfma_f32_16x16x32_bf16 v[60:63], v[28:31], v[214:217], v[60:63]
  v_mfma_f32_16x16x32_bf16 v[64:67], v[28:31], v[218:221], v[64:67]
  v_mfma_f32_16x16x32_bf16 v[68:71], v[28:31], v[222:225], v[68:71]
  v_mfma_f32_16x16x32_bf16 v[72:75], v[28:31], v[226:229], v[72:75]
  s_cmp_lt_u32 s55, 4
  s_cbranch_scc0 IF_148_else
  s_waitcnt lgkmcnt(1)
  v_add_f32 v100, v100, v76
  v_add_f32 v101, v101, v77
  v_add_f32 v102, v102, v78
  v_add_f32 v103, v103, v79
  s_waitcnt lgkmcnt(0)
  v_add_f32 v100, v100, v80
  v_add_f32 v101, v101, v81
  v_add_f32 v102, v102, v82
  v_add_f32 v103, v103, v83
  ds_read_b128 v[76:79], v107 offset:20480
  ds_read_b128 v[80:83], v107 offset:24576
IF_148_else:
  s_waitcnt vmcnt(8)
  v_mfma_f32_16x16x32_bf16 v[60:63], v[32:35], v[230:233], v[60:63]
  v_mfma_f32_16x16x32_bf16 v[64:67], v[32:35], v[234:237], v[64:67]
  v_mfma_f32_16x16x32_bf16 v[68:71], v[32:35], v[238:241], v[68:71]
  v_mfma_f32_16x16x32_bf16 v[72:75], v[32:35], v[242:245], v[72:75]
  s_cmp_lt_u32 s55, 4
  s_cbranch_scc0 IF_149_else
  s_waitcnt lgkmcnt(1)
  v_add_f32 v100, v100, v76
  v_add_f32 v101, v101, v77
  v_add_f32 v102, v102, v78
  v_add_f32 v103, v103, v79
  s_waitcnt lgkmcnt(0)
  v_add_f32 v100, v100, v80
  v_add_f32 v101, v101, v81
  v_add_f32 v102, v102, v82
  v_add_f32 v103, v103, v83
  ds_read_b128 v[76:79], v107 offset:28672
  v_lshlrev_b32 v80, 16, v84
  v_and_b32 v81, s57, v84
  v_lshlrev_b32 v82, 16, v85
  v_and_b32 v83, s57, v85
IF_149_else:
  s_waitcnt vmcnt(7)
  v_mfma_f32_16x16x32_bf16 v[44:47], v[36:39], v[118:121], 0
  v_mfma_f32_16x16x32_bf16 v[48:51], v[36:39], v[122:125], 0
  v_mfma_f32_16x16x32_bf16 v[52:55], v[36:39], v[126:129], 0
  v_mfma_f32_16x16x32_bf16 v[56:59], v[36:39], v[130:133], 0
  s_cmp_lt_u32 s55, 4
  s_cbranch_scc0 IF_150_else
  s_waitcnt lgkmcnt(0)
  v_add_f32 v100, v100, v76
  v_add_f32 v101, v101, v77
  v_add_f32 v102, v102, v78
  v_add_f32 v103, v103, v79
  v_add_f32 v100, v100, v104
  v_mul_f32 v100, v100, v80
  v_add_f32 v101, v101, v104
  v_mul_f32 v101, v101, v81
  v_add_f32 v102, v102, v104
  v_mul_f32 v102, v102, v82
  v_add_f32 v103, v103, v104
  v_mul_f32 v103, v103, v83
  v_cvt_pk_bf16_f32 v92, v100, v101
  v_cvt_pk_bf16_f32 v93, v102, v103
IF_150_else:
  s_waitcnt vmcnt(6)
  v_mfma_f32_16x16x32_bf16 v[44:47], v[40:43], v[134:137], v[44:47]
  ds_write_b128 v106, v[60:63] offset:32768
  v_mfma_f32_16x16x32_bf16 v[48:51], v[40:43], v[138:141], v[48:51]
  ds_write_b128 v106, v[64:67] offset:33792
  v_mfma_f32_16x16x32_bf16 v[52:55], v[40:43], v[142:145], v[52:55]
  ds_write_b128 v106, v[68:71] offset:34816
  v_mfma_f32_16x16x32_bf16 v[56:59], v[40:43], v[146:149], v[56:59]
  ds_write_b128 v106, v[72:75] offset:35840
  s_waitcnt vmcnt(5)
  v_mfma_f32_16x16x32_bf16 v[44:47], v[4:7], v[150:153], v[44:47]
  v_mfma_f32_16x16x32_bf16 v[48:51], v[4:7], v[154:157], v[48:51]
  v_mfma_f32_16x16x32_bf16 v[52:55], v[4:7], v[158:161], v[52:55]
  v_mfma_f32_16x16x32_bf16 v[56:59], v[4:7], v[162:165], v[56:59]
  s_waitcnt lgkmcnt(0)
  s_barrier
  s_waitcnt vmcnt(4)
  v_mfma_f32_16x16x32_bf16 v[44:47], v[8:11], v[166:169], v[44:47]
  v_mfma_f32_16x16x32_bf16 v[48:51], v[8:11], v[170:173], v[48:51]
  v_mfma_f32_16x16x32_bf16 v[52:55], v[8:11], v[174:177], v[52:55]
  v_mfma_f32_16x16x32_bf16 v[56:59], v[8:11], v[178:181], v[56:59]
  s_waitcnt vmcnt(3)
  v_mfma_f32_16x16x32_bf16 v[44:47], v[12:15], v[182:185], v[44:47]
  v_mfma_f32_16x16x32_bf16 v[48:51], v[12:15], v[186:189], v[48:51]
  v_mfma_f32_16x16x32_bf16 v[52:55], v[12:15], v[190:193], v[52:55]
  v_mfma_f32_16x16x32_bf16 v[56:59], v[12:15], v[194:197], v[56:59]
  s_cmp_lt_u32 s55, 4
  s_cbranch_scc0 IF_151_else
  ds_read_b128 v[100:103], v107 offset:32768
  ds_read_b128 v[76:79], v107 offset:36864
  ds_read_b128 v[80:83], v107 offset:40960
IF_151_else:
  s_cmp_lt_u32 s55, 4
  s_cbranch_scc1 IF_152_end
  s_lshl_b32 s63, s72, 7
  s_add_u32 s63, s63, 1441792
  v_mov_b32 v2, s54
  v_lshlrev_b32 v3, 26, v1
  v_and_b32 v3, 2147483648, v3
  v_lshl_or_b32 v3, v1, 2, v3
  buffer_store_dword v2, v3, s[44:47], s63 offen
IF_152_end:
  s_waitcnt vmcnt(2)
  v_mfma_f32_16x16x32_bf16 v[44:47], v[16:19], v[198:201], v[44:47]
  v_mfma_f32_16x16x32_bf16 v[48:51], v[16:19], v[202:205], v[48:51]
  v_mfma_f32_16x16x32_bf16 v[52:55], v[16:19], v[206:209], v[52:55]
  v_mfma_f32_16x16x32_bf16 v[56:59], v[16:19], v[210:213], v[56:59]
  s_cmp_lt_u32 s55, 4
  s_cbranch_scc0 IF_153_else
  s_waitcnt lgkmcnt(1)
  v_add_f32 v100, v100, v76
  v_add_f32 v101, v101, v77
  v_add_f32 v102, v102, v78
  v_add_f32 v103, v103, v79
  s_waitcnt lgkmcnt(0)
  v_add_f32 v100, v100, v80
  v_add_f32 v101, v101, v81
  v_add_f32 v102, v102, v82
  v_add_f32 v103, v103, v83
  ds_read_b128 v[76:79], v107 offset:45056
  ds_read_b128 v[80:83], v107 offset:49152
IF_153_else:
  s_waitcnt vmcnt(1)
  v_mfma_f32_16x16x32_bf16 v[44:47], v[20:23], v[214:217], v[44:47]
  v_mfma_f32_16x16x32_bf16 v[48:51], v[20:23], v[218:221], v[48:51]
  v_mfma_f32_16x16x32_bf16 v[52:55], v[20:23], v[222:225], v[52:55]
  v_mfma_f32_16x16x32_bf16 v[56:59], v[20:23], v[226:229], v[56:59]
  s_cmp_lt_u32 s55, 4
  s_cbranch_scc0 IF_154_else
  s_waitcnt lgkmcnt(1)
  v_add_f32 v100, v100, v76
  v_add_f32 v101, v101, v77
  v_add_f32 v102, v102, v78
  v_add_f32 v103, v103, v79
  s_waitcnt lgkmcnt(0)
  v_add_f32 v100, v100, v80
  v_add_f32 v101, v101, v81
  v_add_f32 v102, v102, v82
  v_add_f32 v103, v103, v83
  ds_read_b128 v[76:79], v107 offset:53248
  ds_read_b128 v[80:83], v107 offset:57344
IF_154_else:
  s_waitcnt vmcnt(0)
  v_mfma_f32_16x16x32_bf16 v[44:47], v[24:27], v[230:233], v[44:47]
  v_mfma_f32_16x16x32_bf16 v[48:51], v[24:27], v[234:237], v[48:51]
  v_mfma_f32_16x16x32_bf16 v[52:55], v[24:27], v[238:241], v[52:55]
  v_mfma_f32_16x16x32_bf16 v[56:59], v[24:27], v[242:245], v[56:59]
  s_cmp_lt_u32 s55, 4
  s_cbranch_scc0 IF_155_else
  s_waitcnt lgkmcnt(1)
  v_add_f32 v100, v100, v76
  v_add_f32 v101, v101, v77
  v_add_f32 v102, v102, v78
  v_add_f32 v103, v103, v79
  s_waitcnt lgkmcnt(0)
  v_add_f32 v100, v100, v80
  v_add_f32 v101, v101, v81
  v_add_f32 v102, v102, v82
  v_add_f32 v103, v103, v83
  ds_read_b128 v[76:79], v107 offset:61440
  v_lshlrev_b32 v80, 16, v86
  v_and_b32 v81, s57, v86
  v_lshlrev_b32 v82, 16, v87
  v_and_b32 v83, s57, v87
IF_155_else:
  s_cmp_lt_u32 s55, 4
  s_cbranch_scc0 IF_156_else
  s_waitcnt lgkmcnt(0)
  v_add_f32 v100, v100, v76
  v_add_f32 v101, v101, v77
  v_add_f32 v102, v102, v78
  v_add_f32 v103, v103, v79
  v_add_f32 v100, v100, v104
  v_mul_f32 v100, v100, v80
  v_add_f32 v101, v101, v104
  v_mul_f32 v101, v101, v81
  v_add_f32 v102, v102, v104
  v_mul_f32 v102, v102, v82
  v_add_f32 v103, v103, v104
  v_mul_f32 v103, v103, v83
  v_cvt_pk_bf16_f32 v94, v100, v101
  v_cvt_pk_bf16_f32 v95, v102, v103
IF_156_else:
  s_nop 0
  ds_write_b128 v106, v[44:47] offset:0
  ds_write_b128 v106, v[48:51] offset:1024
  ds_write_b128 v106, v[52:55] offset:2048
  ds_write_b128 v106, v[56:59] offset:3072
  s_waitcnt lgkmcnt(0)
  s_barrier
  s_cmp_lt_u32 s55, 4
  s_cbranch_scc0 IF_162_else
  v_and_b32 v108, 7, v1
  v_lshlrev_b32 v108, 8, v108
  s_lshl_b32 s75, s66, 11
  s_add_u32 s75, s75, 1441792
  v_mov_b32 v243, v108
  buffer_load_dword v244, v243, s[44:47], s75 offen offset:0 sc1
  ds_read_b128 v[4:7], v107 offset:0
  ds_read_b128 v[8:11], v107 offset:4096
  ds_read_b128 v[12:15], v107 offset:8192
  ds_read_b128 v[16:19], v107 offset:12288
  ds_read_b128 v[20:23], v107 offset:16384
  ds_read_b128 v[24:27], v107 offset:20480
  ds_read_b128 v[28:31], v107 offset:24576
  ds_read_b128 v[32:35], v107 offset:28672
  v_lshlrev_b32 v80, 16, v88
  v_and_b32 v81, s57, v88
  v_lshlrev_b32 v82, 16, v89
  v_and_b32 v83, s57, v89
  s_waitcnt lgkmcnt(6)
  v_pk_add_f32 v[4:5], v[4:5], v[8:9]
  v_pk_add_f32 v[6:7], v[6:7], v[10:11]
  s_waitcnt lgkmcnt(4)
  v_pk_add_f32 v[12:13], v[12:13], v[16:17]
  v_pk_add_f32 v[14:15], v[14:15], v[18:19]
  s_waitcnt lgkmcnt(2)
  v_pk_add_f32 v[20:21], v[20:21], v[24:25]
  v_pk_add_f32 v[22:23], v[22:23], v[26:27]
  s_waitcnt lgkmcnt(0)
  v_pk_add_f32 v[28:29], v[28:29], v[32:33]
  v_pk_add_f32 v[30:31], v[30:31], v[34:35]
  v_pk_add_f32 v[4:5], v[4:5], v[12:13]
  v_pk_add_f32 v[6:7], v[6:7], v[14:15]
  v_pk_add_f32 v[20:21], v[20:21], v[28:29]
  v_pk_add_f32 v[22:23], v[22:23], v[30:31]
  v_pk_add_f32 v[4:5], v[4:5], v[20:21]
  v_pk_add_f32 v[6:7], v[6:7], v[22:23]
  v_add_f32 v4, v4, v104
  v_mul_f32 v4, v4, v80
  v_add_f32 v5, v5, v104
  v_mul_f32 v5, v5, v81
  v_add_f32 v6, v6, v104
  v_mul_f32 v6, v6, v82
  v_add_f32 v7, v7, v104
  v_mul_f32 v7, v7, v83
  v_cvt_pk_bf16_f32 v96, v4, v5
  v_cvt_pk_bf16_f32 v97, v6, v7
  buffer_store_dwordx4 v[92:95], v114, s[44:47], s70 offen offset:2048
  buffer_store_dwordx2 v[96:97], v115, s[44:47], s71 offen
  s_barrier
  v_mov_b32 v239, v114
  v_mov_b32 v238, v115
  v_add_u32 v240, 23552, v239
  v_add_u32 v241, 84992, v239
  v_add_u32 v242, 146432, v239
  s_lshr_b32 s65, s59, 1
  s_lshl_b32 s65, s65, 5
  s_and_b32 s63, s59, 1
  s_lshl_b32 s63, s63, 2
  s_add_u32 s65, s65, s63
  s_lshl_b32 s63, s52, 6
  s_add_u32 s65, s65, s63
  v_bfe_u32 v235, v1, 2, 2
  v_and_b32 v2, 3, v1
  v_lshl_add_u32 v235, v235, 3, v2
  v_add_u32 v235, s65, v235
  v_mul_u32_u24 v235, 1280, v235
  v_lshrrev_b32 v2, 4, v1
  v_lshl_add_u32 v235, v2, 3, v235
  s_mul_i32 s63, s53, 5
  s_and_b32 s63, s63, 3
  s_lshl_b32 s63, s63, 6
  s_add_u32 s63, s63, 161792
  v_and_b32 v234, 48, v1
  v_add_u32 v234, s63, v234
  ds_read_b128 v[212:215], v234 offset:1536
  ds_read_b128 v[216:219], v234 offset:1600
  ds_read_b128 v[220:223], v234 offset:1664
  ds_read_b128 v[224:227], v234 offset:1728
  ds_read_b128 v[228:231], v234 offset:1792
  ds_read_b128 v[112:115], v240 offset:46080
  ds_read_b128 v[116:119], v240 offset:47104
  ds_read_b128 v[120:123], v240 offset:48128
  ds_read_b128 v[124:127], v240 offset:49152
  ds_read_b128 v[128:131], v240 offset:50176
  ds_read_b128 v[132:135], v240 offset:51200
  ds_read_b128 v[136:139], v240 offset:52224
  ds_read_b128 v[140:143], v240 offset:53248
  ds_read_b128 v[144:147], v240 offset:54272
  ds_read_b128 v[148:151], v240 offset:55296
  ds_read_b128 v[152:155], v241 offset:0
  ds_read_b128 v[156:159], v241 offset:1024
  ds_read_b128 v[160:163], v241 offset:2048
  ds_read_b128 v[164:167], v241 offset:3072
  ds_read_b128 v[168:171], v241 offset:4096
  s_waitcnt vmcnt(2)
  v_cmp_ne_u32 vcc, s54, v244
  s_cbranch_vccz IF_158_else
  s_mov_b32 s58, 1048576
LP_157:
  s_sleep 2
  buffer_load_dword v244, v243, s[44:47], s75 offen offset:0 sc1
  s_waitcnt vmcnt(0)
  v_cmp_ne_u32 vcc, s54, v244
  s_sub_u32 s58, s58, 1
  s_cselect_b64 vcc, 0, vcc
  s_cbranch_vccnz LP_157
IF_158_else:
  s_add_u32 s65, s69, 8192
  buffer_load_dwordx4 v[4:7], v239, s[44:47], s65 offen offset:1024 sc1
  buffer_load_dwordx4 v[8:11], v239, s[44:47], s65 offen offset:2048 sc1
  s_add_u32 s65, s69, 12288
  buffer_load_dwordx4 v[12:15], v239, s[44:47], s65 offen offset:0 sc1
  buffer_load_dwordx4 v[16:19], v239, s[44:47], s65 offen offset:1024 sc1
  s_lshl_b32 s63, s72, 7
  s_add_u32 s63, s63, 1441792
  v_mov_b32 v2, s54
  v_lshlrev_b32 v3, 26, v1
  v_and_b32 v3, 2147483648, v3
  v_lshl_or_b32 v3, v1, 2, v3
  s_waitcnt vmcnt(4)
  buffer_store_dword v2, v3, s[44:47], s63 offen
  s_waitcnt vmcnt(4) lgkmcnt(14)
  v_mfma_f32_16x16x32_bf16 v[192:195], v[112:115], v[4:7], 0
  ds_read_b128 v[172:175], v241 offset:5120
  s_waitcnt lgkmcnt(14)
  v_mfma_f32_16x16x32_bf16 v[196:199], v[116:119], v[4:7], 0
  ds_read_b128 v[176:179], v241 offset:6144
  s_add_u32 s65, s69, 12288
  buffer_load_dwordx4 v[20:23], v239, s[44:47], s65 offen offset:3072 sc1
  s_waitcnt lgkmcnt(14)
  v_mfma_f32_16x16x32_bf16 v[200:203], v[120:123], v[4:7], 0
  ds_read_b128 v[180:183], v241 offset:7168
  s_waitcnt lgkmcnt(14)
  v_mfma_f32_16x16x32_bf16 v[204:207], v[124:127], v[4:7], 0
  ds_read_b128 v[184:187], v241 offset:8192
  s_add_u32 s65, s69, 16384
  buffer_load_dwordx4 v[24:27], v239, s[44:47], s65 offen offset:0 sc1
  s_waitcnt lgkmcnt(14)
  v_mfma_f32_16x16x32_bf16 v[208:211], v[128:131], v[4:7], 0
  ds_read_b128 v[188:191], v241 offset:9216
  s_waitcnt vmcnt(5) lgkmcnt(14)
  v_mfma_f32_16x16x32_bf16 v[192:195], v[132:135], v[8:11], v[192:195]
  ds_read_b128 v[112:115], v241 offset:15360
  s_waitcnt lgkmcnt(14)
  v_mfma_f32_16x16x32_bf16 v[196:199], v[136:139], v[8:11], v[196:199]
  ds_read_b128 v[116:119], v241 offset:16384
  s_add_u32 s65, s69, 16384
  buffer_load_dwordx4 v[28:31], v239, s[44:47], s65 offen offset:2048 sc1
  s_waitcnt lgkmcnt(14)
  v_mfma_f32_16x16x32_bf16 v[200:203], v[140:143], v[8:11], v[200:203]
  ds_read_b128 v[120:123], v241 offset:17408
  s_waitcnt lgkmcnt(14)
  v_mfma_f32_16x16x32_bf16 v[204:207], v[144:147], v[8:11], v[204:207]
  ds_read_b128 v[124:127], v241 offset:18432
  buffer_load_dwordx4 v[32:35], v239, s[44:47], s65 offen offset:3072 sc1
  s_waitcnt lgkmcnt(14)
  v_mfma_f32_16x16x32_bf16 v[208:211], v[148:151], v[8:11], v[208:211]
  ds_read_b128 v[128:131], v241 offset:19456
  s_waitcnt vmcnt(6) lgkmcnt(14)
  v_mfma_f32_16x16x32_bf16 v[192:195], v[152:155], v[12:15], v[192:195]
  ds_read_b128 v[132:135], v241 offset:20480
  s_waitcnt lgkmcnt(14)
  v_mfma_f32_16x16x32_bf16 v[196:199], v[156:159], v[12:15], v[196:199]
  ds_read_b128 v[136:139], v241 offset:21504
  s_add_u32 s65, s69, 20480
  buffer_load_dwordx4 v[36:39], v239, s[44:47], s65 offen offset:1024 sc1
  s_waitcnt lgkmcnt(14)
  v_mfma_f32_16x16x32_bf16 v[200:203], v[160:163], v[12:15], v[200:203]
  ds_read_b128 v[140:143], v241 offset:22528
  s_waitcnt lgkmcnt(14)
  v_mfma_f32_16x16x32_bf16 v[204:207], v[164:167], v[12:15], v[204:207]
  ds_read_b128 v[144:147], v241 offset:23552
  buffer_load_dwordx4 v[40:43], v239, s[44:47], s65 offen offset:2048 sc1
  s_waitcnt lgkmcnt(14)
  v_mfma_f32_16x16x32_bf16 v[208:211], v[168:171], v[12:15], v[208:211]
  ds_read_b128 v[148:151], v241 offset:24576
  s_waitcnt vmcnt(7) lgkmcnt(14)
  v_mfma_f32_16x16x32_bf16 v[192:195], v[172:175], v[16:19], v[192:195]
  ds_read_b128 v[152:155], v241 offset:30720
  s_waitcnt lgkmcnt(14)
  v_mfma_f32_16x16x32_bf16 v[196:199], v[176:179], v[16:19], v[196:199]
  ds_read_b128 v[156:159], v241 offset:31744
  s_add_u32 s65, s69, 0
  buffer_load_dwordx4 v[44:47], v239, s[44:47], s65 offen offset:0 sc1
  s_waitcnt lgkmcnt(14)
  v_mfma_f32_16x16x32_bf16 v[200:203], v[180:183], v[16:19], v[200:203]
  ds_read_b128 v[160:163], v241 offset:32768
  s_waitcnt lgkmcnt(14)
  v_mfma_f32_16x16x32_bf16 v[204:207], v[184:187], v[16:19], v[204:207]
  ds_read_b128 v[164:167], v241 offset:33792
  buffer_load_dwordx4 v[48:51], v239, s[44:47], s65 offen offset:1024 sc1
  s_waitcnt lgkmcnt(14)
  v_mfma_f32_16x16x32_bf16 v[208:211], v[188:191], v[16:19], v[208:211]
  ds_read_b128 v[168:171], v241 offset:34816
  s_waitcnt vmcnt(7) lgkmcnt(14)
  v_mfma_f32_16x16x32_bf16 v[192:195], v[112:115], v[20:23], v[192:195]
  ds_read_b128 v[172:175], v241 offset:35840
  s_waitcnt lgkmcnt(14)
  v_mfma_f32_16x16x32_bf16 v[196:199], v[116:119], v[20:23], v[196:199]
  ds_read_b128 v[176:179], v241 offset:36864
  s_add_u32 s65, s69, 0
  buffer_load_dwordx4 v[52:55], v239, s[44:47], s65 offen offset:3072 sc1
  s_waitcnt lgkmcnt(14)
  v_mfma_f32_16x16x32_bf16 v[200:203], v[120:123], v[20:23], v[200:203]
  ds_read_b128 v[180:183], v241 offset:37888
  s_waitcnt lgkmcnt(14)
  v_mfma_f32_16x16x32_bf16 v[204:207], v[124:127], v[20:23], v[204:207]
  ds_read_b128 v[184:187], v241 offset:38912
  s_add_u32 s65, s69, 4096
  buffer_load_dwordx4 v[56:59], v239, s[44:47], s65 offen offset:0 sc1
  s_waitcnt lgkmcnt(14)
  v_mfma_f32_16x16x32_bf16 v[208:211], v[128:131], v[20:23], v[208:211]
  ds_read_b128 v[188:191], v241 offset:39936
  s_waitcnt vmcnt(8) lgkmcnt(14)
  v_mfma_f32_16x16x32_bf16 v[192:195], v[132:135], v[24:27], v[192:195]
  ds_read_b128 v[112:115], v241 offset:46080
  s_waitcnt lgkmcnt(14)
  v_mfma_f32_16x16x32_bf16 v[196:199], v[136:139], v[24:27], v[196:199]
  ds_read_b128 v[116:119], v241 offset:47104
  s_add_u32 s65, s69, 4096
  buffer_load_dwordx4 v[60:63], v239, s[44:47], s65 offen offset:2048 sc1
  s_waitcnt lgkmcnt(14)
  v_mfma_f32_16x16x32_bf16 v[200:203], v[140:143], v[24:27], v[200:203]
  ds_read_b128 v[120:123], v241 offset:48128
  s_waitcnt lgkmcnt(14)
  v_mfma_f32_16x16x32_bf16 v[204:207], v[144:147], v[24:27], v[204:207]
  ds_read_b128 v[124:127], v241 offset:49152
  s_waitcnt lgkmcnt(14)
  v_mfma_f32_16x16x32_bf16 v[208:211], v[148:151], v[24:27], v[208:211]
  ds_read_b128 v[128:131], v241 offset:50176
  s_waitcnt vmcnt(8) lgkmcnt(14)
  v_mfma_f32_16x16x32_bf16 v[192:195], v[152:155], v[28:31], v[192:195]
  ds_read_b128 v[132:135], v241 offset:51200
  s_waitcnt lgkmcnt(14)
  v_mfma_f32_16x16x32_bf16 v[196:199], v[156:159], v[28:31], v[196:199]
  ds_read_b128 v[136:139], v241 offset:52224
  buffer_load_dwordx4 v[64:67], v239, s[44:47], s65 offen offset:3072 sc1
  s_waitcnt lgkmcnt(14)
  v_mfma_f32_16x16x32_bf16 v[200:203], v[160:163], v[28:31], v[200:203]
  ds_read_b128 v[140:143], v241 offset:53248
  s_waitcnt lgkmcnt(14)
  v_mfma_f32_16x16x32_bf16 v[204:207], v[164:167], v[28:31], v[204:207]
  ds_read_b128 v[144:147], v241 offset:54272
  s_waitcnt lgkmcnt(14)
  v_mfma_f32_16x16x32_bf16 v[208:211], v[168:171], v[28:31], v[208:211]
  ds_read_b128 v[148:151], v241 offset:55296
  s_barrier
  s_waitcnt vmcnt(8) lgkmcnt(14)
  v_mfma_f32_16x16x32_bf16 v[192:195], v[172:175], v[32:35], v[192:195]
  ds_read_b128 v[152:155], v240 offset:0
  s_waitcnt lgkmcnt(14)
  v_mfma_f32_16x16x32_bf16 v[196:199], v[176:179], v[32:35], v[196:199]
  ds_read_b128 v[156:159], v240 offset:1024
  s_waitcnt lgkmcnt(14)
  v_mfma_f32_16x16x32_bf16 v[200:203], v[180:183], v[32:35], v[200:203]
  ds_read_b128 v[160:163], v240 offset:2048
  s_waitcnt lgkmcnt(14)
  v_mfma_f32_16x16x32_bf16 v[204:207], v[184:187], v[32:35], v[204:207]
  ds_read_b128 v[164:167], v240 offset:3072
  s_waitcnt lgkmcnt(14)
  v_mfma_f32_16x16x32_bf16 v[208:211], v[188:191], v[32:35], v[208:211]
  ds_read_b128 v[168:171], v240 offset:4096
  s_waitcnt vmcnt(7) lgkmcnt(14)
  v_mfma_f32_16x16x32_bf16 v[192:195], v[112:115], v[36:39], v[192:195]
  ds_read_b128 v[172:175], v240 offset:5120
  s_waitcnt lgkmcnt(14)
  v_mfma_f32_16x16x32_bf16 v[196:199], v[116:119], v[36:39], v[196:199]
  ds_read_b128 v[176:179], v240 offset:6144
  s_waitcnt lgkmcnt(14)
  v_mfma_f32_16x16x32_bf16 v[200:203], v[120:123], v[36:39], v[200:203]
  ds_read_b128 v[180:183], v240 offset:7168
  s_waitcnt lgkmcnt(14)
  v_mfma_f32_16x16x32_bf16 v[204:207], v[124:127], v[36:39], v[204:207]
  ds_read_b128 v[184:187], v240 offset:8192
  s_waitcnt lgkmcnt(14)
  v_mfma_f32_16x16x32_bf16 v[208:211], v[128:131], v[36:39], v[208:211]
  ds_read_b128 v[188:191], v240 offset:9216
  buffer_load_dword v244, v243, s[44:47], s75 offen offset:128 sc1
  s_waitcnt vmcnt(7) lgkmcnt(14)
  v_mfma_f32_16x16x32_bf16 v[192:195], v[132:135], v[40:43], v[192:195]
  ds_read_b128 v[112:115], v240 offset:15360
  s_waitcnt lgkmcnt(14)
  v_mfma_f32_16x16x32_bf16 v[196:199], v[136:139], v[40:43], v[196:199]
  ds_read_b128 v[116:119], v240 offset:16384
  s_waitcnt lgkmcnt(14)
  v_mfma_f32_16x16x32_bf16 v[200:203], v[140:143], v[40:43], v[200:203]
  ds_read_b128 v[120:123], v240 offset:17408
  s_waitcnt lgkmcnt(14)
  v_mfma_f32_16x16x32_bf16 v[204:207], v[144:147], v[40:43], v[204:207]
  ds_read_b128 v[124:127], v240 offset:18432
  s_waitcnt lgkmcnt(14)
  v_mfma_f32_16x16x32_bf16 v[208:211], v[148:151], v[40:43], v[208:211]
  ds_read_b128 v[128:131], v240 offset:19456
  s_waitcnt vmcnt(6) lgkmcnt(14)
  v_mfma_f32_16x16x32_bf16 v[192:195], v[152:155], v[44:47], v[192:195]
  ds_read_b128 v[132:135], v240 offset:20480
  s_waitcnt lgkmcnt(14)
  v_mfma_f32_16x16x32_bf16 v[196:199], v[156:159], v[44:47], v[196:199]
  ds_read_b128 v[136:139], v240 offset:21504
  s_waitcnt lgkmcnt(14)
  v_mfma_f32_16x16x32_bf16 v[200:203], v[160:163], v[44:47], v[200:203]
  ds_read_b128 v[140:143], v240 offset:22528
  s_waitcnt lgkmcnt(14)
  v_mfma_f32_16x16x32_bf16 v[204:207], v[164:167], v[44:47], v[204:207]
  ds_read_b128 v[144:147], v240 offset:23552
  s_waitcnt lgkmcnt(14)
  v_mfma_f32_16x16x32_bf16 v[208:211], v[168:171], v[44:47], v[208:211]
  ds_read_b128 v[148:151], v240 offset:24576
  s_waitcnt vmcnt(0)
  v_cmp_ne_u32 vcc, s54, v244
  s_cbranch_vccz IF_160_else
  s_mov_b32 s58, 1048576
LP_159:
  s_sleep 2
  buffer_load_dword v244, v243, s[44:47], s75 offen offset:128 sc1
  s_waitcnt vmcnt(0)
  v_cmp_ne_u32 vcc, s54, v244
  s_sub_u32 s58, s58, 1
  s_cselect_b64 vcc, 0, vcc
  s_cbranch_vccnz LP_159
IF_160_else:
  s_waitcnt lgkmcnt(14)
  v_mfma_f32_16x16x32_bf16 v[192:195], v[172:175], v[48:51], v[192:195]
  ds_read_b128 v[152:155], v240 offset:30720
  s_waitcnt lgkmcnt(14)
  v_mfma_f32_16x16x32_bf16 v[196:199], v[176:179], v[48:51], v[196:199]
  ds_read_b128 v[156:159], v240 offset:31744
  s_add_u32 s65, s69, 8192
  buffer_load_dwordx4 v[68:71], v239, s[44:47], s65 offen offset:3072 sc1
  s_waitcnt lgkmcnt(14)
  v_mfma_f32_16x16x32_bf16 v[200:203], v[180:183], v[48:51], v[200:203]
  ds_read_b128 v[160:163], v240 offset:32768
  s_waitcnt lgkmcnt(14)
  v_mfma_f32_16x16x32_bf16 v[204:207], v[184:187], v[48:51], v[204:207]
  ds_read_b128 v[164:167], v240 offset:33792
  s_add_u32 s65, s69, 12288
  buffer_load_dwordx4 v[72:75], v239, s[44:47], s65 offen offset:2048 sc1
  s_waitcnt lgkmcnt(14)
  v_mfma_f32_16x16x32_bf16 v[208:211], v[188:191], v[48:51], v[208:211]
  ds_read_b128 v[168:171], v240 offset:34816
  s_waitcnt lgkmcnt(14)
  v_mfma_f32_16x16x32_bf16 v[192:195], v[112:115], v[52:55], v[192:195]
  ds_read_b128 v[172:175], v240 offset:35840
  s_waitcnt lgkmcnt(14)
  v_mfma_f32_16x16x32_bf16 v[196:199], v[116:119], v[52:55], v[196:199]
  ds_read_b128 v[176:179], v240 offset:36864
  s_add_u32 s65, s69, 16384
  buffer_load_dwordx4 v[76:79], v239, s[44:47], s65 offen offset:1024 sc1
  s_waitcnt lgkmcnt(14)
  v_mfma_f32_16x16x32_bf16 v[200:203], v[120:123], v[52:55], v[200:203]
  ds_read_b128 v[180:183], v240 offset:37888
  s_waitcnt lgkmcnt(14)
  v_mfma_f32_16x16x32_bf16 v[204:207], v[124:127], v[52:55], v[204:207]
  ds_read_b128 v[184:187], v240 offset:38912
  s_add_u32 s65, s69, 20480
  buffer_load_dwordx4 v[80:83], v239, s[44:47], s65 offen offset:0 sc1
  s_waitcnt lgkmcnt(14)
  v_mfma_f32_16x16x32_bf16 v[208:211], v[128:131], v[52:55], v[208:211]
  ds_read_b128 v[188:191], v240 offset:39936
  s_waitcnt lgkmcnt(14)
  v_mfma_f32_16x16x32_bf16 v[192:195], v[132:135], v[56:59], v[192:195]
  ds_read_b128 v[112:115], v240 offset:56320
  s_waitcnt lgkmcnt(14)
  v_mfma_f32_16x16x32_bf16 v[196:199], v[136:139], v[56:59], v[196:199]
  ds_read_b128 v[116:119], v240 offset:57344
  s_add_u32 s65, s69, 20480
  buffer_load_dwordx4 v[84:87], v239, s[44:47], s65 offen offset:3072 sc1
  s_waitcnt lgkmcnt(14)
  v_mfma_f32_16x16x32_bf16 v[200:203], v[140:143], v[56:59], v[200:203]
  ds_read_b128 v[120:123], v240 offset:58368
  s_waitcnt lgkmcnt(14)
  v_mfma_f32_16x16x32_bf16 v[204:207], v[144:147], v[56:59], v[204:207]
  ds_read_b128 v[124:127], v240 offset:59392
  s_add_u32 s65, s69, 24576
  buffer_load_dwordx2 v[88:89], v238, s[44:47], s65 offen offset:0 sc1
  buffer_load_dwordx2 v[90:91], v238, s[44:47], s65 offen offset:512 sc1
  s_waitcnt lgkmcnt(14)
  v_mfma_f32_16x16x32_bf16 v[208:211], v[148:151], v[56:59], v[208:211]
  ds_read_b128 v[128:131], v240 offset:60416
  s_waitcnt lgkmcnt(14)
  v_mfma_f32_16x16x32_bf16 v[192:195], v[152:155], v[60:63], v[192:195]
  ds_read_b128 v[132:135], v241 offset:10240
  s_waitcnt lgkmcnt(14)
  v_mfma_f32_16x16x32_bf16 v[196:199], v[156:159], v[60:63], v[196:199]
  ds_read_b128 v[136:139], v241 offset:11264
  buffer_load_dwordx2 v[92:93], v238, s[44:47], s65 offen offset:1024 sc1
  buffer_load_dwordx2 v[94:95], v238, s[44:47], s65 offen offset:1536 sc1
  s_waitcnt lgkmcnt(14)
  v_mfma_f32_16x16x32_bf16 v[200:203], v[160:163], v[60:63], v[200:203]
  ds_read_b128 v[140:143], v241 offset:12288
  s_waitcnt lgkmcnt(14)
  v_mfma_f32_16x16x32_bf16 v[204:207], v[164:167], v[60:63], v[204:207]
  ds_read_b128 v[144:147], v241 offset:13312
  buffer_load_dwordx2 v[96:97], v238, s[44:47], s65 offen offset:2048 sc1
  buffer_load_dwordx2 v[98:99], v238, s[44:47], s65 offen offset:2560 sc1
  s_waitcnt lgkmcnt(14)
  v_mfma_f32_16x16x32_bf16 v[208:211], v[168:171], v[60:63], v[208:211]
  ds_read_b128 v[148:151], v241 offset:14336
  s_waitcnt lgkmcnt(14)
  v_mfma_f32_16x16x32_bf16 v[192:195], v[172:175], v[64:67], v[192:195]
  ds_read_b128 v[152:155], v241 offset:25600
  s_waitcnt lgkmcnt(14)
  v_mfma_f32_16x16x32_bf16 v[196:199], v[176:179], v[64:67], v[196:199]
  ds_read_b128 v[156:159], v241 offset:26624
  s_add_u32 s65, s69, 0
  buffer_load_dwordx4 v[100:103], v239, s[44:47], s65 offen offset:2048 sc1
  s_waitcnt lgkmcnt(14)
  v_mfma_f32_16x16x32_bf16 v[200:203], v[180:183], v[64:67], v[200:203]
  ds_read_b128 v[160:163], v241 offset:27648
  s_waitcnt lgkmcnt(14)
  v_mfma_f32_16x16x32_bf16 v[204:207], v[184:187], v[64:67], v[204:207]
  ds_read_b128 v[164:167], v241 offset:28672
  s_waitcnt lgkmcnt(14)
  v_mfma_f32_16x16x32_bf16 v[208:211], v[188:191], v[64:67], v[208:211]
  ds_read_b128 v[168:171], v241 offset:29696
  s_waitcnt vmcnt(11) lgkmcnt(14)
  v_mfma_f32_16x16x32_bf16 v[192:195], v[112:115], v[68:71], v[192:195]
  ds_read_b128 v[172:175], v241 offset:40960
  s_waitcnt lgkmcnt(14)
  v_mfma_f32_16x16x32_bf16 v[196:199], v[116:119], v[68:71], v[196:199]
  ds_read_b128 v[176:179], v241 offset:41984
  s_add_u32 s65, s69, 4096
  buffer_load_dwordx4 v[104:107], v239, s[44:47], s65 offen offset:1024 sc1
  s_waitcnt lgkmcnt(14)
  v_mfma_f32_16x16x32_bf16 v[200:203], v[120:123], v[68:71], v[200:203]
  ds_read_b128 v[180:183], v241 offset:43008
  s_waitcnt lgkmcnt(14)
  v_mfma_f32_16x16x32_bf16 v[204:207], v[124:127], v[68:71], v[204:207]
  ds_read_b128 v[184:187], v241 offset:44032
  s_waitcnt lgkmcnt(14)
  v_mfma_f32_16x16x32_bf16 v[208:211], v[128:131], v[68:71], v[208:211]
  ds_read_b128 v[188:191], v241 offset:45056
  s_waitcnt vmcnt(11) lgkmcnt(14)
  v_mfma_f32_16x16x32_bf16 v[192:195], v[132:135], v[72:75], v[192:195]
  ds_read_b128 v[112:115], v241 offset:56320
  s_waitcnt lgkmcnt(14)
  v_mfma_f32_16x16x32_bf16 v[196:199], v[136:139], v[72:75], v[196:199]
  ds_read_b128 v[116:119], v241 offset:57344
  s_add_u32 s65, s69, 8192
  buffer_load_dwordx4 v[108:111], v239, s[44:47], s65 offen offset:0 sc1
  s_waitcnt lgkmcnt(14)
  v_mfma_f32_16x16x32_bf16 v[200:203], v[140:143], v[72:75], v[200:203]
  ds_read_b128 v[120:123], v241 offset:58368
  s_waitcnt lgkmcnt(14)
  v_mfma_f32_16x16x32_bf16 v[204:207], v[144:147], v[72:75], v[204:207]
  ds_read_b128 v[124:127], v241 offset:59392
  s_waitcnt lgkmcnt(14)
  v_mfma_f32_16x16x32_bf16 v[208:211], v[148:151], v[72:75], v[208:211]
  ds_read_b128 v[128:131], v241 offset:60416
  s_waitcnt vmcnt(11) lgkmcnt(14)
  v_mfma_f32_16x16x32_bf16 v[192:195], v[152:155], v[76:79], v[192:195]
  ds_read_b128 v[132:135], v242 offset:0
  s_waitcnt lgkmcnt(14)
  v_mfma_f32_16x16x32_bf16 v[196:199], v[156:159], v[76:79], v[196:199]
  ds_read_b128 v[136:139], v242 offset:1024
  s_waitcnt lgkmcnt(14)
  v_mfma_f32_16x16x32_bf16 v[200:203], v[160:163], v[76:79], v[200:203]
  ds_read_b128 v[140:143], v242 offset:2048
  s_waitcnt lgkmcnt(14)
  v_mfma_f32_16x16x32_bf16 v[204:207], v[164:167], v[76:79], v[204:207]
  ds_read_b128 v[144:147], v242 offset:3072
  s_waitcnt lgkmcnt(14)
  v_mfma_f32_16x16x32_bf16 v[208:211], v[168:171], v[76:79], v[208:211]
  ds_read_b128 v[148:151], v242 offset:4096
  s_barrier
  s_waitcnt vmcnt(10) lgkmcnt(14)
  v_mfma_f32_16x16x32_bf16 v[192:195], v[172:175], v[80:83], v[192:195]
  ds_read_b128 v[152:155], v242 offset:5120
  s_waitcnt lgkmcnt(14)
  v_mfma_f32_16x16x32_bf16 v[196:199], v[176:179], v[80:83], v[196:199]
  ds_read_b128 v[156:159], v242 offset:6144
  s_waitcnt lgkmcnt(14)
  v_mfma_f32_16x16x32_bf16 v[200:203], v[180:183], v[80:83], v[200:203]
  ds_read_b128 v[160:163], v242 offset:7168
  s_waitcnt lgkmcnt(14)
  v_mfma_f32_16x16x32_bf16 v[204:207], v[184:187], v[80:83], v[204:207]
  ds_read_b128 v[164:167], v242 offset:8192
  s_waitcnt lgkmcnt(14)
  v_mfma_f32_16x16x32_bf16 v[208:211], v[188:191], v[80:83], v[208:211]
  ds_read_b128 v[168:171], v242 offset:9216
  s_waitcnt vmcnt(9) lgkmcnt(14)
  v_mfma_f32_16x16x32_bf16 v[192:195], v[112:115], v[84:87], v[192:195]
  ds_read_b128 v[172:175], v242 offset:10240
  s_waitcnt lgkmcnt(14)
  v_mfma_f32_16x16x32_bf16 v[196:199], v[116:119], v[84:87], v[196:199]
  ds_read_b128 v[176:179], v242 offset:11264
  s_waitcnt lgkmcnt(14)
  v_mfma_f32_16x16x32_bf16 v[200:203], v[120:123], v[84:87], v[200:203]
  ds_read_b128 v[180:183], v242 offset:12288
  s_waitcnt lgkmcnt(14)
  v_mfma_f32_16x16x32_bf16 v[204:207], v[124:127], v[84:87], v[204:207]
  ds_read_b128 v[184:187], v242 offset:13312
  s_waitcnt lgkmcnt(14)
  v_mfma_f32_16x16x32_bf16 v[208:211], v[128:131], v[84:87], v[208:211]
  ds_read_b128 v[188:191], v242 offset:14336
  s_waitcnt vmcnt(7) lgkmcnt(14)
  v_mfma_f32_16x16x32_bf16 v[192:195], v[132:135], v[88:91], v[192:195]
  ds_read_b128 v[112:115], v240 offset:10240
  s_waitcnt lgkmcnt(14)
  v_mfma_f32_16x16x32_bf16 v[196:199], v[136:139], v[88:91], v[196:199]
  ds_read_b128 v[116:119], v240 offset:11264
  s_waitcnt lgkmcnt(14)
  v_mfma_f32_16x16x32_bf16 v[200:203], v[140:143], v[88:91], v[200:203]
  ds_read_b128 v[120:123], v240 offset:12288
  s_waitcnt lgkmcnt(14)
  v_mfma_f32_16x16x32_bf16 v[204:207], v[144:147], v[88:91], v[204:207]
  ds_read_b128 v[124:127], v240 offset:13312
  s_waitcnt lgkmcnt(14)
  v_mfma_f32_16x16x32_bf16 v[208:211], v[148:151], v[88:91], v[208:211]
  ds_read_b128 v[128:131], v240 offset:14336
  s_waitcnt vmcnt(5) lgkmcnt(14)
  v_mfma_f32_16x16x32_bf16 v[192:195], v[152:155], v[92:95], v[192:195]
  ds_read_b128 v[132:135], v240 offset:25600
  s_waitcnt lgkmcnt(14)
  v_mfma_f32_16x16x32_bf16 v[196:199], v[156:159], v[92:95], v[196:199]
  ds_read_b128 v[136:139], v240 offset:26624
  s_waitcnt lgkmcnt(14)
  v_mfma_f32_16x16x32_bf16 v[200:203], v[160:163], v[92:95], v[200:203]
  ds_read_b128 v[140:143], v240 offset:27648
  s_waitcnt lgkmcnt(14)
  v_mfma_f32_16x16x32_bf16 v[204:207], v[164:167], v[92:95], v[204:207]
  ds_read_b128 v[144:147], v240 offset:28672
  s_waitcnt lgkmcnt(14)
  v_mfma_f32_16x16x32_bf16 v[208:211], v[168:171], v[92:95], v[208:211]
  ds_read_b128 v[148:151], v240 offset:29696
  s_waitcnt vmcnt(3) lgkmcnt(14)
  v_mfma_f32_16x16x32_bf16 v[192:195], v[172:175], v[96:99], v[192:195]
  ds_read_b128 v[152:155], v240 offset:40960
  s_waitcnt lgkmcnt(14)
  v_mfma_f32_16x16x32_bf16 v[196:199], v[176:179], v[96:99], v[196:199]
  ds_read_b128 v[156:159], v240 offset:41984
  s_waitcnt lgkmcnt(14)
  v_mfma_f32_16x16x32_bf16 v[200:203], v[180:183], v[96:99], v[200:203]
  ds_read_b128 v[160:163], v240 offset:43008
  s_waitcnt lgkmcnt(14)
  v_mfma_f32_16x16x32_bf16 v[204:207], v[184:187], v[96:99], v[204:207]
  ds_read_b128 v[164:167], v240 offset:44032
  s_waitcnt lgkmcnt(14)
  v_mfma_f32_16x16x32_bf16 v[208:211], v[188:191], v[96:99], v[208:211]
  ds_read_b128 v[168:171], v240 offset:45056
  s_waitcnt vmcnt(2) lgkmcnt(14)
  v_mfma_f32_16x16x32_bf16 v[192:195], v[112:115], v[100:103], v[192:195]
  s_waitcnt lgkmcnt(13)
  v_mfma_f32_16x16x32_bf16 v[196:199], v[116:119], v[100:103], v[196:199]
  s_waitcnt lgkmcnt(12)
  v_mfma_f32_16x16x32_bf16 v[200:203], v[120:123], v[100:103], v[200:203]
  s_waitcnt lgkmcnt(11)
  v_mfma_f32_16x16x32_bf16 v[204:207], v[124:127], v[100:103], v[204:207]
  s_waitcnt lgkmcnt(10)
  v_mfma_f32_16x16x32_bf16 v[208:211], v[128:131], v[100:103], v[208:211]
  s_waitcnt vmcnt(1) lgkmcnt(9)
  v_mfma_f32_16x16x32_bf16 v[192:195], v[132:135], v[104:107], v[192:195]
  s_waitcnt lgkmcnt(8)
  v_mfma_f32_16x16x32_bf16 v[196:199], v[136:139], v[104:107], v[196:199]
  s_waitcnt lgkmcnt(7)
  v_mfma_f32_16x16x32_bf16 v[200:203], v[140:143], v[104:107], v[200:203]
  s_waitcnt lgkmcnt(6)
  v_mfma_f32_16x16x32_bf16 v[204:207], v[144:147], v[104:107], v[204:207]
  s_waitcnt lgkmcnt(5)
  v_mfma_f32_16x16x32_bf16 v[208:211], v[148:151], v[104:107], v[208:211]
  s_waitcnt vmcnt(0) lgkmcnt(4)
  v_mfma_f32_16x16x32_bf16 v[192:195], v[152:155], v[108:111], v[192:195]
  s_waitcnt lgkmcnt(3)
  v_mfma_f32_16x16x32_bf16 v[196:199], v[156:159], v[108:111], v[196:199]
  s_waitcnt lgkmcnt(2)
  v_mfma_f32_16x16x32_bf16 v[200:203], v[160:163], v[108:111], v[200:203]
  s_waitcnt lgkmcnt(1)
  v_mfma_f32_16x16x32_bf16 v[204:207], v[164:167], v[108:111], v[204:207]
  s_waitcnt lgkmcnt(0)
  v_mfma_f32_16x16x32_bf16 v[208:211], v[168:171], v[108:111], v[208:211]
  s_mul_i32 s65, s53, 160
  v_lshlrev_b32 v4, 16, v246
  v_and_b32 v5, s57, v246
  v_fmac_f32 v4, v212, v192
  v_fmac_f32 v5, v213, v193
  v_cvt_pk_bf16_f32 v30, v4, v5
  v_lshlrev_b32 v6, 16, v247
  v_and_b32 v7, s57, v247
  v_fmac_f32 v6, v214, v194
  v_fmac_f32 v7, v215, v195
  v_cvt_pk_bf16_f32 v31, v6, v7
  buffer_store_dwordx2 v[30:31], v235, s[40:43], s65 offen offset:0
  v_lshlrev_b32 v8, 16, v248
  v_and_b32 v9, s57, v248
  v_fmac_f32 v8, v216, v196
  v_fmac_f32 v9, v217, v197
  v_cvt_pk_bf16_f32 v32, v8, v9
  v_lshlrev_b32 v10, 16, v249
  v_and_b32 v11, s57, v249
  v_fmac_f32 v10, v218, v198
  v_fmac_f32 v11, v219, v199
  v_cvt_pk_bf16_f32 v33, v10, v11
  buffer_store_dwordx2 v[32:33], v235, s[40:43], s65 offen offset:32
  v_lshlrev_b32 v12, 16, v250
  v_and_b32 v13, s57, v250
  v_fmac_f32 v12, v220, v200
  v_fmac_f32 v13, v221, v201
  v_cvt_pk_bf16_f32 v34, v12, v13
  v_lshlrev_b32 v14, 16, v251
  v_and_b32 v15, s57, v251
  v_fmac_f32 v14, v222, v202
  v_fmac_f32 v15, v223, v203
  v_cvt_pk_bf16_f32 v35, v14, v15
  buffer_store_dwordx2 v[34:35], v235, s[40:43], s65 offen offset:64
  v_lshlrev_b32 v16, 16, v252
  v_and_b32 v17, s57, v252
  v_fmac_f32 v16, v224, v204
  v_fmac_f32 v17, v225, v205
  v_cvt_pk_bf16_f32 v36, v16, v17
  v_lshlrev_b32 v18, 16, v253
  v_and_b32 v19, s57, v253
  v_fmac_f32 v18, v226, v206
  v_fmac_f32 v19, v227, v207
  v_cvt_pk_bf16_f32 v37, v18, v19
  buffer_store_dwordx2 v[36:37], v235, s[40:43], s65 offen offset:96
  v_lshlrev_b32 v20, 16, v254
  v_and_b32 v21, s57, v254
  v_fmac_f32 v20, v228, v208
  v_fmac_f32 v21, v229, v209
  v_cvt_pk_bf16_f32 v38, v20, v21
  v_lshlrev_b32 v22, 16, v255
  v_and_b32 v23, s57, v255
  v_fmac_f32 v22, v230, v210
  v_fmac_f32 v23, v231, v211
  v_cvt_pk_bf16_f32 v39, v22, v23
  buffer_store_dwordx2 v[38:39], v235, s[40:43], s65 offen offset:128
  s_branch IF_162_end
IF_162_else:
  s_mov_b32 s74, 87040
  s_cmp_eq_u32 s59, 1
  s_cselect_b32 s74, 102400, s74
  s_cmp_eq_u32 s59, 2
  s_cselect_b32 s74, 117760, s74
  s_cmp_eq_u32 s59, 3
  s_cselect_b32 s74, 122880, s74
  s_mul_i32 s73, s53, 138240
  s_add_u32 s73, s74, s73
  s_add_u32 s63, s73, 24559616
  s_add_u32 m0, s74, 23552
  s_nop 0
  buffer_load_dwordx4 v114, s[44:47], s63 offen offset:0 sc1 lds
  s_add_u32 m0, s74, 23552
  s_nop 0
  buffer_load_dwordx4 v114, s[44:47], s63 offen offset:1024 sc1 lds
  s_add_u32 m0, s74, 23552
  s_nop 0
  buffer_load_dwordx4 v114, s[44:47], s63 offen offset:2048 sc1 lds
  s_add_u32 m0, s74, 23552
  s_nop 0
  buffer_load_dwordx4 v114, s[44:47], s63 offen offset:3072 sc1 lds
  s_add_u32 s63, s73, 24563712
  s_add_u32 m0, s74, 27648
  s_nop 0
  buffer_load_dwordx4 v114, s[44:47], s63 offen offset:0 sc1 lds
  s_barrier
  s_mov_b32 s74, 0
  s_cmp_eq_u32 s59, 1
  s_cselect_b32 s74, 5120, s74
  s_cmp_eq_u32 s59, 2
  s_cselect_b32 s74, 15360, s74
  s_cmp_eq_u32 s59, 3
  s_cselect_b32 s74, 20480, s74
  s_mul_i32 s73, s53, 138240
  s_add_u32 s73, s74, s73
  s_add_u32 s63, s73, 24559616
  s_add_u32 m0, s74, 23552
  s_nop 0
  buffer_load_dwordx4 v114, s[44:47], s63 offen offset:0 sc1 lds
  s_add_u32 m0, s74, 23552
  s_nop 0
  buffer_load_dwordx4 v114, s[44:47], s63 offen offset:1024 sc1 lds
  s_add_u32 m0, s74, 23552
  s_nop 0
  buffer_load_dwordx4 v114, s[44:47], s63 offen offset:2048 sc1 lds
  s_add_u32 m0, s74, 23552
  s_nop 0
  buffer_load_dwordx4 v114, s[44:47], s63 offen offset:3072 sc1 lds
  s_add_u32 s63, s73, 24563712
  s_add_u32 m0, s74, 27648
  s_nop 0
  buffer_load_dwordx4 v114, s[44:47], s63 offen offset:0 sc1 lds
  s_mov_b32 s74, 30720
  s_cmp_eq_u32 s59, 1
  s_cselect_b32 s74, 35840, s74
  s_cmp_eq_u32 s59, 2
  s_cselect_b32 s74, 10240, s74
  s_cmp_eq_u32 s59, 3
  s_cselect_b32 s74, 25600, s74
  s_mul_i32 s73, s53, 138240
  s_add_u32 s73, s74, s73
  s_add_u32 s63, s73, 24559616
  s_add_u32 m0, s74, 23552
  s_nop 0
  buffer_load_dwordx4 v114, s[44:47], s63 offen offset:0 sc1 lds
  s_add_u32 m0, s74, 23552
  s_nop 0
  buffer_load_dwordx4 v114, s[44:47], s63 offen offset:1024 sc1 lds
  s_add_u32 m0, s74, 23552
  s_nop 0
  buffer_load_dwordx4 v114, s[44:47], s63 offen offset:2048 sc1 lds
  s_add_u32 m0, s74, 23552
  s_nop 0
  buffer_load_dwordx4 v114, s[44:47], s63 offen offset:3072 sc1 lds
  s_add_u32 s63, s73, 24563712
  s_add_u32 m0, s74, 27648
  s_nop 0
  buffer_load_dwordx4 v114, s[44:47], s63 offen offset:0 sc1 lds
  s_waitcnt vmcnt(0)
  s_barrier
  s_mov_b32 s74, 40960
  s_cmp_eq_u32 s59, 1
  s_cselect_b32 s74, 128000, s74
  s_cmp_eq_u32 s59, 2
  s_cselect_b32 s74, 133120, s74
  s_mul_i32 s73, s53, 138240
  s_add_u32 s73, s74, s73
  s_cmp_lt_u32 s59, 3
  s_cbranch_scc0 IF_161_else
  s_add_u32 s63, s73, 24559616
  s_add_u32 m0, s74, 23552
  s_nop 0
  buffer_load_dwordx4 v114, s[44:47], s63 offen offset:0 sc1 lds
  s_add_u32 m0, s74, 23552
  s_nop 0
  buffer_load_dwordx4 v114, s[44:47], s63 offen offset:1024 sc1 lds
  s_add_u32 m0, s74, 23552
  s_nop 0
  buffer_load_dwordx4 v114, s[44:47], s63 offen offset:2048 sc1 lds
  s_add_u32 m0, s74, 23552
  s_nop 0
  buffer_load_dwordx4 v114, s[44:47], s63 offen offset:3072 sc1 lds
  s_add_u32 s63, s73, 24563712
  s_add_u32 m0, s74, 27648
  s_nop 0
  buffer_load_dwordx4 v114, s[44:47], s63 offen offset:0 sc1 lds
IF_161_else:
  s_waitcnt vmcnt(0)
  s_barrier
IF_162_end:
  s_cmp_eq_u32 s2, 0
  s_cbranch_scc0 IF_163_else
  v_mov_b32 v2, s54
  v_cmp_eq_u32 vcc, 0, v0
  v_mov_b32 v3, 2147483648
  s_nop 0
  v_cndmask_b32 v3, v3, 0, vcc
  buffer_store_dword v2, v3, s[44:47], 0 offen sc1
IF_163_else:
  s_endpgm
L_code_end:
  s_branch IF_238_end
IF_238_else:
  buffer_store_dwordx4 v[72:75], v24, s[44:47], s75 offen sc1
  buffer_store_dwordx2 v[76:77], v23, s[44:47], s74 offen offset:512 sc1
  s_cmp_lt_u32 s55, 4
  s_cbranch_scc0 IF_168_else
  s_lshr_b32 s65, s59, 1
  s_lshl_b32 s65, s65, 5
  s_and_b32 s63, s59, 1
  s_lshl_b32 s63, s63, 2
  s_add_u32 s65, s65, s63
  s_lshl_b32 s63, s52, 6
  s_add_u32 s65, s65, s63
  v_bfe_u32 v235, v1, 2, 2
  v_and_b32 v2, 3, v1
  v_lshl_add_u32 v235, v235, 3, v2
  v_add_u32 v235, s65, v235
  v_mul_u32_u24 v235, 1280, v235
  v_lshrrev_b32 v2, 4, v1
  v_lshl_add_u32 v235, v2, 3, v235
  s_mul_i32 s65, s53, 160
  buffer_load_dwordx2 v[224:225], v235, s[4:7], s65 offen offset:0
  buffer_load_dwordx2 v[226:227], v235, s[4:7], s65 offen offset:32
  buffer_load_dwordx2 v[228:229], v235, s[4:7], s65 offen offset:64
  buffer_load_dwordx2 v[230:231], v235, s[4:7], s65 offen offset:96
  buffer_load_dwordx2 v[232:233], v235, s[4:7], s65 offen offset:128
  s_waitcnt vmcnt(7)
  v_cmp_ne_u32 vcc, s54, v245
  s_cbranch_vccz IF_165_else
  s_mov_b32 s58, 1048576
LP_164:
  s_sleep 2
  buffer_load_dword v245, v246, s[44:47], s70 offen sc1
  s_waitcnt vmcnt(0)
  v_cmp_ne_u32 vcc, s54, v245
  s_sub_u32 s58, s58, 1
  s_cselect_b64 vcc, 0, vcc
  s_cbranch_vccnz LP_164
IF_165_else:
  s_mul_i32 s66, s59, 5120
  s_mul_i32 s67, s53, 102400
  s_add_u32 s67, s67, s66
  s_add_u32 s63, s67, 21446656
  s_add_u32 m0, s66, 62464
  s_nop 0
  buffer_load_dwordx4 v30, s[44:47], s63 offen offset:0 sc1 lds
  s_add_u32 m0, s66, 62464
  s_nop 0
  buffer_load_dwordx4 v30, s[44:47], s63 offen offset:1024 sc1 lds
  s_add_u32 m0, s66, 62464
  s_nop 0
  buffer_load_dwordx4 v30, s[44:47], s63 offen offset:2048 sc1 lds
  s_add_u32 m0, s66, 62464
  s_nop 0
  buffer_load_dwordx4 v30, s[44:47], s63 offen offset:3072 sc1 lds
  s_add_u32 s63, s67, 21450752
  s_add_u32 m0, s66, 66560
  s_nop 0
  buffer_load_dwordx4 v30, s[44:47], s63 offen offset:0 sc1 lds
  s_lshl_b32 s63, s73, 7
  s_add_u32 s63, s63, 393216
  v_mov_b32 v236, s54
  v_lshlrev_b32 v237, 26, v1
  v_and_b32 v237, 2147483648, v237
  v_lshl_or_b32 v237, v1, 2, v237
  s_waitcnt vmcnt(10)
  buffer_store_dword v236, v237, s[44:47], s63 offen sc1
  s_add_u32 s63, s67, 21467136
  s_add_u32 m0, s66, 82944
  s_nop 0
  buffer_load_dwordx4 v30, s[44:47], s63 offen offset:0 sc1 lds
  s_add_u32 m0, s66, 82944
  s_nop 0
  buffer_load_dwordx4 v30, s[44:47], s63 offen offset:1024 sc1 lds
  s_add_u32 m0, s66, 82944
  s_nop 0
  buffer_load_dwordx4 v30, s[44:47], s63 offen offset:2048 sc1 lds
  s_add_u32 m0, s66, 82944
  s_nop 0
  buffer_load_dwordx4 v30, s[44:47], s63 offen offset:3072 sc1 lds
  s_add_u32 s63, s67, 21471232
  s_add_u32 m0, s66, 87040
  s_nop 0
  buffer_load_dwordx4 v30, s[44:47], s63 offen offset:0 sc1 lds
  v_xor_b32 v188, s54, v83
  v_xor_b32 v189, s54, v87
  v_xor_b32 v190, s54, v91
  v_xor_b32 v191, s54, v95
  v_or3_b32 v188, v188, v189, v190
  v_or_b32 v188, v188, v191
  v_cmp_ne_u32 vcc, 0, v188
  s_cbranch_vccz IF_167_else
  s_mov_b32 s58, 1048576
LP_166:
  s_sleep 2
  s_mov_b32 s65, 4096
  buffer_load_dwordx4 v[80:83], v184, s[44:47], s65 offen offset:0 sc1
  buffer_load_dwordx4 v[84:87], v184, s[44:47], s65 offen offset:512 sc1
  buffer_load_dwordx4 v[88:91], v184, s[44:47], s65 offen offset:1024 sc1
  buffer_load_dwordx4 v[92:95], v184, s[44:47], s65 offen offset:1536 sc1
  s_waitcnt vmcnt(3)
  v_xor_b32 v188, s54, v83
  s_waitcnt vmcnt(2)
  v_xor_b32 v189, s54, v87
  s_waitcnt vmcnt(1)
  v_xor_b32 v190, s54, v91
  s_waitcnt vmcnt(0)
  v_xor_b32 v191, s54, v95
  v_or3_b32 v188, v188, v189, v190
  v_or_b32 v188, v188, v191
  v_cmp_ne_u32 vcc, 0, v188
  s_sub_u32 s58, s58, 1
  s_cselect_b64 vcc, 0, vcc
  s_cbranch_vccnz LP_166
IF_167_else:
  v_add_f32 v80, v80, v84
  v_add_f32 v88, v88, v92
  v_add_f32 v81, v81, v85
  v_add_f32 v89, v89, v93
  v_add_f32 v82, v82, v86
  v_add_f32 v90, v90, v94
  v_add_f32 v80, v80, v88
  v_add_f32 v81, v81, v89
  v_add_f32 v82, v82, v90
  v_cvt_pk_bf16_f32 v84, v80, v81
  v_cvt_pk_bf16_f32 v85, v82, v82
  v_lshlrev_b32 v80, 16, v84
  v_and_b32 v81, s57, v84
  v_lshlrev_b32 v82, 16, v85
  v_add_f32 v80, v80, v187
  v_add_f32 v81, v81, v187
  v_add_f32 v82, v82, v187
  v_cvt_pk_bf16_f32 v84, v80, v81
  v_cvt_pk_bf16_f32 v85, v82, v82
  v_lshlrev_b32 v80, 16, v84
  v_and_b32 v81, s57, v84
  v_lshlrev_b32 v82, 16, v85
  ds_write_b32 v185, v80
  ds_write2_b32 v186, v81, v82 offset0:1 offset1:2
  s_waitcnt vmcnt(0)
  s_branch IF_168_end
IF_168_else:
  s_lshl_b32 s63, s73, 7
  s_add_u32 s63, s63, 393216
  v_mov_b32 v236, s54
  v_lshlrev_b32 v237, 26, v1
  v_and_b32 v237, 2147483648, v237
  v_lshl_or_b32 v237, v1, 2, v237
  s_waitcnt vmcnt(0)
  buffer_store_dword v236, v237, s[44:47], s63 offen sc1
  s_setprio 0
  s_lshl_b32 s65, s56, 3
  s_add_u32 s65, s65, s53
  s_mul_i32 s65, s65, 20
  s_mul_i32 s70, s59, 7168
  s_mul_i32 s69, s65, 7168
  s_add_u32 s69, s69, s70
  s_add_u32 s65, s65, 160
  v_min_u32 v20, 19, v1
  v_lshlrev_b32 v20, 7, v20
  s_lshl_b32 s65, s65, 7
  s_add_u32 s71, s65, 2228224
  buffer_load_dword v21, v20, s[44:47], s71 offen sc1
IF_168_end:
  s_waitcnt lgkmcnt(0)
  s_barrier
  s_cmp_lt_u32 s55, 4
  s_cbranch_scc0 IF_185_else
  v_lshlrev_b32 v239, 4, v1
  v_add_u32 v237, 62464, v239
  v_add_u32 v238, 123904, v239
  s_lshl_b32 s66, s52, 2
  s_add_u32 s66, s66, s59
  s_mul_i32 s67, s66, 20480
  s_add_u32 s67, s67, 8257536
  ds_read_b128 v[144:147], v237 offset:0
  ds_read_b128 v[148:151], v237 offset:1024
  ds_read_b128 v[152:155], v237 offset:2048
  ds_read_b128 v[156:159], v237 offset:3072
  ds_read_b128 v[160:163], v237 offset:4096
  ds_read_b128 v[164:167], v237 offset:5120
  ds_read_b128 v[168:171], v237 offset:6144
  ds_read_b128 v[172:175], v237 offset:7168
  ds_read_b128 v[176:179], v237 offset:8192
  ds_read_b128 v[180:183], v237 offset:9216
  s_mul_i32 s63, s53, 5
  s_and_b32 s63, s63, 3
  s_lshl_b32 s63, s63, 6
  s_add_u32 s63, s63, 161792
  v_and_b32 v234, 48, v1
  v_add_u32 v234, s63, v234
  ds_read_b128 v[4:7], v234 offset:0
  ds_read_b128 v[8:11], v234 offset:64
  ds_read_b128 v[12:15], v234 offset:128
  ds_read_b128 v[16:19], v234 offset:192
  ds_read_b128 v[20:23], v234 offset:256
  ds_read_b128 v[24:27], v234 offset:512
  ds_read_b128 v[28:31], v234 offset:576
  ds_read_b128 v[32:35], v234 offset:640
  ds_read_b128 v[36:39], v234 offset:704
  ds_read_b128 v[40:43], v234 offset:768
  ds_read_b128 v[44:47], v234 offset:1024
  ds_read_b128 v[48:51], v234 offset:1088
  ds_read_b128 v[52:55], v234 offset:1152
  ds_read_b128 v[56:59], v234 offset:1216
  ds_read_b128 v[60:63], v234 offset:1280
  s_lshr_b32 s65, s66, 1
  s_lshl_b32 s65, s65, 5
  v_and_b32 v240, 31, v1
  v_lshlrev_b32 v240, 7, v240
  s_lshl_b32 s63, s65, 7
  s_add_u32 s63, s63, 393216
  buffer_load_dword v241, v240, s[44:47], s63 offen sc1
  s_waitcnt vmcnt(0)
  v_cmp_ne_u32 vcc, s54, v241
  s_cbranch_vccz IF_170_else
  s_mov_b32 s58, 1048576
LP_169:
  s_sleep 2
  buffer_load_dword v241, v240, s[44:47], s63 offen sc1
  s_waitcnt vmcnt(0)
  v_cmp_ne_u32 vcc, s54, v241
  s_sub_u32 s58, s58, 1
  s_cselect_b64 vcc, 0, vcc
  s_cbranch_vccnz LP_169
IF_170_else:
  buffer_load_dwordx4 v[64:67], v239, s[44:47], s67 offen offset:0 sc1
  buffer_load_dwordx4 v[68:71], v239, s[44:47], s67 offen offset:1024 sc1
  buffer_load_dwordx4 v[72:75], v239, s[44:47], s67 offen offset:2048 sc1
  buffer_load_dwordx4 v[76:79], v239, s[44:47], s67 offen offset:3072 sc1
  s_waitcnt vmcnt(3) lgkmcnt(15)
  v_mfma_f32_16x16x32_bf16 v[204:207], v[144:147], v[64:67], 0
  ds_read_b128 v[184:187], v237 offset:10240
  v_mfma_f32_16x16x32_bf16 v[208:211], v[148:151], v[64:67], 0
  ds_read_b128 v[188:191], v237 offset:11264
  s_add_u32 s67, s67, 4096
  buffer_load_dwordx4 v[80:83], v239, s[44:47], s67 offen offset:0 sc1
  v_mfma_f32_16x16x32_bf16 v[212:215], v[152:155], v[64:67], 0
  ds_read_b128 v[192:195], v237 offset:12288
  v_mfma_f32_16x16x32_bf16 v[216:219], v[156:159], v[64:67], 0
  ds_read_b128 v[196:199], v237 offset:13312
  buffer_load_dwordx4 v[84:87], v239, s[44:47], s67 offen offset:1024 sc1
  v_mfma_f32_16x16x32_bf16 v[220:223], v[160:163], v[64:67], 0
  ds_read_b128 v[200:203], v237 offset:14336
  s_waitcnt vmcnt(4)
  v_mfma_f32_16x16x32_bf16 v[204:207], v[164:167], v[68:71], v[204:207]
  ds_read_b128 v[144:147], v237 offset:15360
  v_mfma_f32_16x16x32_bf16 v[208:211], v[168:171], v[68:71], v[208:211]
  ds_read_b128 v[148:151], v237 offset:16384
  buffer_load_dwordx4 v[88:91], v239, s[44:47], s67 offen offset:2048 sc1
  v_mfma_f32_16x16x32_bf16 v[212:215], v[172:175], v[68:71], v[212:215]
  ds_read_b128 v[152:155], v237 offset:17408
  v_mfma_f32_16x16x32_bf16 v[216:219], v[176:179], v[68:71], v[216:219]
  ds_read_b128 v[156:159], v237 offset:18432
  buffer_load_dwordx4 v[92:95], v239, s[44:47], s67 offen offset:3072 sc1
  v_mfma_f32_16x16x32_bf16 v[220:223], v[180:183], v[68:71], v[220:223]
  ds_read_b128 v[160:163], v237 offset:19456
  s_waitcnt vmcnt(5) lgkmcnt(9)
  v_mfma_f32_16x16x32_bf16 v[204:207], v[184:187], v[72:75], v[204:207]
  ds_read_b128 v[164:167], v237 offset:20480
  s_waitcnt lgkmcnt(9)
  v_mfma_f32_16x16x32_bf16 v[208:211], v[188:191], v[72:75], v[208:211]
  ds_read_b128 v[168:171], v237 offset:21504
  s_add_u32 s67, s67, 4096
  buffer_load_dwordx4 v[96:99], v239, s[44:47], s67 offen offset:0 sc1
  s_waitcnt lgkmcnt(9)
  v_mfma_f32_16x16x32_bf16 v[212:215], v[192:195], v[72:75], v[212:215]
  ds_read_b128 v[172:175], v237 offset:22528
  s_waitcnt lgkmcnt(9)
  v_mfma_f32_16x16x32_bf16 v[216:219], v[196:199], v[72:75], v[216:219]
  ds_read_b128 v[176:179], v237 offset:23552
  buffer_load_dwordx4 v[100:103], v239, s[44:47], s67 offen offset:1024 sc1
  s_waitcnt lgkmcnt(9)
  v_mfma_f32_16x16x32_bf16 v[220:223], v[200:203], v[72:75], v[220:223]
  ds_read_b128 v[180:183], v237 offset:24576
  s_waitcnt vmcnt(6) lgkmcnt(9)
  v_mfma_f32_16x16x32_bf16 v[204:207], v[144:147], v[76:79], v[204:207]
  ds_read_b128 v[184:187], v237 offset:25600
  s_waitcnt lgkmcnt(9)
  v_mfma_f32_16x16x32_bf16 v[208:211], v[148:151], v[76:79], v[208:211]
  ds_read_b128 v[188:191], v237 offset:26624
  buffer_load_dwordx4 v[104:107], v239, s[44:47], s67 offen offset:2048 sc1
  s_waitcnt lgkmcnt(9)
  v_mfma_f32_16x16x32_bf16 v[212:215], v[152:155], v[76:79], v[212:215]
  ds_read_b128 v[192:195], v237 offset:27648
  s_waitcnt lgkmcnt(9)
  v_mfma_f32_16x16x32_bf16 v[216:219], v[156:159], v[76:79], v[216:219]
  ds_read_b128 v[196:199], v237 offset:28672
  buffer_load_dwordx4 v[108:111], v239, s[44:47], s67 offen offset:3072 sc1
  s_waitcnt lgkmcnt(9)
  v_mfma_f32_16x16x32_bf16 v[220:223], v[160:163], v[76:79], v[220:223]
  ds_read_b128 v[200:203], v237 offset:29696
  s_waitcnt vmcnt(7) lgkmcnt(9)
  v_mfma_f32_16x16x32_bf16 v[204:207], v[164:167], v[80:83], v[204:207]
  ds_read_b128 v[144:147], v237 offset:30720
  s_waitcnt lgkmcnt(9)
  v_mfma_f32_16x16x32_bf16 v[208:211], v[168:171], v[80:83], v[208:211]
  ds_read_b128 v[148:151], v237 offset:31744
  s_add_u32 s67, s67, 4096
  buffer_load_dwordx4 v[112:115], v239, s[44:47], s67 offen offset:0 sc1
  s_waitcnt lgkmcnt(9)
  v_mfma_f32_16x16x32_bf16 v[212:215], v[172:175], v[80:83], v[212:215]
  ds_read_b128 v[152:155], v237 offset:32768
  s_waitcnt lgkmcnt(9)
  v_mfma_f32_16x16x32_bf16 v[216:219], v[176:179], v[80:83], v[216:219]
  ds_read_b128 v[156:159], v237 offset:33792
  buffer_load_dwordx4 v[116:119], v239, s[44:47], s67 offen offset:1024 sc1
  s_waitcnt lgkmcnt(9)
  v_mfma_f32_16x16x32_bf16 v[220:223], v[180:183], v[80:83], v[220:223]
  ds_read_b128 v[160:163], v237 offset:34816
  s_waitcnt vmcnt(8) lgkmcnt(9)
  v_mfma_f32_16x16x32_bf16 v[204:207], v[184:187], v[84:87], v[204:207]
  ds_read_b128 v[164:167], v237 offset:35840
  s_waitcnt lgkmcnt(9)
  v_mfma_f32_16x16x32_bf16 v[208:211], v[188:191], v[84:87], v[208:211]
  ds_read_b128 v[168:171], v237 offset:36864
  buffer_load_dwordx4 v[120:123], v239, s[44:47], s67 offen offset:2048 sc1
  s_waitcnt lgkmcnt(9)
  v_mfma_f32_16x16x32_bf16 v[212:215], v[192:195], v[84:87], v[212:215]
  ds_read_b128 v[172:175], v237 offset:37888
  s_waitcnt lgkmcnt(9)
  v_mfma_f32_16x16x32_bf16 v[216:219], v[196:199], v[84:87], v[216:219]
  ds_read_b128 v[176:179], v237 offset:38912
  s_waitcnt lgkmcnt(9)
  v_mfma_f32_16x16x32_bf16 v[220:223], v[200:203], v[84:87], v[220:223]
  ds_read_b128 v[180:183], v237 offset:39936
  s_barrier
  s_waitcnt vmcnt(8) lgkmcnt(9)
  v_mfma_f32_16x16x32_bf16 v[204:207], v[144:147], v[88:91], v[204:207]
  ds_read_b128 v[184:187], v237 offset:40960
  s_waitcnt lgkmcnt(9)
  v_mfma_f32_16x16x32_bf16 v[208:211], v[148:151], v[88:91], v[208:211]
  ds_read_b128 v[188:191], v237 offset:41984
  buffer_load_dwordx4 v[124:127], v239, s[44:47], s67 offen offset:3072 sc1
  s_waitcnt lgkmcnt(9)
  v_mfma_f32_16x16x32_bf16 v[212:215], v[152:155], v[88:91], v[212:215]
  ds_read_b128 v[192:195], v237 offset:43008
  s_waitcnt lgkmcnt(9)
  v_mfma_f32_16x16x32_bf16 v[216:219], v[156:159], v[88:91], v[216:219]
  ds_read_b128 v[196:199], v237 offset:44032
  s_waitcnt lgkmcnt(9)
  v_mfma_f32_16x16x32_bf16 v[220:223], v[160:163], v[88:91], v[220:223]
  ds_read_b128 v[200:203], v237 offset:45056
  s_waitcnt vmcnt(8) lgkmcnt(9)
  v_mfma_f32_16x16x32_bf16 v[204:207], v[164:167], v[92:95], v[204:207]
  ds_read_b128 v[144:147], v237 offset:46080
  s_waitcnt lgkmcnt(9)
  v_mfma_f32_16x16x32_bf16 v[208:211], v[168:171], v[92:95], v[208:211]
  ds_read_b128 v[148:151], v237 offset:47104
  s_add_u32 s67, s67, 4096
  buffer_load_dwordx4 v[128:131], v239, s[44:47], s67 offen offset:0 sc1
  s_waitcnt lgkmcnt(9)
  v_mfma_f32_16x16x32_bf16 v[212:215], v[172:175], v[92:95], v[212:215]
  ds_read_b128 v[152:155], v237 offset:48128
  s_waitcnt lgkmcnt(9)
  v_mfma_f32_16x16x32_bf16 v[216:219], v[176:179], v[92:95], v[216:219]
  ds_read_b128 v[156:159], v237 offset:49152
  s_waitcnt lgkmcnt(9)
  v_mfma_f32_16x16x32_bf16 v[220:223], v[180:183], v[92:95], v[220:223]
  ds_read_b128 v[160:163], v237 offset:50176
  s_waitcnt vmcnt(8) lgkmcnt(9)
  v_mfma_f32_16x16x32_bf16 v[204:207], v[184:187], v[96:99], v[204:207]
  ds_read_b128 v[164:167], v237 offset:51200
  s_waitcnt lgkmcnt(9)
  v_mfma_f32_16x16x32_bf16 v[208:211], v[188:191], v[96:99], v[208:211]
  ds_read_b128 v[168:171], v237 offset:52224
  buffer_load_dwordx4 v[132:135], v239, s[44:47], s67 offen offset:1024 sc1
  s_waitcnt lgkmcnt(9)
  v_mfma_f32_16x16x32_bf16 v[212:215], v[192:195], v[96:99], v[212:215]
  ds_read_b128 v[172:175], v237 offset:53248
  s_waitcnt lgkmcnt(9)
  v_mfma_f32_16x16x32_bf16 v[216:219], v[196:199], v[96:99], v[216:219]
  ds_read_b128 v[176:179], v237 offset:54272
  s_waitcnt lgkmcnt(9)
  v_mfma_f32_16x16x32_bf16 v[220:223], v[200:203], v[96:99], v[220:223]
  ds_read_b128 v[180:183], v237 offset:55296
  s_waitcnt vmcnt(8) lgkmcnt(9)
  v_mfma_f32_16x16x32_bf16 v[204:207], v[144:147], v[100:103], v[204:207]
  ds_read_b128 v[184:187], v237 offset:56320
  s_waitcnt lgkmcnt(9)
  v_mfma_f32_16x16x32_bf16 v[208:211], v[148:151], v[100:103], v[208:211]
  ds_read_b128 v[188:191], v237 offset:57344
  buffer_load_dwordx4 v[136:139], v239, s[44:47], s67 offen offset:2048 sc1
  s_waitcnt lgkmcnt(9)
  v_mfma_f32_16x16x32_bf16 v[212:215], v[152:155], v[100:103], v[212:215]
  ds_read_b128 v[192:195], v237 offset:58368
  s_waitcnt lgkmcnt(9)
  v_mfma_f32_16x16x32_bf16 v[216:219], v[156:159], v[100:103], v[216:219]
  ds_read_b128 v[196:199], v237 offset:59392
  s_waitcnt lgkmcnt(9)
  v_mfma_f32_16x16x32_bf16 v[220:223], v[160:163], v[100:103], v[220:223]
  ds_read_b128 v[200:203], v237 offset:60416
  s_barrier
  s_waitcnt vmcnt(8) lgkmcnt(9)
  v_mfma_f32_16x16x32_bf16 v[204:207], v[164:167], v[104:107], v[204:207]
  ds_read_b128 v[144:147], v238 offset:0
  s_waitcnt lgkmcnt(9)
  v_mfma_f32_16x16x32_bf16 v[208:211], v[168:171], v[104:107], v[208:211]
  ds_read_b128 v[148:151], v238 offset:1024
  buffer_load_dwordx4 v[140:143], v239, s[44:47], s67 offen offset:3072 sc1
  s_waitcnt lgkmcnt(9)
  v_mfma_f32_16x16x32_bf16 v[212:215], v[172:175], v[104:107], v[212:215]
  ds_read_b128 v[152:155], v238 offset:2048
  s_waitcnt lgkmcnt(9)
  v_mfma_f32_16x16x32_bf16 v[216:219], v[176:179], v[104:107], v[216:219]
  ds_read_b128 v[156:159], v238 offset:3072
  s_waitcnt lgkmcnt(9)
  v_mfma_f32_16x16x32_bf16 v[220:223], v[180:183], v[104:107], v[220:223]
  ds_read_b128 v[160:163], v238 offset:4096
  s_waitcnt vmcnt(8) lgkmcnt(9)
  v_mfma_f32_16x16x32_bf16 v[204:207], v[184:187], v[108:111], v[204:207]
  ds_read_b128 v[164:167], v238 offset:5120
  s_waitcnt lgkmcnt(9)
  v_mfma_f32_16x16x32_bf16 v[208:211], v[188:191], v[108:111], v[208:211]
  ds_read_b128 v[168:171], v238 offset:6144
  s_waitcnt lgkmcnt(9)
  v_mfma_f32_16x16x32_bf16 v[212:215], v[192:195], v[108:111], v[212:215]
  ds_read_b128 v[172:175], v238 offset:7168
  s_waitcnt lgkmcnt(9)
  v_mfma_f32_16x16x32_bf16 v[216:219], v[196:199], v[108:111], v[216:219]
  ds_read_b128 v[176:179], v238 offset:8192
  s_waitcnt lgkmcnt(9)
  v_mfma_f32_16x16x32_bf16 v[220:223], v[200:203], v[108:111], v[220:223]
  ds_read_b128 v[180:183], v238 offset:9216
  s_waitcnt vmcnt(7) lgkmcnt(9)
  v_mfma_f32_16x16x32_bf16 v[204:207], v[144:147], v[112:115], v[204:207]
  ds_read_b128 v[184:187], v238 offset:10240
  s_waitcnt lgkmcnt(9)
  v_mfma_f32_16x16x32_bf16 v[208:211], v[148:151], v[112:115], v[208:211]
  ds_read_b128 v[188:191], v238 offset:11264
  s_waitcnt lgkmcnt(9)
  v_mfma_f32_16x16x32_bf16 v[212:215], v[152:155], v[112:115], v[212:215]
  ds_read_b128 v[192:195], v238 offset:12288
  s_waitcnt lgkmcnt(9)
  v_mfma_f32_16x16x32_bf16 v[216:219], v[156:159], v[112:115], v[216:219]
  ds_read_b128 v[196:199], v238 offset:13312
  s_waitcnt lgkmcnt(9)
  v_mfma_f32_16x16x32_bf16 v[220:223], v[160:163], v[112:115], v[220:223]
  ds_read_b128 v[200:203], v238 offset:14336
  s_waitcnt vmcnt(6) lgkmcnt(9)
  v_mfma_f32_16x16x32_bf16 v[204:207], v[164:167], v[116:119], v[204:207]
  ds_read_b128 v[144:147], v238 offset:15360
  s_waitcnt lgkmcnt(9)
  v_mfma_f32_16x16x32_bf16 v[208:211], v[168:171], v[116:119], v[208:211]
  ds_read_b128 v[148:151], v238 offset:16384
  s_waitcnt lgkmcnt(9)
  v_mfma_f32_16x16x32_bf16 v[212:215], v[172:175], v[116:119], v[212:215]
  ds_read_b128 v[152:155], v238 offset:17408
  s_waitcnt lgkmcnt(9)
  v_mfma_f32_16x16x32_bf16 v[216:219], v[176:179], v[116:119], v[216:219]
  ds_read_b128 v[156:159], v238 offset:18432
  s_waitcnt lgkmcnt(9)
  v_mfma_f32_16x16x32_bf16 v[220:223], v[180:183], v[116:119], v[220:223]
  ds_read_b128 v[160:163], v238 offset:19456
  s_waitcnt vmcnt(5) lgkmcnt(9)
  v_mfma_f32_16x16x32_bf16 v[204:207], v[184:187], v[120:123], v[204:207]
  ds_read_b128 v[164:167], v238 offset:20480
  s_waitcnt lgkmcnt(9)
  v_mfma_f32_16x16x32_bf16 v[208:211], v[188:191], v[120:123], v[208:211]
  ds_read_b128 v[168:171], v238 offset:21504
  s_waitcnt lgkmcnt(9)
  v_mfma_f32_16x16x32_bf16 v[212:215], v[192:195], v[120:123], v[212:215]
  ds_read_b128 v[172:175], v238 offset:22528
  s_waitcnt lgkmcnt(9)
  v_mfma_f32_16x16x32_bf16 v[216:219], v[196:199], v[120:123], v[216:219]
  ds_read_b128 v[176:179], v238 offset:23552
  s_waitcnt lgkmcnt(9)
  v_mfma_f32_16x16x32_bf16 v[220:223], v[200:203], v[120:123], v[220:223]
  ds_read_b128 v[180:183], v238 offset:24576
  s_waitcnt vmcnt(4) lgkmcnt(9)
  v_mfma_f32_16x16x32_bf16 v[204:207], v[144:147], v[124:127], v[204:207]
  ds_read_b128 v[184:187], v238 offset:25600
  s_waitcnt lgkmcnt(9)
  v_mfma_f32_16x16x32_bf16 v[208:211], v[148:151], v[124:127], v[208:211]
  ds_read_b128 v[188:191], v238 offset:26624
  s_waitcnt lgkmcnt(9)
  v_mfma_f32_16x16x32_bf16 v[212:215], v[152:155], v[124:127], v[212:215]
  ds_read_b128 v[192:195], v238 offset:27648
  s_waitcnt lgkmcnt(9)
  v_mfma_f32_16x16x32_bf16 v[216:219], v[156:159], v[124:127], v[216:219]
  ds_read_b128 v[196:199], v238 offset:28672
  s_waitcnt lgkmcnt(9)
  v_mfma_f32_16x16x32_bf16 v[220:223], v[160:163], v[124:127], v[220:223]
  ds_read_b128 v[200:203], v238 offset:29696
  s_waitcnt vmcnt(3) lgkmcnt(9)
  v_mfma_f32_16x16x32_bf16 v[204:207], v[164:167], v[128:131], v[204:207]
  ds_read_b128 v[144:147], v238 offset:30720
  s_waitcnt lgkmcnt(9)
  v_mfma_f32_16x16x32_bf16 v[208:211], v[168:171], v[128:131], v[208:211]
  ds_read_b128 v[148:151], v238 offset:31744
  s_waitcnt lgkmcnt(9)
  v_mfma_f32_16x16x32_bf16 v[212:215], v[172:175], v[128:131], v[212:215]
  ds_read_b128 v[152:155], v238 offset:32768
  s_waitcnt lgkmcnt(9)
  v_mfma_f32_16x16x32_bf16 v[216:219], v[176:179], v[128:131], v[216:219]
  ds_read_b128 v[156:159], v238 offset:33792
  s_waitcnt lgkmcnt(9)
  v_mfma_f32_16x16x32_bf16 v[220:223], v[180:183], v[128:131], v[220:223]
  ds_read_b128 v[160:163], v238 offset:34816
  s_waitcnt vmcnt(2) lgkmcnt(9)
  v_mfma_f32_16x16x32_bf16 v[204:207], v[184:187], v[132:135], v[204:207]
  ds_read_b128 v[164:167], v239 offset:0
  s_waitcnt lgkmcnt(9)
  v_mfma_f32_16x16x32_bf16 v[208:211], v[188:191], v[132:135], v[208:211]
  ds_read_b128 v[168:171], v239 offset:1024
  s_waitcnt lgkmcnt(9)
  v_mfma_f32_16x16x32_bf16 v[212:215], v[192:195], v[132:135], v[212:215]
  ds_read_b128 v[172:175], v239 offset:2048
  s_waitcnt lgkmcnt(9)
  v_mfma_f32_16x16x32_bf16 v[216:219], v[196:199], v[132:135], v[216:219]
  ds_read_b128 v[176:179], v239 offset:3072
  s_waitcnt lgkmcnt(9)
  v_mfma_f32_16x16x32_bf16 v[220:223], v[200:203], v[132:135], v[220:223]
  ds_read_b128 v[180:183], v239 offset:4096
  s_waitcnt vmcnt(1) lgkmcnt(9)
  v_mfma_f32_16x16x32_bf16 v[204:207], v[144:147], v[136:139], v[204:207]
  s_waitcnt lgkmcnt(8)
  v_mfma_f32_16x16x32_bf16 v[208:211], v[148:151], v[136:139], v[208:211]
  s_waitcnt lgkmcnt(7)
  v_mfma_f32_16x16x32_bf16 v[212:215], v[152:155], v[136:139], v[212:215]
  s_waitcnt lgkmcnt(6)
  v_mfma_f32_16x16x32_bf16 v[216:219], v[156:159], v[136:139], v[216:219]
  s_waitcnt lgkmcnt(5)
  v_mfma_f32_16x16x32_bf16 v[220:223], v[160:163], v[136:139], v[220:223]
  s_waitcnt vmcnt(0) lgkmcnt(4)
  v_mfma_f32_16x16x32_bf16 v[204:207], v[164:167], v[140:143], v[204:207]
  s_waitcnt lgkmcnt(3)
  v_mfma_f32_16x16x32_bf16 v[208:211], v[168:171], v[140:143], v[208:211]
  s_waitcnt lgkmcnt(2)
  v_mfma_f32_16x16x32_bf16 v[212:215], v[172:175], v[140:143], v[212:215]
  s_waitcnt lgkmcnt(1)
  v_mfma_f32_16x16x32_bf16 v[216:219], v[176:179], v[140:143], v[216:219]
  s_waitcnt lgkmcnt(0)
  v_mfma_f32_16x16x32_bf16 v[220:223], v[180:183], v[140:143], v[220:223]
  v_lshlrev_b32 v240, 16, v224
  v_and_b32 v241, s57, v224
  v_fmac_f32 v240, v4, v204
  v_fmac_f32 v241, v5, v205
  v_cvt_pk_bf16_f32 v246, v240, v241
  v_lshlrev_b32 v242, 16, v225
  v_and_b32 v243, s57, v225
  v_fmac_f32 v242, v6, v206
  v_fmac_f32 v243, v7, v207
  v_cvt_pk_bf16_f32 v247, v242, v243
  v_lshlrev_b32 v240, 16, v226
  v_and_b32 v241, s57, v226
  v_fmac_f32 v240, v8, v208
  v_fmac_f32 v241, v9, v209
  v_cvt_pk_bf16_f32 v248, v240, v241
  v_lshlrev_b32 v242, 16, v227
  v_and_b32 v243, s57, v227
  v_fmac_f32 v242, v10, v210
  v_fmac_f32 v243, v11, v211
  v_cvt_pk_bf16_f32 v249, v242, v243
  v_lshlrev_b32 v240, 16, v228
  v_and_b32 v241, s57, v228
  v_fmac_f32 v240, v12, v212
  v_fmac_f32 v241, v13, v213
  v_cvt_pk_bf16_f32 v250, v240, v241
  v_lshlrev_b32 v242, 16, v229
  v_and_b32 v243, s57, v229
  v_fmac_f32 v242, v14, v214
  v_fmac_f32 v243, v15, v215
  v_cvt_pk_bf16_f32 v251, v242, v243
  v_lshlrev_b32 v240, 16, v230
  v_and_b32 v241, s57, v230
  v_fmac_f32 v240, v16, v216
  v_fmac_f32 v241, v17, v217
  v_cvt_pk_bf16_f32 v252, v240, v241
  v_lshlrev_b32 v242, 16, v231
  v_and_b32 v243, s57, v231
  v_fmac_f32 v242, v18, v218
  v_fmac_f32 v243, v19, v219
  v_cvt_pk_bf16_f32 v253, v242, v243
  v_lshlrev_b32 v240, 16, v232
  v_and_b32 v241, s57, v232
  v_fmac_f32 v240, v20, v220
  v_fmac_f32 v241, v21, v221
  v_cvt_pk_bf16_f32 v254, v240, v241
  v_lshlrev_b32 v242, 16, v233
  v_and_b32 v243, s57, v233
  v_fmac_f32 v242, v22, v222
  v_fmac_f32 v243, v23, v223
  v_cvt_pk_bf16_f32 v255, v242, v243
  s_mov_b32 s65, 0x3f803f80
  v_mov_b32 v64, 0
  v_mov_b32 v65, 0
  v_dot2c_f32_bf16 v64, s65, v246
  v_dot2c_f32_bf16 v65, v246, v246
  v_dot2c_f32_bf16 v64, s65, v247
  v_dot2c_f32_bf16 v65, v247, v247
  v_dot2c_f32_bf16 v64, s65, v248
  v_dot2c_f32_bf16 v65, v248, v248
  v_dot2c_f32_bf16 v64, s65, v249
  v_dot2c_f32_bf16 v65, v249, v249
  v_dot2c_f32_bf16 v64, s65, v250
  v_dot2c_f32_bf16 v65, v250, v250
  v_dot2c_f32_bf16 v64, s65, v251
  v_dot2c_f32_bf16 v65, v251, v251
  v_dot2c_f32_bf16 v64, s65, v252
  v_dot2c_f32_bf16 v65, v252, v252
  v_dot2c_f32_bf16 v64, s65, v253
  v_dot2c_f32_bf16 v65, v253, v253
  v_dot2c_f32_bf16 v64, s65, v254
  v_dot2c_f32_bf16 v65, v254, v254
  v_dot2c_f32_bf16 v64, s65, v255
  v_dot2c_f32_bf16 v65, v255, v255
  s_lshl_b32 s68, s66, 11
  s_add_u32 s68, s68, 2490368
  s_lshl_b32 s65, s53, 8
  s_add_u32 s65, s65, s68
  v_cmp_gt_u32 vcc, 16, v1
  v_mov_b32 v70, 2147483648
  s_nop 0
  v_cndmask_b32 v70, v70, v239, vcc
  v_mov_b32 v66, s54
  v_mov_b32 v67, s54
  v_mov_b32 v68, v64
  v_mov_b32 v69, v65
  s_nop 0
  v_permlane16_swap_b32 v64, v68
  v_permlane16_swap_b32 v65, v69
  v_add_f32 v64, v64, v68
  v_add_f32 v65, v65, v69
  v_mov_b32 v68, v64
  v_mov_b32 v69, v65
  s_nop 0
  v_permlane32_swap_b32 v64, v68
  v_permlane32_swap_b32 v65, v69
  v_add_f32 v64, v64, v68
  v_add_f32 v65, v65, v69
  buffer_store_dwordx4 v[64:67], v70, s[44:47], s65 offen sc1
  v_and_b32 v71, 15, v1
  v_lshlrev_b32 v71, 4, v71
  v_lshrrev_b32 v72, 4, v1
  v_lshl_add_u32 v71, v72, 9, v71
  v_lshlrev_b32 v96, 16, v246
  v_and_b32 v97, s57, v246
  v_lshlrev_b32 v98, 16, v247
  v_and_b32 v99, s57, v247
  v_lshlrev_b32 v100, 16, v248
  v_and_b32 v101, s57, v248
  v_lshlrev_b32 v102, 16, v249
  v_and_b32 v103, s57, v249
  v_lshlrev_b32 v104, 16, v250
  v_and_b32 v105, s57, v250
  v_lshlrev_b32 v106, 16, v251
  v_and_b32 v107, s57, v251
  v_lshlrev_b32 v108, 16, v252
  v_and_b32 v109, s57, v252
  v_lshlrev_b32 v110, 16, v253
  v_and_b32 v111, s57, v253
  v_lshlrev_b32 v112, 16, v254
  v_and_b32 v113, s57, v254
  v_lshlrev_b32 v114, 16, v255
  v_and_b32 v115, s57, v255
  s_mul_i32 s65, s53, 5
  s_lshr_b32 s65, s65, 1
  s_lshl_b32 s65, s65, 10
  s_mul_i32 s67, s66, 20480
  s_add_u32 s67, s67, 8257536
  s_add_u32 s67, s67, s65
  v_lshlrev_b32 v73, 3, v1
  buffer_load_dwordx4 v[76:79], v71, s[44:47], s68 offen sc1
  buffer_load_dwordx4 v[80:83], v71, s[44:47], s68 offen offset:256 sc1
  s_waitcnt vmcnt(1)
  v_xor_b32 v74, s54, v78
  s_waitcnt vmcnt(0)
  v_xor_b32 v75, s54, v82
  v_or_b32 v74, v74, v75
  v_cmp_ne_u32 vcc, 0, v74
  s_cbranch_vccz IF_172_else
  s_mov_b32 s58, 1048576
LP_171:
  s_sleep 2
  buffer_load_dwordx4 v[76:79], v71, s[44:47], s68 offen sc1
  buffer_load_dwordx4 v[80:83], v71, s[44:47], s68 offen offset:256 sc1
  s_waitcnt vmcnt(1)
  v_xor_b32 v74, s54, v78
  s_waitcnt vmcnt(0)
  v_xor_b32 v75, s54, v82
  v_or_b32 v74, v74, v75
  v_cmp_ne_u32 vcc, 0, v74
  s_sub_u32 s58, s58, 1
  s_cselect_b64 vcc, 0, vcc
  s_cbranch_vccnz LP_171
IF_172_else:
  v_add_f32 v64, v76, v80
  v_add_f32 v66, v77, v81
  v_mov_b32 v68, v64
  v_mov_b32 v69, v66
  s_nop 0
  v_permlane16_swap_b32 v64, v68
  v_permlane16_swap_b32 v66, v69
  v_add_f32 v64, v64, v68
  v_add_f32 v66, v66, v69
  v_mov_b32 v68, v64
  v_mov_b32 v69, v66
  s_nop 0
  v_permlane32_swap_b32 v64, v68
  v_permlane32_swap_b32 v66, v69
  v_add_f32 v64, v64, v68
  v_add_f32 v66, v66, v69
  v_mul_f32 v64, 0.0015625, v64
  v_mul_f32 v68, v64, v64
  v_mul_f32 v66, 0.0015625, v66
  v_sub_f32 v66, v66, v68
  v_max_f32 v66, 0, v66
  v_add_f32 v66, 0x3727c5ac, v66
  v_rsq_f32 v66, v66
  s_nop 0
  v_mul_f32 v64, v64, v66
  v_sub_f32 v64, 0, v64
  v_pk_fma_f32 v[96:97], v[96:97], v[66:67], v[64:65] op_sel_hi:[1,0,0]
  v_pk_fma_f32 v[96:97], v[96:97], v[44:45], v[24:25]
  v_cvt_pk_bf16_f32 v120, v96, v97
  v_pk_fma_f32 v[98:99], v[98:99], v[66:67], v[64:65] op_sel_hi:[1,0,0]
  v_pk_fma_f32 v[98:99], v[98:99], v[46:47], v[26:27]
  v_cvt_pk_bf16_f32 v121, v98, v99
  v_pk_fma_f32 v[100:101], v[100:101], v[66:67], v[64:65] op_sel_hi:[1,0,0]
  v_pk_fma_f32 v[100:101], v[100:101], v[48:49], v[28:29]
  v_cvt_pk_bf16_f32 v122, v100, v101
  v_pk_fma_f32 v[102:103], v[102:103], v[66:67], v[64:65] op_sel_hi:[1,0,0]
  v_pk_fma_f32 v[102:103], v[102:103], v[50:51], v[30:31]
  v_cvt_pk_bf16_f32 v123, v102, v103
  v_pk_fma_f32 v[104:105], v[104:105], v[66:67], v[64:65] op_sel_hi:[1,0,0]
  v_pk_fma_f32 v[104:105], v[104:105], v[52:53], v[32:33]
  v_cvt_pk_bf16_f32 v124, v104, v105
  v_pk_fma_f32 v[106:107], v[106:107], v[66:67], v[64:65] op_sel_hi:[1,0,0]
  v_pk_fma_f32 v[106:107], v[106:107], v[54:55], v[34:35]
  v_cvt_pk_bf16_f32 v125, v106, v107
  v_pk_fma_f32 v[108:109], v[108:109], v[66:67], v[64:65] op_sel_hi:[1,0,0]
  v_pk_fma_f32 v[108:109], v[108:109], v[56:57], v[36:37]
  v_cvt_pk_bf16_f32 v126, v108, v109
  v_pk_fma_f32 v[110:111], v[110:111], v[66:67], v[64:65] op_sel_hi:[1,0,0]
  v_pk_fma_f32 v[110:111], v[110:111], v[58:59], v[38:39]
  v_cvt_pk_bf16_f32 v127, v110, v111
  v_pk_fma_f32 v[112:113], v[112:113], v[66:67], v[64:65] op_sel_hi:[1,0,0]
  v_pk_fma_f32 v[112:113], v[112:113], v[60:61], v[40:41]
  v_cvt_pk_bf16_f32 v128, v112, v113
  v_pk_fma_f32 v[114:115], v[114:115], v[66:67], v[64:65] op_sel_hi:[1,0,0]
  v_pk_fma_f32 v[114:115], v[114:115], v[62:63], v[42:43]
  v_cvt_pk_bf16_f32 v129, v114, v115
  s_bitcmp0_b32 s53, 0
  s_cbranch_scc0 IF_173_else
  buffer_store_dwordx4 v[120:123], v239, s[44:47], s67 offen sc1
  buffer_store_dwordx4 v[124:127], v239, s[44:47], s67 offen offset:1024 sc1
  buffer_store_dwordx2 v[128:129], v73, s[44:47], s67 offen offset:2048 sc1
  s_branch IF_173_end
IF_173_else:
  buffer_store_dwordx2 v[120:121], v73, s[44:47], s67 offen offset:512 sc1
  buffer_store_dwordx4 v[122:125], v239, s[44:47], s67 offen offset:1024 sc1
  buffer_store_dwordx4 v[126:129], v239, s[44:47], s67 offen offset:2048 sc1
IF_173_end:
  s_lshl_b32 s65, s66, 3
  s_add_u32 s65, s65, s53
  s_lshl_b32 s63, s65, 7
  s_add_u32 s63, s63, 655360
  v_mov_b32 v64, s54
  v_lshlrev_b32 v65, 26, v1
  v_and_b32 v65, 2147483648, v65
  v_lshl_or_b32 v65, v1, 2, v65
  s_waitcnt vmcnt(0)
  buffer_store_dword v64, v65, s[44:47], s63 offen sc1
  s_barrier
  v_add_u32 v232, 5120, v239
  v_add_u32 v233, 69632, v239
  v_add_u32 v234, 134144, v239
  v_lshlrev_b32 v238, 3, v1
  s_lshl_b32 s65, s50, 2
  s_add_u32 s65, s65, s59
  s_mul_i32 s66, s65, 40960
  s_add_u32 s66, s66, 8257536
  s_add_u32 s67, s66, 20480
  s_lshl_b32 s65, s65, 4
  v_and_b32 v240, 15, v1
  v_lshlrev_b32 v240, 7, v240
  s_lshl_b32 s63, s65, 7
  s_add_u32 s63, s63, 655360
  buffer_load_dword v241, v240, s[44:47], s63 offen sc1
  s_waitcnt vmcnt(0)
  v_cmp_ne_u32 vcc, s54, v241
  s_cbranch_vccz IF_175_else
  s_mov_b32 s58, 1048576
LP_174:
  s_sleep 2
  buffer_load_dword v241, v240, s[44:47], s63 offen sc1
  s_waitcnt vmcnt(0)
  v_cmp_ne_u32 vcc, s54, v241
  s_sub_u32 s58, s58, 1
  s_cselect_b64 vcc, 0, vcc
  s_cbranch_vccnz LP_174
IF_175_else:
  buffer_load_dwordx4 v[116:119], v239, s[44:47], s66 offen offset:0 sc1
  buffer_load_dwordx4 v[120:123], v239, s[44:47], s67 offen offset:0 sc1
  buffer_load_dwordx4 v[124:127], v239, s[44:47], s66 offen offset:1024 sc1
  buffer_load_dwordx4 v[128:131], v239, s[44:47], s67 offen offset:1024 sc1
  buffer_load_dwordx2 v[132:133], v238, s[44:47], s66 offen offset:2048 sc1
  buffer_load_dwordx2 v[134:135], v238, s[44:47], s66 offen offset:2560 sc1
  buffer_load_dwordx2 v[136:137], v238, s[44:47], s67 offen offset:2048 sc1
  buffer_load_dwordx2 v[138:139], v238, s[44:47], s67 offen offset:2560 sc1
  s_barrier
  s_cmp_eq_u32 s56, 1
  s_cbranch_scc0 IF_176_else
  ds_read_b128 v[60:63], v232 offset:0
  ds_read_b128 v[64:67], v232 offset:1024
  ds_read_b128 v[68:71], v232 offset:2048
  ds_read_b128 v[72:75], v232 offset:3072
  ds_read_b128 v[76:79], v232 offset:4096
  ds_read_b128 v[80:83], v232 offset:5120
  ds_read_b128 v[84:87], v232 offset:6144
  s_waitcnt vmcnt(7) lgkmcnt(6)
  v_mfma_f32_16x16x32_bf16 v[4:7], v[116:119], v[60:63], 0
  ds_read_b128 v[88:91], v232 offset:7168
  s_waitcnt vmcnt(6)
  v_mfma_f32_16x16x32_bf16 v[32:35], v[120:123], v[60:63], 0
  s_waitcnt lgkmcnt(6)
  v_mfma_f32_16x16x32_bf16 v[8:11], v[116:119], v[64:67], 0
  ds_read_b128 v[92:95], v232 offset:8192
  v_mfma_f32_16x16x32_bf16 v[36:39], v[120:123], v[64:67], 0
  s_waitcnt lgkmcnt(6)
  v_mfma_f32_16x16x32_bf16 v[12:15], v[116:119], v[68:71], 0
  ds_read_b128 v[96:99], v232 offset:9216
  v_mfma_f32_16x16x32_bf16 v[40:43], v[120:123], v[68:71], 0
  buffer_load_dwordx4 v[140:143], v239, s[44:47], s66 offen offset:3072 sc1
  buffer_load_dwordx4 v[144:147], v239, s[44:47], s67 offen offset:3072 sc1
  s_waitcnt lgkmcnt(6)
  v_mfma_f32_16x16x32_bf16 v[16:19], v[116:119], v[72:75], 0
  ds_read_b128 v[100:103], v232 offset:10240
  v_mfma_f32_16x16x32_bf16 v[44:47], v[120:123], v[72:75], 0
  s_waitcnt lgkmcnt(6)
  v_mfma_f32_16x16x32_bf16 v[20:23], v[116:119], v[76:79], 0
  ds_read_b128 v[104:107], v232 offset:11264
  v_mfma_f32_16x16x32_bf16 v[48:51], v[120:123], v[76:79], 0
  s_waitcnt lgkmcnt(6)
  v_mfma_f32_16x16x32_bf16 v[24:27], v[116:119], v[80:83], 0
  ds_read_b128 v[108:111], v232 offset:12288
  v_mfma_f32_16x16x32_bf16 v[52:55], v[120:123], v[80:83], 0
  s_add_u32 s66, s66, 4096
  buffer_load_dwordx4 v[148:151], v239, s[44:47], s66 offen offset:0 sc1
  s_add_u32 s67, s67, 4096
  buffer_load_dwordx4 v[152:155], v239, s[44:47], s67 offen offset:0 sc1
  s_waitcnt lgkmcnt(6)
  v_mfma_f32_16x16x32_bf16 v[28:31], v[116:119], v[84:87], 0
  ds_read_b128 v[112:115], v232 offset:13312
  v_mfma_f32_16x16x32_bf16 v[56:59], v[120:123], v[84:87], 0
  s_waitcnt vmcnt(9) lgkmcnt(6)
  v_mfma_f32_16x16x32_bf16 v[4:7], v[124:127], v[88:91], v[4:7]
  ds_read_b128 v[60:63], v232 offset:14336
  s_waitcnt vmcnt(8)
  v_mfma_f32_16x16x32_bf16 v[32:35], v[128:131], v[88:91], v[32:35]
  s_waitcnt lgkmcnt(6)
  v_mfma_f32_16x16x32_bf16 v[8:11], v[124:127], v[92:95], v[8:11]
  ds_read_b128 v[64:67], v232 offset:15360
  v_mfma_f32_16x16x32_bf16 v[36:39], v[128:131], v[92:95], v[36:39]
  s_waitcnt lgkmcnt(6)
  v_mfma_f32_16x16x32_bf16 v[12:15], v[124:127], v[96:99], v[12:15]
  ds_read_b128 v[68:71], v232 offset:16384
  v_mfma_f32_16x16x32_bf16 v[40:43], v[128:131], v[96:99], v[40:43]
  buffer_load_dwordx4 v[156:159], v239, s[44:47], s66 offen offset:1024 sc1
  buffer_load_dwordx4 v[160:163], v239, s[44:47], s67 offen offset:1024 sc1
  s_waitcnt lgkmcnt(6)
  v_mfma_f32_16x16x32_bf16 v[16:19], v[124:127], v[100:103], v[16:19]
  ds_read_b128 v[72:75], v232 offset:17408
  v_mfma_f32_16x16x32_bf16 v[44:47], v[128:131], v[100:103], v[44:47]
  s_waitcnt lgkmcnt(6)
  v_mfma_f32_16x16x32_bf16 v[20:23], v[124:127], v[104:107], v[20:23]
  ds_read_b128 v[76:79], v232 offset:18432
  v_mfma_f32_16x16x32_bf16 v[48:51], v[128:131], v[104:107], v[48:51]
  s_waitcnt lgkmcnt(6)
  v_mfma_f32_16x16x32_bf16 v[24:27], v[124:127], v[108:111], v[24:27]
  ds_read_b128 v[80:83], v232 offset:19456
  v_mfma_f32_16x16x32_bf16 v[52:55], v[128:131], v[108:111], v[52:55]
  buffer_load_dwordx4 v[164:167], v239, s[44:47], s66 offen offset:2048 sc1
  buffer_load_dwordx4 v[168:171], v239, s[44:47], s67 offen offset:2048 sc1
  s_waitcnt lgkmcnt(6)
  v_mfma_f32_16x16x32_bf16 v[28:31], v[124:127], v[112:115], v[28:31]
  ds_read_b128 v[84:87], v232 offset:20480
  v_mfma_f32_16x16x32_bf16 v[56:59], v[128:131], v[112:115], v[56:59]
  s_waitcnt vmcnt(10) lgkmcnt(6)
  v_mfma_f32_16x16x32_bf16 v[4:7], v[132:135], v[60:63], v[4:7]
  ds_read_b128 v[88:91], v232 offset:21504
  s_waitcnt vmcnt(8)
  v_mfma_f32_16x16x32_bf16 v[32:35], v[136:139], v[60:63], v[32:35]
  s_waitcnt lgkmcnt(6)
  v_mfma_f32_16x16x32_bf16 v[8:11], v[132:135], v[64:67], v[8:11]
  ds_read_b128 v[92:95], v232 offset:22528
  v_mfma_f32_16x16x32_bf16 v[36:39], v[136:139], v[64:67], v[36:39]
  s_waitcnt lgkmcnt(6)
  v_mfma_f32_16x16x32_bf16 v[12:15], v[132:135], v[68:71], v[12:15]
  ds_read_b128 v[96:99], v232 offset:23552
  v_mfma_f32_16x16x32_bf16 v[40:43], v[136:139], v[68:71], v[40:43]
  buffer_load_dwordx2 v[172:173], v238, s[44:47], s66 offen offset:3072 sc1
  buffer_load_dwordx2 v[174:175], v238, s[44:47], s66 offen offset:3584 sc1
  buffer_load_dwordx2 v[176:177], v238, s[44:47], s67 offen offset:3072 sc1
  buffer_load_dwordx2 v[178:179], v238, s[44:47], s67 offen offset:3584 sc1
  s_waitcnt lgkmcnt(6)
  v_mfma_f32_16x16x32_bf16 v[16:19], v[132:135], v[72:75], v[16:19]
  ds_read_b128 v[100:103], v232 offset:24576
  v_mfma_f32_16x16x32_bf16 v[44:47], v[136:139], v[72:75], v[44:47]
  s_waitcnt lgkmcnt(6)
  v_mfma_f32_16x16x32_bf16 v[20:23], v[132:135], v[76:79], v[20:23]
  ds_read_b128 v[104:107], v232 offset:25600
  v_mfma_f32_16x16x32_bf16 v[48:51], v[136:139], v[76:79], v[48:51]
  s_waitcnt lgkmcnt(6)
  v_mfma_f32_16x16x32_bf16 v[24:27], v[132:135], v[80:83], v[24:27]
  ds_read_b128 v[108:111], v232 offset:26624
  v_mfma_f32_16x16x32_bf16 v[52:55], v[136:139], v[80:83], v[52:55]
  s_add_u32 s66, s66, 4096
  buffer_load_dwordx4 v[180:183], v239, s[44:47], s66 offen offset:0 sc1
  s_add_u32 s67, s67, 4096
  buffer_load_dwordx4 v[184:187], v239, s[44:47], s67 offen offset:0 sc1
  s_waitcnt lgkmcnt(6)
  v_mfma_f32_16x16x32_bf16 v[28:31], v[132:135], v[84:87], v[28:31]
  ds_read_b128 v[112:115], v232 offset:27648
  v_mfma_f32_16x16x32_bf16 v[56:59], v[136:139], v[84:87], v[56:59]
  s_waitcnt vmcnt(13) lgkmcnt(6)
  v_mfma_f32_16x16x32_bf16 v[4:7], v[140:143], v[88:91], v[4:7]
  ds_read_b128 v[60:63], v232 offset:28672
  s_waitcnt vmcnt(12)
  v_mfma_f32_16x16x32_bf16 v[32:35], v[144:147], v[88:91], v[32:35]
  s_waitcnt lgkmcnt(6)
  v_mfma_f32_16x16x32_bf16 v[8:11], v[140:143], v[92:95], v[8:11]
  ds_read_b128 v[64:67], v232 offset:29696
  v_mfma_f32_16x16x32_bf16 v[36:39], v[144:147], v[92:95], v[36:39]
  s_waitcnt lgkmcnt(6)
  v_mfma_f32_16x16x32_bf16 v[12:15], v[140:143], v[96:99], v[12:15]
  ds_read_b128 v[68:71], v232 offset:30720
  v_mfma_f32_16x16x32_bf16 v[40:43], v[144:147], v[96:99], v[40:43]
  buffer_load_dwordx4 v[188:191], v239, s[44:47], s66 offen offset:1024 sc1
  buffer_load_dwordx4 v[192:195], v239, s[44:47], s67 offen offset:1024 sc1
  s_waitcnt lgkmcnt(6)
  v_mfma_f32_16x16x32_bf16 v[16:19], v[140:143], v[100:103], v[16:19]
  ds_read_b128 v[72:75], v232 offset:31744
  v_mfma_f32_16x16x32_bf16 v[44:47], v[144:147], v[100:103], v[44:47]
  s_waitcnt lgkmcnt(6)
  v_mfma_f32_16x16x32_bf16 v[20:23], v[140:143], v[104:107], v[20:23]
  ds_read_b128 v[76:79], v232 offset:32768
  v_mfma_f32_16x16x32_bf16 v[48:51], v[144:147], v[104:107], v[48:51]
  s_waitcnt lgkmcnt(6)
  v_mfma_f32_16x16x32_bf16 v[24:27], v[140:143], v[108:111], v[24:27]
  ds_read_b128 v[80:83], v232 offset:33792
  v_mfma_f32_16x16x32_bf16 v[52:55], v[144:147], v[108:111], v[52:55]
  buffer_load_dwordx4 v[196:199], v239, s[44:47], s66 offen offset:2048 sc1
  buffer_load_dwordx4 v[200:203], v239, s[44:47], s67 offen offset:2048 sc1
  s_waitcnt lgkmcnt(6)
  v_mfma_f32_16x16x32_bf16 v[28:31], v[140:143], v[112:115], v[28:31]
  ds_read_b128 v[84:87], v232 offset:34816
  v_mfma_f32_16x16x32_bf16 v[56:59], v[144:147], v[112:115], v[56:59]
  s_waitcnt vmcnt(15) lgkmcnt(6)
  v_mfma_f32_16x16x32_bf16 v[4:7], v[148:151], v[60:63], v[4:7]
  ds_read_b128 v[88:91], v232 offset:35840
  s_waitcnt vmcnt(14)
  v_mfma_f32_16x16x32_bf16 v[32:35], v[152:155], v[60:63], v[32:35]
  s_waitcnt lgkmcnt(6)
  v_mfma_f32_16x16x32_bf16 v[8:11], v[148:151], v[64:67], v[8:11]
  ds_read_b128 v[92:95], v232 offset:36864
  v_mfma_f32_16x16x32_bf16 v[36:39], v[152:155], v[64:67], v[36:39]
  s_waitcnt lgkmcnt(6)
  v_mfma_f32_16x16x32_bf16 v[12:15], v[148:151], v[68:71], v[12:15]
  ds_read_b128 v[96:99], v232 offset:37888
  v_mfma_f32_16x16x32_bf16 v[40:43], v[152:155], v[68:71], v[40:43]
  buffer_load_dwordx4 v[204:207], v239, s[44:47], s66 offen offset:3072 sc1
  buffer_load_dwordx4 v[208:211], v239, s[44:47], s67 offen offset:3072 sc1
  s_waitcnt lgkmcnt(6)
  v_mfma_f32_16x16x32_bf16 v[16:19], v[148:151], v[72:75], v[16:19]
  ds_read_b128 v[100:103], v232 offset:38912
  v_mfma_f32_16x16x32_bf16 v[44:47], v[152:155], v[72:75], v[44:47]
  s_waitcnt lgkmcnt(6)
  v_mfma_f32_16x16x32_bf16 v[20:23], v[148:151], v[76:79], v[20:23]
  ds_read_b128 v[104:107], v232 offset:39936
  v_mfma_f32_16x16x32_bf16 v[48:51], v[152:155], v[76:79], v[48:51]
  s_waitcnt lgkmcnt(6)
  v_mfma_f32_16x16x32_bf16 v[24:27], v[148:151], v[80:83], v[24:27]
  ds_read_b128 v[108:111], v232 offset:40960
  v_mfma_f32_16x16x32_bf16 v[52:55], v[152:155], v[80:83], v[52:55]
  s_waitcnt lgkmcnt(6)
  v_mfma_f32_16x16x32_bf16 v[28:31], v[148:151], v[84:87], v[28:31]
  ds_read_b128 v[112:115], v232 offset:41984
  v_mfma_f32_16x16x32_bf16 v[56:59], v[152:155], v[84:87], v[56:59]
  s_waitcnt vmcnt(15) lgkmcnt(6)
  v_mfma_f32_16x16x32_bf16 v[4:7], v[156:159], v[88:91], v[4:7]
  ds_read_b128 v[60:63], v232 offset:43008
  s_waitcnt vmcnt(14)
  v_mfma_f32_16x16x32_bf16 v[32:35], v[160:163], v[88:91], v[32:35]
  s_waitcnt lgkmcnt(6)
  v_mfma_f32_16x16x32_bf16 v[8:11], v[156:159], v[92:95], v[8:11]
  ds_read_b128 v[64:67], v232 offset:44032
  v_mfma_f32_16x16x32_bf16 v[36:39], v[160:163], v[92:95], v[36:39]
  s_waitcnt lgkmcnt(6)
  v_mfma_f32_16x16x32_bf16 v[12:15], v[156:159], v[96:99], v[12:15]
  ds_read_b128 v[68:71], v232 offset:45056
  v_mfma_f32_16x16x32_bf16 v[40:43], v[160:163], v[96:99], v[40:43]
  s_add_u32 s66, s66, 4096
  buffer_load_dwordx2 v[116:117], v238, s[44:47], s66 offen offset:0 sc1
  buffer_load_dwordx2 v[118:119], v238, s[44:47], s66 offen offset:512 sc1
  s_add_u32 s67, s67, 4096
  buffer_load_dwordx2 v[120:121], v238, s[44:47], s67 offen offset:0 sc1
  buffer_load_dwordx2 v[122:123], v238, s[44:47], s67 offen offset:512 sc1
  s_waitcnt lgkmcnt(6)
  v_mfma_f32_16x16x32_bf16 v[16:19], v[156:159], v[100:103], v[16:19]
  ds_read_b128 v[72:75], v232 offset:46080
  v_mfma_f32_16x16x32_bf16 v[44:47], v[160:163], v[100:103], v[44:47]
  s_waitcnt lgkmcnt(6)
  v_mfma_f32_16x16x32_bf16 v[20:23], v[156:159], v[104:107], v[20:23]
  ds_read_b128 v[76:79], v232 offset:47104
  v_mfma_f32_16x16x32_bf16 v[48:51], v[160:163], v[104:107], v[48:51]
  s_waitcnt lgkmcnt(6)
  v_mfma_f32_16x16x32_bf16 v[24:27], v[156:159], v[108:111], v[24:27]
  ds_read_b128 v[80:83], v232 offset:48128
  v_mfma_f32_16x16x32_bf16 v[52:55], v[160:163], v[108:111], v[52:55]
  s_waitcnt lgkmcnt(6)
  v_mfma_f32_16x16x32_bf16 v[28:31], v[156:159], v[112:115], v[28:31]
  ds_read_b128 v[84:87], v232 offset:49152
  v_mfma_f32_16x16x32_bf16 v[56:59], v[160:163], v[112:115], v[56:59]
  s_waitcnt vmcnt(17) lgkmcnt(6)
  v_mfma_f32_16x16x32_bf16 v[4:7], v[164:167], v[60:63], v[4:7]
  ds_read_b128 v[88:91], v232 offset:50176
  s_waitcnt vmcnt(16)
  v_mfma_f32_16x16x32_bf16 v[32:35], v[168:171], v[60:63], v[32:35]
  s_waitcnt lgkmcnt(6)
  v_mfma_f32_16x16x32_bf16 v[8:11], v[164:167], v[64:67], v[8:11]
  ds_read_b128 v[92:95], v232 offset:51200
  v_mfma_f32_16x16x32_bf16 v[36:39], v[168:171], v[64:67], v[36:39]
  s_waitcnt lgkmcnt(6)
  v_mfma_f32_16x16x32_bf16 v[12:15], v[164:167], v[68:71], v[12:15]
  ds_read_b128 v[96:99], v232 offset:52224
  v_mfma_f32_16x16x32_bf16 v[40:43], v[168:171], v[68:71], v[40:43]
  buffer_load_dwordx4 v[124:127], v239, s[44:47], s66 offen offset:1024 sc1
  buffer_load_dwordx4 v[128:131], v239, s[44:47], s67 offen offset:1024 sc1
  s_waitcnt lgkmcnt(6)
  v_mfma_f32_16x16x32_bf16 v[16:19], v[164:167], v[72:75], v[16:19]
  ds_read_b128 v[100:103], v232 offset:53248
  v_mfma_f32_16x16x32_bf16 v[44:47], v[168:171], v[72:75], v[44:47]
  s_waitcnt lgkmcnt(6)
  v_mfma_f32_16x16x32_bf16 v[20:23], v[164:167], v[76:79], v[20:23]
  ds_read_b128 v[104:107], v232 offset:54272
  v_mfma_f32_16x16x32_bf16 v[48:51], v[168:171], v[76:79], v[48:51]
  s_waitcnt lgkmcnt(6)
  v_mfma_f32_16x16x32_bf16 v[24:27], v[164:167], v[80:83], v[24:27]
  ds_read_b128 v[108:111], v232 offset:55296
  v_mfma_f32_16x16x32_bf16 v[52:55], v[168:171], v[80:83], v[52:55]
  s_waitcnt lgkmcnt(6)
  v_mfma_f32_16x16x32_bf16 v[28:31], v[164:167], v[84:87], v[28:31]
  ds_read_b128 v[112:115], v232 offset:56320
  v_mfma_f32_16x16x32_bf16 v[56:59], v[168:171], v[84:87], v[56:59]
  s_waitcnt vmcnt(16) lgkmcnt(6)
  v_mfma_f32_16x16x32_bf16 v[4:7], v[172:175], v[88:91], v[4:7]
  ds_read_b128 v[60:63], v232 offset:57344
  s_waitcnt vmcnt(14)
  v_mfma_f32_16x16x32_bf16 v[32:35], v[176:179], v[88:91], v[32:35]
  s_waitcnt lgkmcnt(6)
  v_mfma_f32_16x16x32_bf16 v[8:11], v[172:175], v[92:95], v[8:11]
  ds_read_b128 v[64:67], v232 offset:58368
  v_mfma_f32_16x16x32_bf16 v[36:39], v[176:179], v[92:95], v[36:39]
  s_waitcnt lgkmcnt(6)
  v_mfma_f32_16x16x32_bf16 v[12:15], v[172:175], v[96:99], v[12:15]
  ds_read_b128 v[68:71], v232 offset:59392
  v_mfma_f32_16x16x32_bf16 v[40:43], v[176:179], v[96:99], v[40:43]
  buffer_load_dwordx4 v[132:135], v239, s[44:47], s66 offen offset:2048 sc1
  buffer_load_dwordx4 v[136:139], v239, s[44:47], s67 offen offset:2048 sc1
  s_waitcnt lgkmcnt(6)
  v_mfma_f32_16x16x32_bf16 v[16:19], v[172:175], v[100:103], v[16:19]
  ds_read_b128 v[72:75], v232 offset:60416
  v_mfma_f32_16x16x32_bf16 v[44:47], v[176:179], v[100:103], v[44:47]
  s_waitcnt lgkmcnt(6)
  v_mfma_f32_16x16x32_bf16 v[20:23], v[172:175], v[104:107], v[20:23]
  ds_read_b128 v[76:79], v232 offset:61440
  v_mfma_f32_16x16x32_bf16 v[48:51], v[176:179], v[104:107], v[48:51]
  s_waitcnt lgkmcnt(6)
  v_mfma_f32_16x16x32_bf16 v[24:27], v[172:175], v[108:111], v[24:27]
  ds_read_b128 v[80:83], v232 offset:62464
  v_mfma_f32_16x16x32_bf16 v[52:55], v[176:179], v[108:111], v[52:55]
  s_waitcnt lgkmcnt(6)
  v_mfma_f32_16x16x32_bf16 v[28:31], v[172:175], v[112:115], v[28:31]
  ds_read_b128 v[84:87], v232 offset:63488
  v_mfma_f32_16x16x32_bf16 v[56:59], v[176:179], v[112:115], v[56:59]
  s_waitcnt vmcnt(15) lgkmcnt(6)
  v_mfma_f32_16x16x32_bf16 v[4:7], v[180:183], v[60:63], v[4:7]
  ds_read_b128 v[88:91], v233 offset:0
  s_waitcnt vmcnt(14)
  v_mfma_f32_16x16x32_bf16 v[32:35], v[184:187], v[60:63], v[32:35]
  s_waitcnt lgkmcnt(6)
  v_mfma_f32_16x16x32_bf16 v[8:11], v[180:183], v[64:67], v[8:11]
  ds_read_b128 v[92:95], v233 offset:1024
  v_mfma_f32_16x16x32_bf16 v[36:39], v[184:187], v[64:67], v[36:39]
  s_waitcnt lgkmcnt(6)
  v_mfma_f32_16x16x32_bf16 v[12:15], v[180:183], v[68:71], v[12:15]
  ds_read_b128 v[96:99], v233 offset:2048
  v_mfma_f32_16x16x32_bf16 v[40:43], v[184:187], v[68:71], v[40:43]
  buffer_load_dwordx4 v[140:143], v239, s[44:47], s66 offen offset:3072 sc1
  buffer_load_dwordx4 v[144:147], v239, s[44:47], s67 offen offset:3072 sc1
  s_waitcnt lgkmcnt(6)
  v_mfma_f32_16x16x32_bf16 v[16:19], v[180:183], v[72:75], v[16:19]
  ds_read_b128 v[100:103], v233 offset:3072
  v_mfma_f32_16x16x32_bf16 v[44:47], v[184:187], v[72:75], v[44:47]
  s_waitcnt lgkmcnt(6)
  v_mfma_f32_16x16x32_bf16 v[20:23], v[180:183], v[76:79], v[20:23]
  ds_read_b128 v[104:107], v233 offset:4096
  v_mfma_f32_16x16x32_bf16 v[48:51], v[184:187], v[76:79], v[48:51]
  s_waitcnt lgkmcnt(6)
  v_mfma_f32_16x16x32_bf16 v[24:27], v[180:183], v[80:83], v[24:27]
  ds_read_b128 v[108:111], v233 offset:5120
  v_mfma_f32_16x16x32_bf16 v[52:55], v[184:187], v[80:83], v[52:55]
  s_waitcnt lgkmcnt(6)
  v_mfma_f32_16x16x32_bf16 v[28:31], v[180:183], v[84:87], v[28:31]
  ds_read_b128 v[112:115], v233 offset:6144
  v_mfma_f32_16x16x32_bf16 v[56:59], v[184:187], v[84:87], v[56:59]
  s_waitcnt vmcnt(15) lgkmcnt(6)
  v_mfma_f32_16x16x32_bf16 v[4:7], v[188:191], v[88:91], v[4:7]
  ds_read_b128 v[60:63], v233 offset:7168
  s_waitcnt vmcnt(14)
  v_mfma_f32_16x16x32_bf16 v[32:35], v[192:195], v[88:91], v[32:35]
  s_waitcnt lgkmcnt(6)
  v_mfma_f32_16x16x32_bf16 v[8:11], v[188:191], v[92:95], v[8:11]
  ds_read_b128 v[64:67], v233 offset:8192
  v_mfma_f32_16x16x32_bf16 v[36:39], v[192:195], v[92:95], v[36:39]
  s_waitcnt lgkmcnt(6)
  v_mfma_f32_16x16x32_bf16 v[12:15], v[188:191], v[96:99], v[12:15]
  ds_read_b128 v[68:71], v233 offset:9216
  v_mfma_f32_16x16x32_bf16 v[40:43], v[192:195], v[96:99], v[40:43]
  s_add_u32 s66, s66, 4096
  buffer_load_dwordx4 v[148:151], v239, s[44:47], s66 offen offset:0 sc1
  s_add_u32 s67, s67, 4096
  buffer_load_dwordx4 v[152:155], v239, s[44:47], s67 offen offset:0 sc1
  s_waitcnt lgkmcnt(6)
  v_mfma_f32_16x16x32_bf16 v[16:19], v[188:191], v[100:103], v[16:19]
  ds_read_b128 v[72:75], v233 offset:10240
  v_mfma_f32_16x16x32_bf16 v[44:47], v[192:195], v[100:103], v[44:47]
  s_waitcnt lgkmcnt(6)
  v_mfma_f32_16x16x32_bf16 v[20:23], v[188:191], v[104:107], v[20:23]
  ds_read_b128 v[76:79], v233 offset:11264
  v_mfma_f32_16x16x32_bf16 v[48:51], v[192:195], v[104:107], v[48:51]
  s_waitcnt lgkmcnt(6)
  v_mfma_f32_16x16x32_bf16 v[24:27], v[188:191], v[108:111], v[24:27]
  ds_read_b128 v[80:83], v233 offset:12288
  v_mfma_f32_16x16x32_bf16 v[52:55], v[192:195], v[108:111], v[52:55]
  s_waitcnt lgkmcnt(6)
  v_mfma_f32_16x16x32_bf16 v[28:31], v[188:191], v[112:115], v[28:31]
  ds_read_b128 v[84:87], v233 offset:13312
  v_mfma_f32_16x16x32_bf16 v[56:59], v[192:195], v[112:115], v[56:59]
  s_waitcnt vmcnt(15) lgkmcnt(6)
  v_mfma_f32_16x16x32_bf16 v[4:7], v[196:199], v[60:63], v[4:7]
  ds_read_b128 v[88:91], v233 offset:14336
  s_waitcnt vmcnt(14)
  v_mfma_f32_16x16x32_bf16 v[32:35], v[200:203], v[60:63], v[32:35]
  s_waitcnt lgkmcnt(6)
  v_mfma_f32_16x16x32_bf16 v[8:11], v[196:199], v[64:67], v[8:11]
  ds_read_b128 v[92:95], v233 offset:15360
  v_mfma_f32_16x16x32_bf16 v[36:39], v[200:203], v[64:67], v[36:39]
  s_waitcnt lgkmcnt(6)
  v_mfma_f32_16x16x32_bf16 v[12:15], v[196:199], v[68:71], v[12:15]
  ds_read_b128 v[96:99], v233 offset:16384
  v_mfma_f32_16x16x32_bf16 v[40:43], v[200:203], v[68:71], v[40:43]
  buffer_load_dwordx2 v[156:157], v238, s[44:47], s66 offen offset:1024 sc1
  buffer_load_dwordx2 v[158:159], v238, s[44:47], s66 offen offset:1536 sc1
  buffer_load_dwordx2 v[160:161], v238, s[44:47], s67 offen offset:1024 sc1
  buffer_load_dwordx2 v[162:163], v238, s[44:47], s67 offen offset:1536 sc1
  s_waitcnt lgkmcnt(6)
  v_mfma_f32_16x16x32_bf16 v[16:19], v[196:199], v[72:75], v[16:19]
  ds_read_b128 v[100:103], v233 offset:17408
  v_mfma_f32_16x16x32_bf16 v[44:47], v[200:203], v[72:75], v[44:47]
  s_waitcnt lgkmcnt(6)
  v_mfma_f32_16x16x32_bf16 v[20:23], v[196:199], v[76:79], v[20:23]
  ds_read_b128 v[104:107], v233 offset:18432
  v_mfma_f32_16x16x32_bf16 v[48:51], v[200:203], v[76:79], v[48:51]
  s_waitcnt lgkmcnt(6)
  v_mfma_f32_16x16x32_bf16 v[24:27], v[196:199], v[80:83], v[24:27]
  ds_read_b128 v[108:111], v233 offset:19456
  v_mfma_f32_16x16x32_bf16 v[52:55], v[200:203], v[80:83], v[52:55]
  s_waitcnt lgkmcnt(6)
  v_mfma_f32_16x16x32_bf16 v[28:31], v[196:199], v[84:87], v[28:31]
  ds_read_b128 v[112:115], v233 offset:20480
  v_mfma_f32_16x16x32_bf16 v[56:59], v[200:203], v[84:87], v[56:59]
  s_barrier
  s_waitcnt vmcnt(17) lgkmcnt(6)
  v_mfma_f32_16x16x32_bf16 v[4:7], v[204:207], v[88:91], v[4:7]
  ds_read_b128 v[60:63], v233 offset:21504
  s_waitcnt vmcnt(16)
  v_mfma_f32_16x16x32_bf16 v[32:35], v[208:211], v[88:91], v[32:35]
  s_waitcnt lgkmcnt(6)
  v_mfma_f32_16x16x32_bf16 v[8:11], v[204:207], v[92:95], v[8:11]
  ds_read_b128 v[64:67], v233 offset:22528
  v_mfma_f32_16x16x32_bf16 v[36:39], v[208:211], v[92:95], v[36:39]
  s_waitcnt lgkmcnt(6)
  v_mfma_f32_16x16x32_bf16 v[12:15], v[204:207], v[96:99], v[12:15]
  ds_read_b128 v[68:71], v233 offset:23552
  v_mfma_f32_16x16x32_bf16 v[40:43], v[208:211], v[96:99], v[40:43]
  buffer_load_dwordx4 v[164:167], v239, s[44:47], s66 offen offset:2048 sc1
  buffer_load_dwordx4 v[168:171], v239, s[44:47], s67 offen offset:2048 sc1
  s_waitcnt lgkmcnt(6)
  v_mfma_f32_16x16x32_bf16 v[16:19], v[204:207], v[100:103], v[16:19]
  ds_read_b128 v[72:75], v233 offset:24576
  v_mfma_f32_16x16x32_bf16 v[44:47], v[208:211], v[100:103], v[44:47]
  s_waitcnt lgkmcnt(6)
  v_mfma_f32_16x16x32_bf16 v[20:23], v[204:207], v[104:107], v[20:23]
  ds_read_b128 v[76:79], v233 offset:25600
  v_mfma_f32_16x16x32_bf16 v[48:51], v[208:211], v[104:107], v[48:51]
  s_waitcnt lgkmcnt(6)
  v_mfma_f32_16x16x32_bf16 v[24:27], v[204:207], v[108:111], v[24:27]
  ds_read_b128 v[80:83], v233 offset:26624
  v_mfma_f32_16x16x32_bf16 v[52:55], v[208:211], v[108:111], v[52:55]
  s_waitcnt lgkmcnt(6)
  v_mfma_f32_16x16x32_bf16 v[28:31], v[204:207], v[112:115], v[28:31]
  ds_read_b128 v[84:87], v233 offset:27648
  v_mfma_f32_16x16x32_bf16 v[56:59], v[208:211], v[112:115], v[56:59]
  s_waitcnt vmcnt(16) lgkmcnt(6)
  v_mfma_f32_16x16x32_bf16 v[4:7], v[116:119], v[60:63], v[4:7]
  ds_read_b128 v[88:91], v233 offset:28672
  s_waitcnt vmcnt(14)
  v_mfma_f32_16x16x32_bf16 v[32:35], v[120:123], v[60:63], v[32:35]
  s_waitcnt lgkmcnt(6)
  v_mfma_f32_16x16x32_bf16 v[8:11], v[116:119], v[64:67], v[8:11]
  ds_read_b128 v[92:95], v233 offset:29696
  v_mfma_f32_16x16x32_bf16 v[36:39], v[120:123], v[64:67], v[36:39]
  s_waitcnt lgkmcnt(6)
  v_mfma_f32_16x16x32_bf16 v[12:15], v[116:119], v[68:71], v[12:15]
  ds_read_b128 v[96:99], v233 offset:30720
  v_mfma_f32_16x16x32_bf16 v[40:43], v[120:123], v[68:71], v[40:43]
  buffer_load_dwordx4 v[172:175], v239, s[44:47], s66 offen offset:3072 sc1
  buffer_load_dwordx4 v[176:179], v239, s[44:47], s67 offen offset:3072 sc1
  s_waitcnt lgkmcnt(6)
  v_mfma_f32_16x16x32_bf16 v[16:19], v[116:119], v[72:75], v[16:19]
  ds_read_b128 v[100:103], v233 offset:31744
  v_mfma_f32_16x16x32_bf16 v[44:47], v[120:123], v[72:75], v[44:47]
  s_waitcnt lgkmcnt(6)
  v_mfma_f32_16x16x32_bf16 v[20:23], v[116:119], v[76:79], v[20:23]
  ds_read_b128 v[104:107], v233 offset:32768
  v_mfma_f32_16x16x32_bf16 v[48:51], v[120:123], v[76:79], v[48:51]
  s_waitcnt lgkmcnt(6)
  v_mfma_f32_16x16x32_bf16 v[24:27], v[116:119], v[80:83], v[24:27]
  ds_read_b128 v[108:111], v233 offset:33792
  v_mfma_f32_16x16x32_bf16 v[52:55], v[120:123], v[80:83], v[52:55]
  s_waitcnt lgkmcnt(6)
  v_mfma_f32_16x16x32_bf16 v[28:31], v[116:119], v[84:87], v[28:31]
  ds_read_b128 v[112:115], v233 offset:34816
  v_mfma_f32_16x16x32_bf16 v[56:59], v[120:123], v[84:87], v[56:59]
  s_barrier
  s_waitcnt vmcnt(15) lgkmcnt(6)
  v_mfma_f32_16x16x32_bf16 v[4:7], v[124:127], v[88:91], v[4:7]
  ds_read_b128 v[60:63], v233 offset:35840
  s_waitcnt vmcnt(14)
  v_mfma_f32_16x16x32_bf16 v[32:35], v[128:131], v[88:91], v[32:35]
  s_waitcnt lgkmcnt(6)
  v_mfma_f32_16x16x32_bf16 v[8:11], v[124:127], v[92:95], v[8:11]
  ds_read_b128 v[64:67], v233 offset:36864
  v_mfma_f32_16x16x32_bf16 v[36:39], v[128:131], v[92:95], v[36:39]
  s_waitcnt lgkmcnt(6)
  v_mfma_f32_16x16x32_bf16 v[12:15], v[124:127], v[96:99], v[12:15]
  ds_read_b128 v[68:71], v233 offset:37888
  v_mfma_f32_16x16x32_bf16 v[40:43], v[128:131], v[96:99], v[40:43]
  s_waitcnt lgkmcnt(6)
  v_mfma_f32_16x16x32_bf16 v[16:19], v[124:127], v[100:103], v[16:19]
  ds_read_b128 v[72:75], v233 offset:38912
  v_mfma_f32_16x16x32_bf16 v[44:47], v[128:131], v[100:103], v[44:47]
  s_waitcnt lgkmcnt(6)
  v_mfma_f32_16x16x32_bf16 v[20:23], v[124:127], v[104:107], v[20:23]
  ds_read_b128 v[76:79], v233 offset:39936
  v_mfma_f32_16x16x32_bf16 v[48:51], v[128:131], v[104:107], v[48:51]
  s_waitcnt lgkmcnt(6)
  v_mfma_f32_16x16x32_bf16 v[24:27], v[124:127], v[108:111], v[24:27]
  ds_read_b128 v[80:83], v233 offset:40960
  v_mfma_f32_16x16x32_bf16 v[52:55], v[128:131], v[108:111], v[52:55]
  s_waitcnt lgkmcnt(6)
  v_mfma_f32_16x16x32_bf16 v[28:31], v[124:127], v[112:115], v[28:31]
  ds_read_b128 v[84:87], v233 offset:41984
  v_mfma_f32_16x16x32_bf16 v[56:59], v[128:131], v[112:115], v[56:59]
  s_waitcnt vmcnt(13) lgkmcnt(6)
  v_mfma_f32_16x16x32_bf16 v[4:7], v[132:135], v[60:63], v[4:7]
  ds_read_b128 v[88:91], v233 offset:43008
  s_waitcnt vmcnt(12)
  v_mfma_f32_16x16x32_bf16 v[32:35], v[136:139], v[60:63], v[32:35]
  s_waitcnt lgkmcnt(6)
  v_mfma_f32_16x16x32_bf16 v[8:11], v[132:135], v[64:67], v[8:11]
  ds_read_b128 v[92:95], v233 offset:44032
  v_mfma_f32_16x16x32_bf16 v[36:39], v[136:139], v[64:67], v[36:39]
  s_waitcnt lgkmcnt(6)
  v_mfma_f32_16x16x32_bf16 v[12:15], v[132:135], v[68:71], v[12:15]
  ds_read_b128 v[96:99], v233 offset:45056
  v_mfma_f32_16x16x32_bf16 v[40:43], v[136:139], v[68:71], v[40:43]
  s_waitcnt lgkmcnt(6)
  v_mfma_f32_16x16x32_bf16 v[16:19], v[132:135], v[72:75], v[16:19]
  ds_read_b128 v[100:103], v233 offset:46080
  v_mfma_f32_16x16x32_bf16 v[44:47], v[136:139], v[72:75], v[44:47]
  s_waitcnt lgkmcnt(6)
  v_mfma_f32_16x16x32_bf16 v[20:23], v[132:135], v[76:79], v[20:23]
  ds_read_b128 v[104:107], v233 offset:47104
  v_mfma_f32_16x16x32_bf16 v[48:51], v[136:139], v[76:79], v[48:51]
  s_waitcnt lgkmcnt(6)
  v_mfma_f32_16x16x32_bf16 v[24:27], v[132:135], v[80:83], v[24:27]
  ds_read_b128 v[108:111], v233 offset:48128
  v_mfma_f32_16x16x32_bf16 v[52:55], v[136:139], v[80:83], v[52:55]
  s_waitcnt lgkmcnt(6)
  v_mfma_f32_16x16x32_bf16 v[28:31], v[132:135], v[84:87], v[28:31]
  ds_read_b128 v[112:115], v233 offset:49152
  v_mfma_f32_16x16x32_bf16 v[56:59], v[136:139], v[84:87], v[56:59]
  s_waitcnt vmcnt(11) lgkmcnt(6)
  v_mfma_f32_16x16x32_bf16 v[4:7], v[140:143], v[88:91], v[4:7]
  ds_read_b128 v[60:63], v233 offset:50176
  s_waitcnt vmcnt(10)
  v_mfma_f32_16x16x32_bf16 v[32:35], v[144:147], v[88:91], v[32:35]
  s_waitcnt lgkmcnt(6)
  v_mfma_f32_16x16x32_bf16 v[8:11], v[140:143], v[92:95], v[8:11]
  ds_read_b128 v[64:67], v233 offset:51200
  v_mfma_f32_16x16x32_bf16 v[36:39], v[144:147], v[92:95], v[36:39]
  s_waitcnt lgkmcnt(6)
  v_mfma_f32_16x16x32_bf16 v[12:15], v[140:143], v[96:99], v[12:15]
  ds_read_b128 v[68:71], v233 offset:52224
  v_mfma_f32_16x16x32_bf16 v[40:43], v[144:147], v[96:99], v[40:43]
  s_waitcnt lgkmcnt(6)
  v_mfma_f32_16x16x32_bf16 v[16:19], v[140:143], v[100:103], v[16:19]
  ds_read_b128 v[72:75], v233 offset:53248
  v_mfma_f32_16x16x32_bf16 v[44:47], v[144:147], v[100:103], v[44:47]
  s_waitcnt lgkmcnt(6)
  v_mfma_f32_16x16x32_bf16 v[20:23], v[140:143], v[104:107], v[20:23]
  ds_read_b128 v[76:79], v233 offset:54272
  v_mfma_f32_16x16x32_bf16 v[48:51], v[144:147], v[104:107], v[48:51]
  s_waitcnt lgkmcnt(6)
  v_mfma_f32_16x16x32_bf16 v[24:27], v[140:143], v[108:111], v[24:27]
  ds_read_b128 v[80:83], v233 offset:55296
  v_mfma_f32_16x16x32_bf16 v[52:55], v[144:147], v[108:111], v[52:55]
  s_waitcnt lgkmcnt(6)
  v_mfma_f32_16x16x32_bf16 v[28:31], v[140:143], v[112:115], v[28:31]
  ds_read_b128 v[84:87], v233 offset:56320
  v_mfma_f32_16x16x32_bf16 v[56:59], v[144:147], v[112:115], v[56:59]
  s_waitcnt vmcnt(9) lgkmcnt(6)
  v_mfma_f32_16x16x32_bf16 v[4:7], v[148:151], v[60:63], v[4:7]
  ds_read_b128 v[88:91], v233 offset:57344
  s_waitcnt vmcnt(8)
  v_mfma_f32_16x16x32_bf16 v[32:35], v[152:155], v[60:63], v[32:35]
  s_waitcnt lgkmcnt(6)
  v_mfma_f32_16x16x32_bf16 v[8:11], v[148:151], v[64:67], v[8:11]
  ds_read_b128 v[92:95], v233 offset:58368
  v_mfma_f32_16x16x32_bf16 v[36:39], v[152:155], v[64:67], v[36:39]
  s_waitcnt lgkmcnt(6)
  v_mfma_f32_16x16x32_bf16 v[12:15], v[148:151], v[68:71], v[12:15]
  ds_read_b128 v[96:99], v233 offset:59392
  v_mfma_f32_16x16x32_bf16 v[40:43], v[152:155], v[68:71], v[40:43]
  s_waitcnt lgkmcnt(6)
  v_mfma_f32_16x16x32_bf16 v[16:19], v[148:151], v[72:75], v[16:19]
  ds_read_b128 v[100:103], v233 offset:60416
  v_mfma_f32_16x16x32_bf16 v[44:47], v[152:155], v[72:75], v[44:47]
  s_waitcnt lgkmcnt(6)
  v_mfma_f32_16x16x32_bf16 v[20:23], v[148:151], v[76:79], v[20:23]
  ds_read_b128 v[104:107], v233 offset:61440
  v_mfma_f32_16x16x32_bf16 v[48:51], v[152:155], v[76:79], v[48:51]
  s_waitcnt lgkmcnt(6)
  v_mfma_f32_16x16x32_bf16 v[24:27], v[148:151], v[80:83], v[24:27]
  ds_read_b128 v[108:111], v233 offset:62464
  v_mfma_f32_16x16x32_bf16 v[52:55], v[152:155], v[80:83], v[52:55]
  s_waitcnt lgkmcnt(6)
  v_mfma_f32_16x16x32_bf16 v[28:31], v[148:151], v[84:87], v[28:31]
  ds_read_b128 v[112:115], v233 offset:63488
  v_mfma_f32_16x16x32_bf16 v[56:59], v[152:155], v[84:87], v[56:59]
  s_waitcnt vmcnt(6) lgkmcnt(6)
  v_mfma_f32_16x16x32_bf16 v[4:7], v[156:159], v[88:91], v[4:7]
  ds_read_b128 v[60:63], v234 offset:0
  s_waitcnt vmcnt(4)
  v_mfma_f32_16x16x32_bf16 v[32:35], v[160:163], v[88:91], v[32:35]
  s_waitcnt lgkmcnt(6)
  v_mfma_f32_16x16x32_bf16 v[8:11], v[156:159], v[92:95], v[8:11]
  ds_read_b128 v[64:67], v234 offset:1024
  v_mfma_f32_16x16x32_bf16 v[36:39], v[160:163], v[92:95], v[36:39]
  s_waitcnt lgkmcnt(6)
  v_mfma_f32_16x16x32_bf16 v[12:15], v[156:159], v[96:99], v[12:15]
  ds_read_b128 v[68:71], v234 offset:2048
  v_mfma_f32_16x16x32_bf16 v[40:43], v[160:163], v[96:99], v[40:43]
  s_waitcnt lgkmcnt(6)
  v_mfma_f32_16x16x32_bf16 v[16:19], v[156:159], v[100:103], v[16:19]
  ds_read_b128 v[72:75], v234 offset:3072
  v_mfma_f32_16x16x32_bf16 v[44:47], v[160:163], v[100:103], v[44:47]
  s_waitcnt lgkmcnt(6)
  v_mfma_f32_16x16x32_bf16 v[20:23], v[156:159], v[104:107], v[20:23]
  ds_read_b128 v[76:79], v234 offset:4096
  v_mfma_f32_16x16x32_bf16 v[48:51], v[160:163], v[104:107], v[48:51]
  s_waitcnt lgkmcnt(6)
  v_mfma_f32_16x16x32_bf16 v[24:27], v[156:159], v[108:111], v[24:27]
  ds_read_b128 v[80:83], v234 offset:5120
  v_mfma_f32_16x16x32_bf16 v[52:55], v[160:163], v[108:111], v[52:55]
  s_waitcnt lgkmcnt(6)
  v_mfma_f32_16x16x32_bf16 v[28:31], v[156:159], v[112:115], v[28:31]
  ds_read_b128 v[84:87], v234 offset:6144
  v_mfma_f32_16x16x32_bf16 v[56:59], v[160:163], v[112:115], v[56:59]
  s_waitcnt vmcnt(3) lgkmcnt(6)
  v_mfma_f32_16x16x32_bf16 v[4:7], v[164:167], v[60:63], v[4:7]
  ds_read_b128 v[88:91], v234 offset:7168
  s_waitcnt vmcnt(2)
  v_mfma_f32_16x16x32_bf16 v[32:35], v[168:171], v[60:63], v[32:35]
  s_waitcnt lgkmcnt(6)
  v_mfma_f32_16x16x32_bf16 v[8:11], v[164:167], v[64:67], v[8:11]
  ds_read_b128 v[92:95], v234 offset:8192
  v_mfma_f32_16x16x32_bf16 v[36:39], v[168:171], v[64:67], v[36:39]
  s_waitcnt lgkmcnt(6)
  v_mfma_f32_16x16x32_bf16 v[12:15], v[164:167], v[68:71], v[12:15]
  ds_read_b128 v[96:99], v234 offset:9216
  v_mfma_f32_16x16x32_bf16 v[40:43], v[168:171], v[68:71], v[40:43]
  s_waitcnt lgkmcnt(6)
  v_mfma_f32_16x16x32_bf16 v[16:19], v[164:167], v[72:75], v[16:19]
  ds_read_b128 v[100:103], v234 offset:10240
  v_mfma_f32_16x16x32_bf16 v[44:47], v[168:171], v[72:75], v[44:47]
  s_waitcnt lgkmcnt(6)
  v_mfma_f32_16x16x32_bf16 v[20:23], v[164:167], v[76:79], v[20:23]
  ds_read_b128 v[104:107], v234 offset:11264
  v_mfma_f32_16x16x32_bf16 v[48:51], v[168:171], v[76:79], v[48:51]
  s_waitcnt lgkmcnt(6)
  v_mfma_f32_16x16x32_bf16 v[24:27], v[164:167], v[80:83], v[24:27]
  ds_read_b128 v[108:111], v234 offset:12288
  v_mfma_f32_16x16x32_bf16 v[52:55], v[168:171], v[80:83], v[52:55]
  s_waitcnt lgkmcnt(6)
  v_mfma_f32_16x16x32_bf16 v[28:31], v[164:167], v[84:87], v[28:31]
  ds_read_b128 v[112:115], v234 offset:13312
  v_mfma_f32_16x16x32_bf16 v[56:59], v[168:171], v[84:87], v[56:59]
  s_waitcnt vmcnt(1) lgkmcnt(6)
  v_mfma_f32_16x16x32_bf16 v[4:7], v[172:175], v[88:91], v[4:7]
  s_waitcnt vmcnt(0)
  v_mfma_f32_16x16x32_bf16 v[32:35], v[176:179], v[88:91], v[32:35]
  s_waitcnt lgkmcnt(5)
  v_mfma_f32_16x16x32_bf16 v[8:11], v[172:175], v[92:95], v[8:11]
  v_mfma_f32_16x16x32_bf16 v[36:39], v[176:179], v[92:95], v[36:39]
  s_waitcnt lgkmcnt(4)
  v_mfma_f32_16x16x32_bf16 v[12:15], v[172:175], v[96:99], v[12:15]
  v_mfma_f32_16x16x32_bf16 v[40:43], v[176:179], v[96:99], v[40:43]
  s_waitcnt lgkmcnt(3)
  v_mfma_f32_16x16x32_bf16 v[16:19], v[172:175], v[100:103], v[16:19]
  v_mfma_f32_16x16x32_bf16 v[44:47], v[176:179], v[100:103], v[44:47]
  s_waitcnt lgkmcnt(2)
  v_mfma_f32_16x16x32_bf16 v[20:23], v[172:175], v[104:107], v[20:23]
  v_mfma_f32_16x16x32_bf16 v[48:51], v[176:179], v[104:107], v[48:51]
  s_waitcnt lgkmcnt(1)
  v_mfma_f32_16x16x32_bf16 v[24:27], v[172:175], v[108:111], v[24:27]
  v_mfma_f32_16x16x32_bf16 v[52:55], v[176:179], v[108:111], v[52:55]
  s_waitcnt lgkmcnt(0)
  v_mfma_f32_16x16x32_bf16 v[28:31], v[172:175], v[112:115], v[28:31]
  v_mfma_f32_16x16x32_bf16 v[56:59], v[176:179], v[112:115], v[56:59]
  s_branch IF_176_end
IF_176_else:
  ds_read_b128 v[60:63], v232 offset:0
  ds_read_b128 v[64:67], v232 offset:1024
  ds_read_b128 v[68:71], v232 offset:2048
  ds_read_b128 v[72:75], v232 offset:3072
  ds_read_b128 v[76:79], v232 offset:4096
  ds_read_b128 v[80:83], v232 offset:5120
  ds_read_b128 v[84:87], v232 offset:6144
  s_waitcnt vmcnt(7) lgkmcnt(6)
  v_mfma_f32_16x16x32_bf16 v[4:7], v[60:63], v[116:119], 0
  ds_read_b128 v[88:91], v232 offset:7168
  s_waitcnt vmcnt(6)
  v_mfma_f32_16x16x32_bf16 v[32:35], v[60:63], v[120:123], 0
  s_waitcnt lgkmcnt(6)
  v_mfma_f32_16x16x32_bf16 v[8:11], v[64:67], v[116:119], 0
  ds_read_b128 v[92:95], v232 offset:8192
  v_mfma_f32_16x16x32_bf16 v[36:39], v[64:67], v[120:123], 0
  s_waitcnt lgkmcnt(6)
  v_mfma_f32_16x16x32_bf16 v[12:15], v[68:71], v[116:119], 0
  ds_read_b128 v[96:99], v232 offset:9216
  v_mfma_f32_16x16x32_bf16 v[40:43], v[68:71], v[120:123], 0
  buffer_load_dwordx4 v[140:143], v239, s[44:47], s66 offen offset:3072 sc1
  buffer_load_dwordx4 v[144:147], v239, s[44:47], s67 offen offset:3072 sc1
  s_waitcnt lgkmcnt(6)
  v_mfma_f32_16x16x32_bf16 v[16:19], v[72:75], v[116:119], 0
  ds_read_b128 v[100:103], v232 offset:10240
  v_mfma_f32_16x16x32_bf16 v[44:47], v[72:75], v[120:123], 0
  s_waitcnt lgkmcnt(6)
  v_mfma_f32_16x16x32_bf16 v[20:23], v[76:79], v[116:119], 0
  ds_read_b128 v[104:107], v232 offset:11264
  v_mfma_f32_16x16x32_bf16 v[48:51], v[76:79], v[120:123], 0
  s_waitcnt lgkmcnt(6)
  v_mfma_f32_16x16x32_bf16 v[24:27], v[80:83], v[116:119], 0
  ds_read_b128 v[108:111], v232 offset:12288
  v_mfma_f32_16x16x32_bf16 v[52:55], v[80:83], v[120:123], 0
  s_add_u32 s66, s66, 4096
  buffer_load_dwordx4 v[148:151], v239, s[44:47], s66 offen offset:0 sc1
  s_add_u32 s67, s67, 4096
  buffer_load_dwordx4 v[152:155], v239, s[44:47], s67 offen offset:0 sc1
  s_waitcnt lgkmcnt(6)
  v_mfma_f32_16x16x32_bf16 v[28:31], v[84:87], v[116:119], 0
  ds_read_b128 v[112:115], v232 offset:13312
  v_mfma_f32_16x16x32_bf16 v[56:59], v[84:87], v[120:123], 0
  s_waitcnt vmcnt(9) lgkmcnt(6)
  v_mfma_f32_16x16x32_bf16 v[4:7], v[88:91], v[124:127], v[4:7]
  ds_read_b128 v[60:63], v232 offset:14336
  s_waitcnt vmcnt(8)
  v_mfma_f32_16x16x32_bf16 v[32:35], v[88:91], v[128:131], v[32:35]
  s_waitcnt lgkmcnt(6)
  v_mfma_f32_16x16x32_bf16 v[8:11], v[92:95], v[124:127], v[8:11]
  ds_read_b128 v[64:67], v232 offset:15360
  v_mfma_f32_16x16x32_bf16 v[36:39], v[92:95], v[128:131], v[36:39]
  s_waitcnt lgkmcnt(6)
  v_mfma_f32_16x16x32_bf16 v[12:15], v[96:99], v[124:127], v[12:15]
  ds_read_b128 v[68:71], v232 offset:16384
  v_mfma_f32_16x16x32_bf16 v[40:43], v[96:99], v[128:131], v[40:43]
  buffer_load_dwordx4 v[156:159], v239, s[44:47], s66 offen offset:1024 sc1
  buffer_load_dwordx4 v[160:163], v239, s[44:47], s67 offen offset:1024 sc1
  s_waitcnt lgkmcnt(6)
  v_mfma_f32_16x16x32_bf16 v[16:19], v[100:103], v[124:127], v[16:19]
  ds_read_b128 v[72:75], v232 offset:17408
  v_mfma_f32_16x16x32_bf16 v[44:47], v[100:103], v[128:131], v[44:47]
  s_waitcnt lgkmcnt(6)
  v_mfma_f32_16x16x32_bf16 v[20:23], v[104:107], v[124:127], v[20:23]
  ds_read_b128 v[76:79], v232 offset:18432
  v_mfma_f32_16x16x32_bf16 v[48:51], v[104:107], v[128:131], v[48:51]
  s_waitcnt lgkmcnt(6)
  v_mfma_f32_16x16x32_bf16 v[24:27], v[108:111], v[124:127], v[24:27]
  ds_read_b128 v[80:83], v232 offset:19456
  v_mfma_f32_16x16x32_bf16 v[52:55], v[108:111], v[128:131], v[52:55]
  buffer_load_dwordx4 v[164:167], v239, s[44:47], s66 offen offset:2048 sc1
  buffer_load_dwordx4 v[168:171], v239, s[44:47], s67 offen offset:2048 sc1
  s_waitcnt lgkmcnt(6)
  v_mfma_f32_16x16x32_bf16 v[28:31], v[112:115], v[124:127], v[28:31]
  ds_read_b128 v[84:87], v232 offset:20480
  v_mfma_f32_16x16x32_bf16 v[56:59], v[112:115], v[128:131], v[56:59]
  s_waitcnt vmcnt(10) lgkmcnt(6)
  v_mfma_f32_16x16x32_bf16 v[4:7], v[60:63], v[132:135], v[4:7]
  ds_read_b128 v[88:91], v232 offset:21504
  s_waitcnt vmcnt(8)
  v_mfma_f32_16x16x32_bf16 v[32:35], v[60:63], v[136:139], v[32:35]
  s_waitcnt lgkmcnt(6)
  v_mfma_f32_16x16x32_bf16 v[8:11], v[64:67], v[132:135], v[8:11]
  ds_read_b128 v[92:95], v232 offset:22528
  v_mfma_f32_16x16x32_bf16 v[36:39], v[64:67], v[136:139], v[36:39]
  s_waitcnt lgkmcnt(6)
  v_mfma_f32_16x16x32_bf16 v[12:15], v[68:71], v[132:135], v[12:15]
  ds_read_b128 v[96:99], v232 offset:23552
  v_mfma_f32_16x16x32_bf16 v[40:43], v[68:71], v[136:139], v[40:43]
  buffer_load_dwordx2 v[172:173], v238, s[44:47], s66 offen offset:3072 sc1
  buffer_load_dwordx2 v[174:175], v238, s[44:47], s66 offen offset:3584 sc1
  buffer_load_dwordx2 v[176:177], v238, s[44:47], s67 offen offset:3072 sc1
  buffer_load_dwordx2 v[178:179], v238, s[44:47], s67 offen offset:3584 sc1
  s_waitcnt lgkmcnt(6)
  v_mfma_f32_16x16x32_bf16 v[16:19], v[72:75], v[132:135], v[16:19]
  ds_read_b128 v[100:103], v232 offset:24576
  v_mfma_f32_16x16x32_bf16 v[44:47], v[72:75], v[136:139], v[44:47]
  s_waitcnt lgkmcnt(6)
  v_mfma_f32_16x16x32_bf16 v[20:23], v[76:79], v[132:135], v[20:23]
  ds_read_b128 v[104:107], v232 offset:25600
  v_mfma_f32_16x16x32_bf16 v[48:51], v[76:79], v[136:139], v[48:51]
  s_waitcnt lgkmcnt(6)
  v_mfma_f32_16x16x32_bf16 v[24:27], v[80:83], v[132:135], v[24:27]
  ds_read_b128 v[108:111], v232 offset:26624
  v_mfma_f32_16x16x32_bf16 v[52:55], v[80:83], v[136:139], v[52:55]
  s_add_u32 s66, s66, 4096
  buffer_load_dwordx4 v[180:183], v239, s[44:47], s66 offen offset:0 sc1
  s_add_u32 s67, s67, 4096
  buffer_load_dwordx4 v[184:187], v239, s[44:47], s67 offen offset:0 sc1
  s_waitcnt lgkmcnt(6)
  v_mfma_f32_16x16x32_bf16 v[28:31], v[84:87], v[132:135], v[28:31]
  ds_read_b128 v[112:115], v232 offset:27648
  v_mfma_f32_16x16x32_bf16 v[56:59], v[84:87], v[136:139], v[56:59]
  s_waitcnt vmcnt(13) lgkmcnt(6)
  v_mfma_f32_16x16x32_bf16 v[4:7], v[88:91], v[140:143], v[4:7]
  ds_read_b128 v[60:63], v232 offset:28672
  s_waitcnt vmcnt(12)
  v_mfma_f32_16x16x32_bf16 v[32:35], v[88:91], v[144:147], v[32:35]
  s_waitcnt lgkmcnt(6)
  v_mfma_f32_16x16x32_bf16 v[8:11], v[92:95], v[140:143], v[8:11]
  ds_read_b128 v[64:67], v232 offset:29696
  v_mfma_f32_16x16x32_bf16 v[36:39], v[92:95], v[144:147], v[36:39]
  s_waitcnt lgkmcnt(6)
  v_mfma_f32_16x16x32_bf16 v[12:15], v[96:99], v[140:143], v[12:15]
  ds_read_b128 v[68:71], v232 offset:30720
  v_mfma_f32_16x16x32_bf16 v[40:43], v[96:99], v[144:147], v[40:43]
  buffer_load_dwordx4 v[188:191], v239, s[44:47], s66 offen offset:1024 sc1
  buffer_load_dwordx4 v[192:195], v239, s[44:47], s67 offen offset:1024 sc1
  s_waitcnt lgkmcnt(6)
  v_mfma_f32_16x16x32_bf16 v[16:19], v[100:103], v[140:143], v[16:19]
  ds_read_b128 v[72:75], v232 offset:31744
  v_mfma_f32_16x16x32_bf16 v[44:47], v[100:103], v[144:147], v[44:47]
  s_waitcnt lgkmcnt(6)
  v_mfma_f32_16x16x32_bf16 v[20:23], v[104:107], v[140:143], v[20:23]
  ds_read_b128 v[76:79], v232 offset:32768
  v_mfma_f32_16x16x32_bf16 v[48:51], v[104:107], v[144:147], v[48:51]
  s_waitcnt lgkmcnt(6)
  v_mfma_f32_16x16x32_bf16 v[24:27], v[108:111], v[140:143], v[24:27]
  ds_read_b128 v[80:83], v232 offset:33792
  v_mfma_f32_16x16x32_bf16 v[52:55], v[108:111], v[144:147], v[52:55]
  buffer_load_dwordx4 v[196:199], v239, s[44:47], s66 offen offset:2048 sc1
  buffer_load_dwordx4 v[200:203], v239, s[44:47], s67 offen offset:2048 sc1
  s_waitcnt lgkmcnt(6)
  v_mfma_f32_16x16x32_bf16 v[28:31], v[112:115], v[140:143], v[28:31]
  ds_read_b128 v[84:87], v232 offset:34816
  v_mfma_f32_16x16x32_bf16 v[56:59], v[112:115], v[144:147], v[56:59]
  s_waitcnt vmcnt(15) lgkmcnt(6)
  v_mfma_f32_16x16x32_bf16 v[4:7], v[60:63], v[148:151], v[4:7]
  ds_read_b128 v[88:91], v232 offset:35840
  s_waitcnt vmcnt(14)
  v_mfma_f32_16x16x32_bf16 v[32:35], v[60:63], v[152:155], v[32:35]
  s_waitcnt lgkmcnt(6)
  v_mfma_f32_16x16x32_bf16 v[8:11], v[64:67], v[148:151], v[8:11]
  ds_read_b128 v[92:95], v232 offset:36864
  v_mfma_f32_16x16x32_bf16 v[36:39], v[64:67], v[152:155], v[36:39]
  s_waitcnt lgkmcnt(6)
  v_mfma_f32_16x16x32_bf16 v[12:15], v[68:71], v[148:151], v[12:15]
  ds_read_b128 v[96:99], v232 offset:37888
  v_mfma_f32_16x16x32_bf16 v[40:43], v[68:71], v[152:155], v[40:43]
  buffer_load_dwordx4 v[204:207], v239, s[44:47], s66 offen offset:3072 sc1
  buffer_load_dwordx4 v[208:211], v239, s[44:47], s67 offen offset:3072 sc1
  s_waitcnt lgkmcnt(6)
  v_mfma_f32_16x16x32_bf16 v[16:19], v[72:75], v[148:151], v[16:19]
  ds_read_b128 v[100:103], v232 offset:38912
  v_mfma_f32_16x16x32_bf16 v[44:47], v[72:75], v[152:155], v[44:47]
  s_waitcnt lgkmcnt(6)
  v_mfma_f32_16x16x32_bf16 v[20:23], v[76:79], v[148:151], v[20:23]
  ds_read_b128 v[104:107], v232 offset:39936
  v_mfma_f32_16x16x32_bf16 v[48:51], v[76:79], v[152:155], v[48:51]
  s_waitcnt lgkmcnt(6)
  v_mfma_f32_16x16x32_bf16 v[24:27], v[80:83], v[148:151], v[24:27]
  ds_read_b128 v[108:111], v232 offset:40960
  v_mfma_f32_16x16x32_bf16 v[52:55], v[80:83], v[152:155], v[52:55]
  s_waitcnt lgkmcnt(6)
  v_mfma_f32_16x16x32_bf16 v[28:31], v[84:87], v[148:151], v[28:31]
  ds_read_b128 v[112:115], v232 offset:41984
  v_mfma_f32_16x16x32_bf16 v[56:59], v[84:87], v[152:155], v[56:59]
  s_waitcnt vmcnt(15) lgkmcnt(6)
  v_mfma_f32_16x16x32_bf16 v[4:7], v[88:91], v[156:159], v[4:7]
  ds_read_b128 v[60:63], v232 offset:43008
  s_waitcnt vmcnt(14)
  v_mfma_f32_16x16x32_bf16 v[32:35], v[88:91], v[160:163], v[32:35]
  s_waitcnt lgkmcnt(6)
  v_mfma_f32_16x16x32_bf16 v[8:11], v[92:95], v[156:159], v[8:11]
  ds_read_b128 v[64:67], v232 offset:44032
  v_mfma_f32_16x16x32_bf16 v[36:39], v[92:95], v[160:163], v[36:39]
  s_waitcnt lgkmcnt(6)
  v_mfma_f32_16x16x32_bf16 v[12:15], v[96:99], v[156:159], v[12:15]
  ds_read_b128 v[68:71], v232 offset:45056
  v_mfma_f32_16x16x32_bf16 v[40:43], v[96:99], v[160:163], v[40:43]
  s_add_u32 s66, s66, 4096
  buffer_load_dwordx2 v[116:117], v238, s[44:47], s66 offen offset:0 sc1
  buffer_load_dwordx2 v[118:119], v238, s[44:47], s66 offen offset:512 sc1
  s_add_u32 s67, s67, 4096
  buffer_load_dwordx2 v[120:121], v238, s[44:47], s67 offen offset:0 sc1
  buffer_load_dwordx2 v[122:123], v238, s[44:47], s67 offen offset:512 sc1
  s_waitcnt lgkmcnt(6)
  v_mfma_f32_16x16x32_bf16 v[16:19], v[100:103], v[156:159], v[16:19]
  ds_read_b128 v[72:75], v232 offset:46080
  v_mfma_f32_16x16x32_bf16 v[44:47], v[100:103], v[160:163], v[44:47]
  s_waitcnt lgkmcnt(6)
  v_mfma_f32_16x16x32_bf16 v[20:23], v[104:107], v[156:159], v[20:23]
  ds_read_b128 v[76:79], v232 offset:47104
  v_mfma_f32_16x16x32_bf16 v[48:51], v[104:107], v[160:163], v[48:51]
  s_waitcnt lgkmcnt(6)
  v_mfma_f32_16x16x32_bf16 v[24:27], v[108:111], v[156:159], v[24:27]
  ds_read_b128 v[80:83], v232 offset:48128
  v_mfma_f32_16x16x32_bf16 v[52:55], v[108:111], v[160:163], v[52:55]
  s_waitcnt lgkmcnt(6)
  v_mfma_f32_16x16x32_bf16 v[28:31], v[112:115], v[156:159], v[28:31]
  ds_read_b128 v[84:87], v232 offset:49152
  v_mfma_f32_16x16x32_bf16 v[56:59], v[112:115], v[160:163], v[56:59]
  s_waitcnt vmcnt(17) lgkmcnt(6)
  v_mfma_f32_16x16x32_bf16 v[4:7], v[60:63], v[164:167], v[4:7]
  ds_read_b128 v[88:91], v232 offset:50176
  s_waitcnt vmcnt(16)
  v_mfma_f32_16x16x32_bf16 v[32:35], v[60:63], v[168:171], v[32:35]
  s_waitcnt lgkmcnt(6)
  v_mfma_f32_16x16x32_bf16 v[8:11], v[64:67], v[164:167], v[8:11]
  ds_read_b128 v[92:95], v232 offset:51200
  v_mfma_f32_16x16x32_bf16 v[36:39], v[64:67], v[168:171], v[36:39]
  s_waitcnt lgkmcnt(6)
  v_mfma_f32_16x16x32_bf16 v[12:15], v[68:71], v[164:167], v[12:15]
  ds_read_b128 v[96:99], v232 offset:52224
  v_mfma_f32_16x16x32_bf16 v[40:43], v[68:71], v[168:171], v[40:43]
  buffer_load_dwordx4 v[124:127], v239, s[44:47], s66 offen offset:1024 sc1
  buffer_load_dwordx4 v[128:131], v239, s[44:47], s67 offen offset:1024 sc1
  s_waitcnt lgkmcnt(6)
  v_mfma_f32_16x16x32_bf16 v[16:19], v[72:75], v[164:167], v[16:19]
  ds_read_b128 v[100:103], v232 offset:53248
  v_mfma_f32_16x16x32_bf16 v[44:47], v[72:75], v[168:171], v[44:47]
  s_waitcnt lgkmcnt(6)
  v_mfma_f32_16x16x32_bf16 v[20:23], v[76:79], v[164:167], v[20:23]
  ds_read_b128 v[104:107], v232 offset:54272
  v_mfma_f32_16x16x32_bf16 v[48:51], v[76:79], v[168:171], v[48:51]
  s_waitcnt lgkmcnt(6)
  v_mfma_f32_16x16x32_bf16 v[24:27], v[80:83], v[164:167], v[24:27]
  ds_read_b128 v[108:111], v232 offset:55296
  v_mfma_f32_16x16x32_bf16 v[52:55], v[80:83], v[168:171], v[52:55]
  s_waitcnt lgkmcnt(6)
  v_mfma_f32_16x16x32_bf16 v[28:31], v[84:87], v[164:167], v[28:31]
  ds_read_b128 v[112:115], v232 offset:56320
  v_mfma_f32_16x16x32_bf16 v[56:59], v[84:87], v[168:171], v[56:59]
  s_waitcnt vmcnt(16) lgkmcnt(6)
  v_mfma_f32_16x16x32_bf16 v[4:7], v[88:91], v[172:175], v[4:7]
  ds_read_b128 v[60:63], v232 offset:57344
  s_waitcnt vmcnt(14)
  v_mfma_f32_16x16x32_bf16 v[32:35], v[88:91], v[176:179], v[32:35]
  s_waitcnt lgkmcnt(6)
  v_mfma_f32_16x16x32_bf16 v[8:11], v[92:95], v[172:175], v[8:11]
  ds_read_b128 v[64:67], v232 offset:58368
  v_mfma_f32_16x16x32_bf16 v[36:39], v[92:95], v[176:179], v[36:39]
  s_waitcnt lgkmcnt(6)
  v_mfma_f32_16x16x32_bf16 v[12:15], v[96:99], v[172:175], v[12:15]
  ds_read_b128 v[68:71], v232 offset:59392
  v_mfma_f32_16x16x32_bf16 v[40:43], v[96:99], v[176:179], v[40:43]
  buffer_load_dwordx4 v[132:135], v239, s[44:47], s66 offen offset:2048 sc1
  buffer_load_dwordx4 v[136:139], v239, s[44:47], s67 offen offset:2048 sc1
  s_waitcnt lgkmcnt(6)
  v_mfma_f32_16x16x32_bf16 v[16:19], v[100:103], v[172:175], v[16:19]
  ds_read_b128 v[72:75], v232 offset:60416
  v_mfma_f32_16x16x32_bf16 v[44:47], v[100:103], v[176:179], v[44:47]
  s_waitcnt lgkmcnt(6)
  v_mfma_f32_16x16x32_bf16 v[20:23], v[104:107], v[172:175], v[20:23]
  ds_read_b128 v[76:79], v232 offset:61440
  v_mfma_f32_16x16x32_bf16 v[48:51], v[104:107], v[176:179], v[48:51]
  s_waitcnt lgkmcnt(6)
  v_mfma_f32_16x16x32_bf16 v[24:27], v[108:111], v[172:175], v[24:27]
  ds_read_b128 v[80:83], v232 offset:62464
  v_mfma_f32_16x16x32_bf16 v[52:55], v[108:111], v[176:179], v[52:55]
  s_waitcnt lgkmcnt(6)
  v_mfma_f32_16x16x32_bf16 v[28:31], v[112:115], v[172:175], v[28:31]
  ds_read_b128 v[84:87], v232 offset:63488
  v_mfma_f32_16x16x32_bf16 v[56:59], v[112:115], v[176:179], v[56:59]
  s_waitcnt vmcnt(15) lgkmcnt(6)
  v_mfma_f32_16x16x32_bf16 v[4:7], v[60:63], v[180:183], v[4:7]
  ds_read_b128 v[88:91], v233 offset:0
  s_waitcnt vmcnt(14)
  v_mfma_f32_16x16x32_bf16 v[32:35], v[60:63], v[184:187], v[32:35]
  s_waitcnt lgkmcnt(6)
  v_mfma_f32_16x16x32_bf16 v[8:11], v[64:67], v[180:183], v[8:11]
  ds_read_b128 v[92:95], v233 offset:1024
  v_mfma_f32_16x16x32_bf16 v[36:39], v[64:67], v[184:187], v[36:39]
  s_waitcnt lgkmcnt(6)
  v_mfma_f32_16x16x32_bf16 v[12:15], v[68:71], v[180:183], v[12:15]
  ds_read_b128 v[96:99], v233 offset:2048
  v_mfma_f32_16x16x32_bf16 v[40:43], v[68:71], v[184:187], v[40:43]
  buffer_load_dwordx4 v[140:143], v239, s[44:47], s66 offen offset:3072 sc1
  buffer_load_dwordx4 v[144:147], v239, s[44:47], s67 offen offset:3072 sc1
  s_waitcnt lgkmcnt(6)
  v_mfma_f32_16x16x32_bf16 v[16:19], v[72:75], v[180:183], v[16:19]
  ds_read_b128 v[100:103], v233 offset:3072
  v_mfma_f32_16x16x32_bf16 v[44:47], v[72:75], v[184:187], v[44:47]
  s_waitcnt lgkmcnt(6)
  v_mfma_f32_16x16x32_bf16 v[20:23], v[76:79], v[180:183], v[20:23]
  ds_read_b128 v[104:107], v233 offset:4096
  v_mfma_f32_16x16x32_bf16 v[48:51], v[76:79], v[184:187], v[48:51]
  s_waitcnt lgkmcnt(6)
  v_mfma_f32_16x16x32_bf16 v[24:27], v[80:83], v[180:183], v[24:27]
  ds_read_b128 v[108:111], v233 offset:5120
  v_mfma_f32_16x16x32_bf16 v[52:55], v[80:83], v[184:187], v[52:55]
  s_waitcnt lgkmcnt(6)
  v_mfma_f32_16x16x32_bf16 v[28:31], v[84:87], v[180:183], v[28:31]
  ds_read_b128 v[112:115], v233 offset:6144
  v_mfma_f32_16x16x32_bf16 v[56:59], v[84:87], v[184:187], v[56:59]
  s_waitcnt vmcnt(15) lgkmcnt(6)
  v_mfma_f32_16x16x32_bf16 v[4:7], v[88:91], v[188:191], v[4:7]
  ds_read_b128 v[60:63], v233 offset:7168
  s_waitcnt vmcnt(14)
  v_mfma_f32_16x16x32_bf16 v[32:35], v[88:91], v[192:195], v[32:35]
  s_waitcnt lgkmcnt(6)
  v_mfma_f32_16x16x32_bf16 v[8:11], v[92:95], v[188:191], v[8:11]
  ds_read_b128 v[64:67], v233 offset:8192
  v_mfma_f32_16x16x32_bf16 v[36:39], v[92:95], v[192:195], v[36:39]
  s_waitcnt lgkmcnt(6)
  v_mfma_f32_16x16x32_bf16 v[12:15], v[96:99], v[188:191], v[12:15]
  ds_read_b128 v[68:71], v233 offset:9216
  v_mfma_f32_16x16x32_bf16 v[40:43], v[96:99], v[192:195], v[40:43]
  s_add_u32 s66, s66, 4096
  buffer_load_dwordx4 v[148:151], v239, s[44:47], s66 offen offset:0 sc1
  s_add_u32 s67, s67, 4096
  buffer_load_dwordx4 v[152:155], v239, s[44:47], s67 offen offset:0 sc1
  s_waitcnt lgkmcnt(6)
  v_mfma_f32_16x16x32_bf16 v[16:19], v[100:103], v[188:191], v[16:19]
  ds_read_b128 v[72:75], v233 offset:10240
  v_mfma_f32_16x16x32_bf16 v[44:47], v[100:103], v[192:195], v[44:47]
  s_waitcnt lgkmcnt(6)
  v_mfma_f32_16x16x32_bf16 v[20:23], v[104:107], v[188:191], v[20:23]
  ds_read_b128 v[76:79], v233 offset:11264
  v_mfma_f32_16x16x32_bf16 v[48:51], v[104:107], v[192:195], v[48:51]
  s_waitcnt lgkmcnt(6)
  v_mfma_f32_16x16x32_bf16 v[24:27], v[108:111], v[188:191], v[24:27]
  ds_read_b128 v[80:83], v233 offset:12288
  v_mfma_f32_16x16x32_bf16 v[52:55], v[108:111], v[192:195], v[52:55]
  s_waitcnt lgkmcnt(6)
  v_mfma_f32_16x16x32_bf16 v[28:31], v[112:115], v[188:191], v[28:31]
  ds_read_b128 v[84:87], v233 offset:13312
  v_mfma_f32_16x16x32_bf16 v[56:59], v[112:115], v[192:195], v[56:59]
  s_waitcnt vmcnt(15) lgkmcnt(6)
  v_mfma_f32_16x16x32_bf16 v[4:7], v[60:63], v[196:199], v[4:7]
  ds_read_b128 v[88:91], v233 offset:14336
  s_waitcnt vmcnt(14)
  v_mfma_f32_16x16x32_bf16 v[32:35], v[60:63], v[200:203], v[32:35]
  s_waitcnt lgkmcnt(6)
  v_mfma_f32_16x16x32_bf16 v[8:11], v[64:67], v[196:199], v[8:11]
  ds_read_b128 v[92:95], v233 offset:15360
  v_mfma_f32_16x16x32_bf16 v[36:39], v[64:67], v[200:203], v[36:39]
  s_waitcnt lgkmcnt(6)
  v_mfma_f32_16x16x32_bf16 v[12:15], v[68:71], v[196:199], v[12:15]
  ds_read_b128 v[96:99], v233 offset:16384
  v_mfma_f32_16x16x32_bf16 v[40:43], v[68:71], v[200:203], v[40:43]
  buffer_load_dwordx2 v[156:157], v238, s[44:47], s66 offen offset:1024 sc1
  buffer_load_dwordx2 v[158:159], v238, s[44:47], s66 offen offset:1536 sc1
  buffer_load_dwordx2 v[160:161], v238, s[44:47], s67 offen offset:1024 sc1
  buffer_load_dwordx2 v[162:163], v238, s[44:47], s67 offen offset:1536 sc1
  s_waitcnt lgkmcnt(6)
  v_mfma_f32_16x16x32_bf16 v[16:19], v[72:75], v[196:199], v[16:19]
  ds_read_b128 v[100:103], v233 offset:17408
  v_mfma_f32_16x16x32_bf16 v[44:47], v[72:75], v[200:203], v[44:47]
  s_waitcnt lgkmcnt(6)
  v_mfma_f32_16x16x32_bf16 v[20:23], v[76:79], v[196:199], v[20:23]
  ds_read_b128 v[104:107], v233 offset:18432
  v_mfma_f32_16x16x32_bf16 v[48:51], v[76:79], v[200:203], v[48:51]
  s_waitcnt lgkmcnt(6)
  v_mfma_f32_16x16x32_bf16 v[24:27], v[80:83], v[196:199], v[24:27]
  ds_read_b128 v[108:111], v233 offset:19456
  v_mfma_f32_16x16x32_bf16 v[52:55], v[80:83], v[200:203], v[52:55]
  s_waitcnt lgkmcnt(6)
  v_mfma_f32_16x16x32_bf16 v[28:31], v[84:87], v[196:199], v[28:31]
  ds_read_b128 v[112:115], v233 offset:20480
  v_mfma_f32_16x16x32_bf16 v[56:59], v[84:87], v[200:203], v[56:59]
  s_barrier
  s_waitcnt vmcnt(17) lgkmcnt(6)
  v_mfma_f32_16x16x32_bf16 v[4:7], v[88:91], v[204:207], v[4:7]
  ds_read_b128 v[60:63], v233 offset:21504
  s_waitcnt vmcnt(16)
  v_mfma_f32_16x16x32_bf16 v[32:35], v[88:91], v[208:211], v[32:35]
  s_waitcnt lgkmcnt(6)
  v_mfma_f32_16x16x32_bf16 v[8:11], v[92:95], v[204:207], v[8:11]
  ds_read_b128 v[64:67], v233 offset:22528
  v_mfma_f32_16x16x32_bf16 v[36:39], v[92:95], v[208:211], v[36:39]
  s_waitcnt lgkmcnt(6)
  v_mfma_f32_16x16x32_bf16 v[12:15], v[96:99], v[204:207], v[12:15]
  ds_read_b128 v[68:71], v233 offset:23552
  v_mfma_f32_16x16x32_bf16 v[40:43], v[96:99], v[208:211], v[40:43]
  buffer_load_dwordx4 v[164:167], v239, s[44:47], s66 offen offset:2048 sc1
  buffer_load_dwordx4 v[168:171], v239, s[44:47], s67 offen offset:2048 sc1
  s_waitcnt lgkmcnt(6)
  v_mfma_f32_16x16x32_bf16 v[16:19], v[100:103], v[204:207], v[16:19]
  ds_read_b128 v[72:75], v233 offset:24576
  v_mfma_f32_16x16x32_bf16 v[44:47], v[100:103], v[208:211], v[44:47]
  s_waitcnt lgkmcnt(6)
  v_mfma_f32_16x16x32_bf16 v[20:23], v[104:107], v[204:207], v[20:23]
  ds_read_b128 v[76:79], v233 offset:25600
  v_mfma_f32_16x16x32_bf16 v[48:51], v[104:107], v[208:211], v[48:51]
  s_waitcnt lgkmcnt(6)
  v_mfma_f32_16x16x32_bf16 v[24:27], v[108:111], v[204:207], v[24:27]
  ds_read_b128 v[80:83], v233 offset:26624
  v_mfma_f32_16x16x32_bf16 v[52:55], v[108:111], v[208:211], v[52:55]
  s_waitcnt lgkmcnt(6)
  v_mfma_f32_16x16x32_bf16 v[28:31], v[112:115], v[204:207], v[28:31]
  ds_read_b128 v[84:87], v233 offset:27648
  v_mfma_f32_16x16x32_bf16 v[56:59], v[112:115], v[208:211], v[56:59]
  s_waitcnt vmcnt(16) lgkmcnt(6)
  v_mfma_f32_16x16x32_bf16 v[4:7], v[60:63], v[116:119], v[4:7]
  ds_read_b128 v[88:91], v233 offset:28672
  s_waitcnt vmcnt(14)
  v_mfma_f32_16x16x32_bf16 v[32:35], v[60:63], v[120:123], v[32:35]
  s_waitcnt lgkmcnt(6)
  v_mfma_f32_16x16x32_bf16 v[8:11], v[64:67], v[116:119], v[8:11]
  ds_read_b128 v[92:95], v233 offset:29696
  v_mfma_f32_16x16x32_bf16 v[36:39], v[64:67], v[120:123], v[36:39]
  s_waitcnt lgkmcnt(6)
  v_mfma_f32_16x16x32_bf16 v[12:15], v[68:71], v[116:119], v[12:15]
  ds_read_b128 v[96:99], v233 offset:30720
  v_mfma_f32_16x16x32_bf16 v[40:43], v[68:71], v[120:123], v[40:43]
  buffer_load_dwordx4 v[172:175], v239, s[44:47], s66 offen offset:3072 sc1
  buffer_load_dwordx4 v[176:179], v239, s[44:47], s67 offen offset:3072 sc1
  s_waitcnt lgkmcnt(6)
  v_mfma_f32_16x16x32_bf16 v[16:19], v[72:75], v[116:119], v[16:19]
  ds_read_b128 v[100:103], v233 offset:31744
  v_mfma_f32_16x16x32_bf16 v[44:47], v[72:75], v[120:123], v[44:47]
  s_waitcnt lgkmcnt(6)
  v_mfma_f32_16x16x32_bf16 v[20:23], v[76:79], v[116:119], v[20:23]
  ds_read_b128 v[104:107], v233 offset:32768
  v_mfma_f32_16x16x32_bf16 v[48:51], v[76:79], v[120:123], v[48:51]
  s_waitcnt lgkmcnt(6)
  v_mfma_f32_16x16x32_bf16 v[24:27], v[80:83], v[116:119], v[24:27]
  ds_read_b128 v[108:111], v233 offset:33792
  v_mfma_f32_16x16x32_bf16 v[52:55], v[80:83], v[120:123], v[52:55]
  s_waitcnt lgkmcnt(6)
  v_mfma_f32_16x16x32_bf16 v[28:31], v[84:87], v[116:119], v[28:31]
  ds_read_b128 v[112:115], v233 offset:34816
  v_mfma_f32_16x16x32_bf16 v[56:59], v[84:87], v[120:123], v[56:59]
  s_barrier
  s_waitcnt vmcnt(15) lgkmcnt(6)
  v_mfma_f32_16x16x32_bf16 v[4:7], v[88:91], v[124:127], v[4:7]
  ds_read_b128 v[60:63], v233 offset:35840
  s_waitcnt vmcnt(14)
  v_mfma_f32_16x16x32_bf16 v[32:35], v[88:91], v[128:131], v[32:35]
  s_waitcnt lgkmcnt(6)
  v_mfma_f32_16x16x32_bf16 v[8:11], v[92:95], v[124:127], v[8:11]
  ds_read_b128 v[64:67], v233 offset:36864
  v_mfma_f32_16x16x32_bf16 v[36:39], v[92:95], v[128:131], v[36:39]
  s_waitcnt lgkmcnt(6)
  v_mfma_f32_16x16x32_bf16 v[12:15], v[96:99], v[124:127], v[12:15]
  ds_read_b128 v[68:71], v233 offset:37888
  v_mfma_f32_16x16x32_bf16 v[40:43], v[96:99], v[128:131], v[40:43]
  s_waitcnt lgkmcnt(6)
  v_mfma_f32_16x16x32_bf16 v[16:19], v[100:103], v[124:127], v[16:19]
  ds_read_b128 v[72:75], v233 offset:38912
  v_mfma_f32_16x16x32_bf16 v[44:47], v[100:103], v[128:131], v[44:47]
  s_waitcnt lgkmcnt(6)
  v_mfma_f32_16x16x32_bf16 v[20:23], v[104:107], v[124:127], v[20:23]
  ds_read_b128 v[76:79], v233 offset:39936
  v_mfma_f32_16x16x32_bf16 v[48:51], v[104:107], v[128:131], v[48:51]
  s_waitcnt lgkmcnt(6)
  v_mfma_f32_16x16x32_bf16 v[24:27], v[108:111], v[124:127], v[24:27]
  ds_read_b128 v[80:83], v233 offset:40960
  v_mfma_f32_16x16x32_bf16 v[52:55], v[108:111], v[128:131], v[52:55]
  s_waitcnt lgkmcnt(6)
  v_mfma_f32_16x16x32_bf16 v[28:31], v[112:115], v[124:127], v[28:31]
  ds_read_b128 v[84:87], v233 offset:41984
  v_mfma_f32_16x16x32_bf16 v[56:59], v[112:115], v[128:131], v[56:59]
  s_waitcnt vmcnt(13) lgkmcnt(6)
  v_mfma_f32_16x16x32_bf16 v[4:7], v[60:63], v[132:135], v[4:7]
  ds_read_b128 v[88:91], v233 offset:43008
  s_waitcnt vmcnt(12)
  v_mfma_f32_16x16x32_bf16 v[32:35], v[60:63], v[136:139], v[32:35]
  s_waitcnt lgkmcnt(6)
  v_mfma_f32_16x16x32_bf16 v[8:11], v[64:67], v[132:135], v[8:11]
  ds_read_b128 v[92:95], v233 offset:44032
  v_mfma_f32_16x16x32_bf16 v[36:39], v[64:67], v[136:139], v[36:39]
  s_waitcnt lgkmcnt(6)
  v_mfma_f32_16x16x32_bf16 v[12:15], v[68:71], v[132:135], v[12:15]
  ds_read_b128 v[96:99], v233 offset:45056
  v_mfma_f32_16x16x32_bf16 v[40:43], v[68:71], v[136:139], v[40:43]
  s_waitcnt lgkmcnt(6)
  v_mfma_f32_16x16x32_bf16 v[16:19], v[72:75], v[132:135], v[16:19]
  ds_read_b128 v[100:103], v233 offset:46080
  v_mfma_f32_16x16x32_bf16 v[44:47], v[72:75], v[136:139], v[44:47]
  s_waitcnt lgkmcnt(6)
  v_mfma_f32_16x16x32_bf16 v[20:23], v[76:79], v[132:135], v[20:23]
  ds_read_b128 v[104:107], v233 offset:47104
  v_mfma_f32_16x16x32_bf16 v[48:51], v[76:79], v[136:139], v[48:51]
  s_waitcnt lgkmcnt(6)
  v_mfma_f32_16x16x32_bf16 v[24:27], v[80:83], v[132:135], v[24:27]
  ds_read_b128 v[108:111], v233 offset:48128
  v_mfma_f32_16x16x32_bf16 v[52:55], v[80:83], v[136:139], v[52:55]
  s_waitcnt lgkmcnt(6)
  v_mfma_f32_16x16x32_bf16 v[28:31], v[84:87], v[132:135], v[28:31]
  ds_read_b128 v[112:115], v233 offset:49152
  v_mfma_f32_16x16x32_bf16 v[56:59], v[84:87], v[136:139], v[56:59]
  s_waitcnt vmcnt(11) lgkmcnt(6)
  v_mfma_f32_16x16x32_bf16 v[4:7], v[88:91], v[140:143], v[4:7]
  ds_read_b128 v[60:63], v233 offset:50176
  s_waitcnt vmcnt(10)
  v_mfma_f32_16x16x32_bf16 v[32:35], v[88:91], v[144:147], v[32:35]
  s_waitcnt lgkmcnt(6)
  v_mfma_f32_16x16x32_bf16 v[8:11], v[92:95], v[140:143], v[8:11]
  ds_read_b128 v[64:67], v233 offset:51200
  v_mfma_f32_16x16x32_bf16 v[36:39], v[92:95], v[144:147], v[36:39]
  s_waitcnt lgkmcnt(6)
  v_mfma_f32_16x16x32_bf16 v[12:15], v[96:99], v[140:143], v[12:15]
  ds_read_b128 v[68:71], v233 offset:52224
  v_mfma_f32_16x16x32_bf16 v[40:43], v[96:99], v[144:147], v[40:43]
  s_waitcnt lgkmcnt(6)
  v_mfma_f32_16x16x32_bf16 v[16:19], v[100:103], v[140:143], v[16:19]
  ds_read_b128 v[72:75], v233 offset:53248
  v_mfma_f32_16x16x32_bf16 v[44:47], v[100:103], v[144:147], v[44:47]
  s_waitcnt lgkmcnt(6)
  v_mfma_f32_16x16x32_bf16 v[20:23], v[104:107], v[140:143], v[20:23]
  ds_read_b128 v[76:79], v233 offset:54272
  v_mfma_f32_16x16x32_bf16 v[48:51], v[104:107], v[144:147], v[48:51]
  s_waitcnt lgkmcnt(6)
  v_mfma_f32_16x16x32_bf16 v[24:27], v[108:111], v[140:143], v[24:27]
  ds_read_b128 v[80:83], v233 offset:55296
  v_mfma_f32_16x16x32_bf16 v[52:55], v[108:111], v[144:147], v[52:55]
  s_waitcnt lgkmcnt(6)
  v_mfma_f32_16x16x32_bf16 v[28:31], v[112:115], v[140:143], v[28:31]
  ds_read_b128 v[84:87], v233 offset:56320
  v_mfma_f32_16x16x32_bf16 v[56:59], v[112:115], v[144:147], v[56:59]
  s_waitcnt vmcnt(9) lgkmcnt(6)
  v_mfma_f32_16x16x32_bf16 v[4:7], v[60:63], v[148:151], v[4:7]
  ds_read_b128 v[88:91], v233 offset:57344
  s_waitcnt vmcnt(8)
  v_mfma_f32_16x16x32_bf16 v[32:35], v[60:63], v[152:155], v[32:35]
  s_waitcnt lgkmcnt(6)
  v_mfma_f32_16x16x32_bf16 v[8:11], v[64:67], v[148:151], v[8:11]
  ds_read_b128 v[92:95], v233 offset:58368
  v_mfma_f32_16x16x32_bf16 v[36:39], v[64:67], v[152:155], v[36:39]
  s_waitcnt lgkmcnt(6)
  v_mfma_f32_16x16x32_bf16 v[12:15], v[68:71], v[148:151], v[12:15]
  ds_read_b128 v[96:99], v233 offset:59392
  v_mfma_f32_16x16x32_bf16 v[40:43], v[68:71], v[152:155], v[40:43]
  s_waitcnt lgkmcnt(6)
  v_mfma_f32_16x16x32_bf16 v[16:19], v[72:75], v[148:151], v[16:19]
  ds_read_b128 v[100:103], v233 offset:60416
  v_mfma_f32_16x16x32_bf16 v[44:47], v[72:75], v[152:155], v[44:47]
  s_waitcnt lgkmcnt(6)
  v_mfma_f32_16x16x32_bf16 v[20:23], v[76:79], v[148:151], v[20:23]
  ds_read_b128 v[104:107], v233 offset:61440
  v_mfma_f32_16x16x32_bf16 v[48:51], v[76:79], v[152:155], v[48:51]
  s_waitcnt lgkmcnt(6)
  v_mfma_f32_16x16x32_bf16 v[24:27], v[80:83], v[148:151], v[24:27]
  ds_read_b128 v[108:111], v233 offset:62464
  v_mfma_f32_16x16x32_bf16 v[52:55], v[80:83], v[152:155], v[52:55]
  s_waitcnt lgkmcnt(6)
  v_mfma_f32_16x16x32_bf16 v[28:31], v[84:87], v[148:151], v[28:31]
  ds_read_b128 v[112:115], v233 offset:63488
  v_mfma_f32_16x16x32_bf16 v[56:59], v[84:87], v[152:155], v[56:59]
  s_waitcnt vmcnt(6) lgkmcnt(6)
  v_mfma_f32_16x16x32_bf16 v[4:7], v[88:91], v[156:159], v[4:7]
  ds_read_b128 v[60:63], v234 offset:0
  s_waitcnt vmcnt(4)
  v_mfma_f32_16x16x32_bf16 v[32:35], v[88:91], v[160:163], v[32:35]
  s_waitcnt lgkmcnt(6)
  v_mfma_f32_16x16x32_bf16 v[8:11], v[92:95], v[156:159], v[8:11]
  ds_read_b128 v[64:67], v234 offset:1024
  v_mfma_f32_16x16x32_bf16 v[36:39], v[92:95], v[160:163], v[36:39]
  s_waitcnt lgkmcnt(6)
  v_mfma_f32_16x16x32_bf16 v[12:15], v[96:99], v[156:159], v[12:15]
  ds_read_b128 v[68:71], v234 offset:2048
  v_mfma_f32_16x16x32_bf16 v[40:43], v[96:99], v[160:163], v[40:43]
  s_waitcnt lgkmcnt(6)
  v_mfma_f32_16x16x32_bf16 v[16:19], v[100:103], v[156:159], v[16:19]
  ds_read_b128 v[72:75], v234 offset:3072
  v_mfma_f32_16x16x32_bf16 v[44:47], v[100:103], v[160:163], v[44:47]
  s_waitcnt lgkmcnt(6)
  v_mfma_f32_16x16x32_bf16 v[20:23], v[104:107], v[156:159], v[20:23]
  ds_read_b128 v[76:79], v234 offset:4096
  v_mfma_f32_16x16x32_bf16 v[48:51], v[104:107], v[160:163], v[48:51]
  s_waitcnt lgkmcnt(6)
  v_mfma_f32_16x16x32_bf16 v[24:27], v[108:111], v[156:159], v[24:27]
  ds_read_b128 v[80:83], v234 offset:5120
  v_mfma_f32_16x16x32_bf16 v[52:55], v[108:111], v[160:163], v[52:55]
  s_waitcnt lgkmcnt(6)
  v_mfma_f32_16x16x32_bf16 v[28:31], v[112:115], v[156:159], v[28:31]
  ds_read_b128 v[84:87], v234 offset:6144
  v_mfma_f32_16x16x32_bf16 v[56:59], v[112:115], v[160:163], v[56:59]
  s_waitcnt vmcnt(3) lgkmcnt(6)
  v_mfma_f32_16x16x32_bf16 v[4:7], v[60:63], v[164:167], v[4:7]
  ds_read_b128 v[88:91], v234 offset:7168
  s_waitcnt vmcnt(2)
  v_mfma_f32_16x16x32_bf16 v[32:35], v[60:63], v[168:171], v[32:35]
  s_waitcnt lgkmcnt(6)
  v_mfma_f32_16x16x32_bf16 v[8:11], v[64:67], v[164:167], v[8:11]
  ds_read_b128 v[92:95], v234 offset:8192
  v_mfma_f32_16x16x32_bf16 v[36:39], v[64:67], v[168:171], v[36:39]
  s_waitcnt lgkmcnt(6)
  v_mfma_f32_16x16x32_bf16 v[12:15], v[68:71], v[164:167], v[12:15]
  ds_read_b128 v[96:99], v234 offset:9216
  v_mfma_f32_16x16x32_bf16 v[40:43], v[68:71], v[168:171], v[40:43]
  s_waitcnt lgkmcnt(6)
  v_mfma_f32_16x16x32_bf16 v[16:19], v[72:75], v[164:167], v[16:19]
  ds_read_b128 v[100:103], v234 offset:10240
  v_mfma_f32_16x16x32_bf16 v[44:47], v[72:75], v[168:171], v[44:47]
  s_waitcnt lgkmcnt(6)
  v_mfma_f32_16x16x32_bf16 v[20:23], v[76:79], v[164:167], v[20:23]
  ds_read_b128 v[104:107], v234 offset:11264
  v_mfma_f32_16x16x32_bf16 v[48:51], v[76:79], v[168:171], v[48:51]
  s_waitcnt lgkmcnt(6)
  v_mfma_f32_16x16x32_bf16 v[24:27], v[80:83], v[164:167], v[24:27]
  ds_read_b128 v[108:111], v234 offset:12288
  v_mfma_f32_16x16x32_bf16 v[52:55], v[80:83], v[168:171], v[52:55]
  s_waitcnt lgkmcnt(6)
  v_mfma_f32_16x16x32_bf16 v[28:31], v[84:87], v[164:167], v[28:31]
  ds_read_b128 v[112:115], v234 offset:13312
  v_mfma_f32_16x16x32_bf16 v[56:59], v[84:87], v[168:171], v[56:59]
  s_waitcnt vmcnt(1) lgkmcnt(6)
  v_mfma_f32_16x16x32_bf16 v[4:7], v[88:91], v[172:175], v[4:7]
  s_waitcnt vmcnt(0)
  v_mfma_f32_16x16x32_bf16 v[32:35], v[88:91], v[176:179], v[32:35]
  s_waitcnt lgkmcnt(5)
  v_mfma_f32_16x16x32_bf16 v[8:11], v[92:95], v[172:175], v[8:11]
  v_mfma_f32_16x16x32_bf16 v[36:39], v[92:95], v[176:179], v[36:39]
  s_waitcnt lgkmcnt(4)
  v_mfma_f32_16x16x32_bf16 v[12:15], v[96:99], v[172:175], v[12:15]
  v_mfma_f32_16x16x32_bf16 v[40:43], v[96:99], v[176:179], v[40:43]
  s_waitcnt lgkmcnt(3)
  v_mfma_f32_16x16x32_bf16 v[16:19], v[100:103], v[172:175], v[16:19]
  v_mfma_f32_16x16x32_bf16 v[44:47], v[100:103], v[176:179], v[44:47]
  s_waitcnt lgkmcnt(2)
  v_mfma_f32_16x16x32_bf16 v[20:23], v[104:107], v[172:175], v[20:23]
  v_mfma_f32_16x16x32_bf16 v[48:51], v[104:107], v[176:179], v[48:51]
  s_waitcnt lgkmcnt(1)
  v_mfma_f32_16x16x32_bf16 v[24:27], v[108:111], v[172:175], v[24:27]
  v_mfma_f32_16x16x32_bf16 v[52:55], v[108:111], v[176:179], v[52:55]
  s_waitcnt lgkmcnt(0)
  v_mfma_f32_16x16x32_bf16 v[28:31], v[112:115], v[172:175], v[28:31]
  v_mfma_f32_16x16x32_bf16 v[56:59], v[112:115], v[176:179], v[56:59]
IF_176_end:
  s_barrier
  s_branch IF_185_end
IF_185_else:
  s_mul_i32 s66, s59, 5120
  s_mul_i32 s67, s53, 102400
  s_add_u32 s67, s67, s66
  s_add_u32 s63, s67, 21487616
  s_add_u32 m0, s66, 103424
  s_nop 0
  buffer_load_dwordx4 v30, s[44:47], s63 offen offset:0 sc1 lds
  s_add_u32 m0, s66, 103424
  s_nop 0
  buffer_load_dwordx4 v30, s[44:47], s63 offen offset:1024 sc1 lds
  s_add_u32 m0, s66, 103424
  s_nop 0
  buffer_load_dwordx4 v30, s[44:47], s63 offen offset:2048 sc1 lds
  s_add_u32 m0, s66, 103424
  s_nop 0
  buffer_load_dwordx4 v30, s[44:47], s63 offen offset:3072 sc1 lds
  s_add_u32 s63, s67, 21491712
  s_add_u32 m0, s66, 107520
  s_nop 0
  buffer_load_dwordx4 v30, s[44:47], s63 offen offset:0 sc1 lds
  s_add_u32 s63, s67, 21508096
  s_add_u32 m0, s66, 123904
  s_nop 0
  buffer_load_dwordx4 v30, s[44:47], s63 offen offset:0 sc1 lds
  s_add_u32 m0, s66, 123904
  s_nop 0
  buffer_load_dwordx4 v30, s[44:47], s63 offen offset:1024 sc1 lds
  s_add_u32 m0, s66, 123904
  s_nop 0
  buffer_load_dwordx4 v30, s[44:47], s63 offen offset:2048 sc1 lds
  s_add_u32 m0, s66, 123904
  s_nop 0
  buffer_load_dwordx4 v30, s[44:47], s63 offen offset:3072 sc1 lds
  s_add_u32 s63, s67, 21512192
  s_add_u32 m0, s66, 128000
  s_nop 0
  buffer_load_dwordx4 v30, s[44:47], s63 offen offset:0 sc1 lds
  s_cmp_eq_u32 s59, 3
  s_cselect_b32 s66, 4294822912, s66
  s_add_u32 s63, s67, 21528576
  s_add_u32 m0, s66, 144384
  s_nop 0
  buffer_load_dwordx4 v30, s[44:47], s63 offen offset:0 sc1 lds
  s_add_u32 m0, s66, 144384
  s_nop 0
  buffer_load_dwordx4 v30, s[44:47], s63 offen offset:1024 sc1 lds
  s_add_u32 m0, s66, 144384
  s_nop 0
  buffer_load_dwordx4 v30, s[44:47], s63 offen offset:2048 sc1 lds
  s_add_u32 m0, s66, 144384
  s_nop 0
  buffer_load_dwordx4 v30, s[44:47], s63 offen offset:3072 sc1 lds
  s_add_u32 s63, s67, 21532672
  s_add_u32 m0, s66, 148480
  s_nop 0
  buffer_load_dwordx4 v30, s[44:47], s63 offen offset:0 sc1 lds
  s_waitcnt vmcnt(15)
  v_cmp_ne_u32 vcc, s54, v21
  s_cbranch_vccz IF_178_else
  s_mov_b32 s58, 1048576
LP_177:
  s_sleep 2
  buffer_load_dword v21, v20, s[44:47], s71 offen sc1
  s_waitcnt vmcnt(0)
  v_cmp_ne_u32 vcc, s54, v21
  s_sub_u32 s58, s58, 1
  s_cselect_b64 vcc, 0, vcc
  s_cbranch_vccnz LP_177
IF_178_else:
  s_add_u32 s63, s69, 22265856
  s_add_u32 m0, s70, 5120
  s_nop 0
  buffer_load_dwordx4 v30, s[44:47], s63 offen offset:0 sc1 lds
  s_add_u32 m0, s70, 5120
  s_nop 0
  buffer_load_dwordx4 v30, s[44:47], s63 offen offset:1024 sc1 lds
  s_add_u32 m0, s70, 5120
  s_nop 0
  buffer_load_dwordx4 v30, s[44:47], s63 offen offset:2048 sc1 lds
  s_add_u32 m0, s70, 5120
  s_nop 0
  buffer_load_dwordx4 v30, s[44:47], s63 offen offset:3072 sc1 lds
  s_add_u32 s63, s69, 22269952
  s_add_u32 m0, s70, 9216
  s_nop 0
  buffer_load_dwordx4 v30, s[44:47], s63 offen offset:0 sc1 lds
  s_add_u32 m0, s70, 9216
  s_nop 0
  buffer_load_dwordx4 v30, s[44:47], s63 offen offset:1024 sc1 lds
  s_add_u32 m0, s70, 9216
  s_nop 0
  buffer_load_dwordx4 v30, s[44:47], s63 offen offset:2048 sc1 lds
  s_waitcnt vmcnt(17)
  s_barrier
  s_waitcnt vmcnt(7)
  s_barrier
  s_add_u32 s63, s69, 22294528
  s_add_u32 m0, s70, 33792
  s_nop 0
  buffer_load_dwordx4 v30, s[44:47], s63 offen offset:0 sc1 lds
  s_add_u32 m0, s70, 33792
  s_nop 0
  buffer_load_dwordx4 v30, s[44:47], s63 offen offset:1024 sc1 lds
  s_add_u32 m0, s70, 33792
  s_nop 0
  buffer_load_dwordx4 v30, s[44:47], s63 offen offset:2048 sc1 lds
  s_add_u32 m0, s70, 33792
  s_nop 0
  buffer_load_dwordx4 v30, s[44:47], s63 offen offset:3072 sc1 lds
  s_add_u32 s63, s69, 22298624
  s_add_u32 m0, s70, 37888
  s_nop 0
  buffer_load_dwordx4 v30, s[44:47], s63 offen offset:0 sc1 lds
  s_add_u32 m0, s70, 37888
  s_nop 0
  buffer_load_dwordx4 v30, s[44:47], s63 offen offset:1024 sc1 lds
  s_add_u32 m0, s70, 37888
  s_nop 0
  buffer_load_dwordx4 v30, s[44:47], s63 offen offset:2048 sc1 lds
  s_add_u32 s63, s69, 22323200
  s_add_u32 m0, s70, 62464
  s_nop 0
  buffer_load_dwordx4 v30, s[44:47], s63 offen offset:0 sc1 lds
  s_add_u32 m0, s70, 62464
  s_nop 0
  buffer_load_dwordx4 v30, s[44:47], s63 offen offset:1024 sc1 lds
  s_add_u32 m0, s70, 62464
  s_nop 0
  buffer_load_dwordx4 v30, s[44:47], s63 offen offset:2048 sc1 lds
  s_add_u32 m0, s70, 62464
  s_nop 0
  buffer_load_dwordx4 v30, s[44:47], s63 offen offset:3072 sc1 lds
  s_add_u32 s63, s69, 22327296
  s_add_u32 m0, s70, 66560
  s_nop 0
  buffer_load_dwordx4 v30, s[44:47], s63 offen offset:0 sc1 lds
  s_add_u32 m0, s70, 66560
  s_nop 0
  buffer_load_dwordx4 v30, s[44:47], s63 offen offset:1024 sc1 lds
  s_add_u32 m0, s70, 66560
  s_nop 0
  buffer_load_dwordx4 v30, s[44:47], s63 offen offset:2048 sc1 lds
  s_cmp_lt_u32 s59, 3
  s_cbranch_scc0 IF_179_else
  s_add_u32 s63, s69, 22351872
  s_add_u32 m0, s70, 91136
  s_nop 0
  buffer_load_dwordx4 v30, s[44:47], s63 offen offset:0 sc1 lds
  s_add_u32 m0, s70, 91136
  s_nop 0
  buffer_load_dwordx4 v30, s[44:47], s63 offen offset:1024 sc1 lds
  s_add_u32 m0, s70, 91136
  s_nop 0
  buffer_load_dwordx4 v30, s[44:47], s63 offen offset:2048 sc1 lds
  s_add_u32 m0, s70, 91136
  s_nop 0
  buffer_load_dwordx4 v30, s[44:47], s63 offen offset:3072 sc1 lds
  s_add_u32 s63, s69, 22355968
  s_add_u32 m0, s70, 95232
  s_nop 0
  buffer_load_dwordx4 v30, s[44:47], s63 offen offset:0 sc1 lds
  s_add_u32 m0, s70, 95232
  s_nop 0
  buffer_load_dwordx4 v30, s[44:47], s63 offen offset:1024 sc1 lds
  s_add_u32 m0, s70, 95232
  s_nop 0
  buffer_load_dwordx4 v30, s[44:47], s63 offen offset:2048 sc1 lds
IF_179_else:
  s_barrier
  s_add_u32 s63, s69, 22373376
  s_add_u32 m0, s70, 112640
  s_nop 0
  buffer_load_dwordx4 v30, s[44:47], s63 offen offset:0 sc1 lds
  s_add_u32 m0, s70, 112640
  s_nop 0
  buffer_load_dwordx4 v30, s[44:47], s63 offen offset:1024 sc1 lds
  s_add_u32 m0, s70, 112640
  s_nop 0
  buffer_load_dwordx4 v30, s[44:47], s63 offen offset:2048 sc1 lds
  s_add_u32 m0, s70, 112640
  s_nop 0
  buffer_load_dwordx4 v30, s[44:47], s63 offen offset:3072 sc1 lds
  s_add_u32 s63, s69, 22377472
  s_add_u32 m0, s70, 116736
  s_nop 0
  buffer_load_dwordx4 v30, s[44:47], s63 offen offset:0 sc1 lds
  s_add_u32 m0, s70, 116736
  s_nop 0
  buffer_load_dwordx4 v30, s[44:47], s63 offen offset:1024 sc1 lds
  s_add_u32 m0, s70, 116736
  s_nop 0
  buffer_load_dwordx4 v30, s[44:47], s63 offen offset:2048 sc1 lds
  s_cmp_lt_u32 s59, 1
  s_cbranch_scc0 IF_180_else
  s_add_u32 s63, s69, 22402048
  s_add_u32 m0, s70, 141312
  s_nop 0
  buffer_load_dwordx4 v30, s[44:47], s63 offen offset:0 sc1 lds
  s_add_u32 m0, s70, 141312
  s_nop 0
  buffer_load_dwordx4 v30, s[44:47], s63 offen offset:1024 sc1 lds
  s_add_u32 m0, s70, 141312
  s_nop 0
  buffer_load_dwordx4 v30, s[44:47], s63 offen offset:2048 sc1 lds
  s_add_u32 m0, s70, 141312
  s_nop 0
  buffer_load_dwordx4 v30, s[44:47], s63 offen offset:3072 sc1 lds
  s_add_u32 s63, s69, 22406144
  s_add_u32 m0, s70, 145408
  s_nop 0
  buffer_load_dwordx4 v30, s[44:47], s63 offen offset:0 sc1 lds
  s_add_u32 m0, s70, 145408
  s_nop 0
  buffer_load_dwordx4 v30, s[44:47], s63 offen offset:1024 sc1 lds
  s_add_u32 m0, s70, 145408
  s_nop 0
  buffer_load_dwordx4 v30, s[44:47], s63 offen offset:2048 sc1 lds
IF_180_else:
  s_cmp_eq_u32 s55, 4
  s_cbranch_scc0 IF_181_else
  s_waitcnt vmcnt(21)
IF_181_else:
  s_bitcmp1_b32 0xe0, s55
  s_cbranch_scc0 IF_182_else
  s_waitcnt vmcnt(7)
IF_182_else:
  s_barrier
  s_waitcnt vmcnt(0)
  s_barrier
  v_mov_b32 v56, 0
  v_mov_b32 v57, 0
  s_cmp_eq_u32 s55, 5
  s_cbranch_scc0 IF_184_else
  s_cmp_lt_u32 s2, 216
  s_cbranch_scc0 IF_183_else
  s_mov_b32 s67, 149504
  s_mul_i32 s71, s2, 2428
  s_lshr_b32 s71, s71, 16
  s_mul_i32 s72, s71, 27
  s_sub_u32 s72, s2, s72
  s_mul_i32 s74, s72, 86
  s_lshr_b32 s74, s74, 8
  s_min_u32 s74, s74, 6
  s_lshl_b32 s74, s74, 4
  s_lshl_b32 s73, s72, 5
  s_add_u32 s73, s73, s74
  s_mul_i32 s74, s72, 224
  s_sub_u32 s74, s74, 5280
  s_cmp_ge_u32 s72, 24
  s_cselect_b32 s73, s74, s73
  s_cselect_b32 s74, 122880, 0
  s_mul_i32 s73, s73, 1280
  s_mul_i32 s71, s71, 160
  s_add_u32 s73, s73, s71
  v_add_u32 v2, 0, v1
  v_mul_u32_u24 v3, 6554, v2
  v_lshrrev_b32 v3, 16, v3
  v_mul_u32_u24 v4, 10, v3
  v_sub_u32 v4, v2, v4
  v_mul_u32_u24 v7, 1280, v3
  v_lshrrev_b32 v5, 4, v3
  v_mad_u32_u24 v7, v5, s74, v7
  v_lshl_add_u32 v48, v4, 4, v7
  s_add_u32 m0, s67, 0
  s_nop 0
  buffer_load_dwordx4 v48, s[28:31], s73 offen lds
  v_add_u32 v2, 64, v1
  v_mul_u32_u24 v3, 6554, v2
  v_lshrrev_b32 v3, 16, v3
  v_mul_u32_u24 v4, 10, v3
  v_sub_u32 v4, v2, v4
  v_mul_u32_u24 v7, 1280, v3
  v_lshrrev_b32 v5, 4, v3
  v_mad_u32_u24 v7, v5, s74, v7
  v_lshl_add_u32 v49, v4, 4, v7
  s_add_u32 m0, s67, 1024
  s_nop 0
  buffer_load_dwordx4 v49, s[28:31], s73 offen lds
  v_add_u32 v2, 128, v1
  v_mul_u32_u24 v3, 6554, v2
  v_lshrrev_b32 v3, 16, v3
  v_mul_u32_u24 v4, 10, v3
  v_sub_u32 v4, v2, v4
  v_mul_u32_u24 v7, 1280, v3
  v_lshrrev_b32 v5, 4, v3
  v_mad_u32_u24 v7, v5, s74, v7
  v_lshl_add_u32 v50, v4, 4, v7
  s_add_u32 m0, s67, 2048
  s_nop 0
  buffer_load_dwordx4 v50, s[28:31], s73 offen lds
  v_add_u32 v2, 192, v1
  v_mul_u32_u24 v3, 6554, v2
  v_lshrrev_b32 v3, 16, v3
  v_mul_u32_u24 v4, 10, v3
  v_sub_u32 v4, v2, v4
  v_mul_u32_u24 v7, 1280, v3
  v_lshrrev_b32 v5, 4, v3
  v_mad_u32_u24 v7, v5, s74, v7
  v_lshl_add_u32 v51, v4, 4, v7
  s_add_u32 m0, s67, 3072
  s_nop 0
  buffer_load_dwordx4 v51, s[28:31], s73 offen lds
  v_add_u32 v2, 256, v1
  v_mul_u32_u24 v3, 6554, v2
  v_lshrrev_b32 v3, 16, v3
  v_mul_u32_u24 v4, 10, v3
  v_sub_u32 v4, v2, v4
  v_mul_u32_u24 v7, 1280, v3
  v_lshrrev_b32 v5, 4, v3
  v_mad_u32_u24 v7, v5, s74, v7
  v_lshl_add_u32 v52, v4, 4, v7
  s_add_u32 m0, s67, 4096
  s_nop 0
  buffer_load_dwordx4 v52, s[28:31], s73 offen lds
  v_lshrrev_b32 v56, 2, v1
  v_mul_u32_u24 v56, 160, v56
  v_and_b32 v6, 3, v1
  v_lshl_add_u32 v56, v6, 3, v56
  v_add_u32 v56, s67, v56
  v_lshlrev_b32 v57, 4, v1
  s_mul_i32 s73, s2, 5120
  s_add_u32 s73, s73, 24559616
  s_add_u32 s71, s73, 4096
IF_183_else:
IF_184_else:
  s_barrier
  v_lshrrev_b32 v4, 3, v1
  v_lshrrev_b32 v5, 5, v1
  v_and_b32 v4, 3, v4
  v_lshl_add_u32 v4, v5, 3, v4
  v_lshlrev_b32 v4, 12, v4
  v_lshrrev_b32 v5, 4, v1
  v_and_b32 v6, 7, v1
  v_xor_b32 v5, v5, v6
  v_xor_b32 v6, 4, v5
  v_lshl_add_u32 v8, v5, 4, v4
  v_lshl_add_u32 v9, v6, 4, v4
  s_lshl_b32 s65, s52, 18
  s_lshl_b32 s63, s59, 9
  s_add_u32 s65, s65, s63
  s_lshl_b32 s66, s59, 14
  s_add_u32 s76, s53, 0
  s_and_b32 s76, s76, 3
  s_lshl_b32 s76, s76, 7
  s_add_u32 s77, s53, 1
  s_and_b32 s77, s77, 3
  s_lshl_b32 s77, s77, 7
  s_add_u32 s78, s53, 2
  s_and_b32 s78, s78, 3
  s_lshl_b32 s78, s78, 7
  s_add_u32 s79, s53, 3
  s_and_b32 s79, s79, 3
  s_lshl_b32 s79, s79, 7
  s_add_u32 s64, s65, s76
  s_add_u32 m0, s66, 5120
  s_add_u32 s63, s64, 2048
  buffer_load_dwordx4 v8, s[20:23], s63 offen  lds
  s_add_u32 m0, s66, 6144
  s_add_u32 s63, s64, 67584
  buffer_load_dwordx4 v9, s[20:23], s63 offen  lds
  s_add_u32 m0, s66, 7168
  s_add_u32 s63, s64, 18432
  buffer_load_dwordx4 v8, s[20:23], s63 offen  lds
  s_add_u32 m0, s66, 8192
  s_add_u32 s63, s64, 83968
  buffer_load_dwordx4 v9, s[20:23], s63 offen  lds
  s_add_u32 m0, s66, 9216
  s_add_u32 s63, s64, 133120
  buffer_load_dwordx4 v8, s[20:23], s63 offen  lds
  s_add_u32 m0, s66, 10240
  s_add_u32 s63, s64, 198656
  buffer_load_dwordx4 v9, s[20:23], s63 offen  lds
  s_add_u32 m0, s66, 11264
  s_add_u32 s63, s64, 149504
  buffer_load_dwordx4 v8, s[20:23], s63 offen  lds
  s_add_u32 m0, s66, 12288
  s_add_u32 s63, s64, 215040
  buffer_load_dwordx4 v9, s[20:23], s63 offen  lds
  s_add_u32 s64, s65, s77
  s_add_u32 m0, s66, 13312
  s_add_u32 s63, s64, 2048
  buffer_load_dwordx4 v8, s[20:23], s63 offen  lds
  s_add_u32 m0, s66, 14336
  s_add_u32 s63, s64, 67584
  buffer_load_dwordx4 v9, s[20:23], s63 offen  lds
  s_add_u32 m0, s66, 15360
  s_add_u32 s63, s64, 18432
  buffer_load_dwordx4 v8, s[20:23], s63 offen  lds
  s_add_u32 m0, s66, 16384
  s_add_u32 s63, s64, 83968
  buffer_load_dwordx4 v9, s[20:23], s63 offen  lds
  s_add_u32 m0, s66, 17408
  s_add_u32 s63, s64, 133120
  buffer_load_dwordx4 v8, s[20:23], s63 offen  lds
  s_add_u32 m0, s66, 18432
  s_add_u32 s63, s64, 198656
  buffer_load_dwordx4 v9, s[20:23], s63 offen  lds
  s_add_u32 m0, s66, 19456
  s_add_u32 s63, s64, 149504
  buffer_load_dwordx4 v8, s[20:23], s63 offen  lds
  s_add_u32 m0, s66, 20480
  s_add_u32 s63, s64, 215040
  buffer_load_dwordx4 v9, s[20:23], s63 offen  lds
  s_barrier
IF_185_end:
  s_cmp_lt_u32 s55, 4
  s_cbranch_scc0 IF_195_else
  v_mov_b32 v108, -0.1029432395800235
  v_mov_b32 v109, -0.1029432395800235
  v_mov_b32 v110, -2.302208198144325
  v_mov_b32 v111, -2.302208198144325
  v_mov_b32 v112, 1.0
  v_mov_b32 v113, 1.0
  v_and_b32 v2, 15, v1
  v_lshrrev_b32 v3, 1, v2
  v_lshrrev_b32 v116, 4, v1
  v_xor_b32 v116, v116, v3
  v_xor_b32 v117, 4, v116
  v_lshlrev_b32 v2, 7, v2
  s_lshl_b32 s63, s59, 14
  s_add_u32 s63, s63, 5120
  v_add_u32 v2, s63, v2
  v_lshl_add_u32 v116, v116, 4, v2
  v_lshl_add_u32 v117, v117, 4, v2
  v_lshlrev_b32 v114, 4, v1
  v_lshlrev_b32 v115, 3, v1
  v_pk_mul_f32 v[60:61], v[4:5], v[4:5]
  v_pk_mul_f32 v[62:63], v[6:7], v[6:7]
  v_pk_mul_f32 v[64:65], v[8:9], v[8:9]
  v_pk_mul_f32 v[66:67], v[10:11], v[10:11]
  v_pk_fma_f32 v[60:61], v[60:61], v[108:109], v[110:111]
  v_pk_fma_f32 v[62:63], v[62:63], v[108:109], v[110:111]
  v_pk_fma_f32 v[64:65], v[64:65], v[108:109], v[110:111]
  v_pk_fma_f32 v[66:67], v[66:67], v[108:109], v[110:111]
  v_pk_mul_f32 v[60:61], v[60:61], v[4:5]
  v_pk_mul_f32 v[62:63], v[62:63], v[6:7]
  v_pk_mul_f32 v[64:65], v[64:65], v[8:9]
  v_pk_mul_f32 v[66:67], v[66:67], v[10:11]
  v_exp_f32 v60, v60
  v_exp_f32 v61, v61
  v_exp_f32 v62, v62
  v_exp_f32 v63, v63
  v_exp_f32 v64, v64
  v_exp_f32 v65, v65
  v_exp_f32 v66, v66
  v_exp_f32 v67, v67
  v_pk_add_f32 v[60:61], v[60:61], v[112:113]
  v_pk_add_f32 v[62:63], v[62:63], v[112:113]
  v_pk_add_f32 v[64:65], v[64:65], v[112:113]
  v_pk_add_f32 v[66:67], v[66:67], v[112:113]
  v_rcp_f32 v60, v60
  v_rcp_f32 v61, v61
  v_rcp_f32 v62, v62
  v_rcp_f32 v63, v63
  v_rcp_f32 v64, v64
  v_rcp_f32 v65, v65
  v_rcp_f32 v66, v66
  v_rcp_f32 v67, v67
  v_pk_mul_f32 v[4:5], v[4:5], v[60:61]
  v_pk_mul_f32 v[6:7], v[6:7], v[62:63]
  v_pk_mul_f32 v[8:9], v[8:9], v[64:65]
  v_pk_mul_f32 v[10:11], v[10:11], v[66:67]
  v_pk_mul_f32 v[60:61], v[12:13], v[12:13]
  v_pk_mul_f32 v[62:63], v[14:15], v[14:15]
  v_pk_mul_f32 v[64:65], v[16:17], v[16:17]
  v_pk_mul_f32 v[66:67], v[18:19], v[18:19]
  v_pk_fma_f32 v[60:61], v[60:61], v[108:109], v[110:111]
  v_pk_fma_f32 v[62:63], v[62:63], v[108:109], v[110:111]
  v_pk_fma_f32 v[64:65], v[64:65], v[108:109], v[110:111]
  v_pk_fma_f32 v[66:67], v[66:67], v[108:109], v[110:111]
  v_pk_mul_f32 v[60:61], v[60:61], v[12:13]
  v_pk_mul_f32 v[62:63], v[62:63], v[14:15]
  v_pk_mul_f32 v[64:65], v[64:65], v[16:17]
  v_pk_mul_f32 v[66:67], v[66:67], v[18:19]
  v_exp_f32 v60, v60
  v_exp_f32 v61, v61
  v_exp_f32 v62, v62
  v_exp_f32 v63, v63
  v_exp_f32 v64, v64
  v_exp_f32 v65, v65
  v_exp_f32 v66, v66
  v_exp_f32 v67, v67
  v_pk_add_f32 v[60:61], v[60:61], v[112:113]
  v_pk_add_f32 v[62:63], v[62:63], v[112:113]
  v_pk_add_f32 v[64:65], v[64:65], v[112:113]
  v_pk_add_f32 v[66:67], v[66:67], v[112:113]
  v_rcp_f32 v60, v60
  v_rcp_f32 v61, v61
  v_rcp_f32 v62, v62
  v_rcp_f32 v63, v63
  v_rcp_f32 v64, v64
  v_rcp_f32 v65, v65
  v_rcp_f32 v66, v66
  v_rcp_f32 v67, v67
  v_pk_mul_f32 v[12:13], v[12:13], v[60:61]
  v_pk_mul_f32 v[14:15], v[14:15], v[62:63]
  v_pk_mul_f32 v[16:17], v[16:17], v[64:65]
  v_pk_mul_f32 v[18:19], v[18:19], v[66:67]
  v_pk_mul_f32 v[60:61], v[20:21], v[20:21]
  v_pk_mul_f32 v[62:63], v[22:23], v[22:23]
  v_pk_mul_f32 v[64:65], v[24:25], v[24:25]
  v_pk_mul_f32 v[66:67], v[26:27], v[26:27]
  v_pk_fma_f32 v[60:61], v[60:61], v[108:109], v[110:111]
  v_pk_fma_f32 v[62:63], v[62:63], v[108:109], v[110:111]
  v_pk_fma_f32 v[64:65], v[64:65], v[108:109], v[110:111]
  v_pk_fma_f32 v[66:67], v[66:67], v[108:109], v[110:111]
  v_pk_mul_f32 v[60:61], v[60:61], v[20:21]
  v_pk_mul_f32 v[62:63], v[62:63], v[22:23]
  v_pk_mul_f32 v[64:65], v[64:65], v[24:25]
  v_pk_mul_f32 v[66:67], v[66:67], v[26:27]
  v_exp_f32 v60, v60
  v_exp_f32 v61, v61
  v_exp_f32 v62, v62
  v_exp_f32 v63, v63
  v_exp_f32 v64, v64
  v_exp_f32 v65, v65
  v_exp_f32 v66, v66
  v_exp_f32 v67, v67
  v_pk_add_f32 v[60:61], v[60:61], v[112:113]
  v_pk_add_f32 v[62:63], v[62:63], v[112:113]
  v_pk_add_f32 v[64:65], v[64:65], v[112:113]
  v_pk_add_f32 v[66:67], v[66:67], v[112:113]
  v_rcp_f32 v60, v60
  v_rcp_f32 v61, v61
  v_rcp_f32 v62, v62
  v_rcp_f32 v63, v63
  v_rcp_f32 v64, v64
  v_rcp_f32 v65, v65
  v_rcp_f32 v66, v66
  v_rcp_f32 v67, v67
  v_pk_mul_f32 v[20:21], v[20:21], v[60:61]
  v_pk_mul_f32 v[22:23], v[22:23], v[62:63]
  v_pk_mul_f32 v[24:25], v[24:25], v[64:65]
  v_pk_mul_f32 v[26:27], v[26:27], v[66:67]
  v_pk_mul_f32 v[60:61], v[28:29], v[28:29]
  v_pk_mul_f32 v[62:63], v[30:31], v[30:31]
  v_pk_mul_f32 v[64:65], v[32:33], v[32:33]
  v_pk_mul_f32 v[66:67], v[34:35], v[34:35]
  v_pk_fma_f32 v[60:61], v[60:61], v[108:109], v[110:111]
  v_pk_fma_f32 v[62:63], v[62:63], v[108:109], v[110:111]
  v_pk_fma_f32 v[64:65], v[64:65], v[108:109], v[110:111]
  v_pk_fma_f32 v[66:67], v[66:67], v[108:109], v[110:111]
  v_pk_mul_f32 v[60:61], v[60:61], v[28:29]
  v_pk_mul_f32 v[62:63], v[62:63], v[30:31]
  v_pk_mul_f32 v[64:65], v[64:65], v[32:33]
  v_pk_mul_f32 v[66:67], v[66:67], v[34:35]
  v_exp_f32 v60, v60
  v_exp_f32 v61, v61
  v_exp_f32 v62, v62
  v_exp_f32 v63, v63
  v_exp_f32 v64, v64
  v_exp_f32 v65, v65
  v_exp_f32 v66, v66
  v_exp_f32 v67, v67
  v_pk_add_f32 v[60:61], v[60:61], v[112:113]
  v_pk_add_f32 v[62:63], v[62:63], v[112:113]
  v_pk_add_f32 v[64:65], v[64:65], v[112:113]
  v_pk_add_f32 v[66:67], v[66:67], v[112:113]
  v_rcp_f32 v60, v60
  v_rcp_f32 v61, v61
  v_rcp_f32 v62, v62
  v_rcp_f32 v63, v63
  v_rcp_f32 v64, v64
  v_rcp_f32 v65, v65
  v_rcp_f32 v66, v66
  v_rcp_f32 v67, v67
  v_pk_mul_f32 v[28:29], v[28:29], v[60:61]
  v_pk_mul_f32 v[30:31], v[30:31], v[62:63]
  v_pk_mul_f32 v[32:33], v[32:33], v[64:65]
  v_pk_mul_f32 v[34:35], v[34:35], v[66:67]
  v_pk_mul_f32 v[60:61], v[36:37], v[36:37]
  v_pk_mul_f32 v[62:63], v[38:39], v[38:39]
  v_pk_mul_f32 v[64:65], v[40:41], v[40:41]
  v_pk_mul_f32 v[66:67], v[42:43], v[42:43]
  v_pk_fma_f32 v[60:61], v[60:61], v[108:109], v[110:111]
  v_pk_fma_f32 v[62:63], v[62:63], v[108:109], v[110:111]
  v_pk_fma_f32 v[64:65], v[64:65], v[108:109], v[110:111]
  v_pk_fma_f32 v[66:67], v[66:67], v[108:109], v[110:111]
  v_pk_mul_f32 v[60:61], v[60:61], v[36:37]
  v_pk_mul_f32 v[62:63], v[62:63], v[38:39]
  v_pk_mul_f32 v[64:65], v[64:65], v[40:41]
  v_pk_mul_f32 v[66:67], v[66:67], v[42:43]
  v_exp_f32 v60, v60
  v_exp_f32 v61, v61
  v_exp_f32 v62, v62
  v_exp_f32 v63, v63
  v_exp_f32 v64, v64
  v_exp_f32 v65, v65
  v_exp_f32 v66, v66
  v_exp_f32 v67, v67
  v_pk_add_f32 v[60:61], v[60:61], v[112:113]
  v_pk_add_f32 v[62:63], v[62:63], v[112:113]
  v_pk_add_f32 v[64:65], v[64:65], v[112:113]
  v_pk_add_f32 v[66:67], v[66:67], v[112:113]
  v_rcp_f32 v60, v60
  v_rcp_f32 v61, v61
  v_rcp_f32 v62, v62
  v_rcp_f32 v63, v63
  v_rcp_f32 v64, v64
  v_rcp_f32 v65, v65
  v_rcp_f32 v66, v66
  v_rcp_f32 v67, v67
  v_pk_mul_f32 v[36:37], v[36:37], v[60:61]
  v_pk_mul_f32 v[38:39], v[38:39], v[62:63]
  v_pk_mul_f32 v[40:41], v[40:41], v[64:65]
  v_pk_mul_f32 v[42:43], v[42:43], v[66:67]
  v_pk_mul_f32 v[60:61], v[44:45], v[44:45]
  v_pk_mul_f32 v[62:63], v[46:47], v[46:47]
  v_pk_mul_f32 v[64:65], v[48:49], v[48:49]
  v_pk_mul_f32 v[66:67], v[50:51], v[50:51]
  v_pk_fma_f32 v[60:61], v[60:61], v[108:109], v[110:111]
  v_pk_fma_f32 v[62:63], v[62:63], v[108:109], v[110:111]
  v_pk_fma_f32 v[64:65], v[64:65], v[108:109], v[110:111]
  v_pk_fma_f32 v[66:67], v[66:67], v[108:109], v[110:111]
  v_pk_mul_f32 v[60:61], v[60:61], v[44:45]
  v_pk_mul_f32 v[62:63], v[62:63], v[46:47]
  v_pk_mul_f32 v[64:65], v[64:65], v[48:49]
  v_pk_mul_f32 v[66:67], v[66:67], v[50:51]
  v_exp_f32 v60, v60
  v_exp_f32 v61, v61
  v_exp_f32 v62, v62
  v_exp_f32 v63, v63
  v_exp_f32 v64, v64
  v_exp_f32 v65, v65
  v_exp_f32 v66, v66
  v_exp_f32 v67, v67
  v_pk_add_f32 v[60:61], v[60:61], v[112:113]
  v_pk_add_f32 v[62:63], v[62:63], v[112:113]
  v_pk_add_f32 v[64:65], v[64:65], v[112:113]
  v_pk_add_f32 v[66:67], v[66:67], v[112:113]
  v_rcp_f32 v60, v60
  v_rcp_f32 v61, v61
  v_rcp_f32 v62, v62
  v_rcp_f32 v63, v63
  v_rcp_f32 v64, v64
  v_rcp_f32 v65, v65
  v_rcp_f32 v66, v66
  v_rcp_f32 v67, v67
  v_pk_mul_f32 v[44:45], v[44:45], v[60:61]
  v_pk_mul_f32 v[46:47], v[46:47], v[62:63]
  v_pk_mul_f32 v[48:49], v[48:49], v[64:65]
  v_pk_mul_f32 v[50:51], v[50:51], v[66:67]
  v_pk_mul_f32 v[60:61], v[52:53], v[52:53]
  v_pk_mul_f32 v[62:63], v[54:55], v[54:55]
  v_pk_mul_f32 v[64:65], v[56:57], v[56:57]
  v_pk_mul_f32 v[66:67], v[58:59], v[58:59]
  v_pk_fma_f32 v[60:61], v[60:61], v[108:109], v[110:111]
  v_pk_fma_f32 v[62:63], v[62:63], v[108:109], v[110:111]
  v_pk_fma_f32 v[64:65], v[64:65], v[108:109], v[110:111]
  v_pk_fma_f32 v[66:67], v[66:67], v[108:109], v[110:111]
  v_pk_mul_f32 v[60:61], v[60:61], v[52:53]
  v_pk_mul_f32 v[62:63], v[62:63], v[54:55]
  v_pk_mul_f32 v[64:65], v[64:65], v[56:57]
  v_pk_mul_f32 v[66:67], v[66:67], v[58:59]
  v_exp_f32 v60, v60
  v_exp_f32 v61, v61
  v_exp_f32 v62, v62
  v_exp_f32 v63, v63
  v_exp_f32 v64, v64
  v_exp_f32 v65, v65
  v_exp_f32 v66, v66
  v_exp_f32 v67, v67
  v_pk_add_f32 v[60:61], v[60:61], v[112:113]
  v_pk_add_f32 v[62:63], v[62:63], v[112:113]
  v_pk_add_f32 v[64:65], v[64:65], v[112:113]
  v_pk_add_f32 v[66:67], v[66:67], v[112:113]
  v_rcp_f32 v60, v60
  v_rcp_f32 v61, v61
  v_rcp_f32 v62, v62
  v_rcp_f32 v63, v63
  v_rcp_f32 v64, v64
  v_rcp_f32 v65, v65
  v_rcp_f32 v66, v66
  v_rcp_f32 v67, v67
  v_pk_mul_f32 v[52:53], v[52:53], v[60:61]
  v_pk_mul_f32 v[54:55], v[54:55], v[62:63]
  v_pk_mul_f32 v[56:57], v[56:57], v[64:65]
  v_pk_mul_f32 v[58:59], v[58:59], v[66:67]
  s_lshl_b32 s65, s50, 2
  s_add_u32 s65, s65, s59
  s_cmp_eq_u32 s56, 1
  s_cbranch_scc0 IF_188_else
  v_pk_mul_f32 v[68:69], v[4:5], v[4:5]
  v_pk_mul_f32 v[70:71], v[6:7], v[6:7]
  v_pk_mul_f32 v[72:73], v[32:33], v[32:33]
  v_pk_mul_f32 v[74:75], v[34:35], v[34:35]
  v_pk_fma_f32 v[68:69], v[8:9], v[8:9], v[68:69]
  v_pk_add_f32 v[60:61], v[8:9], v[4:5]
  v_pk_fma_f32 v[70:71], v[10:11], v[10:11], v[70:71]
  v_pk_add_f32 v[62:63], v[10:11], v[6:7]
  v_pk_fma_f32 v[72:73], v[36:37], v[36:37], v[72:73]
  v_pk_add_f32 v[64:65], v[36:37], v[32:33]
  v_pk_fma_f32 v[74:75], v[38:39], v[38:39], v[74:75]
  v_pk_add_f32 v[66:67], v[38:39], v[34:35]
  v_pk_fma_f32 v[68:69], v[12:13], v[12:13], v[68:69]
  v_pk_add_f32 v[60:61], v[12:13], v[60:61]
  v_pk_fma_f32 v[70:71], v[14:15], v[14:15], v[70:71]
  v_pk_add_f32 v[62:63], v[14:15], v[62:63]
  v_pk_fma_f32 v[72:73], v[40:41], v[40:41], v[72:73]
  v_pk_add_f32 v[64:65], v[40:41], v[64:65]
  v_pk_fma_f32 v[74:75], v[42:43], v[42:43], v[74:75]
  v_pk_add_f32 v[66:67], v[42:43], v[66:67]
  v_pk_fma_f32 v[68:69], v[16:17], v[16:17], v[68:69]
  v_pk_add_f32 v[60:61], v[16:17], v[60:61]
  v_pk_fma_f32 v[70:71], v[18:19], v[18:19], v[70:71]
  v_pk_add_f32 v[62:63], v[18:19], v[62:63]
  v_pk_fma_f32 v[72:73], v[44:45], v[44:45], v[72:73]
  v_pk_add_f32 v[64:65], v[44:45], v[64:65]
  v_pk_fma_f32 v[74:75], v[46:47], v[46:47], v[74:75]
  v_pk_add_f32 v[66:67], v[46:47], v[66:67]
  v_pk_fma_f32 v[68:69], v[20:21], v[20:21], v[68:69]
  v_pk_add_f32 v[60:61], v[20:21], v[60:61]
  v_pk_fma_f32 v[70:71], v[22:23], v[22:23], v[70:71]
  v_pk_add_f32 v[62:63], v[22:23], v[62:63]
  v_pk_fma_f32 v[72:73], v[48:49], v[48:49], v[72:73]
  v_pk_add_f32 v[64:65], v[48:49], v[64:65]
  v_pk_fma_f32 v[74:75], v[50:51], v[50:51], v[74:75]
  v_pk_add_f32 v[66:67], v[50:51], v[66:67]
  v_pk_fma_f32 v[68:69], v[24:25], v[24:25], v[68:69]
  v_pk_add_f32 v[60:61], v[24:25], v[60:61]
  v_pk_fma_f32 v[70:71], v[26:27], v[26:27], v[70:71]
  v_pk_add_f32 v[62:63], v[26:27], v[62:63]
  v_pk_fma_f32 v[72:73], v[52:53], v[52:53], v[72:73]
  v_pk_add_f32 v[64:65], v[52:53], v[64:65]
  v_pk_fma_f32 v[74:75], v[54:55], v[54:55], v[74:75]
  v_pk_add_f32 v[66:67], v[54:55], v[66:67]
  v_pk_fma_f32 v[68:69], v[28:29], v[28:29], v[68:69]
  v_pk_add_f32 v[60:61], v[28:29], v[60:61]
  v_pk_fma_f32 v[70:71], v[30:31], v[30:31], v[70:71]
  v_pk_add_f32 v[62:63], v[30:31], v[62:63]
  v_pk_fma_f32 v[72:73], v[56:57], v[56:57], v[72:73]
  v_pk_add_f32 v[64:65], v[56:57], v[64:65]
  v_pk_fma_f32 v[74:75], v[58:59], v[58:59], v[74:75]
  v_pk_add_f32 v[66:67], v[58:59], v[66:67]
  v_add_f32_dpp v76, v60, v60 row_ror:8 row_mask:0xf bank_mask:0x3
  v_add_f32_dpp v77, v61, v61 row_ror:8 row_mask:0xf bank_mask:0x3
  v_add_f32_dpp v78, v62, v62 row_ror:8 row_mask:0xf bank_mask:0x3
  v_add_f32_dpp v79, v63, v63 row_ror:8 row_mask:0xf bank_mask:0x3
  v_add_f32_dpp v80, v68, v68 row_ror:8 row_mask:0xf bank_mask:0x3
  v_add_f32_dpp v81, v69, v69 row_ror:8 row_mask:0xf bank_mask:0x3
  v_add_f32_dpp v82, v70, v70 row_ror:8 row_mask:0xf bank_mask:0x3
  v_add_f32_dpp v83, v71, v71 row_ror:8 row_mask:0xf bank_mask:0x3
  v_add_f32_dpp v76, v64, v64 row_ror:8 row_mask:0xf bank_mask:0xc
  v_add_f32_dpp v77, v65, v65 row_ror:8 row_mask:0xf bank_mask:0xc
  v_add_f32_dpp v78, v66, v66 row_ror:8 row_mask:0xf bank_mask:0xc
  v_add_f32_dpp v79, v67, v67 row_ror:8 row_mask:0xf bank_mask:0xc
  v_add_f32_dpp v80, v72, v72 row_ror:8 row_mask:0xf bank_mask:0xc
  v_add_f32_dpp v81, v73, v73 row_ror:8 row_mask:0xf bank_mask:0xc
  v_add_f32_dpp v82, v74, v74 row_ror:8 row_mask:0xf bank_mask:0xc
  v_add_f32_dpp v83, v75, v75 row_ror:8 row_mask:0xf bank_mask:0xc
  v_add_f32_dpp v84, v76, v76 row_half_mirror row_mask:0xf bank_mask:0x5
  v_add_f32_dpp v85, v77, v77 row_half_mirror row_mask:0xf bank_mask:0x5
  v_add_f32_dpp v86, v80, v80 row_half_mirror row_mask:0xf bank_mask:0x5
  v_add_f32_dpp v87, v81, v81 row_half_mirror row_mask:0xf bank_mask:0x5
  v_add_f32_dpp v84, v78, v78 row_half_mirror row_mask:0xf bank_mask:0xa
  v_add_f32_dpp v85, v79, v79 row_half_mirror row_mask:0xf bank_mask:0xa
  v_add_f32_dpp v86, v82, v82 row_half_mirror row_mask:0xf bank_mask:0xa
  v_add_f32_dpp v87, v83, v83 row_half_mirror row_mask:0xf bank_mask:0xa
  v_add_f32_dpp v84, v84, v84 quad_perm:[2,3,0,1] row_mask:0xf bank_mask:0xf
  v_add_f32_dpp v85, v85, v85 quad_perm:[2,3,0,1] row_mask:0xf bank_mask:0xf
  v_add_f32_dpp v86, v86, v86 quad_perm:[2,3,0,1] row_mask:0xf bank_mask:0xf
  v_add_f32_dpp v87, v87, v87 quad_perm:[2,3,0,1] row_mask:0xf bank_mask:0xf
  v_add_f32_dpp v84, v84, v84 quad_perm:[1,0,3,2] row_mask:0xf bank_mask:0xf
  v_add_f32_dpp v85, v85, v85 quad_perm:[1,0,3,2] row_mask:0xf bank_mask:0xf
  v_add_f32_dpp v86, v86, v86 quad_perm:[1,0,3,2] row_mask:0xf bank_mask:0xf
  v_add_f32_dpp v87, v87, v87 quad_perm:[1,0,3,2] row_mask:0xf bank_mask:0xf
  v_and_b32 v2, 1, v1
  v_cmp_eq_u32 vcc, 1, v2
  s_nop 1
  v_cndmask_b32 v88, v84, v85, vcc
  v_cndmask_b32 v89, v86, v87, vcc
  v_mov_b32 v90, s54
  v_mov_b32 v91, s54
  v_lshrrev_b32 v3, 2, v1
  v_lshl_add_u32 v3, v3, 1, v2
  v_lshlrev_b32 v3, 4, v3
  v_bfe_u32 v2, v1, 1, 1
  v_lshl_or_b32 v3, v2, 31, v3
  s_lshl_b32 s66, s65, 12
  s_add_u32 s66, s66, 2752512
  s_lshl_b32 s63, s53, 9
  s_add_u32 s63, s63, s66
  buffer_store_dwordx4 v[88:91], v3, s[44:47], s63 offen sc1
  v_and_b32 v2, 31, v1
  v_lshlrev_b32 v3, 4, v2
  v_lshrrev_b32 v76, 5, v1
  v_lshl_add_u32 v3, v76, 11, v3
  s_lshl_b32 s63, s59, 8
  s_add_u32 s63, s63, 148480
  v_lshlrev_b32 v2, 3, v2
  v_add_u32 v2, s63, v2
  v_lshrrev_b32 v77, 4, v1
  v_lshlrev_b32 v77, 6, v77
  v_add_u32 v77, s63, v77
  buffer_load_dwordx4 v[60:63], v3, s[44:47], s66 offen offset:0 sc1
  buffer_load_dwordx4 v[64:67], v3, s[44:47], s66 offen offset:512 sc1
  buffer_load_dwordx4 v[68:71], v3, s[44:47], s66 offen offset:1024 sc1
  buffer_load_dwordx4 v[72:75], v3, s[44:47], s66 offen offset:1536 sc1
  s_waitcnt vmcnt(3)
  v_xor_b32 v78, s54, v62
  s_waitcnt vmcnt(2)
  v_xor_b32 v79, s54, v66
  s_waitcnt vmcnt(1)
  v_xor_b32 v80, s54, v70
  s_waitcnt vmcnt(0)
  v_xor_b32 v81, s54, v74
  v_or3_b32 v78, v78, v79, v80
  v_or_b32 v78, v78, v81
  v_cmp_ne_u32 vcc, 0, v78
  s_cbranch_vccz IF_187_else
  s_mov_b32 s58, 1048576
LP_186:
  s_sleep 2
  buffer_load_dwordx4 v[60:63], v3, s[44:47], s66 offen offset:0 sc1
  buffer_load_dwordx4 v[64:67], v3, s[44:47], s66 offen offset:512 sc1
  buffer_load_dwordx4 v[68:71], v3, s[44:47], s66 offen offset:1024 sc1
  buffer_load_dwordx4 v[72:75], v3, s[44:47], s66 offen offset:1536 sc1
  s_waitcnt vmcnt(3)
  v_xor_b32 v78, s54, v62
  s_waitcnt vmcnt(2)
  v_xor_b32 v79, s54, v66
  s_waitcnt vmcnt(1)
  v_xor_b32 v80, s54, v70
  s_waitcnt vmcnt(0)
  v_xor_b32 v81, s54, v74
  v_or3_b32 v78, v78, v79, v80
  v_or_b32 v78, v78, v81
  v_cmp_ne_u32 vcc, 0, v78
  s_sub_u32 s58, s58, 1
  s_cselect_b64 vcc, 0, vcc
  s_cbranch_vccnz LP_186
IF_187_else:
  s_setprio 2
  v_pk_add_f32 v[60:61], v[60:61], v[64:65]
  v_pk_add_f32 v[68:69], v[68:69], v[72:73]
  v_pk_add_f32 v[60:61], v[60:61], v[68:69]
  v_mov_b32 v62, v60
  v_mov_b32 v63, v61
  s_nop 0
  v_permlane32_swap_b32 v60, v62
  v_permlane32_swap_b32 v61, v63
  v_add_f32 v65, v60, v62
  v_add_f32 v64, v61, v63
  v_mul_f32 v65, 0.0011574074074074073, v65
  v_mul_f32 v66, v65, v65
  v_mul_f32 v64, 0.0011574074074074073, v64
  v_sub_f32 v64, v64, v66
  v_max_f32 v64, 0, v64
  v_add_f32 v64, 0x3727c5ac, v64
  v_rsq_f32 v64, v64
  s_nop 0
  v_mul_f32 v65, v65, v64
  v_sub_f32 v65, 0, v65
  ds_write_b64 v2, v[64:65]
  s_waitcnt lgkmcnt(0)
  ds_read_b128 v[60:63], v77 offset:0
  ds_read_b128 v[64:67], v77 offset:16
  ds_read_b128 v[68:71], v77 offset:32
  ds_read_b128 v[72:75], v77 offset:48
  s_mul_i32 s66, s53, 458752
  s_lshl_b32 s63, s65, 10
  s_add_u32 s66, s66, s63
  s_add_u32 s66, s66, 15073280
  s_waitcnt lgkmcnt(3)
  v_fma_f32 v4, v4, v60, v61
  v_fma_f32 v5, v5, v62, v63
  s_waitcnt lgkmcnt(2)
  v_fma_f32 v6, v6, v64, v65
  v_fma_f32 v7, v7, v66, v67
  v_cvt_pk_bf16_f32 v76, v4, v5
  v_cvt_pk_bf16_f32 v77, v6, v7
  s_waitcnt lgkmcnt(1)
  v_fma_f32 v32, v32, v68, v69
  v_fma_f32 v33, v33, v70, v71
  s_waitcnt lgkmcnt(0)
  v_fma_f32 v34, v34, v72, v73
  v_fma_f32 v35, v35, v74, v75
  v_cvt_pk_bf16_f32 v78, v32, v33
  v_cvt_pk_bf16_f32 v79, v34, v35
  buffer_store_dwordx4 v[76:79], v114, s[44:47], s66 offen sc1
  s_add_u32 s66, s66, 65536
  v_fma_f32 v8, v8, v60, v61
  v_fma_f32 v9, v9, v62, v63
  v_fma_f32 v10, v10, v64, v65
  v_fma_f32 v11, v11, v66, v67
  v_cvt_pk_bf16_f32 v80, v8, v9
  v_cvt_pk_bf16_f32 v81, v10, v11
  v_fma_f32 v36, v36, v68, v69
  v_fma_f32 v37, v37, v70, v71
  v_fma_f32 v38, v38, v72, v73
  v_fma_f32 v39, v39, v74, v75
  v_cvt_pk_bf16_f32 v82, v36, v37
  v_cvt_pk_bf16_f32 v83, v38, v39
  buffer_store_dwordx4 v[80:83], v114, s[44:47], s66 offen sc1
  s_add_u32 s66, s66, 65536
  v_fma_f32 v12, v12, v60, v61
  v_fma_f32 v13, v13, v62, v63
  v_fma_f32 v14, v14, v64, v65
  v_fma_f32 v15, v15, v66, v67
  v_cvt_pk_bf16_f32 v84, v12, v13
  v_cvt_pk_bf16_f32 v85, v14, v15
  v_fma_f32 v40, v40, v68, v69
  v_fma_f32 v41, v41, v70, v71
  v_fma_f32 v42, v42, v72, v73
  v_fma_f32 v43, v43, v74, v75
  v_cvt_pk_bf16_f32 v86, v40, v41
  v_cvt_pk_bf16_f32 v87, v42, v43
  buffer_store_dwordx4 v[84:87], v114, s[44:47], s66 offen sc1
  s_add_u32 s66, s66, 65536
  v_fma_f32 v16, v16, v60, v61
  v_fma_f32 v17, v17, v62, v63
  v_fma_f32 v18, v18, v64, v65
  v_fma_f32 v19, v19, v66, v67
  v_cvt_pk_bf16_f32 v88, v16, v17
  v_cvt_pk_bf16_f32 v89, v18, v19
  v_fma_f32 v44, v44, v68, v69
  v_fma_f32 v45, v45, v70, v71
  v_fma_f32 v46, v46, v72, v73
  v_fma_f32 v47, v47, v74, v75
  v_cvt_pk_bf16_f32 v90, v44, v45
  v_cvt_pk_bf16_f32 v91, v46, v47
  buffer_store_dwordx4 v[88:91], v114, s[44:47], s66 offen sc1
  s_add_u32 s66, s66, 65536
  v_fma_f32 v20, v20, v60, v61
  v_fma_f32 v21, v21, v62, v63
  v_fma_f32 v22, v22, v64, v65
  v_fma_f32 v23, v23, v66, v67
  v_cvt_pk_bf16_f32 v92, v20, v21
  v_cvt_pk_bf16_f32 v93, v22, v23
  v_fma_f32 v48, v48, v68, v69
  v_fma_f32 v49, v49, v70, v71
  v_fma_f32 v50, v50, v72, v73
  v_fma_f32 v51, v51, v74, v75
  v_cvt_pk_bf16_f32 v94, v48, v49
  v_cvt_pk_bf16_f32 v95, v50, v51
  buffer_store_dwordx4 v[92:95], v114, s[44:47], s66 offen sc1
  s_add_u32 s66, s66, 65536
  v_fma_f32 v24, v24, v60, v61
  v_fma_f32 v25, v25, v62, v63
  v_fma_f32 v26, v26, v64, v65
  v_fma_f32 v27, v27, v66, v67
  v_cvt_pk_bf16_f32 v96, v24, v25
  v_cvt_pk_bf16_f32 v97, v26, v27
  v_fma_f32 v52, v52, v68, v69
  v_fma_f32 v53, v53, v70, v71
  v_fma_f32 v54, v54, v72, v73
  v_fma_f32 v55, v55, v74, v75
  v_cvt_pk_bf16_f32 v98, v52, v53
  v_cvt_pk_bf16_f32 v99, v54, v55
  buffer_store_dwordx4 v[96:99], v114, s[44:47], s66 offen sc1
  s_add_u32 s66, s66, 65536
  v_fma_f32 v28, v28, v60, v61
  v_fma_f32 v29, v29, v62, v63
  v_fma_f32 v30, v30, v64, v65
  v_fma_f32 v31, v31, v66, v67
  v_cvt_pk_bf16_f32 v100, v28, v29
  v_cvt_pk_bf16_f32 v101, v30, v31
  v_fma_f32 v56, v56, v68, v69
  v_fma_f32 v57, v57, v70, v71
  v_fma_f32 v58, v58, v72, v73
  v_fma_f32 v59, v59, v74, v75
  v_cvt_pk_bf16_f32 v102, v56, v57
  v_cvt_pk_bf16_f32 v103, v58, v59
  buffer_store_dwordx4 v[100:103], v114, s[44:47], s66 offen sc1
  s_barrier
  s_lshl_b32 s66, s53, 6
  s_add_u32 s66, s66, s65
  s_lshl_b32 s63, s66, 7
  s_add_u32 s63, s63, 1179648
  v_mov_b32 v60, s54
  v_lshlrev_b32 v61, 26, v1
  v_and_b32 v61, 2147483648, v61
  v_lshl_or_b32 v61, v1, 2, v61
  s_waitcnt vmcnt(0)
  buffer_store_dword v60, v61, s[44:47], s63 offen sc1
  s_branch IF_188_end
IF_188_else:
  v_cvt_pk_bf16_f32 v60, v4, v5
  v_cvt_pk_bf16_f32 v61, v6, v7
  v_cvt_pk_bf16_f32 v62, v8, v9
  v_cvt_pk_bf16_f32 v63, v10, v11
  v_cvt_pk_bf16_f32 v64, v12, v13
  v_cvt_pk_bf16_f32 v65, v14, v15
  v_cvt_pk_bf16_f32 v66, v16, v17
  v_cvt_pk_bf16_f32 v67, v18, v19
  v_cvt_pk_bf16_f32 v68, v20, v21
  v_cvt_pk_bf16_f32 v69, v22, v23
  v_cvt_pk_bf16_f32 v70, v24, v25
  v_cvt_pk_bf16_f32 v71, v26, v27
  v_cvt_pk_bf16_f32 v72, v28, v29
  v_cvt_pk_bf16_f32 v73, v30, v31
  v_cvt_pk_bf16_f32 v74, v32, v33
  v_cvt_pk_bf16_f32 v75, v34, v35
  v_cvt_pk_bf16_f32 v76, v36, v37
  v_cvt_pk_bf16_f32 v77, v38, v39
  v_cvt_pk_bf16_f32 v78, v40, v41
  v_cvt_pk_bf16_f32 v79, v42, v43
  v_cvt_pk_bf16_f32 v80, v44, v45
  v_cvt_pk_bf16_f32 v81, v46, v47
  v_cvt_pk_bf16_f32 v82, v48, v49
  v_cvt_pk_bf16_f32 v83, v50, v51
  v_cvt_pk_bf16_f32 v84, v52, v53
  v_cvt_pk_bf16_f32 v85, v54, v55
  v_cvt_pk_bf16_f32 v86, v56, v57
  v_cvt_pk_bf16_f32 v87, v58, v59
  s_lshl_b32 s66, s65, 16
  s_lshl_b32 s63, s53, 12
  s_add_u32 s66, s66, s63
  s_add_u32 s66, s66, 10878976
  buffer_store_dwordx4 v[60:63], v114, s[44:47], s66 offen offset:0 sc1
  buffer_store_dwordx4 v[64:67], v114, s[44:47], s66 offen offset:1024 sc1
  buffer_store_dwordx4 v[68:71], v114, s[44:47], s66 offen offset:2048 sc1
  buffer_store_dwordx2 v[72:73], v115, s[44:47], s66 offen offset:3072 sc1
  s_add_u32 s66, s66, 32768
  buffer_store_dwordx4 v[74:77], v114, s[44:47], s66 offen offset:0 sc1
  buffer_store_dwordx4 v[78:81], v114, s[44:47], s66 offen offset:1024 sc1
  buffer_store_dwordx4 v[82:85], v114, s[44:47], s66 offen offset:2048 sc1
  buffer_store_dwordx2 v[86:87], v115, s[44:47], s66 offen offset:3072 sc1
  s_lshl_b32 s66, s65, 3
  s_add_u32 s66, s66, s53
  s_barrier
  s_lshl_b32 s63, s66, 7
  s_add_u32 s63, s63, 917504
  v_mov_b32 v90, s54
  v_lshlrev_b32 v91, 26, v1
  v_and_b32 v91, 2147483648, v91
  v_lshl_or_b32 v91, v1, 2, v91
  s_waitcnt vmcnt(0)
  buffer_store_dword v90, v91, s[44:47], s63 offen sc1
IF_188_end:
  s_setprio 0
  s_barrier
  ds_read_b128 v[182:185], v116 offset:0
  ds_read_b128 v[186:189], v116 offset:2048
  ds_read_b128 v[190:193], v116 offset:4096
  ds_read_b128 v[194:197], v116 offset:6144
  ds_read_b128 v[198:201], v117 offset:0
  ds_read_b128 v[202:205], v117 offset:2048
  ds_read_b128 v[206:209], v117 offset:4096
  ds_read_b128 v[210:213], v117 offset:6144
  ds_read_b128 v[214:217], v116 offset:8192
  ds_read_b128 v[218:221], v116 offset:10240
  ds_read_b128 v[222:225], v116 offset:12288
  ds_read_b128 v[226:229], v116 offset:14336
  ds_read_b128 v[230:233], v117 offset:8192
  ds_read_b128 v[234:237], v117 offset:10240
  ds_read_b128 v[238:241], v117 offset:12288
  ds_read_b128 v[242:245], v117 offset:14336
  v_add_u32 v116, 65536, v116
  v_add_u32 v117, 65536, v117
  ds_read_b128 v[118:121], v116 offset:0
  ds_read_b128 v[122:125], v116 offset:2048
  ds_read_b128 v[126:129], v116 offset:4096
  ds_read_b128 v[130:133], v116 offset:6144
  ds_read_b128 v[134:137], v117 offset:0
  ds_read_b128 v[138:141], v117 offset:2048
  ds_read_b128 v[142:145], v117 offset:4096
  ds_read_b128 v[146:149], v117 offset:6144
  ds_read_b128 v[150:153], v116 offset:8192
  ds_read_b128 v[154:157], v116 offset:10240
  ds_read_b128 v[158:161], v116 offset:12288
  ds_read_b128 v[162:165], v116 offset:14336
  ds_read_b128 v[166:169], v117 offset:8192
  ds_read_b128 v[170:173], v117 offset:10240
  ds_read_b128 v[174:177], v117 offset:12288
  ds_read_b128 v[178:181], v117 offset:14336
  s_waitcnt lgkmcnt(0)
  s_barrier
  s_branch IF_195_end
IF_195_else:
  s_add_u32 s64, s65, s76
  s_add_u32 m0, s66, 70656
  s_add_u32 s63, s64, 0
  buffer_load_dwordx4 v8, s[20:23], s63 offen  lds
  s_add_u32 m0, s66, 71680
  s_add_u32 s63, s64, 65536
  buffer_load_dwordx4 v9, s[20:23], s63 offen  lds
  s_add_u32 m0, s66, 72704
  s_add_u32 s63, s64, 16384
  buffer_load_dwordx4 v8, s[20:23], s63 offen  lds
  s_add_u32 m0, s66, 73728
  s_add_u32 s63, s64, 81920
  buffer_load_dwordx4 v9, s[20:23], s63 offen  lds
  s_add_u32 m0, s66, 74752
  s_add_u32 s63, s64, 131072
  buffer_load_dwordx4 v8, s[20:23], s63 offen  lds
  s_add_u32 m0, s66, 75776
  s_add_u32 s63, s64, 196608
  buffer_load_dwordx4 v9, s[20:23], s63 offen  lds
  s_add_u32 m0, s66, 76800
  s_add_u32 s63, s64, 147456
  buffer_load_dwordx4 v8, s[20:23], s63 offen  lds
  s_add_u32 m0, s66, 77824
  s_add_u32 s63, s64, 212992
  buffer_load_dwordx4 v9, s[20:23], s63 offen  lds
  s_add_u32 s64, s65, s77
  s_add_u32 m0, s66, 78848
  s_add_u32 s63, s64, 0
  buffer_load_dwordx4 v8, s[20:23], s63 offen  lds
  s_add_u32 m0, s66, 79872
  s_add_u32 s63, s64, 65536
  buffer_load_dwordx4 v9, s[20:23], s63 offen  lds
  s_add_u32 m0, s66, 80896
  s_add_u32 s63, s64, 16384
  buffer_load_dwordx4 v8, s[20:23], s63 offen  lds
  s_add_u32 m0, s66, 81920
  s_add_u32 s63, s64, 81920
  buffer_load_dwordx4 v9, s[20:23], s63 offen  lds
  s_add_u32 m0, s66, 82944
  s_add_u32 s63, s64, 131072
  buffer_load_dwordx4 v8, s[20:23], s63 offen  lds
  s_add_u32 m0, s66, 83968
  s_add_u32 s63, s64, 196608
  buffer_load_dwordx4 v9, s[20:23], s63 offen  lds
  s_add_u32 m0, s66, 84992
  s_add_u32 s63, s64, 147456
  buffer_load_dwordx4 v8, s[20:23], s63 offen  lds
  s_add_u32 m0, s66, 86016
  s_add_u32 s63, s64, 212992
  buffer_load_dwordx4 v9, s[20:23], s63 offen  lds
  v_and_b32 v2, 15, v1
  v_lshrrev_b32 v3, 1, v2
  v_lshrrev_b32 v116, 4, v1
  v_xor_b32 v116, v116, v3
  v_xor_b32 v117, 4, v116
  v_lshlrev_b32 v2, 7, v2
  s_lshl_b32 s63, s59, 14
  s_add_u32 s63, s63, 5120
  v_add_u32 v2, s63, v2
  v_lshl_add_u32 v116, v116, 4, v2
  v_lshl_add_u32 v117, v117, 4, v2
  s_cmp_eq_u32 s55, 5
  s_cbranch_scc0 IF_190_else
  s_cmp_lt_u32 s2, 216
  s_cbranch_scc0 IF_189_else
  s_waitcnt vmcnt(32)
  ds_read_b64_tr_b16 v[20:21], v56 offset:0
  ds_read_b64_tr_b16 v[22:23], v56 offset:2560
  ds_read_b64_tr_b16 v[24:25], v56 offset:32
  ds_read_b64_tr_b16 v[26:27], v56 offset:2592
  ds_read_b64_tr_b16 v[28:29], v56 offset:64
  ds_read_b64_tr_b16 v[30:31], v56 offset:2624
  ds_read_b64_tr_b16 v[32:33], v56 offset:96
  ds_read_b64_tr_b16 v[34:35], v56 offset:2656
  ds_read_b64_tr_b16 v[36:37], v56 offset:128
  ds_read_b64_tr_b16 v[38:39], v56 offset:2688
  s_waitcnt lgkmcnt(8)
  buffer_store_dwordx4 v[20:23], v57, s[44:47], s73 offen offset:0 sc1
  s_waitcnt lgkmcnt(6)
  buffer_store_dwordx4 v[24:27], v57, s[44:47], s73 offen offset:1024 sc1
  s_waitcnt lgkmcnt(4)
  buffer_store_dwordx4 v[28:31], v57, s[44:47], s73 offen offset:2048 sc1
  s_waitcnt lgkmcnt(2)
  buffer_store_dwordx4 v[32:35], v57, s[44:47], s73 offen offset:3072 sc1
  s_waitcnt lgkmcnt(0)
  buffer_store_dwordx4 v[36:39], v57, s[44:47], s71 offen offset:0 sc1
IF_189_else:
IF_190_else:
  s_waitcnt vmcnt(24)
  ds_read_b128 v[118:121], v116 offset:0
  ds_read_b128 v[122:125], v116 offset:2048
  ds_read_b128 v[126:129], v116 offset:4096
  ds_read_b128 v[130:133], v116 offset:6144
  ds_read_b128 v[134:137], v117 offset:0
  ds_read_b128 v[138:141], v117 offset:2048
  ds_read_b128 v[142:145], v117 offset:4096
  ds_read_b128 v[146:149], v117 offset:6144
  s_waitcnt lgkmcnt(0)
  s_add_u32 s64, s65, s78
  s_add_u32 m0, s66, 5120
  s_add_u32 s63, s64, 2048
  buffer_load_dwordx4 v8, s[20:23], s63 offen  lds
  s_add_u32 m0, s66, 6144
  s_add_u32 s63, s64, 67584
  buffer_load_dwordx4 v9, s[20:23], s63 offen  lds
  s_add_u32 m0, s66, 7168
  s_add_u32 s63, s64, 18432
  buffer_load_dwordx4 v8, s[20:23], s63 offen  lds
  s_add_u32 m0, s66, 8192
  s_add_u32 s63, s64, 83968
  buffer_load_dwordx4 v9, s[20:23], s63 offen  lds
  s_add_u32 m0, s66, 9216
  s_add_u32 s63, s64, 133120
  buffer_load_dwordx4 v8, s[20:23], s63 offen  lds
  s_add_u32 m0, s66, 10240
  s_add_u32 s63, s64, 198656
  buffer_load_dwordx4 v9, s[20:23], s63 offen  lds
  s_add_u32 m0, s66, 11264
  s_add_u32 s63, s64, 149504
  buffer_load_dwordx4 v8, s[20:23], s63 offen  lds
  s_add_u32 m0, s66, 12288
  s_add_u32 s63, s64, 215040
  buffer_load_dwordx4 v9, s[20:23], s63 offen  lds
  s_waitcnt vmcnt(24)
  ds_read_b128 v[150:153], v116 offset:8192
  ds_read_b128 v[154:157], v116 offset:10240
  ds_read_b128 v[158:161], v116 offset:12288
  ds_read_b128 v[162:165], v116 offset:14336
  ds_read_b128 v[166:169], v117 offset:8192
  ds_read_b128 v[170:173], v117 offset:10240
  ds_read_b128 v[174:177], v117 offset:12288
  ds_read_b128 v[178:181], v117 offset:14336
  s_waitcnt lgkmcnt(0)
  s_cmp_eq_u32 s55, 5
  s_cbranch_scc0 IF_192_else
  s_cmp_lt_u32 s2, 216
  s_cbranch_scc0 IF_191_else
  s_add_u32 s67, s2, 480
  s_lshl_b32 s63, s67, 7
  s_add_u32 s63, s63, 2228224
  v_mov_b32 v10, s54
  v_lshlrev_b32 v11, 26, v1
  v_and_b32 v11, 2147483648, v11
  v_lshl_or_b32 v11, v1, 2, v11
  s_waitcnt vmcnt(8)
  buffer_store_dword v10, v11, s[44:47], s63 offen sc1
IF_191_else:
IF_192_else:
  s_barrier
  s_add_u32 s64, s65, s79
  s_add_u32 m0, s66, 13312
  s_add_u32 s63, s64, 2048
  buffer_load_dwordx4 v8, s[20:23], s63 offen  lds
  s_add_u32 m0, s66, 14336
  s_add_u32 s63, s64, 67584
  buffer_load_dwordx4 v9, s[20:23], s63 offen  lds
  s_add_u32 m0, s66, 15360
  s_add_u32 s63, s64, 18432
  buffer_load_dwordx4 v8, s[20:23], s63 offen  lds
  s_add_u32 m0, s66, 16384
  s_add_u32 s63, s64, 83968
  buffer_load_dwordx4 v9, s[20:23], s63 offen  lds
  s_add_u32 m0, s66, 17408
  s_add_u32 s63, s64, 133120
  buffer_load_dwordx4 v8, s[20:23], s63 offen  lds
  s_add_u32 m0, s66, 18432
  s_add_u32 s63, s64, 198656
  buffer_load_dwordx4 v9, s[20:23], s63 offen  lds
  s_add_u32 m0, s66, 19456
  s_add_u32 s63, s64, 149504
  buffer_load_dwordx4 v8, s[20:23], s63 offen  lds
  s_add_u32 m0, s66, 20480
  s_add_u32 s63, s64, 215040
  buffer_load_dwordx4 v9, s[20:23], s63 offen  lds
  s_waitcnt vmcnt(8)
  ds_read_b128 v[182:185], v116 offset:0
  ds_read_b128 v[186:189], v116 offset:2048
  ds_read_b128 v[190:193], v116 offset:4096
  ds_read_b128 v[194:197], v116 offset:6144
  ds_read_b128 v[198:201], v117 offset:0
  ds_read_b128 v[202:205], v117 offset:2048
  ds_read_b128 v[206:209], v117 offset:4096
  ds_read_b128 v[210:213], v117 offset:6144
  s_waitcnt lgkmcnt(0)
  s_add_u32 s64, s65, s78
  s_add_u32 m0, s66, 5120
  s_add_u32 s63, s64, 0
  buffer_load_dwordx4 v8, s[20:23], s63 offen  lds
  s_add_u32 m0, s66, 6144
  s_add_u32 s63, s64, 65536
  buffer_load_dwordx4 v9, s[20:23], s63 offen  lds
  s_add_u32 m0, s66, 7168
  s_add_u32 s63, s64, 16384
  buffer_load_dwordx4 v8, s[20:23], s63 offen  lds
  s_add_u32 m0, s66, 8192
  s_add_u32 s63, s64, 81920
  buffer_load_dwordx4 v9, s[20:23], s63 offen  lds
  s_add_u32 m0, s66, 9216
  s_add_u32 s63, s64, 131072
  buffer_load_dwordx4 v8, s[20:23], s63 offen  lds
  s_add_u32 m0, s66, 10240
  s_add_u32 s63, s64, 196608
  buffer_load_dwordx4 v9, s[20:23], s63 offen  lds
  s_add_u32 m0, s66, 11264
  s_add_u32 s63, s64, 147456
  buffer_load_dwordx4 v8, s[20:23], s63 offen  lds
  s_add_u32 m0, s66, 12288
  s_add_u32 s63, s64, 212992
  buffer_load_dwordx4 v9, s[20:23], s63 offen  lds
  s_waitcnt vmcnt(8)
  ds_read_b128 v[214:217], v116 offset:8192
  ds_read_b128 v[218:221], v116 offset:10240
  ds_read_b128 v[222:225], v116 offset:12288
  ds_read_b128 v[226:229], v116 offset:14336
  ds_read_b128 v[230:233], v117 offset:8192
  ds_read_b128 v[234:237], v117 offset:10240
  ds_read_b128 v[238:241], v117 offset:12288
  ds_read_b128 v[242:245], v117 offset:14336
  s_waitcnt lgkmcnt(0)
  s_add_u32 s64, s65, s79
  s_add_u32 m0, s66, 13312
  s_add_u32 s63, s64, 0
  buffer_load_dwordx4 v8, s[20:23], s63 offen  lds
  s_add_u32 m0, s66, 14336
  s_add_u32 s63, s64, 65536
  buffer_load_dwordx4 v9, s[20:23], s63 offen  lds
  s_add_u32 m0, s66, 15360
  s_add_u32 s63, s64, 16384
  buffer_load_dwordx4 v8, s[20:23], s63 offen  lds
  s_add_u32 m0, s66, 16384
  s_add_u32 s63, s64, 81920
  buffer_load_dwordx4 v9, s[20:23], s63 offen  lds
  s_add_u32 m0, s66, 17408
  s_add_u32 s63, s64, 131072
  buffer_load_dwordx4 v8, s[20:23], s63 offen  lds
  s_add_u32 m0, s66, 18432
  s_add_u32 s63, s64, 196608
  buffer_load_dwordx4 v9, s[20:23], s63 offen  lds
  s_add_u32 m0, s66, 19456
  s_add_u32 s63, s64, 147456
  buffer_load_dwordx4 v8, s[20:23], s63 offen  lds
  s_add_u32 m0, s66, 20480
  s_add_u32 s63, s64, 212992
  buffer_load_dwordx4 v9, s[20:23], s63 offen  lds
  v_min_u32 v108, 26, v1
  v_lshlrev_b32 v108, 7, v108
  s_mul_i32 s75, s53, 3456
  s_add_u32 s75, s75, 2289664
  buffer_load_dword v109, v108, s[44:47], s75 offen sc1
  s_waitcnt vmcnt(0)
  v_cmp_ne_u32 vcc, s54, v109
  s_cbranch_vccz IF_194_else
  s_mov_b32 s58, 1048576
LP_193:
  s_sleep 2
  buffer_load_dword v109, v108, s[44:47], s75 offen sc1
  s_waitcnt vmcnt(0)
  v_cmp_ne_u32 vcc, s54, v109
  s_sub_u32 s58, s58, 1
  s_cselect_b64 vcc, 0, vcc
  s_cbranch_vccnz LP_193
IF_194_else:
  s_barrier
  s_barrier
  v_lshlrev_b32 v114, 4, v1
  s_mov_b32 s74, 46080
  s_cmp_eq_u32 s59, 1
  s_cselect_b32 s74, 51200, s74
  s_cmp_eq_u32 s59, 2
  s_cselect_b32 s74, 61440, s74
  s_cmp_eq_u32 s59, 3
  s_cselect_b32 s74, 66560, s74
  s_mul_i32 s73, s53, 138240
  s_add_u32 s73, s74, s73
  s_add_u32 s63, s73, 24559616
  s_add_u32 m0, s74, 23552
  s_nop 0
  buffer_load_dwordx4 v114, s[44:47], s63 offen offset:0 sc1 lds
  s_add_u32 m0, s74, 23552
  s_nop 0
  buffer_load_dwordx4 v114, s[44:47], s63 offen offset:1024 sc1 lds
  s_add_u32 m0, s74, 23552
  s_nop 0
  buffer_load_dwordx4 v114, s[44:47], s63 offen offset:2048 sc1 lds
  s_add_u32 m0, s74, 23552
  s_nop 0
  buffer_load_dwordx4 v114, s[44:47], s63 offen offset:3072 sc1 lds
  s_add_u32 s63, s73, 24563712
  s_add_u32 m0, s74, 27648
  s_nop 0
  buffer_load_dwordx4 v114, s[44:47], s63 offen offset:0 sc1 lds
  s_mov_b32 s74, 76800
  s_cmp_eq_u32 s59, 1
  s_cselect_b32 s74, 81920, s74
  s_cmp_eq_u32 s59, 2
  s_cselect_b32 s74, 92160, s74
  s_cmp_eq_u32 s59, 3
  s_cselect_b32 s74, 97280, s74
  s_mul_i32 s73, s53, 138240
  s_add_u32 s73, s74, s73
  s_add_u32 s63, s73, 24559616
  s_add_u32 m0, s74, 23552
  s_nop 0
  buffer_load_dwordx4 v114, s[44:47], s63 offen offset:0 sc1 lds
  s_add_u32 m0, s74, 23552
  s_nop 0
  buffer_load_dwordx4 v114, s[44:47], s63 offen offset:1024 sc1 lds
  s_add_u32 m0, s74, 23552
  s_nop 0
  buffer_load_dwordx4 v114, s[44:47], s63 offen offset:2048 sc1 lds
  s_add_u32 m0, s74, 23552
  s_nop 0
  buffer_load_dwordx4 v114, s[44:47], s63 offen offset:3072 sc1 lds
  s_add_u32 s63, s73, 24563712
  s_add_u32 m0, s74, 27648
  s_nop 0
  buffer_load_dwordx4 v114, s[44:47], s63 offen offset:0 sc1 lds
  s_mov_b32 s74, 107520
  s_cmp_eq_u32 s59, 1
  s_cselect_b32 s74, 112640, s74
  s_cmp_eq_u32 s59, 2
  s_cselect_b32 s74, 56320, s74
  s_cmp_eq_u32 s59, 3
  s_cselect_b32 s74, 71680, s74
  s_mul_i32 s73, s53, 138240
  s_add_u32 s73, s74, s73
  s_add_u32 s63, s73, 24559616
  s_add_u32 m0, s74, 23552
  s_nop 0
  buffer_load_dwordx4 v114, s[44:47], s63 offen offset:0 sc1 lds
  s_add_u32 m0, s74, 23552
  s_nop 0
  buffer_load_dwordx4 v114, s[44:47], s63 offen offset:1024 sc1 lds
  s_add_u32 m0, s74, 23552
  s_nop 0
  buffer_load_dwordx4 v114, s[44:47], s63 offen offset:2048 sc1 lds
  s_add_u32 m0, s74, 23552
  s_nop 0
  buffer_load_dwordx4 v114, s[44:47], s63 offen offset:3072 sc1 lds
  s_add_u32 s63, s73, 24563712
  s_add_u32 m0, s74, 27648
  s_nop 0
  buffer_load_dwordx4 v114, s[44:47], s63 offen offset:0 sc1 lds
IF_195_end:
  v_lshlrev_b32 v114, 4, v1
  v_lshlrev_b32 v115, 3, v1
  s_lshl_b32 s66, s52, 2
  s_add_u32 s66, s66, s59
  s_lshr_b32 s68, s59, 1
  s_lshl_b32 s68, s68, 5
  s_and_b32 s63, s59, 1
  s_lshl_b32 s63, s63, 2
  s_add_u32 s68, s68, s63
  s_lshl_b32 s63, s52, 6
  s_add_u32 s68, s68, s63
  v_bfe_u32 v105, v1, 2, 2
  v_and_b32 v2, 3, v1
  v_lshl_add_u32 v105, v105, 3, v2
  v_add_u32 v105, s68, v105
  v_mul_u32_u24 v105, 2, v105
  buffer_load_ushort v104, v105, s[24:27], 0 offen
  s_lshl_b32 s63, s55, 12
  v_add_u32 v106, s63, v114
  s_lshl_b32 s63, s59, 10
  v_add_u32 v107, s63, v114
  s_and_b32 s65, s53, 7
  s_mul_i32 s65, s65, 458752
  s_and_b32 s63, s55, 7
  s_lshl_b32 s63, s63, 13
  s_add_u32 s65, s65, s63
  s_add_u32 s65, s65, 15073280
  s_lshl_b32 s67, s66, 3
  s_add_u32 s67, s67, s53
  s_lshl_b32 s67, s67, 12
  s_add_u32 s67, s67, 10878976
  s_lshl_b32 s68, s60, 11
  s_sub_u32 s67, s67, s68
  s_add_u32 s67, s67, 2048
  v_and_b32 v2, 7, v1
  s_lshl_b32 s63, s53, 6
  s_lshl_b32 s68, s55, 3
  s_add_u32 s63, s63, s68
  s_add_u32 s63, s63, 8192
  v_add_u32 v2, s63, v2
  s_lshr_b32 s63, s66, 1
  s_lshl_b32 s63, s63, 3
  s_add_u32 s63, s63, s53
  s_add_u32 s63, s63, 6144
  v_mov_b32 v3, s63
  v_cmp_gt_u32 vcc, 8, v1
  s_nop 1
  v_cndmask_b32 v2, v3, v2, vcc
  v_lshlrev_b32 v2, 7, v2
  s_mov_b32 s63, 131072
  buffer_load_dword v3, v2, s[44:47], s63 offen sc1
  s_waitcnt vmcnt(0)
  v_cmp_ne_u32 vcc, s54, v3
  s_cbranch_vccz IF_197_else
  s_mov_b32 s58, 1048576
LP_196:
  s_sleep 2
  buffer_load_dword v3, v2, s[44:47], s63 offen sc1
  s_waitcnt vmcnt(0)
  v_cmp_ne_u32 vcc, s54, v3
  s_sub_u32 s58, s58, 1
  s_cselect_b64 vcc, 0, vcc
  s_cbranch_vccnz LP_196
IF_197_else:
  s_add_u32 s76, s53, 0
  s_and_b32 s76, s76, 3
  s_lshl_b32 s76, s76, 11
  s_add_u32 s77, s53, 1
  s_and_b32 s77, s77, 3
  s_lshl_b32 s77, s77, 11
  s_add_u32 s78, s53, 2
  s_and_b32 s78, s78, 3
  s_lshl_b32 s78, s78, 11
  s_add_u32 s79, s53, 3
  s_and_b32 s79, s79, 3
  s_lshl_b32 s79, s79, 11
  s_add_u32 s74, s65, s76
  buffer_load_dwordx4 v[4:7], v114, s[44:47], s74 offen offset:0 sc1
  buffer_load_dwordx4 v[8:11], v114, s[44:47], s74 offen offset:1024 sc1
  s_add_u32 s74, s65, s77
  buffer_load_dwordx4 v[12:15], v114, s[44:47], s74 offen offset:0 sc1
  buffer_load_dwordx4 v[16:19], v114, s[44:47], s74 offen offset:1024 sc1
  s_add_u32 s74, s65, s78
  buffer_load_dwordx4 v[20:23], v114, s[44:47], s74 offen offset:0 sc1
  buffer_load_dwordx4 v[24:27], v114, s[44:47], s74 offen offset:1024 sc1
  s_add_u32 s74, s65, s79
  buffer_load_dwordx4 v[28:31], v114, s[44:47], s74 offen offset:0 sc1
  buffer_load_dwordx4 v[32:35], v114, s[44:47], s74 offen offset:1024 sc1
  s_add_u32 s65, s65, 65536
  s_add_u32 s74, s65, s76
  buffer_load_dwordx4 v[36:39], v114, s[44:47], s74 offen offset:0 sc1
  buffer_load_dwordx4 v[40:43], v114, s[44:47], s74 offen offset:1024 sc1
  buffer_load_dwordx4 v[84:87], v114, s[44:47], s67 offen sc1
  s_cmp_lt_u32 s55, 4
  s_cbranch_scc0 IF_198_else
  buffer_load_dwordx2 v[88:89], v115, s[44:47], s67 offen offset:1024 sc1
  s_branch IF_198_end
IF_198_else:
  buffer_load_dwordx4 v[88:91], v114, s[44:47], s67 offen offset:1024 sc1
IF_198_end:
  v_lshlrev_b32 v104, 16, v104
  s_mul_i32 s69, s66, 27648
  s_add_u32 s69, s69, 3014656
  s_mul_i32 s63, s53, 3072
  s_add_u32 s70, s69, s63
  s_lshl_b32 s71, s53, 9
  s_add_u32 s71, s71, 24576
  s_add_u32 s71, s71, s69
  s_cmp_lt_u32 s53, 6
  s_cselect_b32 s71, s71, 2147483648
  s_lshl_b32 s72, s66, 4
  s_lshl_b32 s63, s53, 1
  s_add_u32 s72, s72, s63
  s_xor_b32 s63, s60, 1
  s_add_u32 s72, s72, s63
  s_waitcnt vmcnt(11)
  v_mfma_f32_16x16x32_bf16 v[44:47], v[4:7], v[118:121], 0
  v_mfma_f32_16x16x32_bf16 v[48:51], v[4:7], v[122:125], 0
  v_mfma_f32_16x16x32_bf16 v[52:55], v[4:7], v[126:129], 0
  v_mfma_f32_16x16x32_bf16 v[56:59], v[4:7], v[130:133], 0
  s_add_u32 s74, s65, s77
  buffer_load_dwordx4 v[4:7], v114, s[44:47], s74 offen offset:0 sc1
  s_waitcnt vmcnt(11)
  v_mfma_f32_16x16x32_bf16 v[44:47], v[8:11], v[134:137], v[44:47]
  v_mfma_f32_16x16x32_bf16 v[48:51], v[8:11], v[138:141], v[48:51]
  v_mfma_f32_16x16x32_bf16 v[52:55], v[8:11], v[142:145], v[52:55]
  v_mfma_f32_16x16x32_bf16 v[56:59], v[8:11], v[146:149], v[56:59]
  buffer_load_dwordx4 v[8:11], v114, s[44:47], s74 offen offset:1024 sc1
  s_waitcnt vmcnt(11)
  v_mfma_f32_16x16x32_bf16 v[44:47], v[12:15], v[150:153], v[44:47]
  v_mfma_f32_16x16x32_bf16 v[48:51], v[12:15], v[154:157], v[48:51]
  v_mfma_f32_16x16x32_bf16 v[52:55], v[12:15], v[158:161], v[52:55]
  v_mfma_f32_16x16x32_bf16 v[56:59], v[12:15], v[162:165], v[56:59]
  s_add_u32 s74, s65, s78
  buffer_load_dwordx4 v[12:15], v114, s[44:47], s74 offen offset:0 sc1
  s_waitcnt vmcnt(11)
  v_mfma_f32_16x16x32_bf16 v[44:47], v[16:19], v[166:169], v[44:47]
  v_mfma_f32_16x16x32_bf16 v[48:51], v[16:19], v[170:173], v[48:51]
  v_mfma_f32_16x16x32_bf16 v[52:55], v[16:19], v[174:177], v[52:55]
  v_mfma_f32_16x16x32_bf16 v[56:59], v[16:19], v[178:181], v[56:59]
  buffer_load_dwordx4 v[16:19], v114, s[44:47], s74 offen offset:1024 sc1
  s_waitcnt vmcnt(11)
  v_mfma_f32_16x16x32_bf16 v[44:47], v[20:23], v[182:185], v[44:47]
  v_mfma_f32_16x16x32_bf16 v[48:51], v[20:23], v[186:189], v[48:51]
  v_mfma_f32_16x16x32_bf16 v[52:55], v[20:23], v[190:193], v[52:55]
  v_mfma_f32_16x16x32_bf16 v[56:59], v[20:23], v[194:197], v[56:59]
  s_add_u32 s74, s65, s79
  buffer_load_dwordx4 v[20:23], v114, s[44:47], s74 offen offset:0 sc1
  s_waitcnt vmcnt(11)
  v_mfma_f32_16x16x32_bf16 v[44:47], v[24:27], v[198:201], v[44:47]
  v_mfma_f32_16x16x32_bf16 v[48:51], v[24:27], v[202:205], v[48:51]
  v_mfma_f32_16x16x32_bf16 v[52:55], v[24:27], v[206:209], v[52:55]
  v_mfma_f32_16x16x32_bf16 v[56:59], v[24:27], v[210:213], v[56:59]
  buffer_load_dwordx4 v[24:27], v114, s[44:47], s74 offen offset:1024 sc1
  s_waitcnt vmcnt(11)
  v_mfma_f32_16x16x32_bf16 v[44:47], v[28:31], v[214:217], v[44:47]
  v_mfma_f32_16x16x32_bf16 v[48:51], v[28:31], v[218:221], v[48:51]
  v_mfma_f32_16x16x32_bf16 v[52:55], v[28:31], v[222:225], v[52:55]
  v_mfma_f32_16x16x32_bf16 v[56:59], v[28:31], v[226:229], v[56:59]
  s_add_u32 s65, s65, 65536
  s_add_u32 s74, s65, s76
  buffer_load_dwordx4 v[28:31], v114, s[44:47], s74 offen offset:0 sc1
  s_waitcnt vmcnt(11)
  v_mfma_f32_16x16x32_bf16 v[44:47], v[32:35], v[230:233], v[44:47]
  v_mfma_f32_16x16x32_bf16 v[48:51], v[32:35], v[234:237], v[48:51]
  v_mfma_f32_16x16x32_bf16 v[52:55], v[32:35], v[238:241], v[52:55]
  v_mfma_f32_16x16x32_bf16 v[56:59], v[32:35], v[242:245], v[56:59]
  buffer_load_dwordx4 v[32:35], v114, s[44:47], s74 offen offset:1024 sc1
  s_waitcnt vmcnt(11)
  v_mfma_f32_16x16x32_bf16 v[60:63], v[36:39], v[118:121], 0
  v_mfma_f32_16x16x32_bf16 v[64:67], v[36:39], v[122:125], 0
  v_mfma_f32_16x16x32_bf16 v[68:71], v[36:39], v[126:129], 0
  v_mfma_f32_16x16x32_bf16 v[72:75], v[36:39], v[130:133], 0
  s_add_u32 s74, s65, s77
  buffer_load_dwordx4 v[36:39], v114, s[44:47], s74 offen offset:0 sc1
  s_waitcnt vmcnt(11)
  v_mfma_f32_16x16x32_bf16 v[60:63], v[40:43], v[134:137], v[60:63]
  ds_write_b128 v106, v[44:47] offset:0
  v_mfma_f32_16x16x32_bf16 v[64:67], v[40:43], v[138:141], v[64:67]
  ds_write_b128 v106, v[48:51] offset:1024
  v_mfma_f32_16x16x32_bf16 v[68:71], v[40:43], v[142:145], v[68:71]
  ds_write_b128 v106, v[52:55] offset:2048
  v_mfma_f32_16x16x32_bf16 v[72:75], v[40:43], v[146:149], v[72:75]
  ds_write_b128 v106, v[56:59] offset:3072
  buffer_load_dwordx4 v[40:43], v114, s[44:47], s74 offen offset:1024 sc1
  s_waitcnt vmcnt(9)
  v_mfma_f32_16x16x32_bf16 v[60:63], v[4:7], v[150:153], v[60:63]
  v_mfma_f32_16x16x32_bf16 v[64:67], v[4:7], v[154:157], v[64:67]
  v_mfma_f32_16x16x32_bf16 v[68:71], v[4:7], v[158:161], v[68:71]
  v_mfma_f32_16x16x32_bf16 v[72:75], v[4:7], v[162:165], v[72:75]
  s_add_u32 s74, s65, s78
  buffer_load_dwordx4 v[4:7], v114, s[44:47], s74 offen offset:0 sc1
  s_waitcnt lgkmcnt(0)
  s_barrier
  s_waitcnt vmcnt(9)
  v_mfma_f32_16x16x32_bf16 v[60:63], v[8:11], v[166:169], v[60:63]
  v_mfma_f32_16x16x32_bf16 v[64:67], v[8:11], v[170:173], v[64:67]
  v_mfma_f32_16x16x32_bf16 v[68:71], v[8:11], v[174:177], v[68:71]
  v_mfma_f32_16x16x32_bf16 v[72:75], v[8:11], v[178:181], v[72:75]
  buffer_load_dwordx4 v[8:11], v114, s[44:47], s74 offen offset:1024 sc1
  s_waitcnt vmcnt(9)
  v_mfma_f32_16x16x32_bf16 v[60:63], v[12:15], v[182:185], v[60:63]
  v_mfma_f32_16x16x32_bf16 v[64:67], v[12:15], v[186:189], v[64:67]
  v_mfma_f32_16x16x32_bf16 v[68:71], v[12:15], v[190:193], v[68:71]
  v_mfma_f32_16x16x32_bf16 v[72:75], v[12:15], v[194:197], v[72:75]
  s_add_u32 s74, s65, s79
  buffer_load_dwordx4 v[12:15], v114, s[44:47], s74 offen offset:0 sc1
  s_cmp_lt_u32 s55, 4
  s_cbranch_scc1 IF_199_end
  ds_read_b128 v[100:103], v107 offset:0
  ds_read_b128 v[76:79], v107 offset:4096
  ds_read_b128 v[80:83], v107 offset:8192
IF_199_end:
  s_waitcnt vmcnt(9)
  v_mfma_f32_16x16x32_bf16 v[60:63], v[16:19], v[198:201], v[60:63]
  v_mfma_f32_16x16x32_bf16 v[64:67], v[16:19], v[202:205], v[64:67]
  v_mfma_f32_16x16x32_bf16 v[68:71], v[16:19], v[206:209], v[68:71]
  v_mfma_f32_16x16x32_bf16 v[72:75], v[16:19], v[210:213], v[72:75]
  buffer_load_dwordx4 v[16:19], v114, s[44:47], s74 offen offset:1024 sc1
  s_cmp_lt_u32 s55, 4
  s_cbranch_scc1 IF_200_end
  s_waitcnt lgkmcnt(1)
  v_add_f32 v100, v100, v76
  v_add_f32 v101, v101, v77
  v_add_f32 v102, v102, v78
  v_add_f32 v103, v103, v79
  s_waitcnt lgkmcnt(0)
  v_add_f32 v100, v100, v80
  v_add_f32 v101, v101, v81
  v_add_f32 v102, v102, v82
  v_add_f32 v103, v103, v83
  ds_read_b128 v[76:79], v107 offset:12288
  ds_read_b128 v[80:83], v107 offset:16384
IF_200_end:
  s_waitcnt vmcnt(9)
  v_mfma_f32_16x16x32_bf16 v[60:63], v[20:23], v[214:217], v[60:63]
  v_mfma_f32_16x16x32_bf16 v[64:67], v[20:23], v[218:221], v[64:67]
  v_mfma_f32_16x16x32_bf16 v[68:71], v[20:23], v[222:225], v[68:71]
  v_mfma_f32_16x16x32_bf16 v[72:75], v[20:23], v[226:229], v[72:75]
  s_add_u32 s65, s65, 65536
  s_add_u32 s74, s65, s76
  buffer_load_dwordx4 v[20:23], v114, s[44:47], s74 offen offset:0 sc1
  s_cmp_lt_u32 s55, 4
  s_cbranch_scc1 IF_201_end
  s_waitcnt lgkmcnt(1)
  v_add_f32 v100, v100, v76
  v_add_f32 v101, v101, v77
  v_add_f32 v102, v102, v78
  v_add_f32 v103, v103, v79
  s_waitcnt lgkmcnt(0)
  v_add_f32 v100, v100, v80
  v_add_f32 v101, v101, v81
  v_add_f32 v102, v102, v82
  v_add_f32 v103, v103, v83
  ds_read_b128 v[76:79], v107 offset:20480
  ds_read_b128 v[80:83], v107 offset:24576
IF_201_end:
  s_waitcnt vmcnt(9)
  v_mfma_f32_16x16x32_bf16 v[60:63], v[24:27], v[230:233], v[60:63]
  v_mfma_f32_16x16x32_bf16 v[64:67], v[24:27], v[234:237], v[64:67]
  v_mfma_f32_16x16x32_bf16 v[68:71], v[24:27], v[238:241], v[68:71]
  v_mfma_f32_16x16x32_bf16 v[72:75], v[24:27], v[242:245], v[72:75]
  buffer_load_dwordx4 v[24:27], v114, s[44:47], s74 offen offset:1024 sc1
  s_cmp_lt_u32 s55, 4
  s_cbranch_scc1 IF_202_end
  s_waitcnt lgkmcnt(1)
  v_add_f32 v100, v100, v76
  v_add_f32 v101, v101, v77
  v_add_f32 v102, v102, v78
  v_add_f32 v103, v103, v79
  s_waitcnt lgkmcnt(0)
  v_add_f32 v100, v100, v80
  v_add_f32 v101, v101, v81
  v_add_f32 v102, v102, v82
  v_add_f32 v103, v103, v83
  ds_read_b128 v[76:79], v107 offset:28672
  v_lshlrev_b32 v80, 16, v84
  v_and_b32 v81, s57, v84
  v_lshlrev_b32 v82, 16, v85
  v_and_b32 v83, s57, v85
IF_202_end:
  s_waitcnt vmcnt(9)
  v_mfma_f32_16x16x32_bf16 v[44:47], v[28:31], v[118:121], 0
  v_mfma_f32_16x16x32_bf16 v[48:51], v[28:31], v[122:125], 0
  v_mfma_f32_16x16x32_bf16 v[52:55], v[28:31], v[126:129], 0
  v_mfma_f32_16x16x32_bf16 v[56:59], v[28:31], v[130:133], 0
  s_add_u32 s74, s65, s77
  buffer_load_dwordx4 v[28:31], v114, s[44:47], s74 offen offset:0 sc1
  s_cmp_lt_u32 s55, 4
  s_cbranch_scc1 IF_203_end
  s_waitcnt lgkmcnt(0)
  v_add_f32 v100, v100, v76
  v_add_f32 v101, v101, v77
  v_add_f32 v102, v102, v78
  v_add_f32 v103, v103, v79
  v_add_f32 v100, v100, v104
  v_mul_f32 v100, v100, v80
  v_add_f32 v101, v101, v104
  v_mul_f32 v101, v101, v81
  v_add_f32 v102, v102, v104
  v_mul_f32 v102, v102, v82
  v_add_f32 v103, v103, v104
  v_mul_f32 v103, v103, v83
  v_cvt_pk_bf16_f32 v92, v100, v101
  v_cvt_pk_bf16_f32 v93, v102, v103
IF_203_end:
  s_waitcnt vmcnt(9)
  v_mfma_f32_16x16x32_bf16 v[44:47], v[32:35], v[134:137], v[44:47]
  ds_write_b128 v106, v[60:63] offset:32768
  v_mfma_f32_16x16x32_bf16 v[48:51], v[32:35], v[138:141], v[48:51]
  ds_write_b128 v106, v[64:67] offset:33792
  v_mfma_f32_16x16x32_bf16 v[52:55], v[32:35], v[142:145], v[52:55]
  ds_write_b128 v106, v[68:71] offset:34816
  v_mfma_f32_16x16x32_bf16 v[56:59], v[32:35], v[146:149], v[56:59]
  ds_write_b128 v106, v[72:75] offset:35840
  buffer_load_dwordx4 v[32:35], v114, s[44:47], s74 offen offset:1024 sc1
  s_waitcnt vmcnt(9)
  v_mfma_f32_16x16x32_bf16 v[44:47], v[36:39], v[150:153], v[44:47]
  v_mfma_f32_16x16x32_bf16 v[48:51], v[36:39], v[154:157], v[48:51]
  v_mfma_f32_16x16x32_bf16 v[52:55], v[36:39], v[158:161], v[52:55]
  v_mfma_f32_16x16x32_bf16 v[56:59], v[36:39], v[162:165], v[56:59]
  s_add_u32 s74, s65, s78
  buffer_load_dwordx4 v[36:39], v114, s[44:47], s74 offen offset:0 sc1
  s_mov_b32 m0, 161536
  v_and_b32 v2, 15, v1
  v_lshlrev_b32 v2, 7, v2
  s_cmp_lt_u32 s55, 4
  s_cbranch_scc0 IF_204_else
  v_and_b32 v2, 0x380, v2
  s_add_u32 s63, s70, 2048
  buffer_load_dword v2, s[44:47], s63 offen lds
  v_and_b32 v2, 0x180, v2
  buffer_load_dword v2, s[44:47], s71 offen lds
  s_branch IF_204_end
IF_204_else:
  buffer_load_dword v2, s[44:47], s70 offen lds
IF_204_end:
  s_waitcnt lgkmcnt(0)
  s_barrier
  s_waitcnt vmcnt(10)
  v_mfma_f32_16x16x32_bf16 v[44:47], v[40:43], v[166:169], v[44:47]
  v_mfma_f32_16x16x32_bf16 v[48:51], v[40:43], v[170:173], v[48:51]
  v_mfma_f32_16x16x32_bf16 v[52:55], v[40:43], v[174:177], v[52:55]
  v_mfma_f32_16x16x32_bf16 v[56:59], v[40:43], v[178:181], v[56:59]
  buffer_load_dwordx4 v[40:43], v114, s[44:47], s74 offen offset:1024 sc1
  s_waitcnt vmcnt(10)
  v_mfma_f32_16x16x32_bf16 v[44:47], v[4:7], v[182:185], v[44:47]
  v_mfma_f32_16x16x32_bf16 v[48:51], v[4:7], v[186:189], v[48:51]
  v_mfma_f32_16x16x32_bf16 v[52:55], v[4:7], v[190:193], v[52:55]
  v_mfma_f32_16x16x32_bf16 v[56:59], v[4:7], v[194:197], v[56:59]
  s_add_u32 s74, s65, s79
  buffer_load_dwordx4 v[4:7], v114, s[44:47], s74 offen offset:0 sc1
  s_cmp_lt_u32 s55, 4
  s_cbranch_scc1 IF_205_end
  ds_read_b128 v[100:103], v107 offset:32768
  ds_read_b128 v[76:79], v107 offset:36864
  ds_read_b128 v[80:83], v107 offset:40960
IF_205_end:
  s_waitcnt vmcnt(10)
  v_mfma_f32_16x16x32_bf16 v[44:47], v[8:11], v[198:201], v[44:47]
  v_mfma_f32_16x16x32_bf16 v[48:51], v[8:11], v[202:205], v[48:51]
  v_mfma_f32_16x16x32_bf16 v[52:55], v[8:11], v[206:209], v[52:55]
  v_mfma_f32_16x16x32_bf16 v[56:59], v[8:11], v[210:213], v[56:59]
  buffer_load_dwordx4 v[8:11], v114, s[44:47], s74 offen offset:1024 sc1
  s_cmp_lt_u32 s55, 4
  s_cbranch_scc1 IF_206_end
  s_waitcnt lgkmcnt(1)
  v_add_f32 v100, v100, v76
  v_add_f32 v101, v101, v77
  v_add_f32 v102, v102, v78
  v_add_f32 v103, v103, v79
  s_waitcnt lgkmcnt(0)
  v_add_f32 v100, v100, v80
  v_add_f32 v101, v101, v81
  v_add_f32 v102, v102, v82
  v_add_f32 v103, v103, v83
  ds_read_b128 v[76:79], v107 offset:45056
  ds_read_b128 v[80:83], v107 offset:49152
IF_206_end:
  s_waitcnt vmcnt(10)
  v_mfma_f32_16x16x32_bf16 v[44:47], v[12:15], v[214:217], v[44:47]
  v_mfma_f32_16x16x32_bf16 v[48:51], v[12:15], v[218:221], v[48:51]
  v_mfma_f32_16x16x32_bf16 v[52:55], v[12:15], v[222:225], v[52:55]
  v_mfma_f32_16x16x32_bf16 v[56:59], v[12:15], v[226:229], v[56:59]
  s_add_u32 s65, s65, 65536
  s_add_u32 s74, s65, s76
  buffer_load_dwordx4 v[12:15], v114, s[44:47], s74 offen offset:0 sc1
  s_cmp_lt_u32 s55, 4
  s_cbranch_scc1 IF_207_end
  s_waitcnt lgkmcnt(1)
  v_add_f32 v100, v100, v76
  v_add_f32 v101, v101, v77
  v_add_f32 v102, v102, v78
  v_add_f32 v103, v103, v79
  s_waitcnt lgkmcnt(0)
  v_add_f32 v100, v100, v80
  v_add_f32 v101, v101, v81
  v_add_f32 v102, v102, v82
  v_add_f32 v103, v103, v83
  ds_read_b128 v[76:79], v107 offset:53248
  ds_read_b128 v[80:83], v107 offset:57344
IF_207_end:
  s_waitcnt vmcnt(10)
  v_mfma_f32_16x16x32_bf16 v[44:47], v[16:19], v[230:233], v[44:47]
  v_mfma_f32_16x16x32_bf16 v[48:51], v[16:19], v[234:237], v[48:51]
  v_mfma_f32_16x16x32_bf16 v[52:55], v[16:19], v[238:241], v[52:55]
  v_mfma_f32_16x16x32_bf16 v[56:59], v[16:19], v[242:245], v[56:59]
  buffer_load_dwordx4 v[16:19], v114, s[44:47], s74 offen offset:1024 sc1
  s_cmp_lt_u32 s55, 4
  s_cbranch_scc1 IF_208_end
  s_waitcnt lgkmcnt(1)
  v_add_f32 v100, v100, v76
  v_add_f32 v101, v101, v77
  v_add_f32 v102, v102, v78
  v_add_f32 v103, v103, v79
  s_waitcnt lgkmcnt(0)
  v_add_f32 v100, v100, v80
  v_add_f32 v101, v101, v81
  v_add_f32 v102, v102, v82
  v_add_f32 v103, v103, v83
  ds_read_b128 v[76:79], v107 offset:61440
  v_lshlrev_b32 v80, 16, v86
  v_and_b32 v81, s57, v86
  v_lshlrev_b32 v82, 16, v87
  v_and_b32 v83, s57, v87
IF_208_end:
  s_waitcnt vmcnt(10)
  v_mfma_f32_16x16x32_bf16 v[60:63], v[20:23], v[118:121], 0
  v_mfma_f32_16x16x32_bf16 v[64:67], v[20:23], v[122:125], 0
  v_mfma_f32_16x16x32_bf16 v[68:71], v[20:23], v[126:129], 0
  v_mfma_f32_16x16x32_bf16 v[72:75], v[20:23], v[130:133], 0
  s_add_u32 s74, s65, s77
  buffer_load_dwordx4 v[20:23], v114, s[44:47], s74 offen offset:0 sc1
  s_cmp_lt_u32 s55, 4
  s_cbranch_scc1 IF_209_end
  s_waitcnt lgkmcnt(0)
  v_add_f32 v100, v100, v76
  v_add_f32 v101, v101, v77
  v_add_f32 v102, v102, v78
  v_add_f32 v103, v103, v79
  v_add_f32 v100, v100, v104
  v_mul_f32 v100, v100, v80
  v_add_f32 v101, v101, v104
  v_mul_f32 v101, v101, v81
  v_add_f32 v102, v102, v104
  v_mul_f32 v102, v102, v82
  v_add_f32 v103, v103, v104
  v_mul_f32 v103, v103, v83
  v_cvt_pk_bf16_f32 v94, v100, v101
  v_cvt_pk_bf16_f32 v95, v102, v103
IF_209_end:
  s_waitcnt vmcnt(10)
  v_mfma_f32_16x16x32_bf16 v[60:63], v[24:27], v[134:137], v[60:63]
  ds_write_b128 v106, v[44:47] offset:0
  v_mfma_f32_16x16x32_bf16 v[64:67], v[24:27], v[138:141], v[64:67]
  ds_write_b128 v106, v[48:51] offset:1024
  v_mfma_f32_16x16x32_bf16 v[68:71], v[24:27], v[142:145], v[68:71]
  ds_write_b128 v106, v[52:55] offset:2048
  v_mfma_f32_16x16x32_bf16 v[72:75], v[24:27], v[146:149], v[72:75]
  ds_write_b128 v106, v[56:59] offset:3072
  buffer_load_dwordx4 v[24:27], v114, s[44:47], s74 offen offset:1024 sc1
  s_waitcnt vmcnt(10)
  v_mfma_f32_16x16x32_bf16 v[60:63], v[28:31], v[150:153], v[60:63]
  v_mfma_f32_16x16x32_bf16 v[64:67], v[28:31], v[154:157], v[64:67]
  v_mfma_f32_16x16x32_bf16 v[68:71], v[28:31], v[158:161], v[68:71]
  v_mfma_f32_16x16x32_bf16 v[72:75], v[28:31], v[162:165], v[72:75]
  s_add_u32 s74, s65, s78
  buffer_load_dwordx4 v[28:31], v114, s[44:47], s74 offen offset:0 sc1
  s_waitcnt lgkmcnt(0)
  s_barrier
  s_waitcnt vmcnt(10)
  v_mfma_f32_16x16x32_bf16 v[60:63], v[32:35], v[166:169], v[60:63]
  v_mfma_f32_16x16x32_bf16 v[64:67], v[32:35], v[170:173], v[64:67]
  v_mfma_f32_16x16x32_bf16 v[68:71], v[32:35], v[174:177], v[68:71]
  v_mfma_f32_16x16x32_bf16 v[72:75], v[32:35], v[178:181], v[72:75]
  buffer_load_dwordx4 v[32:35], v114, s[44:47], s74 offen offset:1024 sc1
  s_waitcnt vmcnt(10)
  v_mfma_f32_16x16x32_bf16 v[60:63], v[36:39], v[182:185], v[60:63]
  v_mfma_f32_16x16x32_bf16 v[64:67], v[36:39], v[186:189], v[64:67]
  v_mfma_f32_16x16x32_bf16 v[68:71], v[36:39], v[190:193], v[68:71]
  v_mfma_f32_16x16x32_bf16 v[72:75], v[36:39], v[194:197], v[72:75]
  s_add_u32 s74, s65, s79
  buffer_load_dwordx4 v[36:39], v114, s[44:47], s74 offen offset:0 sc1
  s_cmp_lt_u32 s55, 4
  s_cbranch_scc1 IF_210_end
  ds_read_b128 v[100:103], v107 offset:0
  ds_read_b128 v[76:79], v107 offset:4096
  ds_read_b128 v[80:83], v107 offset:8192
IF_210_end:
  s_waitcnt vmcnt(9)
  v_mfma_f32_16x16x32_bf16 v[60:63], v[40:43], v[198:201], v[60:63]
  v_mfma_f32_16x16x32_bf16 v[64:67], v[40:43], v[202:205], v[64:67]
  v_mfma_f32_16x16x32_bf16 v[68:71], v[40:43], v[206:209], v[68:71]
  v_mfma_f32_16x16x32_bf16 v[72:75], v[40:43], v[210:213], v[72:75]
  buffer_load_dwordx4 v[40:43], v114, s[44:47], s74 offen offset:1024 sc1
  s_cmp_lt_u32 s55, 4
  s_cbranch_scc1 IF_211_end
  s_waitcnt lgkmcnt(1)
  v_add_f32 v100, v100, v76
  v_add_f32 v101, v101, v77
  v_add_f32 v102, v102, v78
  v_add_f32 v103, v103, v79
  s_waitcnt lgkmcnt(0)
  v_add_f32 v100, v100, v80
  v_add_f32 v101, v101, v81
  v_add_f32 v102, v102, v82
  v_add_f32 v103, v103, v83
  ds_read_b128 v[76:79], v107 offset:12288
  ds_read_b128 v[80:83], v107 offset:16384
IF_211_end:
  s_waitcnt vmcnt(9)
  v_mfma_f32_16x16x32_bf16 v[60:63], v[4:7], v[214:217], v[60:63]
  v_mfma_f32_16x16x32_bf16 v[64:67], v[4:7], v[218:221], v[64:67]
  v_mfma_f32_16x16x32_bf16 v[68:71], v[4:7], v[222:225], v[68:71]
  v_mfma_f32_16x16x32_bf16 v[72:75], v[4:7], v[226:229], v[72:75]
  s_add_u32 s65, s65, 65536
  s_add_u32 s74, s65, s76
  buffer_load_dwordx4 v[4:7], v114, s[44:47], s74 offen offset:0 sc1
  s_cmp_lt_u32 s55, 4
  s_cbranch_scc1 IF_212_end
  s_waitcnt lgkmcnt(1)
  v_add_f32 v100, v100, v76
  v_add_f32 v101, v101, v77
  v_add_f32 v102, v102, v78
  v_add_f32 v103, v103, v79
  s_waitcnt lgkmcnt(0)
  v_add_f32 v100, v100, v80
  v_add_f32 v101, v101, v81
  v_add_f32 v102, v102, v82
  v_add_f32 v103, v103, v83
  ds_read_b128 v[76:79], v107 offset:20480
  ds_read_b128 v[80:83], v107 offset:24576
IF_212_end:
  s_waitcnt vmcnt(9)
  v_mfma_f32_16x16x32_bf16 v[60:63], v[8:11], v[230:233], v[60:63]
  v_mfma_f32_16x16x32_bf16 v[64:67], v[8:11], v[234:237], v[64:67]
  v_mfma_f32_16x16x32_bf16 v[68:71], v[8:11], v[238:241], v[68:71]
  v_mfma_f32_16x16x32_bf16 v[72:75], v[8:11], v[242:245], v[72:75]
  buffer_load_dwordx4 v[8:11], v114, s[44:47], s74 offen offset:1024 sc1
  s_cmp_lt_u32 s55, 4
  s_cbranch_scc1 IF_213_end
  s_waitcnt lgkmcnt(1)
  v_add_f32 v100, v100, v76
  v_add_f32 v101, v101, v77
  v_add_f32 v102, v102, v78
  v_add_f32 v103, v103, v79
  s_waitcnt lgkmcnt(0)
  v_add_f32 v100, v100, v80
  v_add_f32 v101, v101, v81
  v_add_f32 v102, v102, v82
  v_add_f32 v103, v103, v83
  ds_read_b128 v[76:79], v107 offset:28672
  v_lshlrev_b32 v80, 16, v88
  v_and_b32 v81, s57, v88
  v_lshlrev_b32 v82, 16, v89
  v_and_b32 v83, s57, v89
IF_213_end:
  s_waitcnt vmcnt(9)
  v_mfma_f32_16x16x32_bf16 v[44:47], v[12:15], v[118:121], 0
  v_mfma_f32_16x16x32_bf16 v[48:51], v[12:15], v[122:125], 0
  v_mfma_f32_16x16x32_bf16 v[52:55], v[12:15], v[126:129], 0
  v_mfma_f32_16x16x32_bf16 v[56:59], v[12:15], v[130:133], 0
  s_add_u32 s74, s65, s77
  buffer_load_dwordx4 v[12:15], v114, s[44:47], s74 offen offset:0 sc1
  s_cmp_lt_u32 s55, 4
  s_cbranch_scc1 IF_214_end
  s_waitcnt lgkmcnt(0)
  v_add_f32 v100, v100, v76
  v_add_f32 v101, v101, v77
  v_add_f32 v102, v102, v78
  v_add_f32 v103, v103, v79
  v_add_f32 v100, v100, v104
  v_mul_f32 v100, v100, v80
  v_add_f32 v101, v101, v104
  v_mul_f32 v101, v101, v81
  v_add_f32 v102, v102, v104
  v_mul_f32 v102, v102, v82
  v_add_f32 v103, v103, v104
  v_mul_f32 v103, v103, v83
  v_cvt_pk_bf16_f32 v96, v100, v101
  v_cvt_pk_bf16_f32 v97, v102, v103
IF_214_end:
  s_waitcnt vmcnt(9)
  v_mfma_f32_16x16x32_bf16 v[44:47], v[16:19], v[134:137], v[44:47]
  ds_write_b128 v106, v[60:63] offset:32768
  v_mfma_f32_16x16x32_bf16 v[48:51], v[16:19], v[138:141], v[48:51]
  ds_write_b128 v106, v[64:67] offset:33792
  v_mfma_f32_16x16x32_bf16 v[52:55], v[16:19], v[142:145], v[52:55]
  ds_write_b128 v106, v[68:71] offset:34816
  v_mfma_f32_16x16x32_bf16 v[56:59], v[16:19], v[146:149], v[56:59]
  ds_write_b128 v106, v[72:75] offset:35840
  buffer_load_dwordx4 v[16:19], v114, s[44:47], s74 offen offset:1024 sc1
  s_waitcnt vmcnt(9)
  v_mfma_f32_16x16x32_bf16 v[44:47], v[20:23], v[150:153], v[44:47]
  v_mfma_f32_16x16x32_bf16 v[48:51], v[20:23], v[154:157], v[48:51]
  v_mfma_f32_16x16x32_bf16 v[52:55], v[20:23], v[158:161], v[52:55]
  v_mfma_f32_16x16x32_bf16 v[56:59], v[20:23], v[162:165], v[56:59]
  s_add_u32 s74, s65, s78
  buffer_load_dwordx4 v[20:23], v114, s[44:47], s74 offen offset:0 sc1
  s_waitcnt lgkmcnt(0)
  s_barrier
  s_waitcnt vmcnt(9)
  v_mfma_f32_16x16x32_bf16 v[44:47], v[24:27], v[166:169], v[44:47]
  v_mfma_f32_16x16x32_bf16 v[48:51], v[24:27], v[170:173], v[48:51]
  v_mfma_f32_16x16x32_bf16 v[52:55], v[24:27], v[174:177], v[52:55]
  v_mfma_f32_16x16x32_bf16 v[56:59], v[24:27], v[178:181], v[56:59]
  buffer_load_dwordx4 v[24:27], v114, s[44:47], s74 offen offset:1024 sc1
  s_waitcnt vmcnt(9)
  v_mfma_f32_16x16x32_bf16 v[44:47], v[28:31], v[182:185], v[44:47]
  v_mfma_f32_16x16x32_bf16 v[48:51], v[28:31], v[186:189], v[48:51]
  v_mfma_f32_16x16x32_bf16 v[52:55], v[28:31], v[190:193], v[52:55]
  v_mfma_f32_16x16x32_bf16 v[56:59], v[28:31], v[194:197], v[56:59]
  s_add_u32 s74, s65, s79
  buffer_load_dwordx4 v[28:31], v114, s[44:47], s74 offen offset:0 sc1
  s_cmp_lt_u32 s55, 4
  s_cbranch_scc1 IF_215_end
  ds_read_b128 v[100:103], v107 offset:32768
  ds_read_b128 v[76:79], v107 offset:36864
  ds_read_b128 v[80:83], v107 offset:40960
IF_215_end:
  s_waitcnt vmcnt(9)
  v_mfma_f32_16x16x32_bf16 v[44:47], v[32:35], v[198:201], v[44:47]
  v_mfma_f32_16x16x32_bf16 v[48:51], v[32:35], v[202:205], v[48:51]
  v_mfma_f32_16x16x32_bf16 v[52:55], v[32:35], v[206:209], v[52:55]
  v_mfma_f32_16x16x32_bf16 v[56:59], v[32:35], v[210:213], v[56:59]
  buffer_load_dwordx4 v[32:35], v114, s[44:47], s74 offen offset:1024 sc1
  s_cmp_lt_u32 s55, 4
  s_cbranch_scc1 IF_216_end
  s_waitcnt lgkmcnt(1)
  v_add_f32 v100, v100, v76
  v_add_f32 v101, v101, v77
  v_add_f32 v102, v102, v78
  v_add_f32 v103, v103, v79
  s_waitcnt lgkmcnt(0)
  v_add_f32 v100, v100, v80
  v_add_f32 v101, v101, v81
  v_add_f32 v102, v102, v82
  v_add_f32 v103, v103, v83
  ds_read_b128 v[76:79], v107 offset:45056
  ds_read_b128 v[80:83], v107 offset:49152
IF_216_end:
  s_waitcnt vmcnt(9)
  v_mfma_f32_16x16x32_bf16 v[44:47], v[36:39], v[214:217], v[44:47]
  v_mfma_f32_16x16x32_bf16 v[48:51], v[36:39], v[218:221], v[48:51]
  v_mfma_f32_16x16x32_bf16 v[52:55], v[36:39], v[222:225], v[52:55]
  v_mfma_f32_16x16x32_bf16 v[56:59], v[36:39], v[226:229], v[56:59]
  s_add_u32 s65, s65, 65536
  s_cmp_lt_u32 s53, 6
  s_cselect_b32 s65, s65, 2147483648
  s_add_u32 s74, s65, s76
  buffer_load_dwordx4 v[36:39], v114, s[44:47], s74 offen offset:0 sc1
  s_cmp_lt_u32 s55, 4
  s_cbranch_scc1 IF_217_end
  s_waitcnt lgkmcnt(1)
  v_add_f32 v100, v100, v76
  v_add_f32 v101, v101, v77
  v_add_f32 v102, v102, v78
  v_add_f32 v103, v103, v79
  s_waitcnt lgkmcnt(0)
  v_add_f32 v100, v100, v80
  v_add_f32 v101, v101, v81
  v_add_f32 v102, v102, v82
  v_add_f32 v103, v103, v83
  ds_read_b128 v[76:79], v107 offset:53248
  ds_read_b128 v[80:83], v107 offset:57344
IF_217_end:
  s_waitcnt vmcnt(9)
  v_mfma_f32_16x16x32_bf16 v[44:47], v[40:43], v[230:233], v[44:47]
  v_mfma_f32_16x16x32_bf16 v[48:51], v[40:43], v[234:237], v[48:51]
  v_mfma_f32_16x16x32_bf16 v[52:55], v[40:43], v[238:241], v[52:55]
  v_mfma_f32_16x16x32_bf16 v[56:59], v[40:43], v[242:245], v[56:59]
  buffer_load_dwordx4 v[40:43], v114, s[44:47], s74 offen offset:1024 sc1
  s_cmp_lt_u32 s55, 4
  s_cbranch_scc1 IF_218_end
  s_waitcnt lgkmcnt(1)
  v_add_f32 v100, v100, v76
  v_add_f32 v101, v101, v77
  v_add_f32 v102, v102, v78
  v_add_f32 v103, v103, v79
  s_waitcnt lgkmcnt(0)
  v_add_f32 v100, v100, v80
  v_add_f32 v101, v101, v81
  v_add_f32 v102, v102, v82
  v_add_f32 v103, v103, v83
  ds_read_b128 v[76:79], v107 offset:61440
  v_lshlrev_b32 v80, 16, v90
  v_and_b32 v81, s57, v90
  v_lshlrev_b32 v82, 16, v91
  v_and_b32 v83, s57, v91
IF_218_end:
  s_waitcnt vmcnt(9)
  v_mfma_f32_16x16x32_bf16 v[60:63], v[4:7], v[118:121], 0
  v_mfma_f32_16x16x32_bf16 v[64:67], v[4:7], v[122:125], 0
  v_mfma_f32_16x16x32_bf16 v[68:71], v[4:7], v[126:129], 0
  v_mfma_f32_16x16x32_bf16 v[72:75], v[4:7], v[130:133], 0
  s_add_u32 s74, s65, s77
  buffer_load_dwordx4 v[4:7], v114, s[44:47], s74 offen offset:0 sc1
  s_cmp_lt_u32 s55, 4
  s_cbranch_scc1 IF_219_end
  s_waitcnt lgkmcnt(0)
  v_add_f32 v100, v100, v76
  v_add_f32 v101, v101, v77
  v_add_f32 v102, v102, v78
  v_add_f32 v103, v103, v79
  v_add_f32 v100, v100, v104
  v_mul_f32 v100, v100, v80
  v_add_f32 v101, v101, v104
  v_mul_f32 v101, v101, v81
  v_add_f32 v102, v102, v104
  v_mul_f32 v102, v102, v82
  v_add_f32 v103, v103, v104
  v_mul_f32 v103, v103, v83
  v_cvt_pk_bf16_f32 v98, v100, v101
  v_cvt_pk_bf16_f32 v99, v102, v103
  buffer_store_dwordx4 v[92:95], v114, s[44:47], s70 offen sc1
  buffer_store_dwordx4 v[96:99], v114, s[44:47], s70 offen offset:1024 sc1
IF_219_end:
  s_waitcnt vmcnt(9)
  v_mfma_f32_16x16x32_bf16 v[60:63], v[8:11], v[134:137], v[60:63]
  ds_write_b128 v106, v[44:47] offset:0
  v_mfma_f32_16x16x32_bf16 v[64:67], v[8:11], v[138:141], v[64:67]
  ds_write_b128 v106, v[48:51] offset:1024
  v_mfma_f32_16x16x32_bf16 v[68:71], v[8:11], v[142:145], v[68:71]
  ds_write_b128 v106, v[52:55] offset:2048
  v_mfma_f32_16x16x32_bf16 v[72:75], v[8:11], v[146:149], v[72:75]
  ds_write_b128 v106, v[56:59] offset:3072
  buffer_load_dwordx4 v[8:11], v114, s[44:47], s74 offen offset:1024 sc1
  s_waitcnt vmcnt(9)
  v_mfma_f32_16x16x32_bf16 v[60:63], v[12:15], v[150:153], v[60:63]
  v_mfma_f32_16x16x32_bf16 v[64:67], v[12:15], v[154:157], v[64:67]
  v_mfma_f32_16x16x32_bf16 v[68:71], v[12:15], v[158:161], v[68:71]
  v_mfma_f32_16x16x32_bf16 v[72:75], v[12:15], v[162:165], v[72:75]
  s_add_u32 s74, s65, s78
  buffer_load_dwordx4 v[12:15], v114, s[44:47], s74 offen offset:0 sc1
  s_waitcnt lgkmcnt(0)
  s_barrier
  s_waitcnt vmcnt(9)
  v_mfma_f32_16x16x32_bf16 v[60:63], v[16:19], v[166:169], v[60:63]
  v_mfma_f32_16x16x32_bf16 v[64:67], v[16:19], v[170:173], v[64:67]
  v_mfma_f32_16x16x32_bf16 v[68:71], v[16:19], v[174:177], v[68:71]
  v_mfma_f32_16x16x32_bf16 v[72:75], v[16:19], v[178:181], v[72:75]
  buffer_load_dwordx4 v[16:19], v114, s[44:47], s74 offen offset:1024 sc1
  s_waitcnt vmcnt(9)
  v_mfma_f32_16x16x32_bf16 v[60:63], v[20:23], v[182:185], v[60:63]
  v_mfma_f32_16x16x32_bf16 v[64:67], v[20:23], v[186:189], v[64:67]
  v_mfma_f32_16x16x32_bf16 v[68:71], v[20:23], v[190:193], v[68:71]
  v_mfma_f32_16x16x32_bf16 v[72:75], v[20:23], v[194:197], v[72:75]
  s_add_u32 s74, s65, s79
  buffer_load_dwordx4 v[20:23], v114, s[44:47], s74 offen offset:0 sc1
  s_cmp_lt_u32 s55, 4
  s_cbranch_scc0 IF_220_else
  ds_read_b128 v[100:103], v107 offset:0
  ds_read_b128 v[76:79], v107 offset:4096
  ds_read_b128 v[80:83], v107 offset:8192
IF_220_else:
  s_waitcnt vmcnt(9)
  v_mfma_f32_16x16x32_bf16 v[60:63], v[24:27], v[198:201], v[60:63]
  v_mfma_f32_16x16x32_bf16 v[64:67], v[24:27], v[202:205], v[64:67]
  v_mfma_f32_16x16x32_bf16 v[68:71], v[24:27], v[206:209], v[68:71]
  v_mfma_f32_16x16x32_bf16 v[72:75], v[24:27], v[210:213], v[72:75]
  buffer_load_dwordx4 v[24:27], v114, s[44:47], s74 offen offset:1024 sc1
  s_cmp_lt_u32 s55, 4
  s_cbranch_scc0 IF_221_else
  s_waitcnt lgkmcnt(1)
  v_add_f32 v100, v100, v76
  v_add_f32 v101, v101, v77
  v_add_f32 v102, v102, v78
  v_add_f32 v103, v103, v79
  s_waitcnt lgkmcnt(0)
  v_add_f32 v100, v100, v80
  v_add_f32 v101, v101, v81
  v_add_f32 v102, v102, v82
  v_add_f32 v103, v103, v83
  ds_read_b128 v[76:79], v107 offset:12288
  ds_read_b128 v[80:83], v107 offset:16384
IF_221_else:
  s_waitcnt vmcnt(9)
  v_mfma_f32_16x16x32_bf16 v[60:63], v[28:31], v[214:217], v[60:63]
  v_mfma_f32_16x16x32_bf16 v[64:67], v[28:31], v[218:221], v[64:67]
  v_mfma_f32_16x16x32_bf16 v[68:71], v[28:31], v[222:225], v[68:71]
  v_mfma_f32_16x16x32_bf16 v[72:75], v[28:31], v[226:229], v[72:75]
  s_cmp_lt_u32 s55, 4
  s_cbranch_scc0 IF_222_else
  s_waitcnt lgkmcnt(1)
  v_add_f32 v100, v100, v76
  v_add_f32 v101, v101, v77
  v_add_f32 v102, v102, v78
  v_add_f32 v103, v103, v79
  s_waitcnt lgkmcnt(0)
  v_add_f32 v100, v100, v80
  v_add_f32 v101, v101, v81
  v_add_f32 v102, v102, v82
  v_add_f32 v103, v103, v83
  ds_read_b128 v[76:79], v107 offset:20480
  ds_read_b128 v[80:83], v107 offset:24576
IF_222_else:
  s_waitcnt vmcnt(8)
  v_mfma_f32_16x16x32_bf16 v[60:63], v[32:35], v[230:233], v[60:63]
  v_mfma_f32_16x16x32_bf16 v[64:67], v[32:35], v[234:237], v[64:67]
  v_mfma_f32_16x16x32_bf16 v[68:71], v[32:35], v[238:241], v[68:71]
  v_mfma_f32_16x16x32_bf16 v[72:75], v[32:35], v[242:245], v[72:75]
  s_cmp_lt_u32 s55, 4
  s_cbranch_scc0 IF_223_else
  s_waitcnt lgkmcnt(1)
  v_add_f32 v100, v100, v76
  v_add_f32 v101, v101, v77
  v_add_f32 v102, v102, v78
  v_add_f32 v103, v103, v79
  s_waitcnt lgkmcnt(0)
  v_add_f32 v100, v100, v80
  v_add_f32 v101, v101, v81
  v_add_f32 v102, v102, v82
  v_add_f32 v103, v103, v83
  ds_read_b128 v[76:79], v107 offset:28672
  v_lshlrev_b32 v80, 16, v84
  v_and_b32 v81, s57, v84
  v_lshlrev_b32 v82, 16, v85
  v_and_b32 v83, s57, v85
IF_223_else:
  s_waitcnt vmcnt(7)
  v_mfma_f32_16x16x32_bf16 v[44:47], v[36:39], v[118:121], 0
  v_mfma_f32_16x16x32_bf16 v[48:51], v[36:39], v[122:125], 0
  v_mfma_f32_16x16x32_bf16 v[52:55], v[36:39], v[126:129], 0
  v_mfma_f32_16x16x32_bf16 v[56:59], v[36:39], v[130:133], 0
  s_cmp_lt_u32 s55, 4
  s_cbranch_scc0 IF_224_else
  s_waitcnt lgkmcnt(0)
  v_add_f32 v100, v100, v76
  v_add_f32 v101, v101, v77
  v_add_f32 v102, v102, v78
  v_add_f32 v103, v103, v79
  v_add_f32 v100, v100, v104
  v_mul_f32 v100, v100, v80
  v_add_f32 v101, v101, v104
  v_mul_f32 v101, v101, v81
  v_add_f32 v102, v102, v104
  v_mul_f32 v102, v102, v82
  v_add_f32 v103, v103, v104
  v_mul_f32 v103, v103, v83
  v_cvt_pk_bf16_f32 v92, v100, v101
  v_cvt_pk_bf16_f32 v93, v102, v103
IF_224_else:
  s_waitcnt vmcnt(6)
  v_mfma_f32_16x16x32_bf16 v[44:47], v[40:43], v[134:137], v[44:47]
  ds_write_b128 v106, v[60:63] offset:32768
  v_mfma_f32_16x16x32_bf16 v[48:51], v[40:43], v[138:141], v[48:51]
  ds_write_b128 v106, v[64:67] offset:33792
  v_mfma_f32_16x16x32_bf16 v[52:55], v[40:43], v[142:145], v[52:55]
  ds_write_b128 v106, v[68:71] offset:34816
  v_mfma_f32_16x16x32_bf16 v[56:59], v[40:43], v[146:149], v[56:59]
  ds_write_b128 v106, v[72:75] offset:35840
  s_waitcnt vmcnt(5)
  v_mfma_f32_16x16x32_bf16 v[44:47], v[4:7], v[150:153], v[44:47]
  v_mfma_f32_16x16x32_bf16 v[48:51], v[4:7], v[154:157], v[48:51]
  v_mfma_f32_16x16x32_bf16 v[52:55], v[4:7], v[158:161], v[52:55]
  v_mfma_f32_16x16x32_bf16 v[56:59], v[4:7], v[162:165], v[56:59]
  s_waitcnt lgkmcnt(0)
  s_barrier
  s_waitcnt vmcnt(4)
  v_mfma_f32_16x16x32_bf16 v[44:47], v[8:11], v[166:169], v[44:47]
  v_mfma_f32_16x16x32_bf16 v[48:51], v[8:11], v[170:173], v[48:51]
  v_mfma_f32_16x16x32_bf16 v[52:55], v[8:11], v[174:177], v[52:55]
  v_mfma_f32_16x16x32_bf16 v[56:59], v[8:11], v[178:181], v[56:59]
  s_waitcnt vmcnt(3)
  v_mfma_f32_16x16x32_bf16 v[44:47], v[12:15], v[182:185], v[44:47]
  v_mfma_f32_16x16x32_bf16 v[48:51], v[12:15], v[186:189], v[48:51]
  v_mfma_f32_16x16x32_bf16 v[52:55], v[12:15], v[190:193], v[52:55]
  v_mfma_f32_16x16x32_bf16 v[56:59], v[12:15], v[194:197], v[56:59]
  s_cmp_lt_u32 s55, 4
  s_cbranch_scc0 IF_225_else
  ds_read_b128 v[100:103], v107 offset:32768
  ds_read_b128 v[76:79], v107 offset:36864
  ds_read_b128 v[80:83], v107 offset:40960
IF_225_else:
  s_cmp_lt_u32 s55, 4
  s_cbranch_scc1 IF_226_end
  s_lshl_b32 s63, s72, 7
  s_add_u32 s63, s63, 1441792
  v_mov_b32 v2, s54
  v_lshlrev_b32 v3, 26, v1
  v_and_b32 v3, 2147483648, v3
  v_lshl_or_b32 v3, v1, 2, v3
  buffer_store_dword v2, v3, s[44:47], s63 offen sc1
IF_226_end:
  s_waitcnt vmcnt(2)
  v_mfma_f32_16x16x32_bf16 v[44:47], v[16:19], v[198:201], v[44:47]
  v_mfma_f32_16x16x32_bf16 v[48:51], v[16:19], v[202:205], v[48:51]
  v_mfma_f32_16x16x32_bf16 v[52:55], v[16:19], v[206:209], v[52:55]
  v_mfma_f32_16x16x32_bf16 v[56:59], v[16:19], v[210:213], v[56:59]
  s_cmp_lt_u32 s55, 4
  s_cbranch_scc0 IF_227_else
  s_waitcnt lgkmcnt(1)
  v_add_f32 v100, v100, v76
  v_add_f32 v101, v101, v77
  v_add_f32 v102, v102, v78
  v_add_f32 v103, v103, v79
  s_waitcnt lgkmcnt(0)
  v_add_f32 v100, v100, v80
  v_add_f32 v101, v101, v81
  v_add_f32 v102, v102, v82
  v_add_f32 v103, v103, v83
  ds_read_b128 v[76:79], v107 offset:45056
  ds_read_b128 v[80:83], v107 offset:49152
IF_227_else:
  s_waitcnt vmcnt(1)
  v_mfma_f32_16x16x32_bf16 v[44:47], v[20:23], v[214:217], v[44:47]
  v_mfma_f32_16x16x32_bf16 v[48:51], v[20:23], v[218:221], v[48:51]
  v_mfma_f32_16x16x32_bf16 v[52:55], v[20:23], v[222:225], v[52:55]
  v_mfma_f32_16x16x32_bf16 v[56:59], v[20:23], v[226:229], v[56:59]
  s_cmp_lt_u32 s55, 4
  s_cbranch_scc0 IF_228_else
  s_waitcnt lgkmcnt(1)
  v_add_f32 v100, v100, v76
  v_add_f32 v101, v101, v77
  v_add_f32 v102, v102, v78
  v_add_f32 v103, v103, v79
  s_waitcnt lgkmcnt(0)
  v_add_f32 v100, v100, v80
  v_add_f32 v101, v101, v81
  v_add_f32 v102, v102, v82
  v_add_f32 v103, v103, v83
  ds_read_b128 v[76:79], v107 offset:53248
  ds_read_b128 v[80:83], v107 offset:57344
IF_228_else:
  s_waitcnt vmcnt(0)
  v_mfma_f32_16x16x32_bf16 v[44:47], v[24:27], v[230:233], v[44:47]
  v_mfma_f32_16x16x32_bf16 v[48:51], v[24:27], v[234:237], v[48:51]
  v_mfma_f32_16x16x32_bf16 v[52:55], v[24:27], v[238:241], v[52:55]
  v_mfma_f32_16x16x32_bf16 v[56:59], v[24:27], v[242:245], v[56:59]
  s_cmp_lt_u32 s55, 4
  s_cbranch_scc0 IF_229_else
  s_waitcnt lgkmcnt(1)
  v_add_f32 v100, v100, v76
  v_add_f32 v101, v101, v77
  v_add_f32 v102, v102, v78
  v_add_f32 v103, v103, v79
  s_waitcnt lgkmcnt(0)
  v_add_f32 v100, v100, v80
  v_add_f32 v101, v101, v81
  v_add_f32 v102, v102, v82
  v_add_f32 v103, v103, v83
  ds_read_b128 v[76:79], v107 offset:61440
  v_lshlrev_b32 v80, 16, v86
  v_and_b32 v81, s57, v86
  v_lshlrev_b32 v82, 16, v87
  v_and_b32 v83, s57, v87
IF_229_else:
  s_cmp_lt_u32 s55, 4
  s_cbranch_scc0 IF_230_else
  s_waitcnt lgkmcnt(0)
  v_add_f32 v100, v100, v76
  v_add_f32 v101, v101, v77
  v_add_f32 v102, v102, v78
  v_add_f32 v103, v103, v79
  v_add_f32 v100, v100, v104
  v_mul_f32 v100, v100, v80
  v_add_f32 v101, v101, v104
  v_mul_f32 v101, v101, v81
  v_add_f32 v102, v102, v104
  v_mul_f32 v102, v102, v82
  v_add_f32 v103, v103, v104
  v_mul_f32 v103, v103, v83
  v_cvt_pk_bf16_f32 v94, v100, v101
  v_cvt_pk_bf16_f32 v95, v102, v103
IF_230_else:
  s_nop 0
  ds_write_b128 v106, v[44:47] offset:0
  ds_write_b128 v106, v[48:51] offset:1024
  ds_write_b128 v106, v[52:55] offset:2048
  ds_write_b128 v106, v[56:59] offset:3072
  s_waitcnt lgkmcnt(0)
  s_barrier
  s_cmp_lt_u32 s55, 4
  s_cbranch_scc0 IF_236_else
  v_and_b32 v108, 7, v1
  v_lshlrev_b32 v108, 8, v108
  s_lshl_b32 s75, s66, 11
  s_add_u32 s75, s75, 1441792
  v_mov_b32 v243, v108
  buffer_load_dword v244, v243, s[44:47], s75 offen offset:0 sc1
  ds_read_b128 v[4:7], v107 offset:0
  ds_read_b128 v[8:11], v107 offset:4096
  ds_read_b128 v[12:15], v107 offset:8192
  ds_read_b128 v[16:19], v107 offset:12288
  ds_read_b128 v[20:23], v107 offset:16384
  ds_read_b128 v[24:27], v107 offset:20480
  ds_read_b128 v[28:31], v107 offset:24576
  ds_read_b128 v[32:35], v107 offset:28672
  v_lshlrev_b32 v80, 16, v88
  v_and_b32 v81, s57, v88
  v_lshlrev_b32 v82, 16, v89
  v_and_b32 v83, s57, v89
  s_waitcnt lgkmcnt(6)
  v_pk_add_f32 v[4:5], v[4:5], v[8:9]
  v_pk_add_f32 v[6:7], v[6:7], v[10:11]
  s_waitcnt lgkmcnt(4)
  v_pk_add_f32 v[12:13], v[12:13], v[16:17]
  v_pk_add_f32 v[14:15], v[14:15], v[18:19]
  s_waitcnt lgkmcnt(2)
  v_pk_add_f32 v[20:21], v[20:21], v[24:25]
  v_pk_add_f32 v[22:23], v[22:23], v[26:27]
  s_waitcnt lgkmcnt(0)
  v_pk_add_f32 v[28:29], v[28:29], v[32:33]
  v_pk_add_f32 v[30:31], v[30:31], v[34:35]
  v_pk_add_f32 v[4:5], v[4:5], v[12:13]
  v_pk_add_f32 v[6:7], v[6:7], v[14:15]
  v_pk_add_f32 v[20:21], v[20:21], v[28:29]
  v_pk_add_f32 v[22:23], v[22:23], v[30:31]
  v_pk_add_f32 v[4:5], v[4:5], v[20:21]
  v_pk_add_f32 v[6:7], v[6:7], v[22:23]
  v_add_f32 v4, v4, v104
  v_mul_f32 v4, v4, v80
  v_add_f32 v5, v5, v104
  v_mul_f32 v5, v5, v81
  v_add_f32 v6, v6, v104
  v_mul_f32 v6, v6, v82
  v_add_f32 v7, v7, v104
  v_mul_f32 v7, v7, v83
  v_cvt_pk_bf16_f32 v96, v4, v5
  v_cvt_pk_bf16_f32 v97, v6, v7
  buffer_store_dwordx4 v[92:95], v114, s[44:47], s70 offen offset:2048 sc1
  buffer_store_dwordx2 v[96:97], v115, s[44:47], s71 offen sc1
  s_barrier
  v_mov_b32 v239, v114
  v_mov_b32 v238, v115
  v_add_u32 v240, 23552, v239
  v_add_u32 v241, 84992, v239
  v_add_u32 v242, 146432, v239
  s_lshr_b32 s65, s59, 1
  s_lshl_b32 s65, s65, 5
  s_and_b32 s63, s59, 1
  s_lshl_b32 s63, s63, 2
  s_add_u32 s65, s65, s63
  s_lshl_b32 s63, s52, 6
  s_add_u32 s65, s65, s63
  v_bfe_u32 v235, v1, 2, 2
  v_and_b32 v2, 3, v1
  v_lshl_add_u32 v235, v235, 3, v2
  v_add_u32 v235, s65, v235
  v_mul_u32_u24 v235, 1280, v235
  v_lshrrev_b32 v2, 4, v1
  v_lshl_add_u32 v235, v2, 3, v235
  s_mul_i32 s63, s53, 5
  s_and_b32 s63, s63, 3
  s_lshl_b32 s63, s63, 6
  s_add_u32 s63, s63, 161792
  v_and_b32 v234, 48, v1
  v_add_u32 v234, s63, v234
  ds_read_b128 v[212:215], v234 offset:1536
  ds_read_b128 v[216:219], v234 offset:1600
  ds_read_b128 v[220:223], v234 offset:1664
  ds_read_b128 v[224:227], v234 offset:1728
  ds_read_b128 v[228:231], v234 offset:1792
  ds_read_b128 v[112:115], v240 offset:46080
  ds_read_b128 v[116:119], v240 offset:47104
  ds_read_b128 v[120:123], v240 offset:48128
  ds_read_b128 v[124:127], v240 offset:49152
  ds_read_b128 v[128:131], v240 offset:50176
  ds_read_b128 v[132:135], v240 offset:51200
  ds_read_b128 v[136:139], v240 offset:52224
  ds_read_b128 v[140:143], v240 offset:53248
  ds_read_b128 v[144:147], v240 offset:54272
  ds_read_b128 v[148:151], v240 offset:55296
  ds_read_b128 v[152:155], v241 offset:0
  ds_read_b128 v[156:159], v241 offset:1024
  ds_read_b128 v[160:163], v241 offset:2048
  ds_read_b128 v[164:167], v241 offset:3072
  ds_read_b128 v[168:171], v241 offset:4096
  s_waitcnt vmcnt(2)
  v_cmp_ne_u32 vcc, s54, v244
  s_cbranch_vccz IF_232_else
  s_mov_b32 s58, 1048576
LP_231:
  s_sleep 2
  buffer_load_dword v244, v243, s[44:47], s75 offen offset:0 sc1
  s_waitcnt vmcnt(0)
  v_cmp_ne_u32 vcc, s54, v244
  s_sub_u32 s58, s58, 1
  s_cselect_b64 vcc, 0, vcc
  s_cbranch_vccnz LP_231
IF_232_else:
  s_add_u32 s65, s69, 8192
  buffer_load_dwordx4 v[4:7], v239, s[44:47], s65 offen offset:1024 sc1
  buffer_load_dwordx4 v[8:11], v239, s[44:47], s65 offen offset:2048 sc1
  s_add_u32 s65, s69, 12288
  buffer_load_dwordx4 v[12:15], v239, s[44:47], s65 offen offset:0 sc1
  buffer_load_dwordx4 v[16:19], v239, s[44:47], s65 offen offset:1024 sc1
  s_lshl_b32 s63, s72, 7
  s_add_u32 s63, s63, 1441792
  v_mov_b32 v2, s54
  v_lshlrev_b32 v3, 26, v1
  v_and_b32 v3, 2147483648, v3
  v_lshl_or_b32 v3, v1, 2, v3
  s_waitcnt vmcnt(4)
  buffer_store_dword v2, v3, s[44:47], s63 offen sc1
  s_waitcnt vmcnt(4) lgkmcnt(14)
  v_mfma_f32_16x16x32_bf16 v[192:195], v[112:115], v[4:7], 0
  ds_read_b128 v[172:175], v241 offset:5120
  s_waitcnt lgkmcnt(14)
  v_mfma_f32_16x16x32_bf16 v[196:199], v[116:119], v[4:7], 0
  ds_read_b128 v[176:179], v241 offset:6144
  s_add_u32 s65, s69, 12288
  buffer_load_dwordx4 v[20:23], v239, s[44:47], s65 offen offset:3072 sc1
  s_waitcnt lgkmcnt(14)
  v_mfma_f32_16x16x32_bf16 v[200:203], v[120:123], v[4:7], 0
  ds_read_b128 v[180:183], v241 offset:7168
  s_waitcnt lgkmcnt(14)
  v_mfma_f32_16x16x32_bf16 v[204:207], v[124:127], v[4:7], 0
  ds_read_b128 v[184:187], v241 offset:8192
  s_add_u32 s65, s69, 16384
  buffer_load_dwordx4 v[24:27], v239, s[44:47], s65 offen offset:0 sc1
  s_waitcnt lgkmcnt(14)
  v_mfma_f32_16x16x32_bf16 v[208:211], v[128:131], v[4:7], 0
  ds_read_b128 v[188:191], v241 offset:9216
  s_waitcnt vmcnt(5) lgkmcnt(14)
  v_mfma_f32_16x16x32_bf16 v[192:195], v[132:135], v[8:11], v[192:195]
  ds_read_b128 v[112:115], v241 offset:15360
  s_waitcnt lgkmcnt(14)
  v_mfma_f32_16x16x32_bf16 v[196:199], v[136:139], v[8:11], v[196:199]
  ds_read_b128 v[116:119], v241 offset:16384
  s_add_u32 s65, s69, 16384
  buffer_load_dwordx4 v[28:31], v239, s[44:47], s65 offen offset:2048 sc1
  s_waitcnt lgkmcnt(14)
  v_mfma_f32_16x16x32_bf16 v[200:203], v[140:143], v[8:11], v[200:203]
  ds_read_b128 v[120:123], v241 offset:17408
  s_waitcnt lgkmcnt(14)
  v_mfma_f32_16x16x32_bf16 v[204:207], v[144:147], v[8:11], v[204:207]
  ds_read_b128 v[124:127], v241 offset:18432
  buffer_load_dwordx4 v[32:35], v239, s[44:47], s65 offen offset:3072 sc1
  s_waitcnt lgkmcnt(14)
  v_mfma_f32_16x16x32_bf16 v[208:211], v[148:151], v[8:11], v[208:211]
  ds_read_b128 v[128:131], v241 offset:19456
  s_waitcnt vmcnt(6) lgkmcnt(14)
  v_mfma_f32_16x16x32_bf16 v[192:195], v[152:155], v[12:15], v[192:195]
  ds_read_b128 v[132:135], v241 offset:20480
  s_waitcnt lgkmcnt(14)
  v_mfma_f32_16x16x32_bf16 v[196:199], v[156:159], v[12:15], v[196:199]
  ds_read_b128 v[136:139], v241 offset:21504
  s_add_u32 s65, s69, 20480
  buffer_load_dwordx4 v[36:39], v239, s[44:47], s65 offen offset:1024 sc1
  s_waitcnt lgkmcnt(14)
  v_mfma_f32_16x16x32_bf16 v[200:203], v[160:163], v[12:15], v[200:203]
  ds_read_b128 v[140:143], v241 offset:22528
  s_waitcnt lgkmcnt(14)
  v_mfma_f32_16x16x32_bf16 v[204:207], v[164:167], v[12:15], v[204:207]
  ds_read_b128 v[144:147], v241 offset:23552
  buffer_load_dwordx4 v[40:43], v239, s[44:47], s65 offen offset:2048 sc1
  s_waitcnt lgkmcnt(14)
  v_mfma_f32_16x16x32_bf16 v[208:211], v[168:171], v[12:15], v[208:211]
  ds_read_b128 v[148:151], v241 offset:24576
  s_waitcnt vmcnt(7) lgkmcnt(14)
  v_mfma_f32_16x16x32_bf16 v[192:195], v[172:175], v[16:19], v[192:195]
  ds_read_b128 v[152:155], v241 offset:30720
  s_waitcnt lgkmcnt(14)
  v_mfma_f32_16x16x32_bf16 v[196:199], v[176:179], v[16:19], v[196:199]
  ds_read_b128 v[156:159], v241 offset:31744
  s_add_u32 s65, s69, 0
  buffer_load_dwordx4 v[44:47], v239, s[44:47], s65 offen offset:0 sc1
  s_waitcnt lgkmcnt(14)
  v_mfma_f32_16x16x32_bf16 v[200:203], v[180:183], v[16:19], v[200:203]
  ds_read_b128 v[160:163], v241 offset:32768
  s_waitcnt lgkmcnt(14)
  v_mfma_f32_16x16x32_bf16 v[204:207], v[184:187], v[16:19], v[204:207]
  ds_read_b128 v[164:167], v241 offset:33792
  buffer_load_dwordx4 v[48:51], v239, s[44:47], s65 offen offset:1024 sc1
  s_waitcnt lgkmcnt(14)
  v_mfma_f32_16x16x32_bf16 v[208:211], v[188:191], v[16:19], v[208:211]
  ds_read_b128 v[168:171], v241 offset:34816
  s_waitcnt vmcnt(7) lgkmcnt(14)
  v_mfma_f32_16x16x32_bf16 v[192:195], v[112:115], v[20:23], v[192:195]
  ds_read_b128 v[172:175], v241 offset:35840
  s_waitcnt lgkmcnt(14)
  v_mfma_f32_16x16x32_bf16 v[196:199], v[116:119], v[20:23], v[196:199]
  ds_read_b128 v[176:179], v241 offset:36864
  s_add_u32 s65, s69, 0
  buffer_load_dwordx4 v[52:55], v239, s[44:47], s65 offen offset:3072 sc1
  s_waitcnt lgkmcnt(14)
  v_mfma_f32_16x16x32_bf16 v[200:203], v[120:123], v[20:23], v[200:203]
  ds_read_b128 v[180:183], v241 offset:37888
  s_waitcnt lgkmcnt(14)
  v_mfma_f32_16x16x32_bf16 v[204:207], v[124:127], v[20:23], v[204:207]
  ds_read_b128 v[184:187], v241 offset:38912
  s_add_u32 s65, s69, 4096
  buffer_load_dwordx4 v[56:59], v239, s[44:47], s65 offen offset:0 sc1
  s_waitcnt lgkmcnt(14)
  v_mfma_f32_16x16x32_bf16 v[208:211], v[128:131], v[20:23], v[208:211]
  ds_read_b128 v[188:191], v241 offset:39936
  s_waitcnt vmcnt(8) lgkmcnt(14)
  v_mfma_f32_16x16x32_bf16 v[192:195], v[132:135], v[24:27], v[192:195]
  ds_read_b128 v[112:115], v241 offset:46080
  s_waitcnt lgkmcnt(14)
  v_mfma_f32_16x16x32_bf16 v[196:199], v[136:139], v[24:27], v[196:199]
  ds_read_b128 v[116:119], v241 offset:47104
  s_add_u32 s65, s69, 4096
  buffer_load_dwordx4 v[60:63], v239, s[44:47], s65 offen offset:2048 sc1
  s_waitcnt lgkmcnt(14)
  v_mfma_f32_16x16x32_bf16 v[200:203], v[140:143], v[24:27], v[200:203]
  ds_read_b128 v[120:123], v241 offset:48128
  s_waitcnt lgkmcnt(14)
  v_mfma_f32_16x16x32_bf16 v[204:207], v[144:147], v[24:27], v[204:207]
  ds_read_b128 v[124:127], v241 offset:49152
  s_waitcnt lgkmcnt(14)
  v_mfma_f32_16x16x32_bf16 v[208:211], v[148:151], v[24:27], v[208:211]
  ds_read_b128 v[128:131], v241 offset:50176
  s_waitcnt vmcnt(8) lgkmcnt(14)
  v_mfma_f32_16x16x32_bf16 v[192:195], v[152:155], v[28:31], v[192:195]
  ds_read_b128 v[132:135], v241 offset:51200
  s_waitcnt lgkmcnt(14)
  v_mfma_f32_16x16x32_bf16 v[196:199], v[156:159], v[28:31], v[196:199]
  ds_read_b128 v[136:139], v241 offset:52224
  buffer_load_dwordx4 v[64:67], v239, s[44:47], s65 offen offset:3072 sc1
  s_waitcnt lgkmcnt(14)
  v_mfma_f32_16x16x32_bf16 v[200:203], v[160:163], v[28:31], v[200:203]
  ds_read_b128 v[140:143], v241 offset:53248
  s_waitcnt lgkmcnt(14)
  v_mfma_f32_16x16x32_bf16 v[204:207], v[164:167], v[28:31], v[204:207]
  ds_read_b128 v[144:147], v241 offset:54272
  s_waitcnt lgkmcnt(14)
  v_mfma_f32_16x16x32_bf16 v[208:211], v[168:171], v[28:31], v[208:211]
  ds_read_b128 v[148:151], v241 offset:55296
  s_barrier
  s_waitcnt vmcnt(8) lgkmcnt(14)
  v_mfma_f32_16x16x32_bf16 v[192:195], v[172:175], v[32:35], v[192:195]
  ds_read_b128 v[152:155], v240 offset:0
  s_waitcnt lgkmcnt(14)
  v_mfma_f32_16x16x32_bf16 v[196:199], v[176:179], v[32:35], v[196:199]
  ds_read_b128 v[156:159], v240 offset:1024
  s_waitcnt lgkmcnt(14)
  v_mfma_f32_16x16x32_bf16 v[200:203], v[180:183], v[32:35], v[200:203]
  ds_read_b128 v[160:163], v240 offset:2048
  s_waitcnt lgkmcnt(14)
  v_mfma_f32_16x16x32_bf16 v[204:207], v[184:187], v[32:35], v[204:207]
  ds_read_b128 v[164:167], v240 offset:3072
  s_waitcnt lgkmcnt(14)
  v_mfma_f32_16x16x32_bf16 v[208:211], v[188:191], v[32:35], v[208:211]
  ds_read_b128 v[168:171], v240 offset:4096
  s_waitcnt vmcnt(7) lgkmcnt(14)
  v_mfma_f32_16x16x32_bf16 v[192:195], v[112:115], v[36:39], v[192:195]
  ds_read_b128 v[172:175], v240 offset:5120
  s_waitcnt lgkmcnt(14)
  v_mfma_f32_16x16x32_bf16 v[196:199], v[116:119], v[36:39], v[196:199]
  ds_read_b128 v[176:179], v240 offset:6144
  s_waitcnt lgkmcnt(14)
  v_mfma_f32_16x16x32_bf16 v[200:203], v[120:123], v[36:39], v[200:203]
  ds_read_b128 v[180:183], v240 offset:7168
  s_waitcnt lgkmcnt(14)
  v_mfma_f32_16x16x32_bf16 v[204:207], v[124:127], v[36:39], v[204:207]
  ds_read_b128 v[184:187], v240 offset:8192
  s_waitcnt lgkmcnt(14)
  v_mfma_f32_16x16x32_bf16 v[208:211], v[128:131], v[36:39], v[208:211]
  ds_read_b128 v[188:191], v240 offset:9216
  buffer_load_dword v244, v243, s[44:47], s75 offen offset:128 sc1
  s_waitcnt vmcnt(7) lgkmcnt(14)
  v_mfma_f32_16x16x32_bf16 v[192:195], v[132:135], v[40:43], v[192:195]
  ds_read_b128 v[112:115], v240 offset:15360
  s_waitcnt lgkmcnt(14)
  v_mfma_f32_16x16x32_bf16 v[196:199], v[136:139], v[40:43], v[196:199]
  ds_read_b128 v[116:119], v240 offset:16384
  s_waitcnt lgkmcnt(14)
  v_mfma_f32_16x16x32_bf16 v[200:203], v[140:143], v[40:43], v[200:203]
  ds_read_b128 v[120:123], v240 offset:17408
  s_waitcnt lgkmcnt(14)
  v_mfma_f32_16x16x32_bf16 v[204:207], v[144:147], v[40:43], v[204:207]
  ds_read_b128 v[124:127], v240 offset:18432
  s_waitcnt lgkmcnt(14)
  v_mfma_f32_16x16x32_bf16 v[208:211], v[148:151], v[40:43], v[208:211]
  ds_read_b128 v[128:131], v240 offset:19456
  s_waitcnt vmcnt(6) lgkmcnt(14)
  v_mfma_f32_16x16x32_bf16 v[192:195], v[152:155], v[44:47], v[192:195]
  ds_read_b128 v[132:135], v240 offset:20480
  s_waitcnt lgkmcnt(14)
  v_mfma_f32_16x16x32_bf16 v[196:199], v[156:159], v[44:47], v[196:199]
  ds_read_b128 v[136:139], v240 offset:21504
  s_waitcnt lgkmcnt(14)
  v_mfma_f32_16x16x32_bf16 v[200:203], v[160:163], v[44:47], v[200:203]
  ds_read_b128 v[140:143], v240 offset:22528
  s_waitcnt lgkmcnt(14)
  v_mfma_f32_16x16x32_bf16 v[204:207], v[164:167], v[44:47], v[204:207]
  ds_read_b128 v[144:147], v240 offset:23552
  s_waitcnt lgkmcnt(14)
  v_mfma_f32_16x16x32_bf16 v[208:211], v[168:171], v[44:47], v[208:211]
  ds_read_b128 v[148:151], v240 offset:24576
  s_waitcnt vmcnt(0)
  v_cmp_ne_u32 vcc, s54, v244
  s_cbranch_vccz IF_234_else
  s_mov_b32 s58, 1048576
LP_233:
  s_sleep 2
  buffer_load_dword v244, v243, s[44:47], s75 offen offset:128 sc1
  s_waitcnt vmcnt(0)
  v_cmp_ne_u32 vcc, s54, v244
  s_sub_u32 s58, s58, 1
  s_cselect_b64 vcc, 0, vcc
  s_cbranch_vccnz LP_233
IF_234_else:
  s_waitcnt lgkmcnt(14)
  v_mfma_f32_16x16x32_bf16 v[192:195], v[172:175], v[48:51], v[192:195]
  ds_read_b128 v[152:155], v240 offset:30720
  s_waitcnt lgkmcnt(14)
  v_mfma_f32_16x16x32_bf16 v[196:199], v[176:179], v[48:51], v[196:199]
  ds_read_b128 v[156:159], v240 offset:31744
  s_add_u32 s65, s69, 8192
  buffer_load_dwordx4 v[68:71], v239, s[44:47], s65 offen offset:3072 sc1
  s_waitcnt lgkmcnt(14)
  v_mfma_f32_16x16x32_bf16 v[200:203], v[180:183], v[48:51], v[200:203]
  ds_read_b128 v[160:163], v240 offset:32768
  s_waitcnt lgkmcnt(14)
  v_mfma_f32_16x16x32_bf16 v[204:207], v[184:187], v[48:51], v[204:207]
  ds_read_b128 v[164:167], v240 offset:33792
  s_add_u32 s65, s69, 12288
  buffer_load_dwordx4 v[72:75], v239, s[44:47], s65 offen offset:2048 sc1
  s_waitcnt lgkmcnt(14)
  v_mfma_f32_16x16x32_bf16 v[208:211], v[188:191], v[48:51], v[208:211]
  ds_read_b128 v[168:171], v240 offset:34816
  s_waitcnt lgkmcnt(14)
  v_mfma_f32_16x16x32_bf16 v[192:195], v[112:115], v[52:55], v[192:195]
  ds_read_b128 v[172:175], v240 offset:35840
  s_waitcnt lgkmcnt(14)
  v_mfma_f32_16x16x32_bf16 v[196:199], v[116:119], v[52:55], v[196:199]
  ds_read_b128 v[176:179], v240 offset:36864
  s_add_u32 s65, s69, 16384
  buffer_load_dwordx4 v[76:79], v239, s[44:47], s65 offen offset:1024 sc1
  s_waitcnt lgkmcnt(14)
  v_mfma_f32_16x16x32_bf16 v[200:203], v[120:123], v[52:55], v[200:203]
  ds_read_b128 v[180:183], v240 offset:37888
  s_waitcnt lgkmcnt(14)
  v_mfma_f32_16x16x32_bf16 v[204:207], v[124:127], v[52:55], v[204:207]
  ds_read_b128 v[184:187], v240 offset:38912
  s_add_u32 s65, s69, 20480
  buffer_load_dwordx4 v[80:83], v239, s[44:47], s65 offen offset:0 sc1
  s_waitcnt lgkmcnt(14)
  v_mfma_f32_16x16x32_bf16 v[208:211], v[128:131], v[52:55], v[208:211]
  ds_read_b128 v[188:191], v240 offset:39936
  s_waitcnt lgkmcnt(14)
  v_mfma_f32_16x16x32_bf16 v[192:195], v[132:135], v[56:59], v[192:195]
  ds_read_b128 v[112:115], v240 offset:56320
  s_waitcnt lgkmcnt(14)
  v_mfma_f32_16x16x32_bf16 v[196:199], v[136:139], v[56:59], v[196:199]
  ds_read_b128 v[116:119], v240 offset:57344
  s_add_u32 s65, s69, 20480
  buffer_load_dwordx4 v[84:87], v239, s[44:47], s65 offen offset:3072 sc1
  s_waitcnt lgkmcnt(14)
  v_mfma_f32_16x16x32_bf16 v[200:203], v[140:143], v[56:59], v[200:203]
  ds_read_b128 v[120:123], v240 offset:58368
  s_waitcnt lgkmcnt(14)
  v_mfma_f32_16x16x32_bf16 v[204:207], v[144:147], v[56:59], v[204:207]
  ds_read_b128 v[124:127], v240 offset:59392
  s_add_u32 s65, s69, 24576
  buffer_load_dwordx2 v[88:89], v238, s[44:47], s65 offen offset:0 sc1
  buffer_load_dwordx2 v[90:91], v238, s[44:47], s65 offen offset:512 sc1
  s_waitcnt lgkmcnt(14)
  v_mfma_f32_16x16x32_bf16 v[208:211], v[148:151], v[56:59], v[208:211]
  ds_read_b128 v[128:131], v240 offset:60416
  s_waitcnt lgkmcnt(14)
  v_mfma_f32_16x16x32_bf16 v[192:195], v[152:155], v[60:63], v[192:195]
  ds_read_b128 v[132:135], v241 offset:10240
  s_waitcnt lgkmcnt(14)
  v_mfma_f32_16x16x32_bf16 v[196:199], v[156:159], v[60:63], v[196:199]
  ds_read_b128 v[136:139], v241 offset:11264
  buffer_load_dwordx2 v[92:93], v238, s[44:47], s65 offen offset:1024 sc1
  buffer_load_dwordx2 v[94:95], v238, s[44:47], s65 offen offset:1536 sc1
  s_waitcnt lgkmcnt(14)
  v_mfma_f32_16x16x32_bf16 v[200:203], v[160:163], v[60:63], v[200:203]
  ds_read_b128 v[140:143], v241 offset:12288
  s_waitcnt lgkmcnt(14)
  v_mfma_f32_16x16x32_bf16 v[204:207], v[164:167], v[60:63], v[204:207]
  ds_read_b128 v[144:147], v241 offset:13312
  buffer_load_dwordx2 v[96:97], v238, s[44:47], s65 offen offset:2048 sc1
  buffer_load_dwordx2 v[98:99], v238, s[44:47], s65 offen offset:2560 sc1
  s_waitcnt lgkmcnt(14)
  v_mfma_f32_16x16x32_bf16 v[208:211], v[168:171], v[60:63], v[208:211]
  ds_read_b128 v[148:151], v241 offset:14336
  s_waitcnt lgkmcnt(14)
  v_mfma_f32_16x16x32_bf16 v[192:195], v[172:175], v[64:67], v[192:195]
  ds_read_b128 v[152:155], v241 offset:25600
  s_waitcnt lgkmcnt(14)
  v_mfma_f32_16x16x32_bf16 v[196:199], v[176:179], v[64:67], v[196:199]
  ds_read_b128 v[156:159], v241 offset:26624
  s_add_u32 s65, s69, 0
  buffer_load_dwordx4 v[100:103], v239, s[44:47], s65 offen offset:2048 sc1
  s_waitcnt lgkmcnt(14)
  v_mfma_f32_16x16x32_bf16 v[200:203], v[180:183], v[64:67], v[200:203]
  ds_read_b128 v[160:163], v241 offset:27648
  s_waitcnt lgkmcnt(14)
  v_mfma_f32_16x16x32_bf16 v[204:207], v[184:187], v[64:67], v[204:207]
  ds_read_b128 v[164:167], v241 offset:28672
  s_waitcnt lgkmcnt(14)
  v_mfma_f32_16x16x32_bf16 v[208:211], v[188:191], v[64:67], v[208:211]
  ds_read_b128 v[168:171], v241 offset:29696
  s_waitcnt vmcnt(11) lgkmcnt(14)
  v_mfma_f32_16x16x32_bf16 v[192:195], v[112:115], v[68:71], v[192:195]
  ds_read_b128 v[172:175], v241 offset:40960
  s_waitcnt lgkmcnt(14)
  v_mfma_f32_16x16x32_bf16 v[196:199], v[116:119], v[68:71], v[196:199]
  ds_read_b128 v[176:179], v241 offset:41984
  s_add_u32 s65, s69, 4096
  buffer_load_dwordx4 v[104:107], v239, s[44:47], s65 offen offset:1024 sc1
  s_waitcnt lgkmcnt(14)
  v_mfma_f32_16x16x32_bf16 v[200:203], v[120:123], v[68:71], v[200:203]
  ds_read_b128 v[180:183], v241 offset:43008
  s_waitcnt lgkmcnt(14)
  v_mfma_f32_16x16x32_bf16 v[204:207], v[124:127], v[68:71], v[204:207]
  ds_read_b128 v[184:187], v241 offset:44032
  s_waitcnt lgkmcnt(14)
  v_mfma_f32_16x16x32_bf16 v[208:211], v[128:131], v[68:71], v[208:211]
  ds_read_b128 v[188:191], v241 offset:45056
  s_waitcnt vmcnt(11) lgkmcnt(14)
  v_mfma_f32_16x16x32_bf16 v[192:195], v[132:135], v[72:75], v[192:195]
  ds_read_b128 v[112:115], v241 offset:56320
  s_waitcnt lgkmcnt(14)
  v_mfma_f32_16x16x32_bf16 v[196:199], v[136:139], v[72:75], v[196:199]
  ds_read_b128 v[116:119], v241 offset:57344
  s_add_u32 s65, s69, 8192
  buffer_load_dwordx4 v[108:111], v239, s[44:47], s65 offen offset:0 sc1
  s_waitcnt lgkmcnt(14)
  v_mfma_f32_16x16x32_bf16 v[200:203], v[140:143], v[72:75], v[200:203]
  ds_read_b128 v[120:123], v241 offset:58368
  s_waitcnt lgkmcnt(14)
  v_mfma_f32_16x16x32_bf16 v[204:207], v[144:147], v[72:75], v[204:207]
  ds_read_b128 v[124:127], v241 offset:59392
  s_waitcnt lgkmcnt(14)
  v_mfma_f32_16x16x32_bf16 v[208:211], v[148:151], v[72:75], v[208:211]
  ds_read_b128 v[128:131], v241 offset:60416
  s_waitcnt vmcnt(11) lgkmcnt(14)
  v_mfma_f32_16x16x32_bf16 v[192:195], v[152:155], v[76:79], v[192:195]
  ds_read_b128 v[132:135], v242 offset:0
  s_waitcnt lgkmcnt(14)
  v_mfma_f32_16x16x32_bf16 v[196:199], v[156:159], v[76:79], v[196:199]
  ds_read_b128 v[136:139], v242 offset:1024
  s_waitcnt lgkmcnt(14)
  v_mfma_f32_16x16x32_bf16 v[200:203], v[160:163], v[76:79], v[200:203]
  ds_read_b128 v[140:143], v242 offset:2048
  s_waitcnt lgkmcnt(14)
  v_mfma_f32_16x16x32_bf16 v[204:207], v[164:167], v[76:79], v[204:207]
  ds_read_b128 v[144:147], v242 offset:3072
  s_waitcnt lgkmcnt(14)
  v_mfma_f32_16x16x32_bf16 v[208:211], v[168:171], v[76:79], v[208:211]
  ds_read_b128 v[148:151], v242 offset:4096
  s_barrier
  s_waitcnt vmcnt(10) lgkmcnt(14)
  v_mfma_f32_16x16x32_bf16 v[192:195], v[172:175], v[80:83], v[192:195]
  ds_read_b128 v[152:155], v242 offset:5120
  s_waitcnt lgkmcnt(14)
  v_mfma_f32_16x16x32_bf16 v[196:199], v[176:179], v[80:83], v[196:199]
  ds_read_b128 v[156:159], v242 offset:6144
  s_waitcnt lgkmcnt(14)
  v_mfma_f32_16x16x32_bf16 v[200:203], v[180:183], v[80:83], v[200:203]
  ds_read_b128 v[160:163], v242 offset:7168
  s_waitcnt lgkmcnt(14)
  v_mfma_f32_16x16x32_bf16 v[204:207], v[184:187], v[80:83], v[204:207]
  ds_read_b128 v[164:167], v242 offset:8192
  s_waitcnt lgkmcnt(14)
  v_mfma_f32_16x16x32_bf16 v[208:211], v[188:191], v[80:83], v[208:211]
  ds_read_b128 v[168:171], v242 offset:9216
  s_waitcnt vmcnt(9) lgkmcnt(14)
  v_mfma_f32_16x16x32_bf16 v[192:195], v[112:115], v[84:87], v[192:195]
  ds_read_b128 v[172:175], v242 offset:10240
  s_waitcnt lgkmcnt(14)
  v_mfma_f32_16x16x32_bf16 v[196:199], v[116:119], v[84:87], v[196:199]
  ds_read_b128 v[176:179], v242 offset:11264
  s_waitcnt lgkmcnt(14)
  v_mfma_f32_16x16x32_bf16 v[200:203], v[120:123], v[84:87], v[200:203]
  ds_read_b128 v[180:183], v242 offset:12288
  s_waitcnt lgkmcnt(14)
  v_mfma_f32_16x16x32_bf16 v[204:207], v[124:127], v[84:87], v[204:207]
  ds_read_b128 v[184:187], v242 offset:13312
  s_waitcnt lgkmcnt(14)
  v_mfma_f32_16x16x32_bf16 v[208:211], v[128:131], v[84:87], v[208:211]
  ds_read_b128 v[188:191], v242 offset:14336
  s_waitcnt vmcnt(7) lgkmcnt(14)
  v_mfma_f32_16x16x32_bf16 v[192:195], v[132:135], v[88:91], v[192:195]
  ds_read_b128 v[112:115], v240 offset:10240
  s_waitcnt lgkmcnt(14)
  v_mfma_f32_16x16x32_bf16 v[196:199], v[136:139], v[88:91], v[196:199]
  ds_read_b128 v[116:119], v240 offset:11264
  s_waitcnt lgkmcnt(14)
  v_mfma_f32_16x16x32_bf16 v[200:203], v[140:143], v[88:91], v[200:203]
  ds_read_b128 v[120:123], v240 offset:12288
  s_waitcnt lgkmcnt(14)
  v_mfma_f32_16x16x32_bf16 v[204:207], v[144:147], v[88:91], v[204:207]
  ds_read_b128 v[124:127], v240 offset:13312
  s_waitcnt lgkmcnt(14)
  v_mfma_f32_16x16x32_bf16 v[208:211], v[148:151], v[88:91], v[208:211]
  ds_read_b128 v[128:131], v240 offset:14336
  s_waitcnt vmcnt(5) lgkmcnt(14)
  v_mfma_f32_16x16x32_bf16 v[192:195], v[152:155], v[92:95], v[192:195]
  ds_read_b128 v[132:135], v240 offset:25600
  s_waitcnt lgkmcnt(14)
  v_mfma_f32_16x16x32_bf16 v[196:199], v[156:159], v[92:95], v[196:199]
  ds_read_b128 v[136:139], v240 offset:26624
  s_waitcnt lgkmcnt(14)
  v_mfma_f32_16x16x32_bf16 v[200:203], v[160:163], v[92:95], v[200:203]
  ds_read_b128 v[140:143], v240 offset:27648
  s_waitcnt lgkmcnt(14)
  v_mfma_f32_16x16x32_bf16 v[204:207], v[164:167], v[92:95], v[204:207]
  ds_read_b128 v[144:147], v240 offset:28672
  s_waitcnt lgkmcnt(14)
  v_mfma_f32_16x16x32_bf16 v[208:211], v[168:171], v[92:95], v[208:211]
  ds_read_b128 v[148:151], v240 offset:29696
  s_waitcnt vmcnt(3) lgkmcnt(14)
  v_mfma_f32_16x16x32_bf16 v[192:195], v[172:175], v[96:99], v[192:195]
  ds_read_b128 v[152:155], v240 offset:40960
  s_waitcnt lgkmcnt(14)
  v_mfma_f32_16x16x32_bf16 v[196:199], v[176:179], v[96:99], v[196:199]
  ds_read_b128 v[156:159], v240 offset:41984
  s_waitcnt lgkmcnt(14)
  v_mfma_f32_16x16x32_bf16 v[200:203], v[180:183], v[96:99], v[200:203]
  ds_read_b128 v[160:163], v240 offset:43008
  s_waitcnt lgkmcnt(14)
  v_mfma_f32_16x16x32_bf16 v[204:207], v[184:187], v[96:99], v[204:207]
  ds_read_b128 v[164:167], v240 offset:44032
  s_waitcnt lgkmcnt(14)
  v_mfma_f32_16x16x32_bf16 v[208:211], v[188:191], v[96:99], v[208:211]
  ds_read_b128 v[168:171], v240 offset:45056
  s_waitcnt vmcnt(2) lgkmcnt(14)
  v_mfma_f32_16x16x32_bf16 v[192:195], v[112:115], v[100:103], v[192:195]
  s_waitcnt lgkmcnt(13)
  v_mfma_f32_16x16x32_bf16 v[196:199], v[116:119], v[100:103], v[196:199]
  s_waitcnt lgkmcnt(12)
  v_mfma_f32_16x16x32_bf16 v[200:203], v[120:123], v[100:103], v[200:203]
  s_waitcnt lgkmcnt(11)
  v_mfma_f32_16x16x32_bf16 v[204:207], v[124:127], v[100:103], v[204:207]
  s_waitcnt lgkmcnt(10)
  v_mfma_f32_16x16x32_bf16 v[208:211], v[128:131], v[100:103], v[208:211]
  s_waitcnt vmcnt(1) lgkmcnt(9)
  v_mfma_f32_16x16x32_bf16 v[192:195], v[132:135], v[104:107], v[192:195]
  s_waitcnt lgkmcnt(8)
  v_mfma_f32_16x16x32_bf16 v[196:199], v[136:139], v[104:107], v[196:199]
  s_waitcnt lgkmcnt(7)
  v_mfma_f32_16x16x32_bf16 v[200:203], v[140:143], v[104:107], v[200:203]
  s_waitcnt lgkmcnt(6)
  v_mfma_f32_16x16x32_bf16 v[204:207], v[144:147], v[104:107], v[204:207]
  s_waitcnt lgkmcnt(5)
  v_mfma_f32_16x16x32_bf16 v[208:211], v[148:151], v[104:107], v[208:211]
  s_waitcnt vmcnt(0) lgkmcnt(4)
  v_mfma_f32_16x16x32_bf16 v[192:195], v[152:155], v[108:111], v[192:195]
  s_waitcnt lgkmcnt(3)
  v_mfma_f32_16x16x32_bf16 v[196:199], v[156:159], v[108:111], v[196:199]
  s_waitcnt lgkmcnt(2)
  v_mfma_f32_16x16x32_bf16 v[200:203], v[160:163], v[108:111], v[200:203]
  s_waitcnt lgkmcnt(1)
  v_mfma_f32_16x16x32_bf16 v[204:207], v[164:167], v[108:111], v[204:207]
  s_waitcnt lgkmcnt(0)
  v_mfma_f32_16x16x32_bf16 v[208:211], v[168:171], v[108:111], v[208:211]
  s_mul_i32 s65, s53, 160
  v_lshlrev_b32 v4, 16, v246
  v_and_b32 v5, s57, v246
  v_fmac_f32 v4, v212, v192
  v_fmac_f32 v5, v213, v193
  v_cvt_pk_bf16_f32 v30, v4, v5
  v_lshlrev_b32 v6, 16, v247
  v_and_b32 v7, s57, v247
  v_fmac_f32 v6, v214, v194
  v_fmac_f32 v7, v215, v195
  v_cvt_pk_bf16_f32 v31, v6, v7
  buffer_store_dwordx2 v[30:31], v235, s[40:43], s65 offen offset:0
  v_lshlrev_b32 v8, 16, v248
  v_and_b32 v9, s57, v248
  v_fmac_f32 v8, v216, v196
  v_fmac_f32 v9, v217, v197
  v_cvt_pk_bf16_f32 v32, v8, v9
  v_lshlrev_b32 v10, 16, v249
  v_and_b32 v11, s57, v249
  v_fmac_f32 v10, v218, v198
  v_fmac_f32 v11, v219, v199
  v_cvt_pk_bf16_f32 v33, v10, v11
  buffer_store_dwordx2 v[32:33], v235, s[40:43], s65 offen offset:32
  v_lshlrev_b32 v12, 16, v250
  v_and_b32 v13, s57, v250
  v_fmac_f32 v12, v220, v200
  v_fmac_f32 v13, v221, v201
  v_cvt_pk_bf16_f32 v34, v12, v13
  v_lshlrev_b32 v14, 16, v251
  v_and_b32 v15, s57, v251
  v_fmac_f32 v14, v222, v202
  v_fmac_f32 v15, v223, v203
  v_cvt_pk_bf16_f32 v35, v14, v15
  buffer_store_dwordx2 v[34:35], v235, s[40:43], s65 offen offset:64
  v_lshlrev_b32 v16, 16, v252
  v_and_b32 v17, s57, v252
  v_fmac_f32 v16, v224, v204
  v_fmac_f32 v17, v225, v205
  v_cvt_pk_bf16_f32 v36, v16, v17
  v_lshlrev_b32 v18, 16, v253
  v_and_b32 v19, s57, v253
  v_fmac_f32 v18, v226, v206
  v_fmac_f32 v19, v227, v207
  v_cvt_pk_bf16_f32 v37, v18, v19
  buffer_store_dwordx2 v[36:37], v235, s[40:43], s65 offen offset:96
  v_lshlrev_b32 v20, 16, v254
  v_and_b32 v21, s57, v254
  v_fmac_f32 v20, v228, v208
  v_fmac_f32 v21, v229, v209
  v_cvt_pk_bf16_f32 v38, v20, v21
  v_lshlrev_b32 v22, 16, v255
  v_and_b32 v23, s57, v255
  v_fmac_f32 v22, v230, v210
  v_fmac_f32 v23, v231, v211
  v_cvt_pk_bf16_f32 v39, v22, v23
  buffer_store_dwordx2 v[38:39], v235, s[40:43], s65 offen offset:128
  s_branch IF_236_end
IF_236_else:
  s_mov_b32 s74, 87040
  s_cmp_eq_u32 s59, 1
  s_cselect_b32 s74, 102400, s74
  s_cmp_eq_u32 s59, 2
  s_cselect_b32 s74, 117760, s74
  s_cmp_eq_u32 s59, 3
  s_cselect_b32 s74, 122880, s74
  s_mul_i32 s73, s53, 138240
  s_add_u32 s73, s74, s73
  s_add_u32 s63, s73, 24559616
  s_add_u32 m0, s74, 23552
  s_nop 0
  buffer_load_dwordx4 v114, s[44:47], s63 offen offset:0 sc1 lds
  s_add_u32 m0, s74, 23552
  s_nop 0
  buffer_load_dwordx4 v114, s[44:47], s63 offen offset:1024 sc1 lds
  s_add_u32 m0, s74, 23552
  s_nop 0
  buffer_load_dwordx4 v114, s[44:47], s63 offen offset:2048 sc1 lds
  s_add_u32 m0, s74, 23552
  s_nop 0
  buffer_load_dwordx4 v114, s[44:47], s63 offen offset:3072 sc1 lds
  s_add_u32 s63, s73, 24563712
  s_add_u32 m0, s74, 27648
  s_nop 0
  buffer_load_dwordx4 v114, s[44:47], s63 offen offset:0 sc1 lds
  s_barrier
  s_mov_b32 s74, 0
  s_cmp_eq_u32 s59, 1
  s_cselect_b32 s74, 5120, s74
  s_cmp_eq_u32 s59, 2
  s_cselect_b32 s74, 15360, s74
  s_cmp_eq_u32 s59, 3
  s_cselect_b32 s74, 20480, s74
  s_mul_i32 s73, s53, 138240
  s_add_u32 s73, s74, s73
  s_add_u32 s63, s73, 24559616
  s_add_u32 m0, s74, 23552
  s_nop 0
  buffer_load_dwordx4 v114, s[44:47], s63 offen offset:0 sc1 lds
  s_add_u32 m0, s74, 23552
  s_nop 0
  buffer_load_dwordx4 v114, s[44:47], s63 offen offset:1024 sc1 lds
  s_add_u32 m0, s74, 23552
  s_nop 0
  buffer_load_dwordx4 v114, s[44:47], s63 offen offset:2048 sc1 lds
  s_add_u32 m0, s74, 23552
  s_nop 0
  buffer_load_dwordx4 v114, s[44:47], s63 offen offset:3072 sc1 lds
  s_add_u32 s63, s73, 24563712
  s_add_u32 m0, s74, 27648
  s_nop 0
  buffer_load_dwordx4 v114, s[44:47], s63 offen offset:0 sc1 lds
  s_mov_b32 s74, 30720
  s_cmp_eq_u32 s59, 1
  s_cselect_b32 s74, 35840, s74
  s_cmp_eq_u32 s59, 2
  s_cselect_b32 s74, 10240, s74
  s_cmp_eq_u32 s59, 3
  s_cselect_b32 s74, 25600, s74
  s_mul_i32 s73, s53, 138240
  s_add_u32 s73, s74, s73
  s_add_u32 s63, s73, 24559616
  s_add_u32 m0, s74, 23552
  s_nop 0
  buffer_load_dwordx4 v114, s[44:47], s63 offen offset:0 sc1 lds
  s_add_u32 m0, s74, 23552
  s_nop 0
  buffer_load_dwordx4 v114, s[44:47], s63 offen offset:1024 sc1 lds
  s_add_u32 m0, s74, 23552
  s_nop 0
  buffer_load_dwordx4 v114, s[44:47], s63 offen offset:2048 sc1 lds
  s_add_u32 m0, s74, 23552
  s_nop 0
  buffer_load_dwordx4 v114, s[44:47], s63 offen offset:3072 sc1 lds
  s_add_u32 s63, s73, 24563712
  s_add_u32 m0, s74, 27648
  s_nop 0
  buffer_load_dwordx4 v114, s[44:47], s63 offen offset:0 sc1 lds
  s_waitcnt vmcnt(0)
  s_barrier
  s_mov_b32 s74, 40960
  s_cmp_eq_u32 s59, 1
  s_cselect_b32 s74, 128000, s74
  s_cmp_eq_u32 s59, 2
  s_cselect_b32 s74, 133120, s74
  s_mul_i32 s73, s53, 138240
  s_add_u32 s73, s74, s73
  s_cmp_lt_u32 s59, 3
  s_cbranch_scc0 IF_235_else
  s_add_u32 s63, s73, 24559616
  s_add_u32 m0, s74, 23552
  s_nop 0
  buffer_load_dwordx4 v114, s[44:47], s63 offen offset:0 sc1 lds
  s_add_u32 m0, s74, 23552
  s_nop 0
  buffer_load_dwordx4 v114, s[44:47], s63 offen offset:1024 sc1 lds
  s_add_u32 m0, s74, 23552
  s_nop 0
  buffer_load_dwordx4 v114, s[44:47], s63 offen offset:2048 sc1 lds
  s_add_u32 m0, s74, 23552
  s_nop 0
  buffer_load_dwordx4 v114, s[44:47], s63 offen offset:3072 sc1 lds
  s_add_u32 s63, s73, 24563712
  s_add_u32 m0, s74, 27648
  s_nop 0
  buffer_load_dwordx4 v114, s[44:47], s63 offen offset:0 sc1 lds
IF_235_else:
  s_waitcnt vmcnt(0)
  s_barrier
IF_236_end:
  s_cmp_eq_u32 s2, 0
  s_cbranch_scc0 IF_237_else
  v_mov_b32 v2, s54
  v_cmp_eq_u32 vcc, 0, v0
  v_mov_b32 v3, 2147483648
  s_nop 0
  v_cndmask_b32 v3, v3, 0, vcc
  buffer_store_dword v2, v3, s[44:47], 0 offen sc1
IF_237_else:
  s_endpgm
IF_238_end:
L_exit:
  s_endpgm
.section .rodata,"a"
.p2align 6
.amdhsa_kernel adaLN_cond__sliding_block__mixer_gmlp__prompt_kernel
  .amdhsa_next_free_vgpr 256
  .amdhsa_next_free_sgpr 102
  .amdhsa_accum_offset 256
  .amdhsa_group_segment_fixed_size 0
  .amdhsa_kernarg_size 104
  .amdhsa_user_sgpr_count 2
  .amdhsa_user_sgpr_kernarg_segment_ptr 1
  .amdhsa_system_sgpr_workgroup_id_x 1
  .amdhsa_float_denorm_mode_32 3
.end_amdhsa_kernel
```
